```python
import torch

def _softmax(x, axis=-1):
    return torch.softmax(x, dim=axis)
def _gelu(x):
    return torch.nn.functional.gelu(x, approximate="tanh")
def _silu(x):
    return torch.nn.functional.silu(x)
def _sigmoid(x):
    return torch.sigmoid(x)
def _layernorm(x, axis=-1, eps=1e-5):
    m = x.mean(dim=axis, keepdim=True)
    v = x.var(dim=axis, keepdim=True, unbiased=False)
    return (x - m) / torch.sqrt(v + eps)
def _scatter_add(tgt, idx, src, axis=0):
    return tgt.clone().index_add_(axis, idx, src)
def _segment_sum(src, seg, n):
    out = torch.zeros((n,) + src.shape[1:], dtype=src.dtype)
    return out.index_add_(0, seg, src)
def _pad(x, pw):
    flat = tuple(v for pair in reversed(pw) for v in pair)
    return torch.nn.functional.pad(x, flat)

kernel_name = 'gated_mix__sliding_block__geglu_ffn__prompt'

def setup_inputs():

    _w = (lambda a: (lambda t: t.to(torch.bfloat16) if t.is_floating_point() else t)(torch.as_tensor(a)))
    def _A_setup():
        B, S, D = 1, 2048, 1024
        return {
            "x": _w((lambda *s: torch.randn(*s, dtype=torch.bfloat16) * 0.05)(B, S, D)),
            "wqkv": _w((lambda *s: torch.randn(*s, dtype=torch.bfloat16) * 1.6)(D, 3 * D)),
            "wo": _w((lambda *s: torch.randn(*s, dtype=torch.bfloat16) * 0.1)(D, D)),
        }
    _A_in = _A_setup()

    def _B_setup():
        B, S, D, F = 1, 2048, 1024, 3584
        return {
            "x": _w((lambda *s: torch.randn(*s, dtype=torch.bfloat16) * 0.05)(B, S, D)),
            "w_gate": _w((lambda *s: torch.randn(*s, dtype=torch.bfloat16) * 0.4)(D, F)),
            "w_up": _w((lambda *s: torch.randn(*s, dtype=torch.bfloat16) * 0.4)(D, F)),
            "w_down": _w((lambda *s: torch.randn(*s, dtype=torch.bfloat16) * 0.4)(F, D)),
        }
    _B_in = _B_setup()

    return {
        "A_x": _A_in["x"],
        "A_wqkv": _A_in["wqkv"],
        "A_wo": _A_in["wo"],
        "B_x": _B_in["x"],
        "B_w_gate": _B_in["w_gate"],
        "B_w_up": _B_in["w_up"],
        "B_w_down": _B_in["w_down"],
        "gate_w": _w((lambda *s: torch.randn(*s, dtype=torch.bfloat16) * 0.05)(1024) * 16.0),
    }

def reference(A_x, A_wqkv, A_wo, B_x, B_w_gate, B_w_up, B_w_down, gate_w):
    def _A_ref(x, wqkv, wo):
        B, S, D = x.shape
        H = 32; Dh = D // H; W = 256
        qkv = (lambda x, *d: x.permute(*d))((x @ wqkv).reshape(B, S, 3, H, Dh), 2, 0, 3, 1, 4)
        q, k, v = qkv[0], qkv[1], qkv[2]
        scores = torch.einsum("bhqd,bhkd->bhqk", q, k) * (Dh ** -0.5)
        idx = torch.arange(S)
        mask = (idx[:, None] - idx[None, :] >= 0) & (idx[:, None] - idx[None, :] < W)
        scores = torch.where(mask[None, None], scores, -1e9)
        p = _softmax(scores, axis=-1)
        o = torch.einsum("bhqk,bhkd->bhqd", p, v)
        return (lambda x, *d: x.permute(*d))(o, 0, 2, 1, 3).reshape(B, S, D) @ wo

    def _B_ref(x, w_gate, w_up, w_down):
        return (_gelu(x @ w_gate) * (x @ w_up)) @ w_down

    x = A_x
    g = _sigmoid((x * gate_w).sum(-1, keepdims=True))
    a = _A_ref(x, A_wqkv, A_wo)
    b = _B_ref(x, B_w_gate, B_w_up, B_w_down)
    return g * a + (1 - g) * b
```

```asm
; @launch kernel=k1_gemm1_kernel grid=(256,1,1) block=(512,1,1) lds=147456
; @launch kernel=k23_kernel grid=(256,1,1) block=(512,1,1) lds=163840
.amdgcn_target "amdgcn-amd-amdhsa--gfx950"
.text
.globl k1_gemm1_kernel
.p2align 8
.type k1_gemm1_kernel,@function
k1_gemm1_kernel:
    s_cmp_ge_u32 s2, 256
    s_cbranch_scc1 K1_END
    s_load_dwordx2 s[4:5], s[0:1], 0
    s_load_dwordx2 s[6:7], s[0:1], 8
    s_load_dwordx4 s[8:11], s[0:1], 32
    s_load_dwordx2 s[12:13], s[0:1], 80
    s_load_dwordx2 s[56:57], s[0:1], 16
    s_load_dwordx2 s[58:59], s[0:1], 48
    s_load_dwordx2 s[54:55], s[0:1], 56
    s_and_b32 s26, s2, 7
    s_lshr_b32 s27, s2, 3
    s_and_b32 s15, s2, 31
    s_lshr_b32 s14, s27, 2
    v_lshrrev_b32 v1, 6, v0
    v_and_b32 v0, 63, v0
    v_readfirstlane_b32 s16, v1
    s_and_b32 s17, s16, 3
    s_lshr_b32 s18, s16, 2
    v_lshlrev_b32 v24, 4, v0
    s_lshl_b32 s19, s16, 11
    s_add_u32 s19, s19, 81920
    s_lshl_b32 s20, s16, 10
    s_lshl_b32 s21, s16, 9
    s_mul_i32 s23, s15, 160
    s_mul_i32 s24, s15, 320
    s_sub_u32 s24, s24, 7168
    s_add_u32 s25, s24, 160
    s_mov_b32 s22, 0
    s_cmp_eq_u32 s15, 22
    s_cselect_b32 s24, -64, s24
    s_cselect_b32 s25, 32, s25
    s_cselect_b32 s22, 8, s22
    s_cmp_lt_u32 s15, 22
    s_cselect_b32 s22, 20, s22
    v_lshrrev_b32 v32, 2, v0
    v_lshrrev_b32 v33, 4, v0
    v_and_b32 v33, 2, v33
    v_and_b32 v34, 3, v0
    v_xor_b32 v34, v34, v33
    s_lshl_b32 s26, s14, 8
    s_lshl_b32 s27, s16, 5
    s_add_u32 s26, s26, s27
    v_add_u32 v32, s26, v32
    v_lshlrev_b32 v32, 11, v32
    v_lshl_add_u32 v2, v34, 4, v32
    v_add_u32 v3, 0x8000, v2
    s_lshl_b32 s53, s2, 3
    s_add_u32 s53, s53, s16
    s_lshl_b32 s26, s53, 11
    v_lshlrev_b32 v96, 5, v0
    v_add_u32 v97, s26, v96
    s_waitcnt lgkmcnt(0)
    s_add_u32 m0, s19, 0
    s_nop 0
    global_load_lds_dwordx4 v2, s[4:5] offset:0
    s_add_u32 m0, s19, 1024
    s_nop 0
    global_load_lds_dwordx4 v3, s[4:5] offset:0
    s_waitcnt lgkmcnt(0)
    s_lshl_b32 s26, s16, 6
    s_add_u32 s26, s26, 0
    v_add_u32 v32, s26, v0
    v_mul_u32_u24 v33, 52429, v32
    v_lshrrev_b32 v33, 21, v33
    v_mul_u32_u24 v34, 40, v33
    v_sub_u32 v34, v32, v34
    v_bfe_u32 v35, v33, 1, 1
    v_lshrrev_b32 v36, 2, v33
    v_and_b32 v36, 2, v36
    v_or_b32 v35, v35, v36
    v_lshlrev_b32 v35, 1, v35
    v_xor_b32 v34, v34, v35
    v_cmp_le_u32 vcc, 20, v34
    v_subrev_u32 v35, 20, v34
    s_nop 1
    v_cndmask_b32 v34, v34, v35, vcc
    v_mov_b32 v35, s8
    v_mov_b32 v36, s10
    v_cndmask_b32 v35, v35, v36, vcc
    v_mov_b32 v36, s9
    v_mov_b32 v37, s11
    v_cndmask_b32 v36, v36, v37, vcc
    v_mov_b32 v37, s24
    v_mov_b32 v38, s25
    v_cndmask_b32 v37, v37, v38, vcc
    v_cmp_gt_u32 vcc, s22, v34
    v_mov_b32 v38, s6
    v_mov_b32 v39, s7
    v_cndmask_b32 v35, v38, v35, vcc
    v_cndmask_b32 v36, v39, v36, vcc
    v_mov_b32 v38, s23
    v_cndmask_b32 v37, v37, v38, vcc
    v_mov_b32 v38, 6144
    v_mov_b32 v39, 7168
    v_cndmask_b32 v38, v38, v39, vcc
    v_lshl_add_u32 v37, v34, 3, v37
    v_mul_u32_u24 v39, v33, v38
    v_lshl_add_u32 v39, v37, 1, v39
    v_add_co_u32 v4, vcc, v35, v39
    v_addc_co_u32 v5, vcc, 0, v36, vcc
    v_lshlrev_b32 v10, 5, v38
    s_add_u32 m0, s20, 0
    s_nop 0
    global_load_lds_dwordx4 v[4:5], off
    v_add_co_u32 v4, vcc, v4, v10
    v_addc_co_u32 v5, vcc, 0, v5, vcc
    s_lshl_b32 s26, s16, 6
    s_add_u32 s26, s26, 512
    v_add_u32 v32, s26, v0
    v_mul_u32_u24 v33, 52429, v32
    v_lshrrev_b32 v33, 21, v33
    v_mul_u32_u24 v34, 40, v33
    v_sub_u32 v34, v32, v34
    v_bfe_u32 v35, v33, 1, 1
    v_lshrrev_b32 v36, 2, v33
    v_and_b32 v36, 2, v36
    v_or_b32 v35, v35, v36
    v_lshlrev_b32 v35, 1, v35
    v_xor_b32 v34, v34, v35
    v_cmp_le_u32 vcc, 20, v34
    v_subrev_u32 v35, 20, v34
    s_nop 1
    v_cndmask_b32 v34, v34, v35, vcc
    v_mov_b32 v35, s8
    v_mov_b32 v36, s10
    v_cndmask_b32 v35, v35, v36, vcc
    v_mov_b32 v36, s9
    v_mov_b32 v37, s11
    v_cndmask_b32 v36, v36, v37, vcc
    v_mov_b32 v37, s24
    v_mov_b32 v38, s25
    v_cndmask_b32 v37, v37, v38, vcc
    v_cmp_gt_u32 vcc, s22, v34
    v_mov_b32 v38, s6
    v_mov_b32 v39, s7
    v_cndmask_b32 v35, v38, v35, vcc
    v_cndmask_b32 v36, v39, v36, vcc
    v_mov_b32 v38, s23
    v_cndmask_b32 v37, v37, v38, vcc
    v_mov_b32 v38, 6144
    v_mov_b32 v39, 7168
    v_cndmask_b32 v38, v38, v39, vcc
    v_lshl_add_u32 v37, v34, 3, v37
    v_mul_u32_u24 v39, v33, v38
    v_lshl_add_u32 v39, v37, 1, v39
    v_add_co_u32 v6, vcc, v35, v39
    v_addc_co_u32 v7, vcc, 0, v36, vcc
    v_lshlrev_b32 v11, 5, v38
    s_add_u32 m0, s20, 8192
    s_nop 0
    global_load_lds_dwordx4 v[6:7], off
    v_add_co_u32 v6, vcc, v6, v11
    v_addc_co_u32 v7, vcc, 0, v7, vcc
    s_lshl_b32 s26, s16, 5
    s_add_u32 s26, s26, 1024
    v_and_b32 v32, 31, v0
    v_add_u32 v32, s26, v32
    v_mul_u32_u24 v33, 52429, v32
    v_lshrrev_b32 v33, 21, v33
    v_mul_u32_u24 v34, 40, v33
    v_sub_u32 v34, v32, v34
    v_bfe_u32 v35, v33, 1, 1
    v_lshrrev_b32 v36, 2, v33
    v_and_b32 v36, 2, v36
    v_or_b32 v35, v35, v36
    v_lshlrev_b32 v35, 1, v35
    v_xor_b32 v34, v34, v35
    v_cmp_le_u32 vcc, 20, v34
    v_subrev_u32 v35, 20, v34
    s_nop 1
    v_cndmask_b32 v34, v34, v35, vcc
    v_mov_b32 v35, s8
    v_mov_b32 v36, s10
    v_cndmask_b32 v35, v35, v36, vcc
    v_mov_b32 v36, s9
    v_mov_b32 v37, s11
    v_cndmask_b32 v36, v36, v37, vcc
    v_mov_b32 v37, s24
    v_mov_b32 v38, s25
    v_cndmask_b32 v37, v37, v38, vcc
    v_cmp_gt_u32 vcc, s22, v34
    v_mov_b32 v38, s6
    v_mov_b32 v39, s7
    v_cndmask_b32 v35, v38, v35, vcc
    v_cndmask_b32 v36, v39, v36, vcc
    v_mov_b32 v38, s23
    v_cndmask_b32 v37, v37, v38, vcc
    v_mov_b32 v38, 6144
    v_mov_b32 v39, 7168
    v_cndmask_b32 v38, v38, v39, vcc
    v_lshl_add_u32 v37, v34, 3, v37
    v_mul_u32_u24 v39, v33, v38
    v_lshl_add_u32 v39, v37, 1, v39
    v_add_co_u32 v8, vcc, v35, v39
    v_addc_co_u32 v9, vcc, 0, v36, vcc
    v_lshlrev_b32 v12, 5, v38
    s_add_u32 m0, s21, 16384
    s_mov_b32 exec_hi, 0
    global_load_lds_dwordx4 v[8:9], off
    s_mov_b32 exec_hi, -1
    v_add_co_u32 v8, vcc, v8, v12
    v_addc_co_u32 v9, vcc, 0, v9, vcc
    v_and_b32 v32, 15, v0
    v_lshrrev_b32 v33, 4, v0
    v_lshrrev_b32 v34, 2, v32
    v_and_b32 v34, 2, v34
    v_xor_b32 v34, v34, v33
    v_lshlrev_b32 v35, 6, v32
    v_lshl_add_u32 v35, v34, 4, v35
    s_lshl_b32 s26, s17, 12
    s_add_u32 s26, s26, 81920
    v_add_u32 v13, s26, v35
    v_lshrrev_b32 v34, 2, v32
    v_lshl_add_u32 v34, v33, 3, v34
    v_mul_u32_u24 v34, 640, v34
    v_and_b32 v35, 3, v32
    v_lshl_add_u32 v34, v35, 3, v34
    v_bfe_u32 v35, v32, 3, 1
    v_and_b32 v36, 1, v33
    v_lshl_or_b32 v35, v36, 1, v35
    s_mul_i32 s26, s18, 6
    s_add_u32 s27, s18, 4
    s_add_u32 s28, s26, 0
    v_xor_b32 v36, s28, v35
    v_lshl_add_u32 v14, v36, 5, v34
    s_add_u32 s28, s26, 10
    v_xor_b32 v36, s28, v35
    v_lshl_add_u32 v19, v36, 5, v34
    s_add_u32 s28, s26, 1
    v_xor_b32 v36, s28, v35
    v_lshl_add_u32 v15, v36, 5, v34
    s_add_u32 s28, s26, 11
    v_xor_b32 v36, s28, v35
    v_lshl_add_u32 v20, v36, 5, v34
    s_add_u32 s28, s26, 2
    v_xor_b32 v36, s28, v35
    v_lshl_add_u32 v16, v36, 5, v34
    s_add_u32 s28, s26, 12
    v_xor_b32 v36, s28, v35
    v_lshl_add_u32 v21, v36, 5, v34
    s_add_u32 s28, s26, 3
    v_xor_b32 v36, s28, v35
    v_lshl_add_u32 v17, v36, 5, v34
    s_add_u32 s28, s26, 13
    v_xor_b32 v36, s28, v35
    v_lshl_add_u32 v22, v36, 5, v34
    s_add_u32 s28, s27, 0
    v_xor_b32 v36, s28, v35
    v_lshl_add_u32 v18, v36, 5, v34
    s_add_u32 s28, s27, 10
    v_xor_b32 v36, s28, v35
    v_lshl_add_u32 v23, v36, 5, v34
    s_mov_b32 s40, s12
    s_and_b32 s41, s13, 0xffff
    s_mov_b32 s42, 0x10000000
    s_mov_b32 s43, 0x00020000
    s_cmp_lg_u32 s16, 0
    s_cbranch_scc1 K1_Z_1
    s_lshl_b32 s26, s2, 5
    s_add_u32 s26, s26, 0x2404000
    v_lshlrev_b32 v32, 2, v0
    v_mov_b32 v33, 0
    s_mov_b64 exec, 0xff
    buffer_store_dword v33, v32, s[40:43], s26 offen
    s_mov_b64 exec, -1
K1_Z_1:
    global_load_dwordx4 v[100:103], v96, s[54:55]
    global_load_dwordx4 v[104:107], v96, s[54:55] offset:16
    global_load_dwordx4 v[108:111], v97, s[4:5]
    global_load_dwordx4 v[112:115], v97, s[4:5] offset:16
    s_add_u32 m0, s19, 16320
    s_nop 0
    global_load_lds_dwordx4 v2, s[4:5] offset:64
    s_add_u32 m0, s19, 17344
    s_nop 0
    global_load_lds_dwordx4 v3, s[4:5] offset:64
    s_add_u32 m0, s20, 20480
    s_nop 0
    global_load_lds_dwordx4 v[4:5], off
    v_add_co_u32 v4, vcc, v4, v10
    v_addc_co_u32 v5, vcc, 0, v5, vcc
    s_add_u32 m0, s20, 28672
    s_nop 0
    global_load_lds_dwordx4 v[6:7], off
    v_add_co_u32 v6, vcc, v6, v11
    v_addc_co_u32 v7, vcc, 0, v7, vcc
    s_add_u32 m0, s21, 36864
    s_mov_b32 exec_hi, 0
    global_load_lds_dwordx4 v[8:9], off
    s_mov_b32 exec_hi, -1
    v_add_co_u32 v8, vcc, v8, v12
    v_addc_co_u32 v9, vcc, 0, v9, vcc
    s_waitcnt vmcnt(5)
    v_lshlrev_b32 v116, 16, v100
    v_and_b32 v117, 0xffff0000, v100
    v_lshlrev_b32 v118, 16, v108
    v_and_b32 v119, 0xffff0000, v108
    v_pk_mul_f32 v[116:117], v[116:117], v[118:119]
    v_cvt_pk_bf16_f32 v116, 0, v116
    v_cvt_pk_bf16_f32 v117, 0, v117
    v_mov_b32 v124, v116
    v_mov_b32 v125, v117
    v_lshlrev_b32 v120, 16, v101
    v_and_b32 v121, 0xffff0000, v101
    v_lshlrev_b32 v122, 16, v109
    v_and_b32 v123, 0xffff0000, v109
    v_pk_mul_f32 v[120:121], v[120:121], v[122:123]
    v_cvt_pk_bf16_f32 v120, 0, v120
    v_cvt_pk_bf16_f32 v121, 0, v121
    v_pk_add_f32 v[124:125], v[124:125], v[120:121]
    v_lshlrev_b32 v116, 16, v102
    v_and_b32 v117, 0xffff0000, v102
    v_lshlrev_b32 v118, 16, v110
    v_and_b32 v119, 0xffff0000, v110
    v_pk_mul_f32 v[116:117], v[116:117], v[118:119]
    v_cvt_pk_bf16_f32 v116, 0, v116
    v_cvt_pk_bf16_f32 v117, 0, v117
    v_pk_add_f32 v[124:125], v[124:125], v[116:117]
    v_lshlrev_b32 v120, 16, v103
    v_and_b32 v121, 0xffff0000, v103
    v_lshlrev_b32 v122, 16, v111
    v_and_b32 v123, 0xffff0000, v111
    v_pk_mul_f32 v[120:121], v[120:121], v[122:123]
    v_cvt_pk_bf16_f32 v120, 0, v120
    v_cvt_pk_bf16_f32 v121, 0, v121
    v_pk_add_f32 v[124:125], v[124:125], v[120:121]
    v_lshlrev_b32 v116, 16, v104
    v_and_b32 v117, 0xffff0000, v104
    v_lshlrev_b32 v118, 16, v112
    v_and_b32 v119, 0xffff0000, v112
    v_pk_mul_f32 v[116:117], v[116:117], v[118:119]
    v_cvt_pk_bf16_f32 v116, 0, v116
    v_cvt_pk_bf16_f32 v117, 0, v117
    v_pk_add_f32 v[124:125], v[124:125], v[116:117]
    v_lshlrev_b32 v120, 16, v105
    v_and_b32 v121, 0xffff0000, v105
    v_lshlrev_b32 v122, 16, v113
    v_and_b32 v123, 0xffff0000, v113
    v_pk_mul_f32 v[120:121], v[120:121], v[122:123]
    v_cvt_pk_bf16_f32 v120, 0, v120
    v_cvt_pk_bf16_f32 v121, 0, v121
    v_pk_add_f32 v[124:125], v[124:125], v[120:121]
    v_lshlrev_b32 v116, 16, v106
    v_and_b32 v117, 0xffff0000, v106
    v_lshlrev_b32 v118, 16, v114
    v_and_b32 v119, 0xffff0000, v114
    v_pk_mul_f32 v[116:117], v[116:117], v[118:119]
    v_cvt_pk_bf16_f32 v116, 0, v116
    v_cvt_pk_bf16_f32 v117, 0, v117
    v_pk_add_f32 v[124:125], v[124:125], v[116:117]
    v_lshlrev_b32 v120, 16, v107
    v_and_b32 v121, 0xffff0000, v107
    v_lshlrev_b32 v122, 16, v115
    v_and_b32 v123, 0xffff0000, v115
    v_pk_mul_f32 v[120:121], v[120:121], v[122:123]
    v_cvt_pk_bf16_f32 v120, 0, v120
    v_cvt_pk_bf16_f32 v121, 0, v121
    v_pk_add_f32 v[124:125], v[124:125], v[120:121]
    v_add_f32 v124, v124, v125
    s_nop 1
    v_add_f32_dpp v124, v124, v124 quad_perm:[1,0,3,2] row_mask:0xf bank_mask:0xf
    s_nop 1
    v_add_f32_dpp v124, v124, v124 quad_perm:[2,3,0,1] row_mask:0xf bank_mask:0xf
    s_nop 1
    v_add_f32_dpp v124, v124, v124 row_half_mirror row_mask:0xf bank_mask:0xf
    s_nop 1
    v_add_f32_dpp v124, v124, v124 row_mirror row_mask:0xf bank_mask:0xf
    v_mov_b32 v125, v124
    s_nop 1
    v_permlane32_swap_b32 v124, v125
    v_add_f32 v124, v124, v125
    v_mov_b32 v125, v124
    s_nop 1
    v_permlane16_swap_b32 v124, v125
    v_add_f32 v124, v124, v125
    v_cvt_pk_bf16_f32 v124, 0, v124
    v_mul_f32 v124, 0xbfb8aa3b, v124
    v_exp_f32 v124, v124
    s_nop 0
    v_add_f32 v124, 1.0, v124
    v_rcp_f32 v124, v124
    s_lshl_b32 s26, s53, 2
    v_cvt_pk_bf16_f32 v28, 0, v124
    v_mov_b32 v29, 0
    s_add_u32 s26, s26, 0x2400000
    s_mov_b64 exec, 1
    buffer_store_dword v28, v29, s[40:43], s26 offen
    s_mov_b64 exec, -1
    s_barrier
    s_cmp_ge_u32 s16, 4
    s_cbranch_scc1 K1_P_2
    s_setprio 1
K1_P_2:
    ds_read_b128 v[32:35], v13 offset:0
    ds_read_b128 v[36:39], v13 offset:1024
    ds_read_b128 v[40:43], v13 offset:2048
    ds_read_b128 v[44:47], v13 offset:3072
    ds_read_b64_tr_b16 v[64:65], v14 offset:0
    ds_read_b64_tr_b16 v[66:67], v14 offset:2560
    ds_read_b64_tr_b16 v[68:69], v15 offset:0
    ds_read_b64_tr_b16 v[70:71], v15 offset:2560
    ds_read_b64_tr_b16 v[72:73], v16 offset:0
    ds_read_b64_tr_b16 v[74:75], v16 offset:2560
    ds_read_b64_tr_b16 v[76:77], v17 offset:0
    ds_read_b64_tr_b16 v[78:79], v17 offset:2560
    s_add_u32 m0, s19, 32640
    s_nop 0
    global_load_lds_dwordx4 v2, s[4:5] offset:128
    ds_read_b64_tr_b16 v[80:81], v18 offset:0
    ds_read_b64_tr_b16 v[82:83], v18 offset:2560
    ds_read_b64_tr_b16 v[84:85], v19 offset:0
    ds_read_b64_tr_b16 v[86:87], v19 offset:2560
    s_waitcnt lgkmcnt(10)
    v_mfma_f32_16x16x32_bf16 v[96:99], v[64:67], v[32:35], 0
    v_mfma_f32_16x16x32_bf16 v[100:103], v[64:67], v[36:39], 0
    v_mfma_f32_16x16x32_bf16 v[104:107], v[64:67], v[40:43], 0
    v_mfma_f32_16x16x32_bf16 v[108:111], v[64:67], v[44:47], 0
    s_add_u32 m0, s19, 33664
    s_nop 0
    global_load_lds_dwordx4 v3, s[4:5] offset:128
    ds_read_b64_tr_b16 v[88:89], v20 offset:0
    ds_read_b64_tr_b16 v[90:91], v20 offset:2560
    ds_read_b64_tr_b16 v[92:93], v21 offset:0
    ds_read_b64_tr_b16 v[94:95], v21 offset:2560
    s_waitcnt lgkmcnt(12)
    v_mfma_f32_16x16x32_bf16 v[112:115], v[68:71], v[32:35], 0
    v_mfma_f32_16x16x32_bf16 v[116:119], v[68:71], v[36:39], 0
    v_mfma_f32_16x16x32_bf16 v[120:123], v[68:71], v[40:43], 0
    v_mfma_f32_16x16x32_bf16 v[124:127], v[68:71], v[44:47], 0
    s_add_u32 m0, s20, 40960
    s_nop 0
    global_load_lds_dwordx4 v[4:5], off
    v_add_co_u32 v4, vcc, v4, v10
    v_addc_co_u32 v5, vcc, 0, v5, vcc
    ds_read_b64_tr_b16 v[64:65], v22 offset:0
    ds_read_b64_tr_b16 v[66:67], v22 offset:2560
    ds_read_b64_tr_b16 v[68:69], v23 offset:0
    ds_read_b64_tr_b16 v[70:71], v23 offset:2560
    s_waitcnt lgkmcnt(14)
    v_mfma_f32_16x16x32_bf16 v[128:131], v[72:75], v[32:35], 0
    v_mfma_f32_16x16x32_bf16 v[132:135], v[72:75], v[36:39], 0
    v_mfma_f32_16x16x32_bf16 v[136:139], v[72:75], v[40:43], 0
    v_mfma_f32_16x16x32_bf16 v[140:143], v[72:75], v[44:47], 0
    s_add_u32 m0, s20, 49152
    s_nop 0
    global_load_lds_dwordx4 v[6:7], off
    v_add_co_u32 v6, vcc, v6, v11
    v_addc_co_u32 v7, vcc, 0, v7, vcc
    s_waitcnt lgkmcnt(12)
    v_mfma_f32_16x16x32_bf16 v[144:147], v[76:79], v[32:35], 0
    v_mfma_f32_16x16x32_bf16 v[148:151], v[76:79], v[36:39], 0
    v_mfma_f32_16x16x32_bf16 v[152:155], v[76:79], v[40:43], 0
    v_mfma_f32_16x16x32_bf16 v[156:159], v[76:79], v[44:47], 0
    s_add_u32 m0, s21, 57344
    s_mov_b32 exec_hi, 0
    global_load_lds_dwordx4 v[8:9], off
    s_mov_b32 exec_hi, -1
    v_add_co_u32 v8, vcc, v8, v12
    v_addc_co_u32 v9, vcc, 0, v9, vcc
    s_waitcnt lgkmcnt(10)
    v_mfma_f32_16x16x32_bf16 v[160:163], v[80:83], v[32:35], 0
    v_mfma_f32_16x16x32_bf16 v[164:167], v[80:83], v[36:39], 0
    v_mfma_f32_16x16x32_bf16 v[168:171], v[80:83], v[40:43], 0
    v_mfma_f32_16x16x32_bf16 v[172:175], v[80:83], v[44:47], 0
    s_add_u32 m0, s19, 48960
    s_nop 0
    global_load_lds_dwordx4 v2, s[4:5] offset:192
    s_add_u32 m0, s19, 49984
    s_nop 0
    global_load_lds_dwordx4 v3, s[4:5] offset:192
    s_add_u32 m0, s20, 61440
    s_nop 0
    global_load_lds_dwordx4 v[4:5], off
    v_add_co_u32 v4, vcc, v4, v10
    v_addc_co_u32 v5, vcc, 0, v5, vcc
    s_add_u32 m0, s20, 69632
    s_nop 0
    global_load_lds_dwordx4 v[6:7], off
    v_add_co_u32 v6, vcc, v6, v11
    v_addc_co_u32 v7, vcc, 0, v7, vcc
    s_add_u32 m0, s21, 77824
    s_mov_b32 exec_hi, 0
    global_load_lds_dwordx4 v[8:9], off
    s_mov_b32 exec_hi, -1
    v_add_co_u32 v8, vcc, v8, v12
    v_addc_co_u32 v9, vcc, 0, v9, vcc
    s_waitcnt lgkmcnt(8)
    v_mfma_f32_16x16x32_bf16 v[176:179], v[84:87], v[32:35], 0
    v_mfma_f32_16x16x32_bf16 v[180:183], v[84:87], v[36:39], 0
    v_mfma_f32_16x16x32_bf16 v[184:187], v[84:87], v[40:43], 0
    v_mfma_f32_16x16x32_bf16 v[188:191], v[84:87], v[44:47], 0
    s_waitcnt vmcnt(11) lgkmcnt(0)
    s_barrier
    s_add_u32 m0, s19, -256
    s_nop 0
    global_load_lds_dwordx4 v2, s[4:5] offset:256
    s_add_u32 m0, s19, 768
    s_nop 0
    global_load_lds_dwordx4 v3, s[4:5] offset:256
    ds_read_b64_tr_b16 v[72:73], v14 offset:20480
    ds_read_b64_tr_b16 v[74:75], v14 offset:23040
    ds_read_b128 v[48:51], v13 offset:16384
    ds_read_b128 v[52:55], v13 offset:17408
    v_mfma_f32_16x16x32_bf16 v[192:195], v[88:91], v[32:35], 0
    v_mfma_f32_16x16x32_bf16 v[196:199], v[88:91], v[36:39], 0
    v_mfma_f32_16x16x32_bf16 v[200:203], v[88:91], v[40:43], 0
    v_mfma_f32_16x16x32_bf16 v[204:207], v[88:91], v[44:47], 0
    s_add_u32 m0, s20, 0
    s_nop 0
    global_load_lds_dwordx4 v[4:5], off
    v_add_co_u32 v4, vcc, v4, v10
    v_addc_co_u32 v5, vcc, 0, v5, vcc
    ds_read_b64_tr_b16 v[76:77], v15 offset:20480
    ds_read_b64_tr_b16 v[78:79], v15 offset:23040
    ds_read_b128 v[56:59], v13 offset:18432
    ds_read_b128 v[60:63], v13 offset:19456
    v_mfma_f32_16x16x32_bf16 v[208:211], v[92:95], v[32:35], 0
    v_mfma_f32_16x16x32_bf16 v[212:215], v[92:95], v[36:39], 0
    v_mfma_f32_16x16x32_bf16 v[216:219], v[92:95], v[40:43], 0
    v_mfma_f32_16x16x32_bf16 v[220:223], v[92:95], v[44:47], 0
    s_add_u32 m0, s20, 8192
    s_nop 0
    global_load_lds_dwordx4 v[6:7], off
    v_add_co_u32 v6, vcc, v6, v11
    v_addc_co_u32 v7, vcc, 0, v7, vcc
    ds_read_b64_tr_b16 v[80:81], v16 offset:20480
    ds_read_b64_tr_b16 v[82:83], v16 offset:23040
    v_mfma_f32_16x16x32_bf16 v[224:227], v[64:67], v[32:35], 0
    v_mfma_f32_16x16x32_bf16 v[228:231], v[64:67], v[36:39], 0
    v_mfma_f32_16x16x32_bf16 v[232:235], v[64:67], v[40:43], 0
    v_mfma_f32_16x16x32_bf16 v[236:239], v[64:67], v[44:47], 0
    s_add_u32 m0, s21, 16384
    s_mov_b32 exec_hi, 0
    global_load_lds_dwordx4 v[8:9], off
    s_mov_b32 exec_hi, -1
    v_add_co_u32 v8, vcc, v8, v12
    v_addc_co_u32 v9, vcc, 0, v9, vcc
    ds_read_b64_tr_b16 v[84:85], v17 offset:20480
    ds_read_b64_tr_b16 v[86:87], v17 offset:23040
    v_mfma_f32_16x16x32_bf16 v[240:243], v[68:71], v[32:35], 0
    v_mfma_f32_16x16x32_bf16 v[244:247], v[68:71], v[36:39], 0
    v_mfma_f32_16x16x32_bf16 v[248:251], v[68:71], v[40:43], 0
    v_mfma_f32_16x16x32_bf16 v[252:255], v[68:71], v[44:47], 0
    ds_read_b64_tr_b16 v[88:89], v18 offset:20480
    ds_read_b64_tr_b16 v[90:91], v18 offset:23040
    ds_read_b64_tr_b16 v[92:93], v19 offset:20480
    ds_read_b64_tr_b16 v[94:95], v19 offset:23040
    s_waitcnt lgkmcnt(8)
    v_mfma_f32_16x16x32_bf16 v[96:99], v[72:75], v[48:51], v[96:99]
    v_mfma_f32_16x16x32_bf16 v[100:103], v[72:75], v[52:55], v[100:103]
    v_mfma_f32_16x16x32_bf16 v[104:107], v[72:75], v[56:59], v[104:107]
    v_mfma_f32_16x16x32_bf16 v[108:111], v[72:75], v[60:63], v[108:111]
    ds_read_b64_tr_b16 v[64:65], v20 offset:20480
    ds_read_b64_tr_b16 v[66:67], v20 offset:23040
    ds_read_b64_tr_b16 v[68:69], v21 offset:20480
    ds_read_b64_tr_b16 v[70:71], v21 offset:23040
    v_mfma_f32_16x16x32_bf16 v[112:115], v[76:79], v[48:51], v[112:115]
    v_mfma_f32_16x16x32_bf16 v[116:119], v[76:79], v[52:55], v[116:119]
    v_mfma_f32_16x16x32_bf16 v[120:123], v[76:79], v[56:59], v[120:123]
    v_mfma_f32_16x16x32_bf16 v[124:127], v[76:79], v[60:63], v[124:127]
    ds_read_b64_tr_b16 v[72:73], v22 offset:20480
    ds_read_b64_tr_b16 v[74:75], v22 offset:23040
    ds_read_b64_tr_b16 v[76:77], v23 offset:20480
    ds_read_b64_tr_b16 v[78:79], v23 offset:23040
    s_waitcnt lgkmcnt(14)
    v_mfma_f32_16x16x32_bf16 v[128:131], v[80:83], v[48:51], v[128:131]
    v_mfma_f32_16x16x32_bf16 v[132:135], v[80:83], v[52:55], v[132:135]
    v_mfma_f32_16x16x32_bf16 v[136:139], v[80:83], v[56:59], v[136:139]
    v_mfma_f32_16x16x32_bf16 v[140:143], v[80:83], v[60:63], v[140:143]
    s_waitcnt lgkmcnt(12)
    v_mfma_f32_16x16x32_bf16 v[144:147], v[84:87], v[48:51], v[144:147]
    v_mfma_f32_16x16x32_bf16 v[148:151], v[84:87], v[52:55], v[148:151]
    v_mfma_f32_16x16x32_bf16 v[152:155], v[84:87], v[56:59], v[152:155]
    v_mfma_f32_16x16x32_bf16 v[156:159], v[84:87], v[60:63], v[156:159]
    s_waitcnt lgkmcnt(10)
    v_mfma_f32_16x16x32_bf16 v[160:163], v[88:91], v[48:51], v[160:163]
    v_mfma_f32_16x16x32_bf16 v[164:167], v[88:91], v[52:55], v[164:167]
    v_mfma_f32_16x16x32_bf16 v[168:171], v[88:91], v[56:59], v[168:171]
    v_mfma_f32_16x16x32_bf16 v[172:175], v[88:91], v[60:63], v[172:175]
    s_waitcnt lgkmcnt(8)
    v_mfma_f32_16x16x32_bf16 v[176:179], v[92:95], v[48:51], v[176:179]
    v_mfma_f32_16x16x32_bf16 v[180:183], v[92:95], v[52:55], v[180:183]
    v_mfma_f32_16x16x32_bf16 v[184:187], v[92:95], v[56:59], v[184:187]
    v_mfma_f32_16x16x32_bf16 v[188:191], v[92:95], v[60:63], v[188:191]
    s_waitcnt vmcnt(10) lgkmcnt(0)
    s_barrier
    s_add_u32 m0, s19, 16064
    s_nop 0
    global_load_lds_dwordx4 v2, s[4:5] offset:320
    s_add_u32 m0, s19, 17088
    s_nop 0
    global_load_lds_dwordx4 v3, s[4:5] offset:320
    ds_read_b64_tr_b16 v[80:81], v14 offset:40960
    ds_read_b64_tr_b16 v[82:83], v14 offset:43520
    ds_read_b128 v[32:35], v13 offset:32768
    ds_read_b128 v[36:39], v13 offset:33792
    v_mfma_f32_16x16x32_bf16 v[192:195], v[64:67], v[48:51], v[192:195]
    v_mfma_f32_16x16x32_bf16 v[196:199], v[64:67], v[52:55], v[196:199]
    v_mfma_f32_16x16x32_bf16 v[200:203], v[64:67], v[56:59], v[200:203]
    v_mfma_f32_16x16x32_bf16 v[204:207], v[64:67], v[60:63], v[204:207]
    s_add_u32 m0, s20, 20480
    s_nop 0
    global_load_lds_dwordx4 v[4:5], off
    v_add_co_u32 v4, vcc, v4, v10
    v_addc_co_u32 v5, vcc, 0, v5, vcc
    ds_read_b64_tr_b16 v[84:85], v15 offset:40960
    ds_read_b64_tr_b16 v[86:87], v15 offset:43520
    ds_read_b128 v[40:43], v13 offset:34816
    ds_read_b128 v[44:47], v13 offset:35840
    v_mfma_f32_16x16x32_bf16 v[208:211], v[68:71], v[48:51], v[208:211]
    v_mfma_f32_16x16x32_bf16 v[212:215], v[68:71], v[52:55], v[212:215]
    v_mfma_f32_16x16x32_bf16 v[216:219], v[68:71], v[56:59], v[216:219]
    v_mfma_f32_16x16x32_bf16 v[220:223], v[68:71], v[60:63], v[220:223]
    s_add_u32 m0, s20, 28672
    s_nop 0
    global_load_lds_dwordx4 v[6:7], off
    v_add_co_u32 v6, vcc, v6, v11
    v_addc_co_u32 v7, vcc, 0, v7, vcc
    ds_read_b64_tr_b16 v[88:89], v16 offset:40960
    ds_read_b64_tr_b16 v[90:91], v16 offset:43520
    v_mfma_f32_16x16x32_bf16 v[224:227], v[72:75], v[48:51], v[224:227]
    v_mfma_f32_16x16x32_bf16 v[228:231], v[72:75], v[52:55], v[228:231]
    v_mfma_f32_16x16x32_bf16 v[232:235], v[72:75], v[56:59], v[232:235]
    v_mfma_f32_16x16x32_bf16 v[236:239], v[72:75], v[60:63], v[236:239]
    s_add_u32 m0, s21, 36864
    s_mov_b32 exec_hi, 0
    global_load_lds_dwordx4 v[8:9], off
    s_mov_b32 exec_hi, -1
    v_add_co_u32 v8, vcc, v8, v12
    v_addc_co_u32 v9, vcc, 0, v9, vcc
    ds_read_b64_tr_b16 v[92:93], v17 offset:40960
    ds_read_b64_tr_b16 v[94:95], v17 offset:43520
    v_mfma_f32_16x16x32_bf16 v[240:243], v[76:79], v[48:51], v[240:243]
    v_mfma_f32_16x16x32_bf16 v[244:247], v[76:79], v[52:55], v[244:247]
    v_mfma_f32_16x16x32_bf16 v[248:251], v[76:79], v[56:59], v[248:251]
    v_mfma_f32_16x16x32_bf16 v[252:255], v[76:79], v[60:63], v[252:255]
    ds_read_b64_tr_b16 v[64:65], v18 offset:40960
    ds_read_b64_tr_b16 v[66:67], v18 offset:43520
    ds_read_b64_tr_b16 v[68:69], v19 offset:40960
    ds_read_b64_tr_b16 v[70:71], v19 offset:43520
    s_waitcnt lgkmcnt(8)
    v_mfma_f32_16x16x32_bf16 v[96:99], v[80:83], v[32:35], v[96:99]
    v_mfma_f32_16x16x32_bf16 v[100:103], v[80:83], v[36:39], v[100:103]
    v_mfma_f32_16x16x32_bf16 v[104:107], v[80:83], v[40:43], v[104:107]
    v_mfma_f32_16x16x32_bf16 v[108:111], v[80:83], v[44:47], v[108:111]
    ds_read_b64_tr_b16 v[72:73], v20 offset:40960
    ds_read_b64_tr_b16 v[74:75], v20 offset:43520
    ds_read_b64_tr_b16 v[76:77], v21 offset:40960
    ds_read_b64_tr_b16 v[78:79], v21 offset:43520
    v_mfma_f32_16x16x32_bf16 v[112:115], v[84:87], v[32:35], v[112:115]
    v_mfma_f32_16x16x32_bf16 v[116:119], v[84:87], v[36:39], v[116:119]
    v_mfma_f32_16x16x32_bf16 v[120:123], v[84:87], v[40:43], v[120:123]
    v_mfma_f32_16x16x32_bf16 v[124:127], v[84:87], v[44:47], v[124:127]
    ds_read_b64_tr_b16 v[80:81], v22 offset:40960
    ds_read_b64_tr_b16 v[82:83], v22 offset:43520
    ds_read_b64_tr_b16 v[84:85], v23 offset:40960
    ds_read_b64_tr_b16 v[86:87], v23 offset:43520
    s_waitcnt lgkmcnt(14)
    v_mfma_f32_16x16x32_bf16 v[128:131], v[88:91], v[32:35], v[128:131]
    v_mfma_f32_16x16x32_bf16 v[132:135], v[88:91], v[36:39], v[132:135]
    v_mfma_f32_16x16x32_bf16 v[136:139], v[88:91], v[40:43], v[136:139]
    v_mfma_f32_16x16x32_bf16 v[140:143], v[88:91], v[44:47], v[140:143]
    s_waitcnt lgkmcnt(12)
    v_mfma_f32_16x16x32_bf16 v[144:147], v[92:95], v[32:35], v[144:147]
    v_mfma_f32_16x16x32_bf16 v[148:151], v[92:95], v[36:39], v[148:151]
    v_mfma_f32_16x16x32_bf16 v[152:155], v[92:95], v[40:43], v[152:155]
    v_mfma_f32_16x16x32_bf16 v[156:159], v[92:95], v[44:47], v[156:159]
    s_waitcnt lgkmcnt(10)
    v_mfma_f32_16x16x32_bf16 v[160:163], v[64:67], v[32:35], v[160:163]
    v_mfma_f32_16x16x32_bf16 v[164:167], v[64:67], v[36:39], v[164:167]
    v_mfma_f32_16x16x32_bf16 v[168:171], v[64:67], v[40:43], v[168:171]
    v_mfma_f32_16x16x32_bf16 v[172:175], v[64:67], v[44:47], v[172:175]
    s_waitcnt lgkmcnt(8)
    v_mfma_f32_16x16x32_bf16 v[176:179], v[68:71], v[32:35], v[176:179]
    v_mfma_f32_16x16x32_bf16 v[180:183], v[68:71], v[36:39], v[180:183]
    v_mfma_f32_16x16x32_bf16 v[184:187], v[68:71], v[40:43], v[184:187]
    v_mfma_f32_16x16x32_bf16 v[188:191], v[68:71], v[44:47], v[188:191]
    s_waitcnt vmcnt(10) lgkmcnt(0)
    s_barrier
    s_add_u32 m0, s19, 32384
    s_nop 0
    global_load_lds_dwordx4 v2, s[4:5] offset:384
    s_add_u32 m0, s19, 33408
    s_nop 0
    global_load_lds_dwordx4 v3, s[4:5] offset:384
    ds_read_b64_tr_b16 v[88:89], v14 offset:61440
    ds_read_b64_tr_b16 v[90:91], v14 offset:64000
    ds_read_b128 v[48:51], v13 offset:49152
    ds_read_b128 v[52:55], v13 offset:50176
    v_mfma_f32_16x16x32_bf16 v[192:195], v[72:75], v[32:35], v[192:195]
    v_mfma_f32_16x16x32_bf16 v[196:199], v[72:75], v[36:39], v[196:199]
    v_mfma_f32_16x16x32_bf16 v[200:203], v[72:75], v[40:43], v[200:203]
    v_mfma_f32_16x16x32_bf16 v[204:207], v[72:75], v[44:47], v[204:207]
    s_add_u32 m0, s20, 40960
    s_nop 0
    global_load_lds_dwordx4 v[4:5], off
    v_add_co_u32 v4, vcc, v4, v10
    v_addc_co_u32 v5, vcc, 0, v5, vcc
    ds_read_b64_tr_b16 v[92:93], v15 offset:61440
    ds_read_b64_tr_b16 v[94:95], v15 offset:64000
    ds_read_b128 v[56:59], v13 offset:51200
    ds_read_b128 v[60:63], v13 offset:52224
    v_mfma_f32_16x16x32_bf16 v[208:211], v[76:79], v[32:35], v[208:211]
    v_mfma_f32_16x16x32_bf16 v[212:215], v[76:79], v[36:39], v[212:215]
    v_mfma_f32_16x16x32_bf16 v[216:219], v[76:79], v[40:43], v[216:219]
    v_mfma_f32_16x16x32_bf16 v[220:223], v[76:79], v[44:47], v[220:223]
    s_add_u32 m0, s20, 49152
    s_nop 0
    global_load_lds_dwordx4 v[6:7], off
    v_add_co_u32 v6, vcc, v6, v11
    v_addc_co_u32 v7, vcc, 0, v7, vcc
    ds_read_b64_tr_b16 v[64:65], v16 offset:61440
    ds_read_b64_tr_b16 v[66:67], v16 offset:64000
    v_mfma_f32_16x16x32_bf16 v[224:227], v[80:83], v[32:35], v[224:227]
    v_mfma_f32_16x16x32_bf16 v[228:231], v[80:83], v[36:39], v[228:231]
    v_mfma_f32_16x16x32_bf16 v[232:235], v[80:83], v[40:43], v[232:235]
    v_mfma_f32_16x16x32_bf16 v[236:239], v[80:83], v[44:47], v[236:239]
    s_add_u32 m0, s21, 57344
    s_mov_b32 exec_hi, 0
    global_load_lds_dwordx4 v[8:9], off
    s_mov_b32 exec_hi, -1
    v_add_co_u32 v8, vcc, v8, v12
    v_addc_co_u32 v9, vcc, 0, v9, vcc
    ds_read_b64_tr_b16 v[68:69], v17 offset:61440
    ds_read_b64_tr_b16 v[70:71], v17 offset:64000
    v_mfma_f32_16x16x32_bf16 v[240:243], v[84:87], v[32:35], v[240:243]
    v_mfma_f32_16x16x32_bf16 v[244:247], v[84:87], v[36:39], v[244:247]
    v_mfma_f32_16x16x32_bf16 v[248:251], v[84:87], v[40:43], v[248:251]
    v_mfma_f32_16x16x32_bf16 v[252:255], v[84:87], v[44:47], v[252:255]
    ds_read_b64_tr_b16 v[72:73], v18 offset:61440
    ds_read_b64_tr_b16 v[74:75], v18 offset:64000
    ds_read_b64_tr_b16 v[76:77], v19 offset:61440
    ds_read_b64_tr_b16 v[78:79], v19 offset:64000
    s_waitcnt lgkmcnt(8)
    v_mfma_f32_16x16x32_bf16 v[96:99], v[88:91], v[48:51], v[96:99]
    v_mfma_f32_16x16x32_bf16 v[100:103], v[88:91], v[52:55], v[100:103]
    v_mfma_f32_16x16x32_bf16 v[104:107], v[88:91], v[56:59], v[104:107]
    v_mfma_f32_16x16x32_bf16 v[108:111], v[88:91], v[60:63], v[108:111]
    ds_read_b64_tr_b16 v[80:81], v20 offset:61440
    ds_read_b64_tr_b16 v[82:83], v20 offset:64000
    ds_read_b64_tr_b16 v[84:85], v21 offset:61440
    ds_read_b64_tr_b16 v[86:87], v21 offset:64000
    v_mfma_f32_16x16x32_bf16 v[112:115], v[92:95], v[48:51], v[112:115]
    v_mfma_f32_16x16x32_bf16 v[116:119], v[92:95], v[52:55], v[116:119]
    v_mfma_f32_16x16x32_bf16 v[120:123], v[92:95], v[56:59], v[120:123]
    v_mfma_f32_16x16x32_bf16 v[124:127], v[92:95], v[60:63], v[124:127]
    ds_read_b64_tr_b16 v[88:89], v22 offset:61440
    ds_read_b64_tr_b16 v[90:91], v22 offset:64000
    ds_read_b64_tr_b16 v[92:93], v23 offset:61440
    ds_read_b64_tr_b16 v[94:95], v23 offset:64000
    s_waitcnt lgkmcnt(14)
    v_mfma_f32_16x16x32_bf16 v[128:131], v[64:67], v[48:51], v[128:131]
    v_mfma_f32_16x16x32_bf16 v[132:135], v[64:67], v[52:55], v[132:135]
    v_mfma_f32_16x16x32_bf16 v[136:139], v[64:67], v[56:59], v[136:139]
    v_mfma_f32_16x16x32_bf16 v[140:143], v[64:67], v[60:63], v[140:143]
    s_waitcnt lgkmcnt(12)
    v_mfma_f32_16x16x32_bf16 v[144:147], v[68:71], v[48:51], v[144:147]
    v_mfma_f32_16x16x32_bf16 v[148:151], v[68:71], v[52:55], v[148:151]
    v_mfma_f32_16x16x32_bf16 v[152:155], v[68:71], v[56:59], v[152:155]
    v_mfma_f32_16x16x32_bf16 v[156:159], v[68:71], v[60:63], v[156:159]
    s_waitcnt lgkmcnt(10)
    v_mfma_f32_16x16x32_bf16 v[160:163], v[72:75], v[48:51], v[160:163]
    v_mfma_f32_16x16x32_bf16 v[164:167], v[72:75], v[52:55], v[164:167]
    v_mfma_f32_16x16x32_bf16 v[168:171], v[72:75], v[56:59], v[168:171]
    v_mfma_f32_16x16x32_bf16 v[172:175], v[72:75], v[60:63], v[172:175]
    s_waitcnt lgkmcnt(8)
    v_mfma_f32_16x16x32_bf16 v[176:179], v[76:79], v[48:51], v[176:179]
    v_mfma_f32_16x16x32_bf16 v[180:183], v[76:79], v[52:55], v[180:183]
    v_mfma_f32_16x16x32_bf16 v[184:187], v[76:79], v[56:59], v[184:187]
    v_mfma_f32_16x16x32_bf16 v[188:191], v[76:79], v[60:63], v[188:191]
    s_waitcnt vmcnt(10) lgkmcnt(0)
    s_barrier
    s_add_u32 m0, s19, 48704
    s_nop 0
    global_load_lds_dwordx4 v2, s[4:5] offset:448
    s_add_u32 m0, s19, 49728
    s_nop 0
    global_load_lds_dwordx4 v3, s[4:5] offset:448
    ds_read_b64_tr_b16 v[64:65], v14 offset:0
    ds_read_b64_tr_b16 v[66:67], v14 offset:2560
    ds_read_b128 v[32:35], v13 offset:0
    ds_read_b128 v[36:39], v13 offset:1024
    v_mfma_f32_16x16x32_bf16 v[192:195], v[80:83], v[48:51], v[192:195]
    v_mfma_f32_16x16x32_bf16 v[196:199], v[80:83], v[52:55], v[196:199]
    v_mfma_f32_16x16x32_bf16 v[200:203], v[80:83], v[56:59], v[200:203]
    v_mfma_f32_16x16x32_bf16 v[204:207], v[80:83], v[60:63], v[204:207]
    s_add_u32 m0, s20, 61440
    s_nop 0
    global_load_lds_dwordx4 v[4:5], off
    v_add_co_u32 v4, vcc, v4, v10
    v_addc_co_u32 v5, vcc, 0, v5, vcc
    ds_read_b64_tr_b16 v[68:69], v15 offset:0
    ds_read_b64_tr_b16 v[70:71], v15 offset:2560
    ds_read_b128 v[40:43], v13 offset:2048
    ds_read_b128 v[44:47], v13 offset:3072
    v_mfma_f32_16x16x32_bf16 v[208:211], v[84:87], v[48:51], v[208:211]
    v_mfma_f32_16x16x32_bf16 v[212:215], v[84:87], v[52:55], v[212:215]
    v_mfma_f32_16x16x32_bf16 v[216:219], v[84:87], v[56:59], v[216:219]
    v_mfma_f32_16x16x32_bf16 v[220:223], v[84:87], v[60:63], v[220:223]
    s_add_u32 m0, s20, 69632
    s_nop 0
    global_load_lds_dwordx4 v[6:7], off
    v_add_co_u32 v6, vcc, v6, v11
    v_addc_co_u32 v7, vcc, 0, v7, vcc
    ds_read_b64_tr_b16 v[72:73], v16 offset:0
    ds_read_b64_tr_b16 v[74:75], v16 offset:2560
    v_mfma_f32_16x16x32_bf16 v[224:227], v[88:91], v[48:51], v[224:227]
    v_mfma_f32_16x16x32_bf16 v[228:231], v[88:91], v[52:55], v[228:231]
    v_mfma_f32_16x16x32_bf16 v[232:235], v[88:91], v[56:59], v[232:235]
    v_mfma_f32_16x16x32_bf16 v[236:239], v[88:91], v[60:63], v[236:239]
    s_add_u32 m0, s21, 77824
    s_mov_b32 exec_hi, 0
    global_load_lds_dwordx4 v[8:9], off
    s_mov_b32 exec_hi, -1
    v_add_co_u32 v8, vcc, v8, v12
    v_addc_co_u32 v9, vcc, 0, v9, vcc
    ds_read_b64_tr_b16 v[76:77], v17 offset:0
    ds_read_b64_tr_b16 v[78:79], v17 offset:2560
    v_mfma_f32_16x16x32_bf16 v[240:243], v[92:95], v[48:51], v[240:243]
    v_mfma_f32_16x16x32_bf16 v[244:247], v[92:95], v[52:55], v[244:247]
    v_mfma_f32_16x16x32_bf16 v[248:251], v[92:95], v[56:59], v[248:251]
    v_mfma_f32_16x16x32_bf16 v[252:255], v[92:95], v[60:63], v[252:255]
    ds_read_b64_tr_b16 v[80:81], v18 offset:0
    ds_read_b64_tr_b16 v[82:83], v18 offset:2560
    ds_read_b64_tr_b16 v[84:85], v19 offset:0
    ds_read_b64_tr_b16 v[86:87], v19 offset:2560
    s_waitcnt lgkmcnt(8)
    v_mfma_f32_16x16x32_bf16 v[96:99], v[64:67], v[32:35], v[96:99]
    v_mfma_f32_16x16x32_bf16 v[100:103], v[64:67], v[36:39], v[100:103]
    v_mfma_f32_16x16x32_bf16 v[104:107], v[64:67], v[40:43], v[104:107]
    v_mfma_f32_16x16x32_bf16 v[108:111], v[64:67], v[44:47], v[108:111]
    ds_read_b64_tr_b16 v[88:89], v20 offset:0
    ds_read_b64_tr_b16 v[90:91], v20 offset:2560
    ds_read_b64_tr_b16 v[92:93], v21 offset:0
    ds_read_b64_tr_b16 v[94:95], v21 offset:2560
    v_mfma_f32_16x16x32_bf16 v[112:115], v[68:71], v[32:35], v[112:115]
    v_mfma_f32_16x16x32_bf16 v[116:119], v[68:71], v[36:39], v[116:119]
    v_mfma_f32_16x16x32_bf16 v[120:123], v[68:71], v[40:43], v[120:123]
    v_mfma_f32_16x16x32_bf16 v[124:127], v[68:71], v[44:47], v[124:127]
    ds_read_b64_tr_b16 v[64:65], v22 offset:0
    ds_read_b64_tr_b16 v[66:67], v22 offset:2560
    ds_read_b64_tr_b16 v[68:69], v23 offset:0
    ds_read_b64_tr_b16 v[70:71], v23 offset:2560
    s_waitcnt lgkmcnt(14)
    v_mfma_f32_16x16x32_bf16 v[128:131], v[72:75], v[32:35], v[128:131]
    v_mfma_f32_16x16x32_bf16 v[132:135], v[72:75], v[36:39], v[132:135]
    v_mfma_f32_16x16x32_bf16 v[136:139], v[72:75], v[40:43], v[136:139]
    v_mfma_f32_16x16x32_bf16 v[140:143], v[72:75], v[44:47], v[140:143]
    s_waitcnt lgkmcnt(12)
    v_mfma_f32_16x16x32_bf16 v[144:147], v[76:79], v[32:35], v[144:147]
    v_mfma_f32_16x16x32_bf16 v[148:151], v[76:79], v[36:39], v[148:151]
    v_mfma_f32_16x16x32_bf16 v[152:155], v[76:79], v[40:43], v[152:155]
    v_mfma_f32_16x16x32_bf16 v[156:159], v[76:79], v[44:47], v[156:159]
    s_waitcnt lgkmcnt(10)
    v_mfma_f32_16x16x32_bf16 v[160:163], v[80:83], v[32:35], v[160:163]
    v_mfma_f32_16x16x32_bf16 v[164:167], v[80:83], v[36:39], v[164:167]
    v_mfma_f32_16x16x32_bf16 v[168:171], v[80:83], v[40:43], v[168:171]
    v_mfma_f32_16x16x32_bf16 v[172:175], v[80:83], v[44:47], v[172:175]
    s_waitcnt lgkmcnt(8)
    v_mfma_f32_16x16x32_bf16 v[176:179], v[84:87], v[32:35], v[176:179]
    v_mfma_f32_16x16x32_bf16 v[180:183], v[84:87], v[36:39], v[180:183]
    v_mfma_f32_16x16x32_bf16 v[184:187], v[84:87], v[40:43], v[184:187]
    v_mfma_f32_16x16x32_bf16 v[188:191], v[84:87], v[44:47], v[188:191]
    s_waitcnt vmcnt(10) lgkmcnt(0)
    s_barrier
    s_add_u32 m0, s19, -512
    s_nop 0
    global_load_lds_dwordx4 v2, s[4:5] offset:512
    s_add_u32 m0, s19, 512
    s_nop 0
    global_load_lds_dwordx4 v3, s[4:5] offset:512
    ds_read_b64_tr_b16 v[72:73], v14 offset:20480
    ds_read_b64_tr_b16 v[74:75], v14 offset:23040
    ds_read_b128 v[48:51], v13 offset:16384
    ds_read_b128 v[52:55], v13 offset:17408
    v_mfma_f32_16x16x32_bf16 v[192:195], v[88:91], v[32:35], v[192:195]
    v_mfma_f32_16x16x32_bf16 v[196:199], v[88:91], v[36:39], v[196:199]
    v_mfma_f32_16x16x32_bf16 v[200:203], v[88:91], v[40:43], v[200:203]
    v_mfma_f32_16x16x32_bf16 v[204:207], v[88:91], v[44:47], v[204:207]
    s_add_u32 m0, s20, 0
    s_nop 0
    global_load_lds_dwordx4 v[4:5], off
    v_add_co_u32 v4, vcc, v4, v10
    v_addc_co_u32 v5, vcc, 0, v5, vcc
    ds_read_b64_tr_b16 v[76:77], v15 offset:20480
    ds_read_b64_tr_b16 v[78:79], v15 offset:23040
    ds_read_b128 v[56:59], v13 offset:18432
    ds_read_b128 v[60:63], v13 offset:19456
    v_mfma_f32_16x16x32_bf16 v[208:211], v[92:95], v[32:35], v[208:211]
    v_mfma_f32_16x16x32_bf16 v[212:215], v[92:95], v[36:39], v[212:215]
    v_mfma_f32_16x16x32_bf16 v[216:219], v[92:95], v[40:43], v[216:219]
    v_mfma_f32_16x16x32_bf16 v[220:223], v[92:95], v[44:47], v[220:223]
    s_add_u32 m0, s20, 8192
    s_nop 0
    global_load_lds_dwordx4 v[6:7], off
    v_add_co_u32 v6, vcc, v6, v11
    v_addc_co_u32 v7, vcc, 0, v7, vcc
    ds_read_b64_tr_b16 v[80:81], v16 offset:20480
    ds_read_b64_tr_b16 v[82:83], v16 offset:23040
    v_mfma_f32_16x16x32_bf16 v[224:227], v[64:67], v[32:35], v[224:227]
    v_mfma_f32_16x16x32_bf16 v[228:231], v[64:67], v[36:39], v[228:231]
    v_mfma_f32_16x16x32_bf16 v[232:235], v[64:67], v[40:43], v[232:235]
    v_mfma_f32_16x16x32_bf16 v[236:239], v[64:67], v[44:47], v[236:239]
    s_add_u32 m0, s21, 16384
    s_mov_b32 exec_hi, 0
    global_load_lds_dwordx4 v[8:9], off
    s_mov_b32 exec_hi, -1
    v_add_co_u32 v8, vcc, v8, v12
    v_addc_co_u32 v9, vcc, 0, v9, vcc
    ds_read_b64_tr_b16 v[84:85], v17 offset:20480
    ds_read_b64_tr_b16 v[86:87], v17 offset:23040
    v_mfma_f32_16x16x32_bf16 v[240:243], v[68:71], v[32:35], v[240:243]
    v_mfma_f32_16x16x32_bf16 v[244:247], v[68:71], v[36:39], v[244:247]
    v_mfma_f32_16x16x32_bf16 v[248:251], v[68:71], v[40:43], v[248:251]
    v_mfma_f32_16x16x32_bf16 v[252:255], v[68:71], v[44:47], v[252:255]
    ds_read_b64_tr_b16 v[88:89], v18 offset:20480
    ds_read_b64_tr_b16 v[90:91], v18 offset:23040
    ds_read_b64_tr_b16 v[92:93], v19 offset:20480
    ds_read_b64_tr_b16 v[94:95], v19 offset:23040
    s_waitcnt lgkmcnt(8)
    v_mfma_f32_16x16x32_bf16 v[96:99], v[72:75], v[48:51], v[96:99]
    v_mfma_f32_16x16x32_bf16 v[100:103], v[72:75], v[52:55], v[100:103]
    v_mfma_f32_16x16x32_bf16 v[104:107], v[72:75], v[56:59], v[104:107]
    v_mfma_f32_16x16x32_bf16 v[108:111], v[72:75], v[60:63], v[108:111]
    ds_read_b64_tr_b16 v[64:65], v20 offset:20480
    ds_read_b64_tr_b16 v[66:67], v20 offset:23040
    ds_read_b64_tr_b16 v[68:69], v21 offset:20480
    ds_read_b64_tr_b16 v[70:71], v21 offset:23040
    v_mfma_f32_16x16x32_bf16 v[112:115], v[76:79], v[48:51], v[112:115]
    v_mfma_f32_16x16x32_bf16 v[116:119], v[76:79], v[52:55], v[116:119]
    v_mfma_f32_16x16x32_bf16 v[120:123], v[76:79], v[56:59], v[120:123]
    v_mfma_f32_16x16x32_bf16 v[124:127], v[76:79], v[60:63], v[124:127]
    ds_read_b64_tr_b16 v[72:73], v22 offset:20480
    ds_read_b64_tr_b16 v[74:75], v22 offset:23040
    ds_read_b64_tr_b16 v[76:77], v23 offset:20480
    ds_read_b64_tr_b16 v[78:79], v23 offset:23040
    s_waitcnt lgkmcnt(14)
    v_mfma_f32_16x16x32_bf16 v[128:131], v[80:83], v[48:51], v[128:131]
    v_mfma_f32_16x16x32_bf16 v[132:135], v[80:83], v[52:55], v[132:135]
    v_mfma_f32_16x16x32_bf16 v[136:139], v[80:83], v[56:59], v[136:139]
    v_mfma_f32_16x16x32_bf16 v[140:143], v[80:83], v[60:63], v[140:143]
    s_waitcnt lgkmcnt(12)
    v_mfma_f32_16x16x32_bf16 v[144:147], v[84:87], v[48:51], v[144:147]
    v_mfma_f32_16x16x32_bf16 v[148:151], v[84:87], v[52:55], v[148:151]
    v_mfma_f32_16x16x32_bf16 v[152:155], v[84:87], v[56:59], v[152:155]
    v_mfma_f32_16x16x32_bf16 v[156:159], v[84:87], v[60:63], v[156:159]
    s_waitcnt lgkmcnt(10)
    v_mfma_f32_16x16x32_bf16 v[160:163], v[88:91], v[48:51], v[160:163]
    v_mfma_f32_16x16x32_bf16 v[164:167], v[88:91], v[52:55], v[164:167]
    v_mfma_f32_16x16x32_bf16 v[168:171], v[88:91], v[56:59], v[168:171]
    v_mfma_f32_16x16x32_bf16 v[172:175], v[88:91], v[60:63], v[172:175]
    s_waitcnt lgkmcnt(8)
    v_mfma_f32_16x16x32_bf16 v[176:179], v[92:95], v[48:51], v[176:179]
    v_mfma_f32_16x16x32_bf16 v[180:183], v[92:95], v[52:55], v[180:183]
    v_mfma_f32_16x16x32_bf16 v[184:187], v[92:95], v[56:59], v[184:187]
    v_mfma_f32_16x16x32_bf16 v[188:191], v[92:95], v[60:63], v[188:191]
    s_waitcnt vmcnt(10) lgkmcnt(0)
    s_barrier
    s_add_u32 m0, s19, 15808
    s_nop 0
    global_load_lds_dwordx4 v2, s[4:5] offset:576
    s_add_u32 m0, s19, 16832
    s_nop 0
    global_load_lds_dwordx4 v3, s[4:5] offset:576
    ds_read_b64_tr_b16 v[80:81], v14 offset:40960
    ds_read_b64_tr_b16 v[82:83], v14 offset:43520
    ds_read_b128 v[32:35], v13 offset:32768
    ds_read_b128 v[36:39], v13 offset:33792
    v_mfma_f32_16x16x32_bf16 v[192:195], v[64:67], v[48:51], v[192:195]
    v_mfma_f32_16x16x32_bf16 v[196:199], v[64:67], v[52:55], v[196:199]
    v_mfma_f32_16x16x32_bf16 v[200:203], v[64:67], v[56:59], v[200:203]
    v_mfma_f32_16x16x32_bf16 v[204:207], v[64:67], v[60:63], v[204:207]
    s_add_u32 m0, s20, 20480
    s_nop 0
    global_load_lds_dwordx4 v[4:5], off
    v_add_co_u32 v4, vcc, v4, v10
    v_addc_co_u32 v5, vcc, 0, v5, vcc
    ds_read_b64_tr_b16 v[84:85], v15 offset:40960
    ds_read_b64_tr_b16 v[86:87], v15 offset:43520
    ds_read_b128 v[40:43], v13 offset:34816
    ds_read_b128 v[44:47], v13 offset:35840
    v_mfma_f32_16x16x32_bf16 v[208:211], v[68:71], v[48:51], v[208:211]
    v_mfma_f32_16x16x32_bf16 v[212:215], v[68:71], v[52:55], v[212:215]
    v_mfma_f32_16x16x32_bf16 v[216:219], v[68:71], v[56:59], v[216:219]
    v_mfma_f32_16x16x32_bf16 v[220:223], v[68:71], v[60:63], v[220:223]
    s_add_u32 m0, s20, 28672
    s_nop 0
    global_load_lds_dwordx4 v[6:7], off
    v_add_co_u32 v6, vcc, v6, v11
    v_addc_co_u32 v7, vcc, 0, v7, vcc
    ds_read_b64_tr_b16 v[88:89], v16 offset:40960
    ds_read_b64_tr_b16 v[90:91], v16 offset:43520
    v_mfma_f32_16x16x32_bf16 v[224:227], v[72:75], v[48:51], v[224:227]
    v_mfma_f32_16x16x32_bf16 v[228:231], v[72:75], v[52:55], v[228:231]
    v_mfma_f32_16x16x32_bf16 v[232:235], v[72:75], v[56:59], v[232:235]
    v_mfma_f32_16x16x32_bf16 v[236:239], v[72:75], v[60:63], v[236:239]
    s_add_u32 m0, s21, 36864
    s_mov_b32 exec_hi, 0
    global_load_lds_dwordx4 v[8:9], off
    s_mov_b32 exec_hi, -1
    v_add_co_u32 v8, vcc, v8, v12
    v_addc_co_u32 v9, vcc, 0, v9, vcc
    ds_read_b64_tr_b16 v[92:93], v17 offset:40960
    ds_read_b64_tr_b16 v[94:95], v17 offset:43520
    v_mfma_f32_16x16x32_bf16 v[240:243], v[76:79], v[48:51], v[240:243]
    v_mfma_f32_16x16x32_bf16 v[244:247], v[76:79], v[52:55], v[244:247]
    v_mfma_f32_16x16x32_bf16 v[248:251], v[76:79], v[56:59], v[248:251]
    v_mfma_f32_16x16x32_bf16 v[252:255], v[76:79], v[60:63], v[252:255]
    ds_read_b64_tr_b16 v[64:65], v18 offset:40960
    ds_read_b64_tr_b16 v[66:67], v18 offset:43520
    ds_read_b64_tr_b16 v[68:69], v19 offset:40960
    ds_read_b64_tr_b16 v[70:71], v19 offset:43520
    s_waitcnt lgkmcnt(8)
    v_mfma_f32_16x16x32_bf16 v[96:99], v[80:83], v[32:35], v[96:99]
    v_mfma_f32_16x16x32_bf16 v[100:103], v[80:83], v[36:39], v[100:103]
    v_mfma_f32_16x16x32_bf16 v[104:107], v[80:83], v[40:43], v[104:107]
    v_mfma_f32_16x16x32_bf16 v[108:111], v[80:83], v[44:47], v[108:111]
    ds_read_b64_tr_b16 v[72:73], v20 offset:40960
    ds_read_b64_tr_b16 v[74:75], v20 offset:43520
    ds_read_b64_tr_b16 v[76:77], v21 offset:40960
    ds_read_b64_tr_b16 v[78:79], v21 offset:43520
    v_mfma_f32_16x16x32_bf16 v[112:115], v[84:87], v[32:35], v[112:115]
    v_mfma_f32_16x16x32_bf16 v[116:119], v[84:87], v[36:39], v[116:119]
    v_mfma_f32_16x16x32_bf16 v[120:123], v[84:87], v[40:43], v[120:123]
    v_mfma_f32_16x16x32_bf16 v[124:127], v[84:87], v[44:47], v[124:127]
    ds_read_b64_tr_b16 v[80:81], v22 offset:40960
    ds_read_b64_tr_b16 v[82:83], v22 offset:43520
    ds_read_b64_tr_b16 v[84:85], v23 offset:40960
    ds_read_b64_tr_b16 v[86:87], v23 offset:43520
    s_waitcnt lgkmcnt(14)
    v_mfma_f32_16x16x32_bf16 v[128:131], v[88:91], v[32:35], v[128:131]
    v_mfma_f32_16x16x32_bf16 v[132:135], v[88:91], v[36:39], v[132:135]
    v_mfma_f32_16x16x32_bf16 v[136:139], v[88:91], v[40:43], v[136:139]
    v_mfma_f32_16x16x32_bf16 v[140:143], v[88:91], v[44:47], v[140:143]
    s_waitcnt lgkmcnt(12)
    v_mfma_f32_16x16x32_bf16 v[144:147], v[92:95], v[32:35], v[144:147]
    v_mfma_f32_16x16x32_bf16 v[148:151], v[92:95], v[36:39], v[148:151]
    v_mfma_f32_16x16x32_bf16 v[152:155], v[92:95], v[40:43], v[152:155]
    v_mfma_f32_16x16x32_bf16 v[156:159], v[92:95], v[44:47], v[156:159]
    s_waitcnt lgkmcnt(10)
    v_mfma_f32_16x16x32_bf16 v[160:163], v[64:67], v[32:35], v[160:163]
    v_mfma_f32_16x16x32_bf16 v[164:167], v[64:67], v[36:39], v[164:167]
    v_mfma_f32_16x16x32_bf16 v[168:171], v[64:67], v[40:43], v[168:171]
    v_mfma_f32_16x16x32_bf16 v[172:175], v[64:67], v[44:47], v[172:175]
    s_waitcnt lgkmcnt(8)
    v_mfma_f32_16x16x32_bf16 v[176:179], v[68:71], v[32:35], v[176:179]
    v_mfma_f32_16x16x32_bf16 v[180:183], v[68:71], v[36:39], v[180:183]
    v_mfma_f32_16x16x32_bf16 v[184:187], v[68:71], v[40:43], v[184:187]
    v_mfma_f32_16x16x32_bf16 v[188:191], v[68:71], v[44:47], v[188:191]
    s_waitcnt vmcnt(10) lgkmcnt(0)
    s_barrier
    s_add_u32 m0, s19, 32128
    s_nop 0
    global_load_lds_dwordx4 v2, s[4:5] offset:640
    s_add_u32 m0, s19, 33152
    s_nop 0
    global_load_lds_dwordx4 v3, s[4:5] offset:640
    ds_read_b64_tr_b16 v[88:89], v14 offset:61440
    ds_read_b64_tr_b16 v[90:91], v14 offset:64000
    ds_read_b128 v[48:51], v13 offset:49152
    ds_read_b128 v[52:55], v13 offset:50176
    v_mfma_f32_16x16x32_bf16 v[192:195], v[72:75], v[32:35], v[192:195]
    v_mfma_f32_16x16x32_bf16 v[196:199], v[72:75], v[36:39], v[196:199]
    v_mfma_f32_16x16x32_bf16 v[200:203], v[72:75], v[40:43], v[200:203]
    v_mfma_f32_16x16x32_bf16 v[204:207], v[72:75], v[44:47], v[204:207]
    s_add_u32 m0, s20, 40960
    s_nop 0
    global_load_lds_dwordx4 v[4:5], off
    v_add_co_u32 v4, vcc, v4, v10
    v_addc_co_u32 v5, vcc, 0, v5, vcc
    ds_read_b64_tr_b16 v[92:93], v15 offset:61440
    ds_read_b64_tr_b16 v[94:95], v15 offset:64000
    ds_read_b128 v[56:59], v13 offset:51200
    ds_read_b128 v[60:63], v13 offset:52224
    v_mfma_f32_16x16x32_bf16 v[208:211], v[76:79], v[32:35], v[208:211]
    v_mfma_f32_16x16x32_bf16 v[212:215], v[76:79], v[36:39], v[212:215]
    v_mfma_f32_16x16x32_bf16 v[216:219], v[76:79], v[40:43], v[216:219]
    v_mfma_f32_16x16x32_bf16 v[220:223], v[76:79], v[44:47], v[220:223]
    s_add_u32 m0, s20, 49152
    s_nop 0
    global_load_lds_dwordx4 v[6:7], off
    v_add_co_u32 v6, vcc, v6, v11
    v_addc_co_u32 v7, vcc, 0, v7, vcc
    ds_read_b64_tr_b16 v[64:65], v16 offset:61440
    ds_read_b64_tr_b16 v[66:67], v16 offset:64000
    v_mfma_f32_16x16x32_bf16 v[224:227], v[80:83], v[32:35], v[224:227]
    v_mfma_f32_16x16x32_bf16 v[228:231], v[80:83], v[36:39], v[228:231]
    v_mfma_f32_16x16x32_bf16 v[232:235], v[80:83], v[40:43], v[232:235]
    v_mfma_f32_16x16x32_bf16 v[236:239], v[80:83], v[44:47], v[236:239]
    s_add_u32 m0, s21, 57344
    s_mov_b32 exec_hi, 0
    global_load_lds_dwordx4 v[8:9], off
    s_mov_b32 exec_hi, -1
    v_add_co_u32 v8, vcc, v8, v12
    v_addc_co_u32 v9, vcc, 0, v9, vcc
    ds_read_b64_tr_b16 v[68:69], v17 offset:61440
    ds_read_b64_tr_b16 v[70:71], v17 offset:64000
    v_mfma_f32_16x16x32_bf16 v[240:243], v[84:87], v[32:35], v[240:243]
    v_mfma_f32_16x16x32_bf16 v[244:247], v[84:87], v[36:39], v[244:247]
    v_mfma_f32_16x16x32_bf16 v[248:251], v[84:87], v[40:43], v[248:251]
    v_mfma_f32_16x16x32_bf16 v[252:255], v[84:87], v[44:47], v[252:255]
    ds_read_b64_tr_b16 v[72:73], v18 offset:61440
    ds_read_b64_tr_b16 v[74:75], v18 offset:64000
    ds_read_b64_tr_b16 v[76:77], v19 offset:61440
    ds_read_b64_tr_b16 v[78:79], v19 offset:64000
    s_waitcnt lgkmcnt(8)
    v_mfma_f32_16x16x32_bf16 v[96:99], v[88:91], v[48:51], v[96:99]
    v_mfma_f32_16x16x32_bf16 v[100:103], v[88:91], v[52:55], v[100:103]
    v_mfma_f32_16x16x32_bf16 v[104:107], v[88:91], v[56:59], v[104:107]
    v_mfma_f32_16x16x32_bf16 v[108:111], v[88:91], v[60:63], v[108:111]
    ds_read_b64_tr_b16 v[80:81], v20 offset:61440
    ds_read_b64_tr_b16 v[82:83], v20 offset:64000
    ds_read_b64_tr_b16 v[84:85], v21 offset:61440
    ds_read_b64_tr_b16 v[86:87], v21 offset:64000
    v_mfma_f32_16x16x32_bf16 v[112:115], v[92:95], v[48:51], v[112:115]
    v_mfma_f32_16x16x32_bf16 v[116:119], v[92:95], v[52:55], v[116:119]
    v_mfma_f32_16x16x32_bf16 v[120:123], v[92:95], v[56:59], v[120:123]
    v_mfma_f32_16x16x32_bf16 v[124:127], v[92:95], v[60:63], v[124:127]
    ds_read_b64_tr_b16 v[88:89], v22 offset:61440
    ds_read_b64_tr_b16 v[90:91], v22 offset:64000
    ds_read_b64_tr_b16 v[92:93], v23 offset:61440
    ds_read_b64_tr_b16 v[94:95], v23 offset:64000
    s_waitcnt lgkmcnt(14)
    v_mfma_f32_16x16x32_bf16 v[128:131], v[64:67], v[48:51], v[128:131]
    v_mfma_f32_16x16x32_bf16 v[132:135], v[64:67], v[52:55], v[132:135]
    v_mfma_f32_16x16x32_bf16 v[136:139], v[64:67], v[56:59], v[136:139]
    v_mfma_f32_16x16x32_bf16 v[140:143], v[64:67], v[60:63], v[140:143]
    s_waitcnt lgkmcnt(12)
    v_mfma_f32_16x16x32_bf16 v[144:147], v[68:71], v[48:51], v[144:147]
    v_mfma_f32_16x16x32_bf16 v[148:151], v[68:71], v[52:55], v[148:151]
    v_mfma_f32_16x16x32_bf16 v[152:155], v[68:71], v[56:59], v[152:155]
    v_mfma_f32_16x16x32_bf16 v[156:159], v[68:71], v[60:63], v[156:159]
    s_waitcnt lgkmcnt(10)
    v_mfma_f32_16x16x32_bf16 v[160:163], v[72:75], v[48:51], v[160:163]
    v_mfma_f32_16x16x32_bf16 v[164:167], v[72:75], v[52:55], v[164:167]
    v_mfma_f32_16x16x32_bf16 v[168:171], v[72:75], v[56:59], v[168:171]
    v_mfma_f32_16x16x32_bf16 v[172:175], v[72:75], v[60:63], v[172:175]
    s_waitcnt lgkmcnt(8)
    v_mfma_f32_16x16x32_bf16 v[176:179], v[76:79], v[48:51], v[176:179]
    v_mfma_f32_16x16x32_bf16 v[180:183], v[76:79], v[52:55], v[180:183]
    v_mfma_f32_16x16x32_bf16 v[184:187], v[76:79], v[56:59], v[184:187]
    v_mfma_f32_16x16x32_bf16 v[188:191], v[76:79], v[60:63], v[188:191]
    s_waitcnt vmcnt(10) lgkmcnt(0)
    s_barrier
    s_add_u32 m0, s19, 48448
    s_nop 0
    global_load_lds_dwordx4 v2, s[4:5] offset:704
    s_add_u32 m0, s19, 49472
    s_nop 0
    global_load_lds_dwordx4 v3, s[4:5] offset:704
    ds_read_b64_tr_b16 v[64:65], v14 offset:0
    ds_read_b64_tr_b16 v[66:67], v14 offset:2560
    ds_read_b128 v[32:35], v13 offset:0
    ds_read_b128 v[36:39], v13 offset:1024
    v_mfma_f32_16x16x32_bf16 v[192:195], v[80:83], v[48:51], v[192:195]
    v_mfma_f32_16x16x32_bf16 v[196:199], v[80:83], v[52:55], v[196:199]
    v_mfma_f32_16x16x32_bf16 v[200:203], v[80:83], v[56:59], v[200:203]
    v_mfma_f32_16x16x32_bf16 v[204:207], v[80:83], v[60:63], v[204:207]
    s_add_u32 m0, s20, 61440
    s_nop 0
    global_load_lds_dwordx4 v[4:5], off
    v_add_co_u32 v4, vcc, v4, v10
    v_addc_co_u32 v5, vcc, 0, v5, vcc
    ds_read_b64_tr_b16 v[68:69], v15 offset:0
    ds_read_b64_tr_b16 v[70:71], v15 offset:2560
    ds_read_b128 v[40:43], v13 offset:2048
    ds_read_b128 v[44:47], v13 offset:3072
    v_mfma_f32_16x16x32_bf16 v[208:211], v[84:87], v[48:51], v[208:211]
    v_mfma_f32_16x16x32_bf16 v[212:215], v[84:87], v[52:55], v[212:215]
    v_mfma_f32_16x16x32_bf16 v[216:219], v[84:87], v[56:59], v[216:219]
    v_mfma_f32_16x16x32_bf16 v[220:223], v[84:87], v[60:63], v[220:223]
    s_add_u32 m0, s20, 69632
    s_nop 0
    global_load_lds_dwordx4 v[6:7], off
    v_add_co_u32 v6, vcc, v6, v11
    v_addc_co_u32 v7, vcc, 0, v7, vcc
    ds_read_b64_tr_b16 v[72:73], v16 offset:0
    ds_read_b64_tr_b16 v[74:75], v16 offset:2560
    v_mfma_f32_16x16x32_bf16 v[224:227], v[88:91], v[48:51], v[224:227]
    v_mfma_f32_16x16x32_bf16 v[228:231], v[88:91], v[52:55], v[228:231]
    v_mfma_f32_16x16x32_bf16 v[232:235], v[88:91], v[56:59], v[232:235]
    v_mfma_f32_16x16x32_bf16 v[236:239], v[88:91], v[60:63], v[236:239]
    s_add_u32 m0, s21, 77824
    s_mov_b32 exec_hi, 0
    global_load_lds_dwordx4 v[8:9], off
    s_mov_b32 exec_hi, -1
    v_add_co_u32 v8, vcc, v8, v12
    v_addc_co_u32 v9, vcc, 0, v9, vcc
    ds_read_b64_tr_b16 v[76:77], v17 offset:0
    ds_read_b64_tr_b16 v[78:79], v17 offset:2560
    v_mfma_f32_16x16x32_bf16 v[240:243], v[92:95], v[48:51], v[240:243]
    v_mfma_f32_16x16x32_bf16 v[244:247], v[92:95], v[52:55], v[244:247]
    v_mfma_f32_16x16x32_bf16 v[248:251], v[92:95], v[56:59], v[248:251]
    v_mfma_f32_16x16x32_bf16 v[252:255], v[92:95], v[60:63], v[252:255]
    ds_read_b64_tr_b16 v[80:81], v18 offset:0
    ds_read_b64_tr_b16 v[82:83], v18 offset:2560
    ds_read_b64_tr_b16 v[84:85], v19 offset:0
    ds_read_b64_tr_b16 v[86:87], v19 offset:2560
    s_waitcnt lgkmcnt(8)
    v_mfma_f32_16x16x32_bf16 v[96:99], v[64:67], v[32:35], v[96:99]
    v_mfma_f32_16x16x32_bf16 v[100:103], v[64:67], v[36:39], v[100:103]
    v_mfma_f32_16x16x32_bf16 v[104:107], v[64:67], v[40:43], v[104:107]
    v_mfma_f32_16x16x32_bf16 v[108:111], v[64:67], v[44:47], v[108:111]
    ds_read_b64_tr_b16 v[88:89], v20 offset:0
    ds_read_b64_tr_b16 v[90:91], v20 offset:2560
    ds_read_b64_tr_b16 v[92:93], v21 offset:0
    ds_read_b64_tr_b16 v[94:95], v21 offset:2560
    v_mfma_f32_16x16x32_bf16 v[112:115], v[68:71], v[32:35], v[112:115]
    v_mfma_f32_16x16x32_bf16 v[116:119], v[68:71], v[36:39], v[116:119]
    v_mfma_f32_16x16x32_bf16 v[120:123], v[68:71], v[40:43], v[120:123]
    v_mfma_f32_16x16x32_bf16 v[124:127], v[68:71], v[44:47], v[124:127]
    ds_read_b64_tr_b16 v[64:65], v22 offset:0
    ds_read_b64_tr_b16 v[66:67], v22 offset:2560
    ds_read_b64_tr_b16 v[68:69], v23 offset:0
    ds_read_b64_tr_b16 v[70:71], v23 offset:2560
    s_waitcnt lgkmcnt(14)
    v_mfma_f32_16x16x32_bf16 v[128:131], v[72:75], v[32:35], v[128:131]
    v_mfma_f32_16x16x32_bf16 v[132:135], v[72:75], v[36:39], v[132:135]
    v_mfma_f32_16x16x32_bf16 v[136:139], v[72:75], v[40:43], v[136:139]
    v_mfma_f32_16x16x32_bf16 v[140:143], v[72:75], v[44:47], v[140:143]
    s_waitcnt lgkmcnt(12)
    v_mfma_f32_16x16x32_bf16 v[144:147], v[76:79], v[32:35], v[144:147]
    v_mfma_f32_16x16x32_bf16 v[148:151], v[76:79], v[36:39], v[148:151]
    v_mfma_f32_16x16x32_bf16 v[152:155], v[76:79], v[40:43], v[152:155]
    v_mfma_f32_16x16x32_bf16 v[156:159], v[76:79], v[44:47], v[156:159]
    s_waitcnt lgkmcnt(10)
    v_mfma_f32_16x16x32_bf16 v[160:163], v[80:83], v[32:35], v[160:163]
    v_mfma_f32_16x16x32_bf16 v[164:167], v[80:83], v[36:39], v[164:167]
    v_mfma_f32_16x16x32_bf16 v[168:171], v[80:83], v[40:43], v[168:171]
    v_mfma_f32_16x16x32_bf16 v[172:175], v[80:83], v[44:47], v[172:175]
    s_waitcnt lgkmcnt(8)
    v_mfma_f32_16x16x32_bf16 v[176:179], v[84:87], v[32:35], v[176:179]
    v_mfma_f32_16x16x32_bf16 v[180:183], v[84:87], v[36:39], v[180:183]
    v_mfma_f32_16x16x32_bf16 v[184:187], v[84:87], v[40:43], v[184:187]
    v_mfma_f32_16x16x32_bf16 v[188:191], v[84:87], v[44:47], v[188:191]
    s_waitcnt vmcnt(10) lgkmcnt(0)
    s_barrier
    s_add_u32 m0, s19, -768
    s_nop 0
    global_load_lds_dwordx4 v2, s[4:5] offset:768
    s_add_u32 m0, s19, 256
    s_nop 0
    global_load_lds_dwordx4 v3, s[4:5] offset:768
    ds_read_b64_tr_b16 v[72:73], v14 offset:20480
    ds_read_b64_tr_b16 v[74:75], v14 offset:23040
    ds_read_b128 v[48:51], v13 offset:16384
    ds_read_b128 v[52:55], v13 offset:17408
    v_mfma_f32_16x16x32_bf16 v[192:195], v[88:91], v[32:35], v[192:195]
    v_mfma_f32_16x16x32_bf16 v[196:199], v[88:91], v[36:39], v[196:199]
    v_mfma_f32_16x16x32_bf16 v[200:203], v[88:91], v[40:43], v[200:203]
    v_mfma_f32_16x16x32_bf16 v[204:207], v[88:91], v[44:47], v[204:207]
    s_add_u32 m0, s20, 0
    s_nop 0
    global_load_lds_dwordx4 v[4:5], off
    v_add_co_u32 v4, vcc, v4, v10
    v_addc_co_u32 v5, vcc, 0, v5, vcc
    ds_read_b64_tr_b16 v[76:77], v15 offset:20480
    ds_read_b64_tr_b16 v[78:79], v15 offset:23040
    ds_read_b128 v[56:59], v13 offset:18432
    ds_read_b128 v[60:63], v13 offset:19456
    v_mfma_f32_16x16x32_bf16 v[208:211], v[92:95], v[32:35], v[208:211]
    v_mfma_f32_16x16x32_bf16 v[212:215], v[92:95], v[36:39], v[212:215]
    v_mfma_f32_16x16x32_bf16 v[216:219], v[92:95], v[40:43], v[216:219]
    v_mfma_f32_16x16x32_bf16 v[220:223], v[92:95], v[44:47], v[220:223]
    s_add_u32 m0, s20, 8192
    s_nop 0
    global_load_lds_dwordx4 v[6:7], off
    v_add_co_u32 v6, vcc, v6, v11
    v_addc_co_u32 v7, vcc, 0, v7, vcc
    ds_read_b64_tr_b16 v[80:81], v16 offset:20480
    ds_read_b64_tr_b16 v[82:83], v16 offset:23040
    v_mfma_f32_16x16x32_bf16 v[224:227], v[64:67], v[32:35], v[224:227]
    v_mfma_f32_16x16x32_bf16 v[228:231], v[64:67], v[36:39], v[228:231]
    v_mfma_f32_16x16x32_bf16 v[232:235], v[64:67], v[40:43], v[232:235]
    v_mfma_f32_16x16x32_bf16 v[236:239], v[64:67], v[44:47], v[236:239]
    s_add_u32 m0, s21, 16384
    s_mov_b32 exec_hi, 0
    global_load_lds_dwordx4 v[8:9], off
    s_mov_b32 exec_hi, -1
    v_add_co_u32 v8, vcc, v8, v12
    v_addc_co_u32 v9, vcc, 0, v9, vcc
    ds_read_b64_tr_b16 v[84:85], v17 offset:20480
    ds_read_b64_tr_b16 v[86:87], v17 offset:23040
    v_mfma_f32_16x16x32_bf16 v[240:243], v[68:71], v[32:35], v[240:243]
    v_mfma_f32_16x16x32_bf16 v[244:247], v[68:71], v[36:39], v[244:247]
    v_mfma_f32_16x16x32_bf16 v[248:251], v[68:71], v[40:43], v[248:251]
    v_mfma_f32_16x16x32_bf16 v[252:255], v[68:71], v[44:47], v[252:255]
    ds_read_b64_tr_b16 v[88:89], v18 offset:20480
    ds_read_b64_tr_b16 v[90:91], v18 offset:23040
    ds_read_b64_tr_b16 v[92:93], v19 offset:20480
    ds_read_b64_tr_b16 v[94:95], v19 offset:23040
    s_waitcnt lgkmcnt(8)
    v_mfma_f32_16x16x32_bf16 v[96:99], v[72:75], v[48:51], v[96:99]
    v_mfma_f32_16x16x32_bf16 v[100:103], v[72:75], v[52:55], v[100:103]
    v_mfma_f32_16x16x32_bf16 v[104:107], v[72:75], v[56:59], v[104:107]
    v_mfma_f32_16x16x32_bf16 v[108:111], v[72:75], v[60:63], v[108:111]
    ds_read_b64_tr_b16 v[64:65], v20 offset:20480
    ds_read_b64_tr_b16 v[66:67], v20 offset:23040
    ds_read_b64_tr_b16 v[68:69], v21 offset:20480
    ds_read_b64_tr_b16 v[70:71], v21 offset:23040
    v_mfma_f32_16x16x32_bf16 v[112:115], v[76:79], v[48:51], v[112:115]
    v_mfma_f32_16x16x32_bf16 v[116:119], v[76:79], v[52:55], v[116:119]
    v_mfma_f32_16x16x32_bf16 v[120:123], v[76:79], v[56:59], v[120:123]
    v_mfma_f32_16x16x32_bf16 v[124:127], v[76:79], v[60:63], v[124:127]
    ds_read_b64_tr_b16 v[72:73], v22 offset:20480
    ds_read_b64_tr_b16 v[74:75], v22 offset:23040
    ds_read_b64_tr_b16 v[76:77], v23 offset:20480
    ds_read_b64_tr_b16 v[78:79], v23 offset:23040
    s_waitcnt lgkmcnt(14)
    v_mfma_f32_16x16x32_bf16 v[128:131], v[80:83], v[48:51], v[128:131]
    v_mfma_f32_16x16x32_bf16 v[132:135], v[80:83], v[52:55], v[132:135]
    v_mfma_f32_16x16x32_bf16 v[136:139], v[80:83], v[56:59], v[136:139]
    v_mfma_f32_16x16x32_bf16 v[140:143], v[80:83], v[60:63], v[140:143]
    s_waitcnt lgkmcnt(12)
    v_mfma_f32_16x16x32_bf16 v[144:147], v[84:87], v[48:51], v[144:147]
    v_mfma_f32_16x16x32_bf16 v[148:151], v[84:87], v[52:55], v[148:151]
    v_mfma_f32_16x16x32_bf16 v[152:155], v[84:87], v[56:59], v[152:155]
    v_mfma_f32_16x16x32_bf16 v[156:159], v[84:87], v[60:63], v[156:159]
    s_waitcnt lgkmcnt(10)
    v_mfma_f32_16x16x32_bf16 v[160:163], v[88:91], v[48:51], v[160:163]
    v_mfma_f32_16x16x32_bf16 v[164:167], v[88:91], v[52:55], v[164:167]
    v_mfma_f32_16x16x32_bf16 v[168:171], v[88:91], v[56:59], v[168:171]
    v_mfma_f32_16x16x32_bf16 v[172:175], v[88:91], v[60:63], v[172:175]
    s_waitcnt lgkmcnt(8)
    v_mfma_f32_16x16x32_bf16 v[176:179], v[92:95], v[48:51], v[176:179]
    v_mfma_f32_16x16x32_bf16 v[180:183], v[92:95], v[52:55], v[180:183]
    v_mfma_f32_16x16x32_bf16 v[184:187], v[92:95], v[56:59], v[184:187]
    v_mfma_f32_16x16x32_bf16 v[188:191], v[92:95], v[60:63], v[188:191]
    s_waitcnt vmcnt(10) lgkmcnt(0)
    s_barrier
    s_add_u32 m0, s19, 15552
    s_nop 0
    global_load_lds_dwordx4 v2, s[4:5] offset:832
    s_add_u32 m0, s19, 16576
    s_nop 0
    global_load_lds_dwordx4 v3, s[4:5] offset:832
    ds_read_b64_tr_b16 v[80:81], v14 offset:40960
    ds_read_b64_tr_b16 v[82:83], v14 offset:43520
    ds_read_b128 v[32:35], v13 offset:32768
    ds_read_b128 v[36:39], v13 offset:33792
    v_mfma_f32_16x16x32_bf16 v[192:195], v[64:67], v[48:51], v[192:195]
    v_mfma_f32_16x16x32_bf16 v[196:199], v[64:67], v[52:55], v[196:199]
    v_mfma_f32_16x16x32_bf16 v[200:203], v[64:67], v[56:59], v[200:203]
    v_mfma_f32_16x16x32_bf16 v[204:207], v[64:67], v[60:63], v[204:207]
    s_add_u32 m0, s20, 20480
    s_nop 0
    global_load_lds_dwordx4 v[4:5], off
    v_add_co_u32 v4, vcc, v4, v10
    v_addc_co_u32 v5, vcc, 0, v5, vcc
    ds_read_b64_tr_b16 v[84:85], v15 offset:40960
    ds_read_b64_tr_b16 v[86:87], v15 offset:43520
    ds_read_b128 v[40:43], v13 offset:34816
    ds_read_b128 v[44:47], v13 offset:35840
    v_mfma_f32_16x16x32_bf16 v[208:211], v[68:71], v[48:51], v[208:211]
    v_mfma_f32_16x16x32_bf16 v[212:215], v[68:71], v[52:55], v[212:215]
    v_mfma_f32_16x16x32_bf16 v[216:219], v[68:71], v[56:59], v[216:219]
    v_mfma_f32_16x16x32_bf16 v[220:223], v[68:71], v[60:63], v[220:223]
    s_add_u32 m0, s20, 28672
    s_nop 0
    global_load_lds_dwordx4 v[6:7], off
    v_add_co_u32 v6, vcc, v6, v11
    v_addc_co_u32 v7, vcc, 0, v7, vcc
    ds_read_b64_tr_b16 v[88:89], v16 offset:40960
    ds_read_b64_tr_b16 v[90:91], v16 offset:43520
    v_mfma_f32_16x16x32_bf16 v[224:227], v[72:75], v[48:51], v[224:227]
    v_mfma_f32_16x16x32_bf16 v[228:231], v[72:75], v[52:55], v[228:231]
    v_mfma_f32_16x16x32_bf16 v[232:235], v[72:75], v[56:59], v[232:235]
    v_mfma_f32_16x16x32_bf16 v[236:239], v[72:75], v[60:63], v[236:239]
    s_add_u32 m0, s21, 36864
    s_mov_b32 exec_hi, 0
    global_load_lds_dwordx4 v[8:9], off
    s_mov_b32 exec_hi, -1
    v_add_co_u32 v8, vcc, v8, v12
    v_addc_co_u32 v9, vcc, 0, v9, vcc
    ds_read_b64_tr_b16 v[92:93], v17 offset:40960
    ds_read_b64_tr_b16 v[94:95], v17 offset:43520
    v_mfma_f32_16x16x32_bf16 v[240:243], v[76:79], v[48:51], v[240:243]
    v_mfma_f32_16x16x32_bf16 v[244:247], v[76:79], v[52:55], v[244:247]
    v_mfma_f32_16x16x32_bf16 v[248:251], v[76:79], v[56:59], v[248:251]
    v_mfma_f32_16x16x32_bf16 v[252:255], v[76:79], v[60:63], v[252:255]
    ds_read_b64_tr_b16 v[64:65], v18 offset:40960
    ds_read_b64_tr_b16 v[66:67], v18 offset:43520
    ds_read_b64_tr_b16 v[68:69], v19 offset:40960
    ds_read_b64_tr_b16 v[70:71], v19 offset:43520
    s_waitcnt lgkmcnt(8)
    v_mfma_f32_16x16x32_bf16 v[96:99], v[80:83], v[32:35], v[96:99]
    v_mfma_f32_16x16x32_bf16 v[100:103], v[80:83], v[36:39], v[100:103]
    v_mfma_f32_16x16x32_bf16 v[104:107], v[80:83], v[40:43], v[104:107]
    v_mfma_f32_16x16x32_bf16 v[108:111], v[80:83], v[44:47], v[108:111]
    ds_read_b64_tr_b16 v[72:73], v20 offset:40960
    ds_read_b64_tr_b16 v[74:75], v20 offset:43520
    ds_read_b64_tr_b16 v[76:77], v21 offset:40960
    ds_read_b64_tr_b16 v[78:79], v21 offset:43520
    v_mfma_f32_16x16x32_bf16 v[112:115], v[84:87], v[32:35], v[112:115]
    v_mfma_f32_16x16x32_bf16 v[116:119], v[84:87], v[36:39], v[116:119]
    v_mfma_f32_16x16x32_bf16 v[120:123], v[84:87], v[40:43], v[120:123]
    v_mfma_f32_16x16x32_bf16 v[124:127], v[84:87], v[44:47], v[124:127]
    ds_read_b64_tr_b16 v[80:81], v22 offset:40960
    ds_read_b64_tr_b16 v[82:83], v22 offset:43520
    ds_read_b64_tr_b16 v[84:85], v23 offset:40960
    ds_read_b64_tr_b16 v[86:87], v23 offset:43520
    s_waitcnt lgkmcnt(14)
    v_mfma_f32_16x16x32_bf16 v[128:131], v[88:91], v[32:35], v[128:131]
    v_mfma_f32_16x16x32_bf16 v[132:135], v[88:91], v[36:39], v[132:135]
    v_mfma_f32_16x16x32_bf16 v[136:139], v[88:91], v[40:43], v[136:139]
    v_mfma_f32_16x16x32_bf16 v[140:143], v[88:91], v[44:47], v[140:143]
    s_waitcnt lgkmcnt(12)
    v_mfma_f32_16x16x32_bf16 v[144:147], v[92:95], v[32:35], v[144:147]
    v_mfma_f32_16x16x32_bf16 v[148:151], v[92:95], v[36:39], v[148:151]
    v_mfma_f32_16x16x32_bf16 v[152:155], v[92:95], v[40:43], v[152:155]
    v_mfma_f32_16x16x32_bf16 v[156:159], v[92:95], v[44:47], v[156:159]
    s_waitcnt lgkmcnt(10)
    v_mfma_f32_16x16x32_bf16 v[160:163], v[64:67], v[32:35], v[160:163]
    v_mfma_f32_16x16x32_bf16 v[164:167], v[64:67], v[36:39], v[164:167]
    v_mfma_f32_16x16x32_bf16 v[168:171], v[64:67], v[40:43], v[168:171]
    v_mfma_f32_16x16x32_bf16 v[172:175], v[64:67], v[44:47], v[172:175]
    s_waitcnt lgkmcnt(8)
    v_mfma_f32_16x16x32_bf16 v[176:179], v[68:71], v[32:35], v[176:179]
    v_mfma_f32_16x16x32_bf16 v[180:183], v[68:71], v[36:39], v[180:183]
    v_mfma_f32_16x16x32_bf16 v[184:187], v[68:71], v[40:43], v[184:187]
    v_mfma_f32_16x16x32_bf16 v[188:191], v[68:71], v[44:47], v[188:191]
    s_waitcnt vmcnt(10) lgkmcnt(0)
    s_barrier
    s_add_u32 m0, s19, 31872
    s_nop 0
    global_load_lds_dwordx4 v2, s[4:5] offset:896
    s_add_u32 m0, s19, 32896
    s_nop 0
    global_load_lds_dwordx4 v3, s[4:5] offset:896
    ds_read_b64_tr_b16 v[88:89], v14 offset:61440
    ds_read_b64_tr_b16 v[90:91], v14 offset:64000
    ds_read_b128 v[48:51], v13 offset:49152
    ds_read_b128 v[52:55], v13 offset:50176
    v_mfma_f32_16x16x32_bf16 v[192:195], v[72:75], v[32:35], v[192:195]
    v_mfma_f32_16x16x32_bf16 v[196:199], v[72:75], v[36:39], v[196:199]
    v_mfma_f32_16x16x32_bf16 v[200:203], v[72:75], v[40:43], v[200:203]
    v_mfma_f32_16x16x32_bf16 v[204:207], v[72:75], v[44:47], v[204:207]
    s_add_u32 m0, s20, 40960
    s_nop 0
    global_load_lds_dwordx4 v[4:5], off
    v_add_co_u32 v4, vcc, v4, v10
    v_addc_co_u32 v5, vcc, 0, v5, vcc
    ds_read_b64_tr_b16 v[92:93], v15 offset:61440
    ds_read_b64_tr_b16 v[94:95], v15 offset:64000
    ds_read_b128 v[56:59], v13 offset:51200
    ds_read_b128 v[60:63], v13 offset:52224
    v_mfma_f32_16x16x32_bf16 v[208:211], v[76:79], v[32:35], v[208:211]
    v_mfma_f32_16x16x32_bf16 v[212:215], v[76:79], v[36:39], v[212:215]
    v_mfma_f32_16x16x32_bf16 v[216:219], v[76:79], v[40:43], v[216:219]
    v_mfma_f32_16x16x32_bf16 v[220:223], v[76:79], v[44:47], v[220:223]
    s_add_u32 m0, s20, 49152
    s_nop 0
    global_load_lds_dwordx4 v[6:7], off
    v_add_co_u32 v6, vcc, v6, v11
    v_addc_co_u32 v7, vcc, 0, v7, vcc
    ds_read_b64_tr_b16 v[64:65], v16 offset:61440
    ds_read_b64_tr_b16 v[66:67], v16 offset:64000
    v_mfma_f32_16x16x32_bf16 v[224:227], v[80:83], v[32:35], v[224:227]
    v_mfma_f32_16x16x32_bf16 v[228:231], v[80:83], v[36:39], v[228:231]
    v_mfma_f32_16x16x32_bf16 v[232:235], v[80:83], v[40:43], v[232:235]
    v_mfma_f32_16x16x32_bf16 v[236:239], v[80:83], v[44:47], v[236:239]
    s_add_u32 m0, s21, 57344
    s_mov_b32 exec_hi, 0
    global_load_lds_dwordx4 v[8:9], off
    s_mov_b32 exec_hi, -1
    v_add_co_u32 v8, vcc, v8, v12
    v_addc_co_u32 v9, vcc, 0, v9, vcc
    ds_read_b64_tr_b16 v[68:69], v17 offset:61440
    ds_read_b64_tr_b16 v[70:71], v17 offset:64000
    v_mfma_f32_16x16x32_bf16 v[240:243], v[84:87], v[32:35], v[240:243]
    v_mfma_f32_16x16x32_bf16 v[244:247], v[84:87], v[36:39], v[244:247]
    v_mfma_f32_16x16x32_bf16 v[248:251], v[84:87], v[40:43], v[248:251]
    v_mfma_f32_16x16x32_bf16 v[252:255], v[84:87], v[44:47], v[252:255]
    ds_read_b64_tr_b16 v[72:73], v18 offset:61440
    ds_read_b64_tr_b16 v[74:75], v18 offset:64000
    ds_read_b64_tr_b16 v[76:77], v19 offset:61440
    ds_read_b64_tr_b16 v[78:79], v19 offset:64000
    s_waitcnt lgkmcnt(8)
    v_mfma_f32_16x16x32_bf16 v[96:99], v[88:91], v[48:51], v[96:99]
    v_mfma_f32_16x16x32_bf16 v[100:103], v[88:91], v[52:55], v[100:103]
    v_mfma_f32_16x16x32_bf16 v[104:107], v[88:91], v[56:59], v[104:107]
    v_mfma_f32_16x16x32_bf16 v[108:111], v[88:91], v[60:63], v[108:111]
    ds_read_b64_tr_b16 v[80:81], v20 offset:61440
    ds_read_b64_tr_b16 v[82:83], v20 offset:64000
    ds_read_b64_tr_b16 v[84:85], v21 offset:61440
    ds_read_b64_tr_b16 v[86:87], v21 offset:64000
    v_mfma_f32_16x16x32_bf16 v[112:115], v[92:95], v[48:51], v[112:115]
    v_mfma_f32_16x16x32_bf16 v[116:119], v[92:95], v[52:55], v[116:119]
    v_mfma_f32_16x16x32_bf16 v[120:123], v[92:95], v[56:59], v[120:123]
    v_mfma_f32_16x16x32_bf16 v[124:127], v[92:95], v[60:63], v[124:127]
    ds_read_b64_tr_b16 v[88:89], v22 offset:61440
    ds_read_b64_tr_b16 v[90:91], v22 offset:64000
    ds_read_b64_tr_b16 v[92:93], v23 offset:61440
    ds_read_b64_tr_b16 v[94:95], v23 offset:64000
    s_waitcnt lgkmcnt(14)
    v_mfma_f32_16x16x32_bf16 v[128:131], v[64:67], v[48:51], v[128:131]
    v_mfma_f32_16x16x32_bf16 v[132:135], v[64:67], v[52:55], v[132:135]
    v_mfma_f32_16x16x32_bf16 v[136:139], v[64:67], v[56:59], v[136:139]
    v_mfma_f32_16x16x32_bf16 v[140:143], v[64:67], v[60:63], v[140:143]
    s_waitcnt lgkmcnt(12)
    v_mfma_f32_16x16x32_bf16 v[144:147], v[68:71], v[48:51], v[144:147]
    v_mfma_f32_16x16x32_bf16 v[148:151], v[68:71], v[52:55], v[148:151]
    v_mfma_f32_16x16x32_bf16 v[152:155], v[68:71], v[56:59], v[152:155]
    v_mfma_f32_16x16x32_bf16 v[156:159], v[68:71], v[60:63], v[156:159]
    s_waitcnt lgkmcnt(10)
    v_mfma_f32_16x16x32_bf16 v[160:163], v[72:75], v[48:51], v[160:163]
    v_mfma_f32_16x16x32_bf16 v[164:167], v[72:75], v[52:55], v[164:167]
    v_mfma_f32_16x16x32_bf16 v[168:171], v[72:75], v[56:59], v[168:171]
    v_mfma_f32_16x16x32_bf16 v[172:175], v[72:75], v[60:63], v[172:175]
    s_waitcnt lgkmcnt(8)
    v_mfma_f32_16x16x32_bf16 v[176:179], v[76:79], v[48:51], v[176:179]
    v_mfma_f32_16x16x32_bf16 v[180:183], v[76:79], v[52:55], v[180:183]
    v_mfma_f32_16x16x32_bf16 v[184:187], v[76:79], v[56:59], v[184:187]
    v_mfma_f32_16x16x32_bf16 v[188:191], v[76:79], v[60:63], v[188:191]
    s_waitcnt vmcnt(10) lgkmcnt(0)
    s_barrier
    s_add_u32 m0, s19, 48192
    s_nop 0
    global_load_lds_dwordx4 v2, s[4:5] offset:960
    s_add_u32 m0, s19, 49216
    s_nop 0
    global_load_lds_dwordx4 v3, s[4:5] offset:960
    ds_read_b64_tr_b16 v[64:65], v14 offset:0
    ds_read_b64_tr_b16 v[66:67], v14 offset:2560
    ds_read_b128 v[32:35], v13 offset:0
    ds_read_b128 v[36:39], v13 offset:1024
    v_mfma_f32_16x16x32_bf16 v[192:195], v[80:83], v[48:51], v[192:195]
    v_mfma_f32_16x16x32_bf16 v[196:199], v[80:83], v[52:55], v[196:199]
    v_mfma_f32_16x16x32_bf16 v[200:203], v[80:83], v[56:59], v[200:203]
    v_mfma_f32_16x16x32_bf16 v[204:207], v[80:83], v[60:63], v[204:207]
    s_add_u32 m0, s20, 61440
    s_nop 0
    global_load_lds_dwordx4 v[4:5], off
    v_add_co_u32 v4, vcc, v4, v10
    v_addc_co_u32 v5, vcc, 0, v5, vcc
    ds_read_b64_tr_b16 v[68:69], v15 offset:0
    ds_read_b64_tr_b16 v[70:71], v15 offset:2560
    ds_read_b128 v[40:43], v13 offset:2048
    ds_read_b128 v[44:47], v13 offset:3072
    v_mfma_f32_16x16x32_bf16 v[208:211], v[84:87], v[48:51], v[208:211]
    v_mfma_f32_16x16x32_bf16 v[212:215], v[84:87], v[52:55], v[212:215]
    v_mfma_f32_16x16x32_bf16 v[216:219], v[84:87], v[56:59], v[216:219]
    v_mfma_f32_16x16x32_bf16 v[220:223], v[84:87], v[60:63], v[220:223]
    s_add_u32 m0, s20, 69632
    s_nop 0
    global_load_lds_dwordx4 v[6:7], off
    v_add_co_u32 v6, vcc, v6, v11
    v_addc_co_u32 v7, vcc, 0, v7, vcc
    ds_read_b64_tr_b16 v[72:73], v16 offset:0
    ds_read_b64_tr_b16 v[74:75], v16 offset:2560
    v_mfma_f32_16x16x32_bf16 v[224:227], v[88:91], v[48:51], v[224:227]
    v_mfma_f32_16x16x32_bf16 v[228:231], v[88:91], v[52:55], v[228:231]
    v_mfma_f32_16x16x32_bf16 v[232:235], v[88:91], v[56:59], v[232:235]
    v_mfma_f32_16x16x32_bf16 v[236:239], v[88:91], v[60:63], v[236:239]
    s_add_u32 m0, s21, 77824
    s_mov_b32 exec_hi, 0
    global_load_lds_dwordx4 v[8:9], off
    s_mov_b32 exec_hi, -1
    v_add_co_u32 v8, vcc, v8, v12
    v_addc_co_u32 v9, vcc, 0, v9, vcc
    ds_read_b64_tr_b16 v[76:77], v17 offset:0
    ds_read_b64_tr_b16 v[78:79], v17 offset:2560
    v_mfma_f32_16x16x32_bf16 v[240:243], v[92:95], v[48:51], v[240:243]
    v_mfma_f32_16x16x32_bf16 v[244:247], v[92:95], v[52:55], v[244:247]
    v_mfma_f32_16x16x32_bf16 v[248:251], v[92:95], v[56:59], v[248:251]
    v_mfma_f32_16x16x32_bf16 v[252:255], v[92:95], v[60:63], v[252:255]
    ds_read_b64_tr_b16 v[80:81], v18 offset:0
    ds_read_b64_tr_b16 v[82:83], v18 offset:2560
    ds_read_b64_tr_b16 v[84:85], v19 offset:0
    ds_read_b64_tr_b16 v[86:87], v19 offset:2560
    s_waitcnt lgkmcnt(8)
    v_mfma_f32_16x16x32_bf16 v[96:99], v[64:67], v[32:35], v[96:99]
    v_mfma_f32_16x16x32_bf16 v[100:103], v[64:67], v[36:39], v[100:103]
    v_mfma_f32_16x16x32_bf16 v[104:107], v[64:67], v[40:43], v[104:107]
    v_mfma_f32_16x16x32_bf16 v[108:111], v[64:67], v[44:47], v[108:111]
    ds_read_b64_tr_b16 v[88:89], v20 offset:0
    ds_read_b64_tr_b16 v[90:91], v20 offset:2560
    ds_read_b64_tr_b16 v[92:93], v21 offset:0
    ds_read_b64_tr_b16 v[94:95], v21 offset:2560
    v_mfma_f32_16x16x32_bf16 v[112:115], v[68:71], v[32:35], v[112:115]
    v_mfma_f32_16x16x32_bf16 v[116:119], v[68:71], v[36:39], v[116:119]
    v_mfma_f32_16x16x32_bf16 v[120:123], v[68:71], v[40:43], v[120:123]
    v_mfma_f32_16x16x32_bf16 v[124:127], v[68:71], v[44:47], v[124:127]
    ds_read_b64_tr_b16 v[64:65], v22 offset:0
    ds_read_b64_tr_b16 v[66:67], v22 offset:2560
    ds_read_b64_tr_b16 v[68:69], v23 offset:0
    ds_read_b64_tr_b16 v[70:71], v23 offset:2560
    s_waitcnt lgkmcnt(14)
    v_mfma_f32_16x16x32_bf16 v[128:131], v[72:75], v[32:35], v[128:131]
    v_mfma_f32_16x16x32_bf16 v[132:135], v[72:75], v[36:39], v[132:135]
    v_mfma_f32_16x16x32_bf16 v[136:139], v[72:75], v[40:43], v[136:139]
    v_mfma_f32_16x16x32_bf16 v[140:143], v[72:75], v[44:47], v[140:143]
    s_waitcnt lgkmcnt(12)
    v_mfma_f32_16x16x32_bf16 v[144:147], v[76:79], v[32:35], v[144:147]
    v_mfma_f32_16x16x32_bf16 v[148:151], v[76:79], v[36:39], v[148:151]
    v_mfma_f32_16x16x32_bf16 v[152:155], v[76:79], v[40:43], v[152:155]
    v_mfma_f32_16x16x32_bf16 v[156:159], v[76:79], v[44:47], v[156:159]
    s_waitcnt lgkmcnt(10)
    v_mfma_f32_16x16x32_bf16 v[160:163], v[80:83], v[32:35], v[160:163]
    v_mfma_f32_16x16x32_bf16 v[164:167], v[80:83], v[36:39], v[164:167]
    v_mfma_f32_16x16x32_bf16 v[168:171], v[80:83], v[40:43], v[168:171]
    v_mfma_f32_16x16x32_bf16 v[172:175], v[80:83], v[44:47], v[172:175]
    s_waitcnt lgkmcnt(8)
    v_mfma_f32_16x16x32_bf16 v[176:179], v[84:87], v[32:35], v[176:179]
    v_mfma_f32_16x16x32_bf16 v[180:183], v[84:87], v[36:39], v[180:183]
    v_mfma_f32_16x16x32_bf16 v[184:187], v[84:87], v[40:43], v[184:187]
    v_mfma_f32_16x16x32_bf16 v[188:191], v[84:87], v[44:47], v[188:191]
    s_waitcnt vmcnt(10) lgkmcnt(0)
    s_barrier
    s_add_u32 m0, s19, -1024
    s_nop 0
    global_load_lds_dwordx4 v2, s[4:5] offset:1024
    s_add_u32 m0, s19, 0
    s_nop 0
    global_load_lds_dwordx4 v3, s[4:5] offset:1024
    ds_read_b64_tr_b16 v[72:73], v14 offset:20480
    ds_read_b64_tr_b16 v[74:75], v14 offset:23040
    ds_read_b128 v[48:51], v13 offset:16384
    ds_read_b128 v[52:55], v13 offset:17408
    v_mfma_f32_16x16x32_bf16 v[192:195], v[88:91], v[32:35], v[192:195]
    v_mfma_f32_16x16x32_bf16 v[196:199], v[88:91], v[36:39], v[196:199]
    v_mfma_f32_16x16x32_bf16 v[200:203], v[88:91], v[40:43], v[200:203]
    v_mfma_f32_16x16x32_bf16 v[204:207], v[88:91], v[44:47], v[204:207]
    s_add_u32 m0, s20, 0
    s_nop 0
    global_load_lds_dwordx4 v[4:5], off
    v_add_co_u32 v4, vcc, v4, v10
    v_addc_co_u32 v5, vcc, 0, v5, vcc
    ds_read_b64_tr_b16 v[76:77], v15 offset:20480
    ds_read_b64_tr_b16 v[78:79], v15 offset:23040
    ds_read_b128 v[56:59], v13 offset:18432
    ds_read_b128 v[60:63], v13 offset:19456
    v_mfma_f32_16x16x32_bf16 v[208:211], v[92:95], v[32:35], v[208:211]
    v_mfma_f32_16x16x32_bf16 v[212:215], v[92:95], v[36:39], v[212:215]
    v_mfma_f32_16x16x32_bf16 v[216:219], v[92:95], v[40:43], v[216:219]
    v_mfma_f32_16x16x32_bf16 v[220:223], v[92:95], v[44:47], v[220:223]
    s_add_u32 m0, s20, 8192
    s_nop 0
    global_load_lds_dwordx4 v[6:7], off
    v_add_co_u32 v6, vcc, v6, v11
    v_addc_co_u32 v7, vcc, 0, v7, vcc
    ds_read_b64_tr_b16 v[80:81], v16 offset:20480
    ds_read_b64_tr_b16 v[82:83], v16 offset:23040
    v_mfma_f32_16x16x32_bf16 v[224:227], v[64:67], v[32:35], v[224:227]
    v_mfma_f32_16x16x32_bf16 v[228:231], v[64:67], v[36:39], v[228:231]
    v_mfma_f32_16x16x32_bf16 v[232:235], v[64:67], v[40:43], v[232:235]
    v_mfma_f32_16x16x32_bf16 v[236:239], v[64:67], v[44:47], v[236:239]
    s_add_u32 m0, s21, 16384
    s_mov_b32 exec_hi, 0
    global_load_lds_dwordx4 v[8:9], off
    s_mov_b32 exec_hi, -1
    v_add_co_u32 v8, vcc, v8, v12
    v_addc_co_u32 v9, vcc, 0, v9, vcc
    ds_read_b64_tr_b16 v[84:85], v17 offset:20480
    ds_read_b64_tr_b16 v[86:87], v17 offset:23040
    v_mfma_f32_16x16x32_bf16 v[240:243], v[68:71], v[32:35], v[240:243]
    v_mfma_f32_16x16x32_bf16 v[244:247], v[68:71], v[36:39], v[244:247]
    v_mfma_f32_16x16x32_bf16 v[248:251], v[68:71], v[40:43], v[248:251]
    v_mfma_f32_16x16x32_bf16 v[252:255], v[68:71], v[44:47], v[252:255]
    ds_read_b64_tr_b16 v[88:89], v18 offset:20480
    ds_read_b64_tr_b16 v[90:91], v18 offset:23040
    ds_read_b64_tr_b16 v[92:93], v19 offset:20480
    ds_read_b64_tr_b16 v[94:95], v19 offset:23040
    s_waitcnt lgkmcnt(8)
    v_mfma_f32_16x16x32_bf16 v[96:99], v[72:75], v[48:51], v[96:99]
    v_mfma_f32_16x16x32_bf16 v[100:103], v[72:75], v[52:55], v[100:103]
    v_mfma_f32_16x16x32_bf16 v[104:107], v[72:75], v[56:59], v[104:107]
    v_mfma_f32_16x16x32_bf16 v[108:111], v[72:75], v[60:63], v[108:111]
    ds_read_b64_tr_b16 v[64:65], v20 offset:20480
    ds_read_b64_tr_b16 v[66:67], v20 offset:23040
    ds_read_b64_tr_b16 v[68:69], v21 offset:20480
    ds_read_b64_tr_b16 v[70:71], v21 offset:23040
    v_mfma_f32_16x16x32_bf16 v[112:115], v[76:79], v[48:51], v[112:115]
    v_mfma_f32_16x16x32_bf16 v[116:119], v[76:79], v[52:55], v[116:119]
    v_mfma_f32_16x16x32_bf16 v[120:123], v[76:79], v[56:59], v[120:123]
    v_mfma_f32_16x16x32_bf16 v[124:127], v[76:79], v[60:63], v[124:127]
    ds_read_b64_tr_b16 v[72:73], v22 offset:20480
    ds_read_b64_tr_b16 v[74:75], v22 offset:23040
    ds_read_b64_tr_b16 v[76:77], v23 offset:20480
    ds_read_b64_tr_b16 v[78:79], v23 offset:23040
    s_waitcnt lgkmcnt(14)
    v_mfma_f32_16x16x32_bf16 v[128:131], v[80:83], v[48:51], v[128:131]
    v_mfma_f32_16x16x32_bf16 v[132:135], v[80:83], v[52:55], v[132:135]
    v_mfma_f32_16x16x32_bf16 v[136:139], v[80:83], v[56:59], v[136:139]
    v_mfma_f32_16x16x32_bf16 v[140:143], v[80:83], v[60:63], v[140:143]
    s_waitcnt lgkmcnt(12)
    v_mfma_f32_16x16x32_bf16 v[144:147], v[84:87], v[48:51], v[144:147]
    v_mfma_f32_16x16x32_bf16 v[148:151], v[84:87], v[52:55], v[148:151]
    v_mfma_f32_16x16x32_bf16 v[152:155], v[84:87], v[56:59], v[152:155]
    v_mfma_f32_16x16x32_bf16 v[156:159], v[84:87], v[60:63], v[156:159]
    s_waitcnt lgkmcnt(10)
    v_mfma_f32_16x16x32_bf16 v[160:163], v[88:91], v[48:51], v[160:163]
    v_mfma_f32_16x16x32_bf16 v[164:167], v[88:91], v[52:55], v[164:167]
    v_mfma_f32_16x16x32_bf16 v[168:171], v[88:91], v[56:59], v[168:171]
    v_mfma_f32_16x16x32_bf16 v[172:175], v[88:91], v[60:63], v[172:175]
    s_waitcnt lgkmcnt(8)
    v_mfma_f32_16x16x32_bf16 v[176:179], v[92:95], v[48:51], v[176:179]
    v_mfma_f32_16x16x32_bf16 v[180:183], v[92:95], v[52:55], v[180:183]
    v_mfma_f32_16x16x32_bf16 v[184:187], v[92:95], v[56:59], v[184:187]
    v_mfma_f32_16x16x32_bf16 v[188:191], v[92:95], v[60:63], v[188:191]
    s_waitcnt vmcnt(10) lgkmcnt(0)
    s_barrier
    s_add_u32 m0, s19, 15296
    s_nop 0
    global_load_lds_dwordx4 v2, s[4:5] offset:1088
    s_add_u32 m0, s19, 16320
    s_nop 0
    global_load_lds_dwordx4 v3, s[4:5] offset:1088
    ds_read_b64_tr_b16 v[80:81], v14 offset:40960
    ds_read_b64_tr_b16 v[82:83], v14 offset:43520
    ds_read_b128 v[32:35], v13 offset:32768
    ds_read_b128 v[36:39], v13 offset:33792
    v_mfma_f32_16x16x32_bf16 v[192:195], v[64:67], v[48:51], v[192:195]
    v_mfma_f32_16x16x32_bf16 v[196:199], v[64:67], v[52:55], v[196:199]
    v_mfma_f32_16x16x32_bf16 v[200:203], v[64:67], v[56:59], v[200:203]
    v_mfma_f32_16x16x32_bf16 v[204:207], v[64:67], v[60:63], v[204:207]
    s_add_u32 m0, s20, 20480
    s_nop 0
    global_load_lds_dwordx4 v[4:5], off
    v_add_co_u32 v4, vcc, v4, v10
    v_addc_co_u32 v5, vcc, 0, v5, vcc
    ds_read_b64_tr_b16 v[84:85], v15 offset:40960
    ds_read_b64_tr_b16 v[86:87], v15 offset:43520
    ds_read_b128 v[40:43], v13 offset:34816
    ds_read_b128 v[44:47], v13 offset:35840
    v_mfma_f32_16x16x32_bf16 v[208:211], v[68:71], v[48:51], v[208:211]
    v_mfma_f32_16x16x32_bf16 v[212:215], v[68:71], v[52:55], v[212:215]
    v_mfma_f32_16x16x32_bf16 v[216:219], v[68:71], v[56:59], v[216:219]
    v_mfma_f32_16x16x32_bf16 v[220:223], v[68:71], v[60:63], v[220:223]
    s_add_u32 m0, s20, 28672
    s_nop 0
    global_load_lds_dwordx4 v[6:7], off
    v_add_co_u32 v6, vcc, v6, v11
    v_addc_co_u32 v7, vcc, 0, v7, vcc
    ds_read_b64_tr_b16 v[88:89], v16 offset:40960
    ds_read_b64_tr_b16 v[90:91], v16 offset:43520
    v_mfma_f32_16x16x32_bf16 v[224:227], v[72:75], v[48:51], v[224:227]
    v_mfma_f32_16x16x32_bf16 v[228:231], v[72:75], v[52:55], v[228:231]
    v_mfma_f32_16x16x32_bf16 v[232:235], v[72:75], v[56:59], v[232:235]
    v_mfma_f32_16x16x32_bf16 v[236:239], v[72:75], v[60:63], v[236:239]
    s_add_u32 m0, s21, 36864
    s_mov_b32 exec_hi, 0
    global_load_lds_dwordx4 v[8:9], off
    s_mov_b32 exec_hi, -1
    v_add_co_u32 v8, vcc, v8, v12
    v_addc_co_u32 v9, vcc, 0, v9, vcc
    ds_read_b64_tr_b16 v[92:93], v17 offset:40960
    ds_read_b64_tr_b16 v[94:95], v17 offset:43520
    v_mfma_f32_16x16x32_bf16 v[240:243], v[76:79], v[48:51], v[240:243]
    v_mfma_f32_16x16x32_bf16 v[244:247], v[76:79], v[52:55], v[244:247]
    v_mfma_f32_16x16x32_bf16 v[248:251], v[76:79], v[56:59], v[248:251]
    v_mfma_f32_16x16x32_bf16 v[252:255], v[76:79], v[60:63], v[252:255]
    ds_read_b64_tr_b16 v[64:65], v18 offset:40960
    ds_read_b64_tr_b16 v[66:67], v18 offset:43520
    ds_read_b64_tr_b16 v[68:69], v19 offset:40960
    ds_read_b64_tr_b16 v[70:71], v19 offset:43520
    s_waitcnt lgkmcnt(8)
    v_mfma_f32_16x16x32_bf16 v[96:99], v[80:83], v[32:35], v[96:99]
    v_mfma_f32_16x16x32_bf16 v[100:103], v[80:83], v[36:39], v[100:103]
    v_mfma_f32_16x16x32_bf16 v[104:107], v[80:83], v[40:43], v[104:107]
    v_mfma_f32_16x16x32_bf16 v[108:111], v[80:83], v[44:47], v[108:111]
    ds_read_b64_tr_b16 v[72:73], v20 offset:40960
    ds_read_b64_tr_b16 v[74:75], v20 offset:43520
    ds_read_b64_tr_b16 v[76:77], v21 offset:40960
    ds_read_b64_tr_b16 v[78:79], v21 offset:43520
    v_mfma_f32_16x16x32_bf16 v[112:115], v[84:87], v[32:35], v[112:115]
    v_mfma_f32_16x16x32_bf16 v[116:119], v[84:87], v[36:39], v[116:119]
    v_mfma_f32_16x16x32_bf16 v[120:123], v[84:87], v[40:43], v[120:123]
    v_mfma_f32_16x16x32_bf16 v[124:127], v[84:87], v[44:47], v[124:127]
    ds_read_b64_tr_b16 v[80:81], v22 offset:40960
    ds_read_b64_tr_b16 v[82:83], v22 offset:43520
    ds_read_b64_tr_b16 v[84:85], v23 offset:40960
    ds_read_b64_tr_b16 v[86:87], v23 offset:43520
    s_waitcnt lgkmcnt(14)
    v_mfma_f32_16x16x32_bf16 v[128:131], v[88:91], v[32:35], v[128:131]
    v_mfma_f32_16x16x32_bf16 v[132:135], v[88:91], v[36:39], v[132:135]
    v_mfma_f32_16x16x32_bf16 v[136:139], v[88:91], v[40:43], v[136:139]
    v_mfma_f32_16x16x32_bf16 v[140:143], v[88:91], v[44:47], v[140:143]
    s_waitcnt lgkmcnt(12)
    v_mfma_f32_16x16x32_bf16 v[144:147], v[92:95], v[32:35], v[144:147]
    v_mfma_f32_16x16x32_bf16 v[148:151], v[92:95], v[36:39], v[148:151]
    v_mfma_f32_16x16x32_bf16 v[152:155], v[92:95], v[40:43], v[152:155]
    v_mfma_f32_16x16x32_bf16 v[156:159], v[92:95], v[44:47], v[156:159]
    s_waitcnt lgkmcnt(10)
    v_mfma_f32_16x16x32_bf16 v[160:163], v[64:67], v[32:35], v[160:163]
    v_mfma_f32_16x16x32_bf16 v[164:167], v[64:67], v[36:39], v[164:167]
    v_mfma_f32_16x16x32_bf16 v[168:171], v[64:67], v[40:43], v[168:171]
    v_mfma_f32_16x16x32_bf16 v[172:175], v[64:67], v[44:47], v[172:175]
    s_waitcnt lgkmcnt(8)
    v_mfma_f32_16x16x32_bf16 v[176:179], v[68:71], v[32:35], v[176:179]
    v_mfma_f32_16x16x32_bf16 v[180:183], v[68:71], v[36:39], v[180:183]
    v_mfma_f32_16x16x32_bf16 v[184:187], v[68:71], v[40:43], v[184:187]
    v_mfma_f32_16x16x32_bf16 v[188:191], v[68:71], v[44:47], v[188:191]
    s_waitcnt vmcnt(10) lgkmcnt(0)
    s_barrier
    s_add_u32 m0, s19, 31616
    s_nop 0
    global_load_lds_dwordx4 v2, s[4:5] offset:1152
    s_add_u32 m0, s19, 32640
    s_nop 0
    global_load_lds_dwordx4 v3, s[4:5] offset:1152
    ds_read_b64_tr_b16 v[88:89], v14 offset:61440
    ds_read_b64_tr_b16 v[90:91], v14 offset:64000
    ds_read_b128 v[48:51], v13 offset:49152
    ds_read_b128 v[52:55], v13 offset:50176
    v_mfma_f32_16x16x32_bf16 v[192:195], v[72:75], v[32:35], v[192:195]
    v_mfma_f32_16x16x32_bf16 v[196:199], v[72:75], v[36:39], v[196:199]
    v_mfma_f32_16x16x32_bf16 v[200:203], v[72:75], v[40:43], v[200:203]
    v_mfma_f32_16x16x32_bf16 v[204:207], v[72:75], v[44:47], v[204:207]
    s_add_u32 m0, s20, 40960
    s_nop 0
    global_load_lds_dwordx4 v[4:5], off
    v_add_co_u32 v4, vcc, v4, v10
    v_addc_co_u32 v5, vcc, 0, v5, vcc
    ds_read_b64_tr_b16 v[92:93], v15 offset:61440
    ds_read_b64_tr_b16 v[94:95], v15 offset:64000
    ds_read_b128 v[56:59], v13 offset:51200
    ds_read_b128 v[60:63], v13 offset:52224
    v_mfma_f32_16x16x32_bf16 v[208:211], v[76:79], v[32:35], v[208:211]
    v_mfma_f32_16x16x32_bf16 v[212:215], v[76:79], v[36:39], v[212:215]
    v_mfma_f32_16x16x32_bf16 v[216:219], v[76:79], v[40:43], v[216:219]
    v_mfma_f32_16x16x32_bf16 v[220:223], v[76:79], v[44:47], v[220:223]
    s_add_u32 m0, s20, 49152
    s_nop 0
    global_load_lds_dwordx4 v[6:7], off
    v_add_co_u32 v6, vcc, v6, v11
    v_addc_co_u32 v7, vcc, 0, v7, vcc
    ds_read_b64_tr_b16 v[64:65], v16 offset:61440
    ds_read_b64_tr_b16 v[66:67], v16 offset:64000
    v_mfma_f32_16x16x32_bf16 v[224:227], v[80:83], v[32:35], v[224:227]
    v_mfma_f32_16x16x32_bf16 v[228:231], v[80:83], v[36:39], v[228:231]
    v_mfma_f32_16x16x32_bf16 v[232:235], v[80:83], v[40:43], v[232:235]
    v_mfma_f32_16x16x32_bf16 v[236:239], v[80:83], v[44:47], v[236:239]
    s_add_u32 m0, s21, 57344
    s_mov_b32 exec_hi, 0
    global_load_lds_dwordx4 v[8:9], off
    s_mov_b32 exec_hi, -1
    v_add_co_u32 v8, vcc, v8, v12
    v_addc_co_u32 v9, vcc, 0, v9, vcc
    ds_read_b64_tr_b16 v[68:69], v17 offset:61440
    ds_read_b64_tr_b16 v[70:71], v17 offset:64000
    v_mfma_f32_16x16x32_bf16 v[240:243], v[84:87], v[32:35], v[240:243]
    v_mfma_f32_16x16x32_bf16 v[244:247], v[84:87], v[36:39], v[244:247]
    v_mfma_f32_16x16x32_bf16 v[248:251], v[84:87], v[40:43], v[248:251]
    v_mfma_f32_16x16x32_bf16 v[252:255], v[84:87], v[44:47], v[252:255]
    ds_read_b64_tr_b16 v[72:73], v18 offset:61440
    ds_read_b64_tr_b16 v[74:75], v18 offset:64000
    ds_read_b64_tr_b16 v[76:77], v19 offset:61440
    ds_read_b64_tr_b16 v[78:79], v19 offset:64000
    s_waitcnt lgkmcnt(8)
    v_mfma_f32_16x16x32_bf16 v[96:99], v[88:91], v[48:51], v[96:99]
    v_mfma_f32_16x16x32_bf16 v[100:103], v[88:91], v[52:55], v[100:103]
    v_mfma_f32_16x16x32_bf16 v[104:107], v[88:91], v[56:59], v[104:107]
    v_mfma_f32_16x16x32_bf16 v[108:111], v[88:91], v[60:63], v[108:111]
    ds_read_b64_tr_b16 v[80:81], v20 offset:61440
    ds_read_b64_tr_b16 v[82:83], v20 offset:64000
    ds_read_b64_tr_b16 v[84:85], v21 offset:61440
    ds_read_b64_tr_b16 v[86:87], v21 offset:64000
    v_mfma_f32_16x16x32_bf16 v[112:115], v[92:95], v[48:51], v[112:115]
    v_mfma_f32_16x16x32_bf16 v[116:119], v[92:95], v[52:55], v[116:119]
    v_mfma_f32_16x16x32_bf16 v[120:123], v[92:95], v[56:59], v[120:123]
    v_mfma_f32_16x16x32_bf16 v[124:127], v[92:95], v[60:63], v[124:127]
    ds_read_b64_tr_b16 v[88:89], v22 offset:61440
    ds_read_b64_tr_b16 v[90:91], v22 offset:64000
    ds_read_b64_tr_b16 v[92:93], v23 offset:61440
    ds_read_b64_tr_b16 v[94:95], v23 offset:64000
    s_waitcnt lgkmcnt(14)
    v_mfma_f32_16x16x32_bf16 v[128:131], v[64:67], v[48:51], v[128:131]
    v_mfma_f32_16x16x32_bf16 v[132:135], v[64:67], v[52:55], v[132:135]
    v_mfma_f32_16x16x32_bf16 v[136:139], v[64:67], v[56:59], v[136:139]
    v_mfma_f32_16x16x32_bf16 v[140:143], v[64:67], v[60:63], v[140:143]
    s_waitcnt lgkmcnt(12)
    v_mfma_f32_16x16x32_bf16 v[144:147], v[68:71], v[48:51], v[144:147]
    v_mfma_f32_16x16x32_bf16 v[148:151], v[68:71], v[52:55], v[148:151]
    v_mfma_f32_16x16x32_bf16 v[152:155], v[68:71], v[56:59], v[152:155]
    v_mfma_f32_16x16x32_bf16 v[156:159], v[68:71], v[60:63], v[156:159]
    s_waitcnt lgkmcnt(10)
    v_mfma_f32_16x16x32_bf16 v[160:163], v[72:75], v[48:51], v[160:163]
    v_mfma_f32_16x16x32_bf16 v[164:167], v[72:75], v[52:55], v[164:167]
    v_mfma_f32_16x16x32_bf16 v[168:171], v[72:75], v[56:59], v[168:171]
    v_mfma_f32_16x16x32_bf16 v[172:175], v[72:75], v[60:63], v[172:175]
    s_waitcnt lgkmcnt(8)
    v_mfma_f32_16x16x32_bf16 v[176:179], v[76:79], v[48:51], v[176:179]
    v_mfma_f32_16x16x32_bf16 v[180:183], v[76:79], v[52:55], v[180:183]
    v_mfma_f32_16x16x32_bf16 v[184:187], v[76:79], v[56:59], v[184:187]
    v_mfma_f32_16x16x32_bf16 v[188:191], v[76:79], v[60:63], v[188:191]
    s_waitcnt vmcnt(10) lgkmcnt(0)
    s_barrier
    s_add_u32 m0, s19, 47936
    s_nop 0
    global_load_lds_dwordx4 v2, s[4:5] offset:1216
    s_add_u32 m0, s19, 48960
    s_nop 0
    global_load_lds_dwordx4 v3, s[4:5] offset:1216
    ds_read_b64_tr_b16 v[64:65], v14 offset:0
    ds_read_b64_tr_b16 v[66:67], v14 offset:2560
    ds_read_b128 v[32:35], v13 offset:0
    ds_read_b128 v[36:39], v13 offset:1024
    v_mfma_f32_16x16x32_bf16 v[192:195], v[80:83], v[48:51], v[192:195]
    v_mfma_f32_16x16x32_bf16 v[196:199], v[80:83], v[52:55], v[196:199]
    v_mfma_f32_16x16x32_bf16 v[200:203], v[80:83], v[56:59], v[200:203]
    v_mfma_f32_16x16x32_bf16 v[204:207], v[80:83], v[60:63], v[204:207]
    s_add_u32 m0, s20, 61440
    s_nop 0
    global_load_lds_dwordx4 v[4:5], off
    v_add_co_u32 v4, vcc, v4, v10
    v_addc_co_u32 v5, vcc, 0, v5, vcc
    ds_read_b64_tr_b16 v[68:69], v15 offset:0
    ds_read_b64_tr_b16 v[70:71], v15 offset:2560
    ds_read_b128 v[40:43], v13 offset:2048
    ds_read_b128 v[44:47], v13 offset:3072
    v_mfma_f32_16x16x32_bf16 v[208:211], v[84:87], v[48:51], v[208:211]
    v_mfma_f32_16x16x32_bf16 v[212:215], v[84:87], v[52:55], v[212:215]
    v_mfma_f32_16x16x32_bf16 v[216:219], v[84:87], v[56:59], v[216:219]
    v_mfma_f32_16x16x32_bf16 v[220:223], v[84:87], v[60:63], v[220:223]
    s_add_u32 m0, s20, 69632
    s_nop 0
    global_load_lds_dwordx4 v[6:7], off
    v_add_co_u32 v6, vcc, v6, v11
    v_addc_co_u32 v7, vcc, 0, v7, vcc
    ds_read_b64_tr_b16 v[72:73], v16 offset:0
    ds_read_b64_tr_b16 v[74:75], v16 offset:2560
    v_mfma_f32_16x16x32_bf16 v[224:227], v[88:91], v[48:51], v[224:227]
    v_mfma_f32_16x16x32_bf16 v[228:231], v[88:91], v[52:55], v[228:231]
    v_mfma_f32_16x16x32_bf16 v[232:235], v[88:91], v[56:59], v[232:235]
    v_mfma_f32_16x16x32_bf16 v[236:239], v[88:91], v[60:63], v[236:239]
    s_add_u32 m0, s21, 77824
    s_mov_b32 exec_hi, 0
    global_load_lds_dwordx4 v[8:9], off
    s_mov_b32 exec_hi, -1
    v_add_co_u32 v8, vcc, v8, v12
    v_addc_co_u32 v9, vcc, 0, v9, vcc
    ds_read_b64_tr_b16 v[76:77], v17 offset:0
    ds_read_b64_tr_b16 v[78:79], v17 offset:2560
    v_mfma_f32_16x16x32_bf16 v[240:243], v[92:95], v[48:51], v[240:243]
    v_mfma_f32_16x16x32_bf16 v[244:247], v[92:95], v[52:55], v[244:247]
    v_mfma_f32_16x16x32_bf16 v[248:251], v[92:95], v[56:59], v[248:251]
    v_mfma_f32_16x16x32_bf16 v[252:255], v[92:95], v[60:63], v[252:255]
    ds_read_b64_tr_b16 v[80:81], v18 offset:0
    ds_read_b64_tr_b16 v[82:83], v18 offset:2560
    ds_read_b64_tr_b16 v[84:85], v19 offset:0
    ds_read_b64_tr_b16 v[86:87], v19 offset:2560
    s_waitcnt lgkmcnt(8)
    v_mfma_f32_16x16x32_bf16 v[96:99], v[64:67], v[32:35], v[96:99]
    v_mfma_f32_16x16x32_bf16 v[100:103], v[64:67], v[36:39], v[100:103]
    v_mfma_f32_16x16x32_bf16 v[104:107], v[64:67], v[40:43], v[104:107]
    v_mfma_f32_16x16x32_bf16 v[108:111], v[64:67], v[44:47], v[108:111]
    ds_read_b64_tr_b16 v[88:89], v20 offset:0
    ds_read_b64_tr_b16 v[90:91], v20 offset:2560
    ds_read_b64_tr_b16 v[92:93], v21 offset:0
    ds_read_b64_tr_b16 v[94:95], v21 offset:2560
    v_mfma_f32_16x16x32_bf16 v[112:115], v[68:71], v[32:35], v[112:115]
    v_mfma_f32_16x16x32_bf16 v[116:119], v[68:71], v[36:39], v[116:119]
    v_mfma_f32_16x16x32_bf16 v[120:123], v[68:71], v[40:43], v[120:123]
    v_mfma_f32_16x16x32_bf16 v[124:127], v[68:71], v[44:47], v[124:127]
    ds_read_b64_tr_b16 v[64:65], v22 offset:0
    ds_read_b64_tr_b16 v[66:67], v22 offset:2560
    ds_read_b64_tr_b16 v[68:69], v23 offset:0
    ds_read_b64_tr_b16 v[70:71], v23 offset:2560
    s_waitcnt lgkmcnt(14)
    v_mfma_f32_16x16x32_bf16 v[128:131], v[72:75], v[32:35], v[128:131]
    v_mfma_f32_16x16x32_bf16 v[132:135], v[72:75], v[36:39], v[132:135]
    v_mfma_f32_16x16x32_bf16 v[136:139], v[72:75], v[40:43], v[136:139]
    v_mfma_f32_16x16x32_bf16 v[140:143], v[72:75], v[44:47], v[140:143]
    s_waitcnt lgkmcnt(12)
    v_mfma_f32_16x16x32_bf16 v[144:147], v[76:79], v[32:35], v[144:147]
    v_mfma_f32_16x16x32_bf16 v[148:151], v[76:79], v[36:39], v[148:151]
    v_mfma_f32_16x16x32_bf16 v[152:155], v[76:79], v[40:43], v[152:155]
    v_mfma_f32_16x16x32_bf16 v[156:159], v[76:79], v[44:47], v[156:159]
    s_waitcnt lgkmcnt(10)
    v_mfma_f32_16x16x32_bf16 v[160:163], v[80:83], v[32:35], v[160:163]
    v_mfma_f32_16x16x32_bf16 v[164:167], v[80:83], v[36:39], v[164:167]
    v_mfma_f32_16x16x32_bf16 v[168:171], v[80:83], v[40:43], v[168:171]
    v_mfma_f32_16x16x32_bf16 v[172:175], v[80:83], v[44:47], v[172:175]
    s_waitcnt lgkmcnt(8)
    v_mfma_f32_16x16x32_bf16 v[176:179], v[84:87], v[32:35], v[176:179]
    v_mfma_f32_16x16x32_bf16 v[180:183], v[84:87], v[36:39], v[180:183]
    v_mfma_f32_16x16x32_bf16 v[184:187], v[84:87], v[40:43], v[184:187]
    v_mfma_f32_16x16x32_bf16 v[188:191], v[84:87], v[44:47], v[188:191]
    s_waitcnt vmcnt(10) lgkmcnt(0)
    s_barrier
    s_add_u32 m0, s19, -1280
    s_nop 0
    global_load_lds_dwordx4 v2, s[4:5] offset:1280
    s_add_u32 m0, s19, -256
    s_nop 0
    global_load_lds_dwordx4 v3, s[4:5] offset:1280
    ds_read_b64_tr_b16 v[72:73], v14 offset:20480
    ds_read_b64_tr_b16 v[74:75], v14 offset:23040
    ds_read_b128 v[48:51], v13 offset:16384
    ds_read_b128 v[52:55], v13 offset:17408
    v_mfma_f32_16x16x32_bf16 v[192:195], v[88:91], v[32:35], v[192:195]
    v_mfma_f32_16x16x32_bf16 v[196:199], v[88:91], v[36:39], v[196:199]
    v_mfma_f32_16x16x32_bf16 v[200:203], v[88:91], v[40:43], v[200:203]
    v_mfma_f32_16x16x32_bf16 v[204:207], v[88:91], v[44:47], v[204:207]
    s_add_u32 m0, s20, 0
    s_nop 0
    global_load_lds_dwordx4 v[4:5], off
    v_add_co_u32 v4, vcc, v4, v10
    v_addc_co_u32 v5, vcc, 0, v5, vcc
    ds_read_b64_tr_b16 v[76:77], v15 offset:20480
    ds_read_b64_tr_b16 v[78:79], v15 offset:23040
    ds_read_b128 v[56:59], v13 offset:18432
    ds_read_b128 v[60:63], v13 offset:19456
    v_mfma_f32_16x16x32_bf16 v[208:211], v[92:95], v[32:35], v[208:211]
    v_mfma_f32_16x16x32_bf16 v[212:215], v[92:95], v[36:39], v[212:215]
    v_mfma_f32_16x16x32_bf16 v[216:219], v[92:95], v[40:43], v[216:219]
    v_mfma_f32_16x16x32_bf16 v[220:223], v[92:95], v[44:47], v[220:223]
    s_add_u32 m0, s20, 8192
    s_nop 0
    global_load_lds_dwordx4 v[6:7], off
    v_add_co_u32 v6, vcc, v6, v11
    v_addc_co_u32 v7, vcc, 0, v7, vcc
    ds_read_b64_tr_b16 v[80:81], v16 offset:20480
    ds_read_b64_tr_b16 v[82:83], v16 offset:23040
    v_mfma_f32_16x16x32_bf16 v[224:227], v[64:67], v[32:35], v[224:227]
    v_mfma_f32_16x16x32_bf16 v[228:231], v[64:67], v[36:39], v[228:231]
    v_mfma_f32_16x16x32_bf16 v[232:235], v[64:67], v[40:43], v[232:235]
    v_mfma_f32_16x16x32_bf16 v[236:239], v[64:67], v[44:47], v[236:239]
    s_add_u32 m0, s21, 16384
    s_mov_b32 exec_hi, 0
    global_load_lds_dwordx4 v[8:9], off
    s_mov_b32 exec_hi, -1
    v_add_co_u32 v8, vcc, v8, v12
    v_addc_co_u32 v9, vcc, 0, v9, vcc
    ds_read_b64_tr_b16 v[84:85], v17 offset:20480
    ds_read_b64_tr_b16 v[86:87], v17 offset:23040
    v_mfma_f32_16x16x32_bf16 v[240:243], v[68:71], v[32:35], v[240:243]
    v_mfma_f32_16x16x32_bf16 v[244:247], v[68:71], v[36:39], v[244:247]
    v_mfma_f32_16x16x32_bf16 v[248:251], v[68:71], v[40:43], v[248:251]
    v_mfma_f32_16x16x32_bf16 v[252:255], v[68:71], v[44:47], v[252:255]
    ds_read_b64_tr_b16 v[88:89], v18 offset:20480
    ds_read_b64_tr_b16 v[90:91], v18 offset:23040
    ds_read_b64_tr_b16 v[92:93], v19 offset:20480
    ds_read_b64_tr_b16 v[94:95], v19 offset:23040
    s_waitcnt lgkmcnt(8)
    v_mfma_f32_16x16x32_bf16 v[96:99], v[72:75], v[48:51], v[96:99]
    v_mfma_f32_16x16x32_bf16 v[100:103], v[72:75], v[52:55], v[100:103]
    v_mfma_f32_16x16x32_bf16 v[104:107], v[72:75], v[56:59], v[104:107]
    v_mfma_f32_16x16x32_bf16 v[108:111], v[72:75], v[60:63], v[108:111]
    ds_read_b64_tr_b16 v[64:65], v20 offset:20480
    ds_read_b64_tr_b16 v[66:67], v20 offset:23040
    ds_read_b64_tr_b16 v[68:69], v21 offset:20480
    ds_read_b64_tr_b16 v[70:71], v21 offset:23040
    v_mfma_f32_16x16x32_bf16 v[112:115], v[76:79], v[48:51], v[112:115]
    v_mfma_f32_16x16x32_bf16 v[116:119], v[76:79], v[52:55], v[116:119]
    v_mfma_f32_16x16x32_bf16 v[120:123], v[76:79], v[56:59], v[120:123]
    v_mfma_f32_16x16x32_bf16 v[124:127], v[76:79], v[60:63], v[124:127]
    ds_read_b64_tr_b16 v[72:73], v22 offset:20480
    ds_read_b64_tr_b16 v[74:75], v22 offset:23040
    ds_read_b64_tr_b16 v[76:77], v23 offset:20480
    ds_read_b64_tr_b16 v[78:79], v23 offset:23040
    s_waitcnt lgkmcnt(14)
    v_mfma_f32_16x16x32_bf16 v[128:131], v[80:83], v[48:51], v[128:131]
    v_mfma_f32_16x16x32_bf16 v[132:135], v[80:83], v[52:55], v[132:135]
    v_mfma_f32_16x16x32_bf16 v[136:139], v[80:83], v[56:59], v[136:139]
    v_mfma_f32_16x16x32_bf16 v[140:143], v[80:83], v[60:63], v[140:143]
    s_waitcnt lgkmcnt(12)
    v_mfma_f32_16x16x32_bf16 v[144:147], v[84:87], v[48:51], v[144:147]
    v_mfma_f32_16x16x32_bf16 v[148:151], v[84:87], v[52:55], v[148:151]
    v_mfma_f32_16x16x32_bf16 v[152:155], v[84:87], v[56:59], v[152:155]
    v_mfma_f32_16x16x32_bf16 v[156:159], v[84:87], v[60:63], v[156:159]
    s_waitcnt lgkmcnt(10)
    v_mfma_f32_16x16x32_bf16 v[160:163], v[88:91], v[48:51], v[160:163]
    v_mfma_f32_16x16x32_bf16 v[164:167], v[88:91], v[52:55], v[164:167]
    v_mfma_f32_16x16x32_bf16 v[168:171], v[88:91], v[56:59], v[168:171]
    v_mfma_f32_16x16x32_bf16 v[172:175], v[88:91], v[60:63], v[172:175]
    s_waitcnt lgkmcnt(8)
    v_mfma_f32_16x16x32_bf16 v[176:179], v[92:95], v[48:51], v[176:179]
    v_mfma_f32_16x16x32_bf16 v[180:183], v[92:95], v[52:55], v[180:183]
    v_mfma_f32_16x16x32_bf16 v[184:187], v[92:95], v[56:59], v[184:187]
    v_mfma_f32_16x16x32_bf16 v[188:191], v[92:95], v[60:63], v[188:191]
    s_waitcnt vmcnt(10) lgkmcnt(0)
    s_barrier
    s_add_u32 m0, s19, 15040
    s_nop 0
    global_load_lds_dwordx4 v2, s[4:5] offset:1344
    s_add_u32 m0, s19, 16064
    s_nop 0
    global_load_lds_dwordx4 v3, s[4:5] offset:1344
    ds_read_b64_tr_b16 v[80:81], v14 offset:40960
    ds_read_b64_tr_b16 v[82:83], v14 offset:43520
    ds_read_b128 v[32:35], v13 offset:32768
    ds_read_b128 v[36:39], v13 offset:33792
    v_mfma_f32_16x16x32_bf16 v[192:195], v[64:67], v[48:51], v[192:195]
    v_mfma_f32_16x16x32_bf16 v[196:199], v[64:67], v[52:55], v[196:199]
    v_mfma_f32_16x16x32_bf16 v[200:203], v[64:67], v[56:59], v[200:203]
    v_mfma_f32_16x16x32_bf16 v[204:207], v[64:67], v[60:63], v[204:207]
    s_add_u32 m0, s20, 20480
    s_nop 0
    global_load_lds_dwordx4 v[4:5], off
    v_add_co_u32 v4, vcc, v4, v10
    v_addc_co_u32 v5, vcc, 0, v5, vcc
    ds_read_b64_tr_b16 v[84:85], v15 offset:40960
    ds_read_b64_tr_b16 v[86:87], v15 offset:43520
    ds_read_b128 v[40:43], v13 offset:34816
    ds_read_b128 v[44:47], v13 offset:35840
    v_mfma_f32_16x16x32_bf16 v[208:211], v[68:71], v[48:51], v[208:211]
    v_mfma_f32_16x16x32_bf16 v[212:215], v[68:71], v[52:55], v[212:215]
    v_mfma_f32_16x16x32_bf16 v[216:219], v[68:71], v[56:59], v[216:219]
    v_mfma_f32_16x16x32_bf16 v[220:223], v[68:71], v[60:63], v[220:223]
    s_add_u32 m0, s20, 28672
    s_nop 0
    global_load_lds_dwordx4 v[6:7], off
    v_add_co_u32 v6, vcc, v6, v11
    v_addc_co_u32 v7, vcc, 0, v7, vcc
    ds_read_b64_tr_b16 v[88:89], v16 offset:40960
    ds_read_b64_tr_b16 v[90:91], v16 offset:43520
    v_mfma_f32_16x16x32_bf16 v[224:227], v[72:75], v[48:51], v[224:227]
    v_mfma_f32_16x16x32_bf16 v[228:231], v[72:75], v[52:55], v[228:231]
    v_mfma_f32_16x16x32_bf16 v[232:235], v[72:75], v[56:59], v[232:235]
    v_mfma_f32_16x16x32_bf16 v[236:239], v[72:75], v[60:63], v[236:239]
    s_add_u32 m0, s21, 36864
    s_mov_b32 exec_hi, 0
    global_load_lds_dwordx4 v[8:9], off
    s_mov_b32 exec_hi, -1
    v_add_co_u32 v8, vcc, v8, v12
    v_addc_co_u32 v9, vcc, 0, v9, vcc
    ds_read_b64_tr_b16 v[92:93], v17 offset:40960
    ds_read_b64_tr_b16 v[94:95], v17 offset:43520
    v_mfma_f32_16x16x32_bf16 v[240:243], v[76:79], v[48:51], v[240:243]
    v_mfma_f32_16x16x32_bf16 v[244:247], v[76:79], v[52:55], v[244:247]
    v_mfma_f32_16x16x32_bf16 v[248:251], v[76:79], v[56:59], v[248:251]
    v_mfma_f32_16x16x32_bf16 v[252:255], v[76:79], v[60:63], v[252:255]
    ds_read_b64_tr_b16 v[64:65], v18 offset:40960
    ds_read_b64_tr_b16 v[66:67], v18 offset:43520
    ds_read_b64_tr_b16 v[68:69], v19 offset:40960
    ds_read_b64_tr_b16 v[70:71], v19 offset:43520
    s_waitcnt lgkmcnt(8)
    v_mfma_f32_16x16x32_bf16 v[96:99], v[80:83], v[32:35], v[96:99]
    v_mfma_f32_16x16x32_bf16 v[100:103], v[80:83], v[36:39], v[100:103]
    v_mfma_f32_16x16x32_bf16 v[104:107], v[80:83], v[40:43], v[104:107]
    v_mfma_f32_16x16x32_bf16 v[108:111], v[80:83], v[44:47], v[108:111]
    ds_read_b64_tr_b16 v[72:73], v20 offset:40960
    ds_read_b64_tr_b16 v[74:75], v20 offset:43520
    ds_read_b64_tr_b16 v[76:77], v21 offset:40960
    ds_read_b64_tr_b16 v[78:79], v21 offset:43520
    v_mfma_f32_16x16x32_bf16 v[112:115], v[84:87], v[32:35], v[112:115]
    v_mfma_f32_16x16x32_bf16 v[116:119], v[84:87], v[36:39], v[116:119]
    v_mfma_f32_16x16x32_bf16 v[120:123], v[84:87], v[40:43], v[120:123]
    v_mfma_f32_16x16x32_bf16 v[124:127], v[84:87], v[44:47], v[124:127]
    ds_read_b64_tr_b16 v[80:81], v22 offset:40960
    ds_read_b64_tr_b16 v[82:83], v22 offset:43520
    ds_read_b64_tr_b16 v[84:85], v23 offset:40960
    ds_read_b64_tr_b16 v[86:87], v23 offset:43520
    s_waitcnt lgkmcnt(14)
    v_mfma_f32_16x16x32_bf16 v[128:131], v[88:91], v[32:35], v[128:131]
    v_mfma_f32_16x16x32_bf16 v[132:135], v[88:91], v[36:39], v[132:135]
    v_mfma_f32_16x16x32_bf16 v[136:139], v[88:91], v[40:43], v[136:139]
    v_mfma_f32_16x16x32_bf16 v[140:143], v[88:91], v[44:47], v[140:143]
    s_waitcnt lgkmcnt(12)
    v_mfma_f32_16x16x32_bf16 v[144:147], v[92:95], v[32:35], v[144:147]
    v_mfma_f32_16x16x32_bf16 v[148:151], v[92:95], v[36:39], v[148:151]
    v_mfma_f32_16x16x32_bf16 v[152:155], v[92:95], v[40:43], v[152:155]
    v_mfma_f32_16x16x32_bf16 v[156:159], v[92:95], v[44:47], v[156:159]
    s_waitcnt lgkmcnt(10)
    v_mfma_f32_16x16x32_bf16 v[160:163], v[64:67], v[32:35], v[160:163]
    v_mfma_f32_16x16x32_bf16 v[164:167], v[64:67], v[36:39], v[164:167]
    v_mfma_f32_16x16x32_bf16 v[168:171], v[64:67], v[40:43], v[168:171]
    v_mfma_f32_16x16x32_bf16 v[172:175], v[64:67], v[44:47], v[172:175]
    s_waitcnt lgkmcnt(8)
    v_mfma_f32_16x16x32_bf16 v[176:179], v[68:71], v[32:35], v[176:179]
    v_mfma_f32_16x16x32_bf16 v[180:183], v[68:71], v[36:39], v[180:183]
    v_mfma_f32_16x16x32_bf16 v[184:187], v[68:71], v[40:43], v[184:187]
    v_mfma_f32_16x16x32_bf16 v[188:191], v[68:71], v[44:47], v[188:191]
    s_waitcnt vmcnt(10) lgkmcnt(0)
    s_barrier
    s_add_u32 m0, s19, 31360
    s_nop 0
    global_load_lds_dwordx4 v2, s[4:5] offset:1408
    s_add_u32 m0, s19, 32384
    s_nop 0
    global_load_lds_dwordx4 v3, s[4:5] offset:1408
    ds_read_b64_tr_b16 v[88:89], v14 offset:61440
    ds_read_b64_tr_b16 v[90:91], v14 offset:64000
    ds_read_b128 v[48:51], v13 offset:49152
    ds_read_b128 v[52:55], v13 offset:50176
    v_mfma_f32_16x16x32_bf16 v[192:195], v[72:75], v[32:35], v[192:195]
    v_mfma_f32_16x16x32_bf16 v[196:199], v[72:75], v[36:39], v[196:199]
    v_mfma_f32_16x16x32_bf16 v[200:203], v[72:75], v[40:43], v[200:203]
    v_mfma_f32_16x16x32_bf16 v[204:207], v[72:75], v[44:47], v[204:207]
    s_add_u32 m0, s20, 40960
    s_nop 0
    global_load_lds_dwordx4 v[4:5], off
    v_add_co_u32 v4, vcc, v4, v10
    v_addc_co_u32 v5, vcc, 0, v5, vcc
    ds_read_b64_tr_b16 v[92:93], v15 offset:61440
    ds_read_b64_tr_b16 v[94:95], v15 offset:64000
    ds_read_b128 v[56:59], v13 offset:51200
    ds_read_b128 v[60:63], v13 offset:52224
    v_mfma_f32_16x16x32_bf16 v[208:211], v[76:79], v[32:35], v[208:211]
    v_mfma_f32_16x16x32_bf16 v[212:215], v[76:79], v[36:39], v[212:215]
    v_mfma_f32_16x16x32_bf16 v[216:219], v[76:79], v[40:43], v[216:219]
    v_mfma_f32_16x16x32_bf16 v[220:223], v[76:79], v[44:47], v[220:223]
    s_add_u32 m0, s20, 49152
    s_nop 0
    global_load_lds_dwordx4 v[6:7], off
    v_add_co_u32 v6, vcc, v6, v11
    v_addc_co_u32 v7, vcc, 0, v7, vcc
    ds_read_b64_tr_b16 v[64:65], v16 offset:61440
    ds_read_b64_tr_b16 v[66:67], v16 offset:64000
    v_mfma_f32_16x16x32_bf16 v[224:227], v[80:83], v[32:35], v[224:227]
    v_mfma_f32_16x16x32_bf16 v[228:231], v[80:83], v[36:39], v[228:231]
    v_mfma_f32_16x16x32_bf16 v[232:235], v[80:83], v[40:43], v[232:235]
    v_mfma_f32_16x16x32_bf16 v[236:239], v[80:83], v[44:47], v[236:239]
    s_add_u32 m0, s21, 57344
    s_mov_b32 exec_hi, 0
    global_load_lds_dwordx4 v[8:9], off
    s_mov_b32 exec_hi, -1
    v_add_co_u32 v8, vcc, v8, v12
    v_addc_co_u32 v9, vcc, 0, v9, vcc
    ds_read_b64_tr_b16 v[68:69], v17 offset:61440
    ds_read_b64_tr_b16 v[70:71], v17 offset:64000
    v_mfma_f32_16x16x32_bf16 v[240:243], v[84:87], v[32:35], v[240:243]
    v_mfma_f32_16x16x32_bf16 v[244:247], v[84:87], v[36:39], v[244:247]
    v_mfma_f32_16x16x32_bf16 v[248:251], v[84:87], v[40:43], v[248:251]
    v_mfma_f32_16x16x32_bf16 v[252:255], v[84:87], v[44:47], v[252:255]
    ds_read_b64_tr_b16 v[72:73], v18 offset:61440
    ds_read_b64_tr_b16 v[74:75], v18 offset:64000
    ds_read_b64_tr_b16 v[76:77], v19 offset:61440
    ds_read_b64_tr_b16 v[78:79], v19 offset:64000
    s_waitcnt lgkmcnt(8)
    v_mfma_f32_16x16x32_bf16 v[96:99], v[88:91], v[48:51], v[96:99]
    v_mfma_f32_16x16x32_bf16 v[100:103], v[88:91], v[52:55], v[100:103]
    v_mfma_f32_16x16x32_bf16 v[104:107], v[88:91], v[56:59], v[104:107]
    v_mfma_f32_16x16x32_bf16 v[108:111], v[88:91], v[60:63], v[108:111]
    ds_read_b64_tr_b16 v[80:81], v20 offset:61440
    ds_read_b64_tr_b16 v[82:83], v20 offset:64000
    ds_read_b64_tr_b16 v[84:85], v21 offset:61440
    ds_read_b64_tr_b16 v[86:87], v21 offset:64000
    v_mfma_f32_16x16x32_bf16 v[112:115], v[92:95], v[48:51], v[112:115]
    v_mfma_f32_16x16x32_bf16 v[116:119], v[92:95], v[52:55], v[116:119]
    v_mfma_f32_16x16x32_bf16 v[120:123], v[92:95], v[56:59], v[120:123]
    v_mfma_f32_16x16x32_bf16 v[124:127], v[92:95], v[60:63], v[124:127]
    ds_read_b64_tr_b16 v[88:89], v22 offset:61440
    ds_read_b64_tr_b16 v[90:91], v22 offset:64000
    ds_read_b64_tr_b16 v[92:93], v23 offset:61440
    ds_read_b64_tr_b16 v[94:95], v23 offset:64000
    s_waitcnt lgkmcnt(14)
    v_mfma_f32_16x16x32_bf16 v[128:131], v[64:67], v[48:51], v[128:131]
    v_mfma_f32_16x16x32_bf16 v[132:135], v[64:67], v[52:55], v[132:135]
    v_mfma_f32_16x16x32_bf16 v[136:139], v[64:67], v[56:59], v[136:139]
    v_mfma_f32_16x16x32_bf16 v[140:143], v[64:67], v[60:63], v[140:143]
    s_waitcnt lgkmcnt(12)
    v_mfma_f32_16x16x32_bf16 v[144:147], v[68:71], v[48:51], v[144:147]
    v_mfma_f32_16x16x32_bf16 v[148:151], v[68:71], v[52:55], v[148:151]
    v_mfma_f32_16x16x32_bf16 v[152:155], v[68:71], v[56:59], v[152:155]
    v_mfma_f32_16x16x32_bf16 v[156:159], v[68:71], v[60:63], v[156:159]
    s_waitcnt lgkmcnt(10)
    v_mfma_f32_16x16x32_bf16 v[160:163], v[72:75], v[48:51], v[160:163]
    v_mfma_f32_16x16x32_bf16 v[164:167], v[72:75], v[52:55], v[164:167]
    v_mfma_f32_16x16x32_bf16 v[168:171], v[72:75], v[56:59], v[168:171]
    v_mfma_f32_16x16x32_bf16 v[172:175], v[72:75], v[60:63], v[172:175]
    s_waitcnt lgkmcnt(8)
    v_mfma_f32_16x16x32_bf16 v[176:179], v[76:79], v[48:51], v[176:179]
    v_mfma_f32_16x16x32_bf16 v[180:183], v[76:79], v[52:55], v[180:183]
    v_mfma_f32_16x16x32_bf16 v[184:187], v[76:79], v[56:59], v[184:187]
    v_mfma_f32_16x16x32_bf16 v[188:191], v[76:79], v[60:63], v[188:191]
    s_waitcnt vmcnt(10) lgkmcnt(0)
    s_barrier
    s_add_u32 m0, s19, 47680
    s_nop 0
    global_load_lds_dwordx4 v2, s[4:5] offset:1472
    s_add_u32 m0, s19, 48704
    s_nop 0
    global_load_lds_dwordx4 v3, s[4:5] offset:1472
    ds_read_b64_tr_b16 v[64:65], v14 offset:0
    ds_read_b64_tr_b16 v[66:67], v14 offset:2560
    ds_read_b128 v[32:35], v13 offset:0
    ds_read_b128 v[36:39], v13 offset:1024
    v_mfma_f32_16x16x32_bf16 v[192:195], v[80:83], v[48:51], v[192:195]
    v_mfma_f32_16x16x32_bf16 v[196:199], v[80:83], v[52:55], v[196:199]
    v_mfma_f32_16x16x32_bf16 v[200:203], v[80:83], v[56:59], v[200:203]
    v_mfma_f32_16x16x32_bf16 v[204:207], v[80:83], v[60:63], v[204:207]
    s_add_u32 m0, s20, 61440
    s_nop 0
    global_load_lds_dwordx4 v[4:5], off
    v_add_co_u32 v4, vcc, v4, v10
    v_addc_co_u32 v5, vcc, 0, v5, vcc
    ds_read_b64_tr_b16 v[68:69], v15 offset:0
    ds_read_b64_tr_b16 v[70:71], v15 offset:2560
    ds_read_b128 v[40:43], v13 offset:2048
    ds_read_b128 v[44:47], v13 offset:3072
    v_mfma_f32_16x16x32_bf16 v[208:211], v[84:87], v[48:51], v[208:211]
    v_mfma_f32_16x16x32_bf16 v[212:215], v[84:87], v[52:55], v[212:215]
    v_mfma_f32_16x16x32_bf16 v[216:219], v[84:87], v[56:59], v[216:219]
    v_mfma_f32_16x16x32_bf16 v[220:223], v[84:87], v[60:63], v[220:223]
    s_add_u32 m0, s20, 69632
    s_nop 0
    global_load_lds_dwordx4 v[6:7], off
    v_add_co_u32 v6, vcc, v6, v11
    v_addc_co_u32 v7, vcc, 0, v7, vcc
    ds_read_b64_tr_b16 v[72:73], v16 offset:0
    ds_read_b64_tr_b16 v[74:75], v16 offset:2560
    v_mfma_f32_16x16x32_bf16 v[224:227], v[88:91], v[48:51], v[224:227]
    v_mfma_f32_16x16x32_bf16 v[228:231], v[88:91], v[52:55], v[228:231]
    v_mfma_f32_16x16x32_bf16 v[232:235], v[88:91], v[56:59], v[232:235]
    v_mfma_f32_16x16x32_bf16 v[236:239], v[88:91], v[60:63], v[236:239]
    s_add_u32 m0, s21, 77824
    s_mov_b32 exec_hi, 0
    global_load_lds_dwordx4 v[8:9], off
    s_mov_b32 exec_hi, -1
    v_add_co_u32 v8, vcc, v8, v12
    v_addc_co_u32 v9, vcc, 0, v9, vcc
    ds_read_b64_tr_b16 v[76:77], v17 offset:0
    ds_read_b64_tr_b16 v[78:79], v17 offset:2560
    v_mfma_f32_16x16x32_bf16 v[240:243], v[92:95], v[48:51], v[240:243]
    v_mfma_f32_16x16x32_bf16 v[244:247], v[92:95], v[52:55], v[244:247]
    v_mfma_f32_16x16x32_bf16 v[248:251], v[92:95], v[56:59], v[248:251]
    v_mfma_f32_16x16x32_bf16 v[252:255], v[92:95], v[60:63], v[252:255]
    ds_read_b64_tr_b16 v[80:81], v18 offset:0
    ds_read_b64_tr_b16 v[82:83], v18 offset:2560
    ds_read_b64_tr_b16 v[84:85], v19 offset:0
    ds_read_b64_tr_b16 v[86:87], v19 offset:2560
    s_waitcnt lgkmcnt(8)
    v_mfma_f32_16x16x32_bf16 v[96:99], v[64:67], v[32:35], v[96:99]
    v_mfma_f32_16x16x32_bf16 v[100:103], v[64:67], v[36:39], v[100:103]
    v_mfma_f32_16x16x32_bf16 v[104:107], v[64:67], v[40:43], v[104:107]
    v_mfma_f32_16x16x32_bf16 v[108:111], v[64:67], v[44:47], v[108:111]
    ds_read_b64_tr_b16 v[88:89], v20 offset:0
    ds_read_b64_tr_b16 v[90:91], v20 offset:2560
    ds_read_b64_tr_b16 v[92:93], v21 offset:0
    ds_read_b64_tr_b16 v[94:95], v21 offset:2560
    v_mfma_f32_16x16x32_bf16 v[112:115], v[68:71], v[32:35], v[112:115]
    v_mfma_f32_16x16x32_bf16 v[116:119], v[68:71], v[36:39], v[116:119]
    v_mfma_f32_16x16x32_bf16 v[120:123], v[68:71], v[40:43], v[120:123]
    v_mfma_f32_16x16x32_bf16 v[124:127], v[68:71], v[44:47], v[124:127]
    ds_read_b64_tr_b16 v[64:65], v22 offset:0
    ds_read_b64_tr_b16 v[66:67], v22 offset:2560
    ds_read_b64_tr_b16 v[68:69], v23 offset:0
    ds_read_b64_tr_b16 v[70:71], v23 offset:2560
    s_waitcnt lgkmcnt(14)
    v_mfma_f32_16x16x32_bf16 v[128:131], v[72:75], v[32:35], v[128:131]
    v_mfma_f32_16x16x32_bf16 v[132:135], v[72:75], v[36:39], v[132:135]
    v_mfma_f32_16x16x32_bf16 v[136:139], v[72:75], v[40:43], v[136:139]
    v_mfma_f32_16x16x32_bf16 v[140:143], v[72:75], v[44:47], v[140:143]
    s_waitcnt lgkmcnt(12)
    v_mfma_f32_16x16x32_bf16 v[144:147], v[76:79], v[32:35], v[144:147]
    v_mfma_f32_16x16x32_bf16 v[148:151], v[76:79], v[36:39], v[148:151]
    v_mfma_f32_16x16x32_bf16 v[152:155], v[76:79], v[40:43], v[152:155]
    v_mfma_f32_16x16x32_bf16 v[156:159], v[76:79], v[44:47], v[156:159]
    s_waitcnt lgkmcnt(10)
    v_mfma_f32_16x16x32_bf16 v[160:163], v[80:83], v[32:35], v[160:163]
    v_mfma_f32_16x16x32_bf16 v[164:167], v[80:83], v[36:39], v[164:167]
    v_mfma_f32_16x16x32_bf16 v[168:171], v[80:83], v[40:43], v[168:171]
    v_mfma_f32_16x16x32_bf16 v[172:175], v[80:83], v[44:47], v[172:175]
    s_waitcnt lgkmcnt(8)
    v_mfma_f32_16x16x32_bf16 v[176:179], v[84:87], v[32:35], v[176:179]
    v_mfma_f32_16x16x32_bf16 v[180:183], v[84:87], v[36:39], v[180:183]
    v_mfma_f32_16x16x32_bf16 v[184:187], v[84:87], v[40:43], v[184:187]
    v_mfma_f32_16x16x32_bf16 v[188:191], v[84:87], v[44:47], v[188:191]
    s_waitcnt vmcnt(10) lgkmcnt(0)
    s_barrier
    s_add_u32 m0, s19, -1536
    s_nop 0
    global_load_lds_dwordx4 v2, s[4:5] offset:1536
    s_add_u32 m0, s19, -512
    s_nop 0
    global_load_lds_dwordx4 v3, s[4:5] offset:1536
    ds_read_b64_tr_b16 v[72:73], v14 offset:20480
    ds_read_b64_tr_b16 v[74:75], v14 offset:23040
    ds_read_b128 v[48:51], v13 offset:16384
    ds_read_b128 v[52:55], v13 offset:17408
    v_mfma_f32_16x16x32_bf16 v[192:195], v[88:91], v[32:35], v[192:195]
    v_mfma_f32_16x16x32_bf16 v[196:199], v[88:91], v[36:39], v[196:199]
    v_mfma_f32_16x16x32_bf16 v[200:203], v[88:91], v[40:43], v[200:203]
    v_mfma_f32_16x16x32_bf16 v[204:207], v[88:91], v[44:47], v[204:207]
    s_add_u32 m0, s20, 0
    s_nop 0
    global_load_lds_dwordx4 v[4:5], off
    v_add_co_u32 v4, vcc, v4, v10
    v_addc_co_u32 v5, vcc, 0, v5, vcc
    ds_read_b64_tr_b16 v[76:77], v15 offset:20480
    ds_read_b64_tr_b16 v[78:79], v15 offset:23040
    ds_read_b128 v[56:59], v13 offset:18432
    ds_read_b128 v[60:63], v13 offset:19456
    v_mfma_f32_16x16x32_bf16 v[208:211], v[92:95], v[32:35], v[208:211]
    v_mfma_f32_16x16x32_bf16 v[212:215], v[92:95], v[36:39], v[212:215]
    v_mfma_f32_16x16x32_bf16 v[216:219], v[92:95], v[40:43], v[216:219]
    v_mfma_f32_16x16x32_bf16 v[220:223], v[92:95], v[44:47], v[220:223]
    s_add_u32 m0, s20, 8192
    s_nop 0
    global_load_lds_dwordx4 v[6:7], off
    v_add_co_u32 v6, vcc, v6, v11
    v_addc_co_u32 v7, vcc, 0, v7, vcc
    ds_read_b64_tr_b16 v[80:81], v16 offset:20480
    ds_read_b64_tr_b16 v[82:83], v16 offset:23040
    v_mfma_f32_16x16x32_bf16 v[224:227], v[64:67], v[32:35], v[224:227]
    v_mfma_f32_16x16x32_bf16 v[228:231], v[64:67], v[36:39], v[228:231]
    v_mfma_f32_16x16x32_bf16 v[232:235], v[64:67], v[40:43], v[232:235]
    v_mfma_f32_16x16x32_bf16 v[236:239], v[64:67], v[44:47], v[236:239]
    s_add_u32 m0, s21, 16384
    s_mov_b32 exec_hi, 0
    global_load_lds_dwordx4 v[8:9], off
    s_mov_b32 exec_hi, -1
    v_add_co_u32 v8, vcc, v8, v12
    v_addc_co_u32 v9, vcc, 0, v9, vcc
    ds_read_b64_tr_b16 v[84:85], v17 offset:20480
    ds_read_b64_tr_b16 v[86:87], v17 offset:23040
    v_mfma_f32_16x16x32_bf16 v[240:243], v[68:71], v[32:35], v[240:243]
    v_mfma_f32_16x16x32_bf16 v[244:247], v[68:71], v[36:39], v[244:247]
    v_mfma_f32_16x16x32_bf16 v[248:251], v[68:71], v[40:43], v[248:251]
    v_mfma_f32_16x16x32_bf16 v[252:255], v[68:71], v[44:47], v[252:255]
    ds_read_b64_tr_b16 v[88:89], v18 offset:20480
    ds_read_b64_tr_b16 v[90:91], v18 offset:23040
    ds_read_b64_tr_b16 v[92:93], v19 offset:20480
    ds_read_b64_tr_b16 v[94:95], v19 offset:23040
    s_waitcnt lgkmcnt(8)
    v_mfma_f32_16x16x32_bf16 v[96:99], v[72:75], v[48:51], v[96:99]
    v_mfma_f32_16x16x32_bf16 v[100:103], v[72:75], v[52:55], v[100:103]
    v_mfma_f32_16x16x32_bf16 v[104:107], v[72:75], v[56:59], v[104:107]
    v_mfma_f32_16x16x32_bf16 v[108:111], v[72:75], v[60:63], v[108:111]
    ds_read_b64_tr_b16 v[64:65], v20 offset:20480
    ds_read_b64_tr_b16 v[66:67], v20 offset:23040
    ds_read_b64_tr_b16 v[68:69], v21 offset:20480
    ds_read_b64_tr_b16 v[70:71], v21 offset:23040
    v_mfma_f32_16x16x32_bf16 v[112:115], v[76:79], v[48:51], v[112:115]
    v_mfma_f32_16x16x32_bf16 v[116:119], v[76:79], v[52:55], v[116:119]
    v_mfma_f32_16x16x32_bf16 v[120:123], v[76:79], v[56:59], v[120:123]
    v_mfma_f32_16x16x32_bf16 v[124:127], v[76:79], v[60:63], v[124:127]
    ds_read_b64_tr_b16 v[72:73], v22 offset:20480
    ds_read_b64_tr_b16 v[74:75], v22 offset:23040
    ds_read_b64_tr_b16 v[76:77], v23 offset:20480
    ds_read_b64_tr_b16 v[78:79], v23 offset:23040
    s_waitcnt lgkmcnt(14)
    v_mfma_f32_16x16x32_bf16 v[128:131], v[80:83], v[48:51], v[128:131]
    v_mfma_f32_16x16x32_bf16 v[132:135], v[80:83], v[52:55], v[132:135]
    v_mfma_f32_16x16x32_bf16 v[136:139], v[80:83], v[56:59], v[136:139]
    v_mfma_f32_16x16x32_bf16 v[140:143], v[80:83], v[60:63], v[140:143]
    s_waitcnt lgkmcnt(12)
    v_mfma_f32_16x16x32_bf16 v[144:147], v[84:87], v[48:51], v[144:147]
    v_mfma_f32_16x16x32_bf16 v[148:151], v[84:87], v[52:55], v[148:151]
    v_mfma_f32_16x16x32_bf16 v[152:155], v[84:87], v[56:59], v[152:155]
    v_mfma_f32_16x16x32_bf16 v[156:159], v[84:87], v[60:63], v[156:159]
    s_waitcnt lgkmcnt(10)
    v_mfma_f32_16x16x32_bf16 v[160:163], v[88:91], v[48:51], v[160:163]
    v_mfma_f32_16x16x32_bf16 v[164:167], v[88:91], v[52:55], v[164:167]
    v_mfma_f32_16x16x32_bf16 v[168:171], v[88:91], v[56:59], v[168:171]
    v_mfma_f32_16x16x32_bf16 v[172:175], v[88:91], v[60:63], v[172:175]
    s_waitcnt lgkmcnt(8)
    v_mfma_f32_16x16x32_bf16 v[176:179], v[92:95], v[48:51], v[176:179]
    v_mfma_f32_16x16x32_bf16 v[180:183], v[92:95], v[52:55], v[180:183]
    v_mfma_f32_16x16x32_bf16 v[184:187], v[92:95], v[56:59], v[184:187]
    v_mfma_f32_16x16x32_bf16 v[188:191], v[92:95], v[60:63], v[188:191]
    s_waitcnt vmcnt(10) lgkmcnt(0)
    s_barrier
    s_add_u32 m0, s19, 14784
    s_nop 0
    global_load_lds_dwordx4 v2, s[4:5] offset:1600
    s_add_u32 m0, s19, 15808
    s_nop 0
    global_load_lds_dwordx4 v3, s[4:5] offset:1600
    ds_read_b64_tr_b16 v[80:81], v14 offset:40960
    ds_read_b64_tr_b16 v[82:83], v14 offset:43520
    ds_read_b128 v[32:35], v13 offset:32768
    ds_read_b128 v[36:39], v13 offset:33792
    v_mfma_f32_16x16x32_bf16 v[192:195], v[64:67], v[48:51], v[192:195]
    v_mfma_f32_16x16x32_bf16 v[196:199], v[64:67], v[52:55], v[196:199]
    v_mfma_f32_16x16x32_bf16 v[200:203], v[64:67], v[56:59], v[200:203]
    v_mfma_f32_16x16x32_bf16 v[204:207], v[64:67], v[60:63], v[204:207]
    s_add_u32 m0, s20, 20480
    s_nop 0
    global_load_lds_dwordx4 v[4:5], off
    v_add_co_u32 v4, vcc, v4, v10
    v_addc_co_u32 v5, vcc, 0, v5, vcc
    ds_read_b64_tr_b16 v[84:85], v15 offset:40960
    ds_read_b64_tr_b16 v[86:87], v15 offset:43520
    ds_read_b128 v[40:43], v13 offset:34816
    ds_read_b128 v[44:47], v13 offset:35840
    v_mfma_f32_16x16x32_bf16 v[208:211], v[68:71], v[48:51], v[208:211]
    v_mfma_f32_16x16x32_bf16 v[212:215], v[68:71], v[52:55], v[212:215]
    v_mfma_f32_16x16x32_bf16 v[216:219], v[68:71], v[56:59], v[216:219]
    v_mfma_f32_16x16x32_bf16 v[220:223], v[68:71], v[60:63], v[220:223]
    s_add_u32 m0, s20, 28672
    s_nop 0
    global_load_lds_dwordx4 v[6:7], off
    v_add_co_u32 v6, vcc, v6, v11
    v_addc_co_u32 v7, vcc, 0, v7, vcc
    ds_read_b64_tr_b16 v[88:89], v16 offset:40960
    ds_read_b64_tr_b16 v[90:91], v16 offset:43520
    v_mfma_f32_16x16x32_bf16 v[224:227], v[72:75], v[48:51], v[224:227]
    v_mfma_f32_16x16x32_bf16 v[228:231], v[72:75], v[52:55], v[228:231]
    v_mfma_f32_16x16x32_bf16 v[232:235], v[72:75], v[56:59], v[232:235]
    v_mfma_f32_16x16x32_bf16 v[236:239], v[72:75], v[60:63], v[236:239]
    s_add_u32 m0, s21, 36864
    s_mov_b32 exec_hi, 0
    global_load_lds_dwordx4 v[8:9], off
    s_mov_b32 exec_hi, -1
    v_add_co_u32 v8, vcc, v8, v12
    v_addc_co_u32 v9, vcc, 0, v9, vcc
    ds_read_b64_tr_b16 v[92:93], v17 offset:40960
    ds_read_b64_tr_b16 v[94:95], v17 offset:43520
    v_mfma_f32_16x16x32_bf16 v[240:243], v[76:79], v[48:51], v[240:243]
    v_mfma_f32_16x16x32_bf16 v[244:247], v[76:79], v[52:55], v[244:247]
    v_mfma_f32_16x16x32_bf16 v[248:251], v[76:79], v[56:59], v[248:251]
    v_mfma_f32_16x16x32_bf16 v[252:255], v[76:79], v[60:63], v[252:255]
    ds_read_b64_tr_b16 v[64:65], v18 offset:40960
    ds_read_b64_tr_b16 v[66:67], v18 offset:43520
    ds_read_b64_tr_b16 v[68:69], v19 offset:40960
    ds_read_b64_tr_b16 v[70:71], v19 offset:43520
    s_waitcnt lgkmcnt(8)
    v_mfma_f32_16x16x32_bf16 v[96:99], v[80:83], v[32:35], v[96:99]
    v_mfma_f32_16x16x32_bf16 v[100:103], v[80:83], v[36:39], v[100:103]
    v_mfma_f32_16x16x32_bf16 v[104:107], v[80:83], v[40:43], v[104:107]
    v_mfma_f32_16x16x32_bf16 v[108:111], v[80:83], v[44:47], v[108:111]
    ds_read_b64_tr_b16 v[72:73], v20 offset:40960
    ds_read_b64_tr_b16 v[74:75], v20 offset:43520
    ds_read_b64_tr_b16 v[76:77], v21 offset:40960
    ds_read_b64_tr_b16 v[78:79], v21 offset:43520
    v_mfma_f32_16x16x32_bf16 v[112:115], v[84:87], v[32:35], v[112:115]
    v_mfma_f32_16x16x32_bf16 v[116:119], v[84:87], v[36:39], v[116:119]
    v_mfma_f32_16x16x32_bf16 v[120:123], v[84:87], v[40:43], v[120:123]
    v_mfma_f32_16x16x32_bf16 v[124:127], v[84:87], v[44:47], v[124:127]
    ds_read_b64_tr_b16 v[80:81], v22 offset:40960
    ds_read_b64_tr_b16 v[82:83], v22 offset:43520
    ds_read_b64_tr_b16 v[84:85], v23 offset:40960
    ds_read_b64_tr_b16 v[86:87], v23 offset:43520
    s_waitcnt lgkmcnt(14)
    v_mfma_f32_16x16x32_bf16 v[128:131], v[88:91], v[32:35], v[128:131]
    v_mfma_f32_16x16x32_bf16 v[132:135], v[88:91], v[36:39], v[132:135]
    v_mfma_f32_16x16x32_bf16 v[136:139], v[88:91], v[40:43], v[136:139]
    v_mfma_f32_16x16x32_bf16 v[140:143], v[88:91], v[44:47], v[140:143]
    s_waitcnt lgkmcnt(12)
    v_mfma_f32_16x16x32_bf16 v[144:147], v[92:95], v[32:35], v[144:147]
    v_mfma_f32_16x16x32_bf16 v[148:151], v[92:95], v[36:39], v[148:151]
    v_mfma_f32_16x16x32_bf16 v[152:155], v[92:95], v[40:43], v[152:155]
    v_mfma_f32_16x16x32_bf16 v[156:159], v[92:95], v[44:47], v[156:159]
    s_waitcnt lgkmcnt(10)
    v_mfma_f32_16x16x32_bf16 v[160:163], v[64:67], v[32:35], v[160:163]
    v_mfma_f32_16x16x32_bf16 v[164:167], v[64:67], v[36:39], v[164:167]
    v_mfma_f32_16x16x32_bf16 v[168:171], v[64:67], v[40:43], v[168:171]
    v_mfma_f32_16x16x32_bf16 v[172:175], v[64:67], v[44:47], v[172:175]
    s_waitcnt lgkmcnt(8)
    v_mfma_f32_16x16x32_bf16 v[176:179], v[68:71], v[32:35], v[176:179]
    v_mfma_f32_16x16x32_bf16 v[180:183], v[68:71], v[36:39], v[180:183]
    v_mfma_f32_16x16x32_bf16 v[184:187], v[68:71], v[40:43], v[184:187]
    v_mfma_f32_16x16x32_bf16 v[188:191], v[68:71], v[44:47], v[188:191]
    s_waitcnt vmcnt(10) lgkmcnt(0)
    s_barrier
    s_add_u32 m0, s19, 31104
    s_nop 0
    global_load_lds_dwordx4 v2, s[4:5] offset:1664
    s_add_u32 m0, s19, 32128
    s_nop 0
    global_load_lds_dwordx4 v3, s[4:5] offset:1664
    ds_read_b64_tr_b16 v[88:89], v14 offset:61440
    ds_read_b64_tr_b16 v[90:91], v14 offset:64000
    ds_read_b128 v[48:51], v13 offset:49152
    ds_read_b128 v[52:55], v13 offset:50176
    v_mfma_f32_16x16x32_bf16 v[192:195], v[72:75], v[32:35], v[192:195]
    v_mfma_f32_16x16x32_bf16 v[196:199], v[72:75], v[36:39], v[196:199]
    v_mfma_f32_16x16x32_bf16 v[200:203], v[72:75], v[40:43], v[200:203]
    v_mfma_f32_16x16x32_bf16 v[204:207], v[72:75], v[44:47], v[204:207]
    s_add_u32 m0, s20, 40960
    s_nop 0
    global_load_lds_dwordx4 v[4:5], off
    v_add_co_u32 v4, vcc, v4, v10
    v_addc_co_u32 v5, vcc, 0, v5, vcc
    ds_read_b64_tr_b16 v[92:93], v15 offset:61440
    ds_read_b64_tr_b16 v[94:95], v15 offset:64000
    ds_read_b128 v[56:59], v13 offset:51200
    ds_read_b128 v[60:63], v13 offset:52224
    v_mfma_f32_16x16x32_bf16 v[208:211], v[76:79], v[32:35], v[208:211]
    v_mfma_f32_16x16x32_bf16 v[212:215], v[76:79], v[36:39], v[212:215]
    v_mfma_f32_16x16x32_bf16 v[216:219], v[76:79], v[40:43], v[216:219]
    v_mfma_f32_16x16x32_bf16 v[220:223], v[76:79], v[44:47], v[220:223]
    s_add_u32 m0, s20, 49152
    s_nop 0
    global_load_lds_dwordx4 v[6:7], off
    v_add_co_u32 v6, vcc, v6, v11
    v_addc_co_u32 v7, vcc, 0, v7, vcc
    ds_read_b64_tr_b16 v[64:65], v16 offset:61440
    ds_read_b64_tr_b16 v[66:67], v16 offset:64000
    v_mfma_f32_16x16x32_bf16 v[224:227], v[80:83], v[32:35], v[224:227]
    v_mfma_f32_16x16x32_bf16 v[228:231], v[80:83], v[36:39], v[228:231]
    v_mfma_f32_16x16x32_bf16 v[232:235], v[80:83], v[40:43], v[232:235]
    v_mfma_f32_16x16x32_bf16 v[236:239], v[80:83], v[44:47], v[236:239]
    s_add_u32 m0, s21, 57344
    s_mov_b32 exec_hi, 0
    global_load_lds_dwordx4 v[8:9], off
    s_mov_b32 exec_hi, -1
    v_add_co_u32 v8, vcc, v8, v12
    v_addc_co_u32 v9, vcc, 0, v9, vcc
    ds_read_b64_tr_b16 v[68:69], v17 offset:61440
    ds_read_b64_tr_b16 v[70:71], v17 offset:64000
    v_mfma_f32_16x16x32_bf16 v[240:243], v[84:87], v[32:35], v[240:243]
    v_mfma_f32_16x16x32_bf16 v[244:247], v[84:87], v[36:39], v[244:247]
    v_mfma_f32_16x16x32_bf16 v[248:251], v[84:87], v[40:43], v[248:251]
    v_mfma_f32_16x16x32_bf16 v[252:255], v[84:87], v[44:47], v[252:255]
    ds_read_b64_tr_b16 v[72:73], v18 offset:61440
    ds_read_b64_tr_b16 v[74:75], v18 offset:64000
    ds_read_b64_tr_b16 v[76:77], v19 offset:61440
    ds_read_b64_tr_b16 v[78:79], v19 offset:64000
    s_waitcnt lgkmcnt(8)
    v_mfma_f32_16x16x32_bf16 v[96:99], v[88:91], v[48:51], v[96:99]
    v_mfma_f32_16x16x32_bf16 v[100:103], v[88:91], v[52:55], v[100:103]
    v_mfma_f32_16x16x32_bf16 v[104:107], v[88:91], v[56:59], v[104:107]
    v_mfma_f32_16x16x32_bf16 v[108:111], v[88:91], v[60:63], v[108:111]
    ds_read_b64_tr_b16 v[80:81], v20 offset:61440
    ds_read_b64_tr_b16 v[82:83], v20 offset:64000
    ds_read_b64_tr_b16 v[84:85], v21 offset:61440
    ds_read_b64_tr_b16 v[86:87], v21 offset:64000
    v_mfma_f32_16x16x32_bf16 v[112:115], v[92:95], v[48:51], v[112:115]
    v_mfma_f32_16x16x32_bf16 v[116:119], v[92:95], v[52:55], v[116:119]
    v_mfma_f32_16x16x32_bf16 v[120:123], v[92:95], v[56:59], v[120:123]
    v_mfma_f32_16x16x32_bf16 v[124:127], v[92:95], v[60:63], v[124:127]
    ds_read_b64_tr_b16 v[88:89], v22 offset:61440
    ds_read_b64_tr_b16 v[90:91], v22 offset:64000
    ds_read_b64_tr_b16 v[92:93], v23 offset:61440
    ds_read_b64_tr_b16 v[94:95], v23 offset:64000
    s_waitcnt lgkmcnt(14)
    v_mfma_f32_16x16x32_bf16 v[128:131], v[64:67], v[48:51], v[128:131]
    v_mfma_f32_16x16x32_bf16 v[132:135], v[64:67], v[52:55], v[132:135]
    v_mfma_f32_16x16x32_bf16 v[136:139], v[64:67], v[56:59], v[136:139]
    v_mfma_f32_16x16x32_bf16 v[140:143], v[64:67], v[60:63], v[140:143]
    s_waitcnt lgkmcnt(12)
    v_mfma_f32_16x16x32_bf16 v[144:147], v[68:71], v[48:51], v[144:147]
    v_mfma_f32_16x16x32_bf16 v[148:151], v[68:71], v[52:55], v[148:151]
    v_mfma_f32_16x16x32_bf16 v[152:155], v[68:71], v[56:59], v[152:155]
    v_mfma_f32_16x16x32_bf16 v[156:159], v[68:71], v[60:63], v[156:159]
    s_waitcnt lgkmcnt(10)
    v_mfma_f32_16x16x32_bf16 v[160:163], v[72:75], v[48:51], v[160:163]
    v_mfma_f32_16x16x32_bf16 v[164:167], v[72:75], v[52:55], v[164:167]
    v_mfma_f32_16x16x32_bf16 v[168:171], v[72:75], v[56:59], v[168:171]
    v_mfma_f32_16x16x32_bf16 v[172:175], v[72:75], v[60:63], v[172:175]
    s_waitcnt lgkmcnt(8)
    v_mfma_f32_16x16x32_bf16 v[176:179], v[76:79], v[48:51], v[176:179]
    v_mfma_f32_16x16x32_bf16 v[180:183], v[76:79], v[52:55], v[180:183]
    v_mfma_f32_16x16x32_bf16 v[184:187], v[76:79], v[56:59], v[184:187]
    v_mfma_f32_16x16x32_bf16 v[188:191], v[76:79], v[60:63], v[188:191]
    s_waitcnt vmcnt(10) lgkmcnt(0)
    s_barrier
    s_add_u32 m0, s19, 47424
    s_nop 0
    global_load_lds_dwordx4 v2, s[4:5] offset:1728
    s_add_u32 m0, s19, 48448
    s_nop 0
    global_load_lds_dwordx4 v3, s[4:5] offset:1728
    ds_read_b64_tr_b16 v[64:65], v14 offset:0
    ds_read_b64_tr_b16 v[66:67], v14 offset:2560
    ds_read_b128 v[32:35], v13 offset:0
    ds_read_b128 v[36:39], v13 offset:1024
    v_mfma_f32_16x16x32_bf16 v[192:195], v[80:83], v[48:51], v[192:195]
    v_mfma_f32_16x16x32_bf16 v[196:199], v[80:83], v[52:55], v[196:199]
    v_mfma_f32_16x16x32_bf16 v[200:203], v[80:83], v[56:59], v[200:203]
    v_mfma_f32_16x16x32_bf16 v[204:207], v[80:83], v[60:63], v[204:207]
    s_add_u32 m0, s20, 61440
    s_nop 0
    global_load_lds_dwordx4 v[4:5], off
    v_add_co_u32 v4, vcc, v4, v10
    v_addc_co_u32 v5, vcc, 0, v5, vcc
    ds_read_b64_tr_b16 v[68:69], v15 offset:0
    ds_read_b64_tr_b16 v[70:71], v15 offset:2560
    ds_read_b128 v[40:43], v13 offset:2048
    ds_read_b128 v[44:47], v13 offset:3072
    v_mfma_f32_16x16x32_bf16 v[208:211], v[84:87], v[48:51], v[208:211]
    v_mfma_f32_16x16x32_bf16 v[212:215], v[84:87], v[52:55], v[212:215]
    v_mfma_f32_16x16x32_bf16 v[216:219], v[84:87], v[56:59], v[216:219]
    v_mfma_f32_16x16x32_bf16 v[220:223], v[84:87], v[60:63], v[220:223]
    s_add_u32 m0, s20, 69632
    s_nop 0
    global_load_lds_dwordx4 v[6:7], off
    v_add_co_u32 v6, vcc, v6, v11
    v_addc_co_u32 v7, vcc, 0, v7, vcc
    ds_read_b64_tr_b16 v[72:73], v16 offset:0
    ds_read_b64_tr_b16 v[74:75], v16 offset:2560
    v_mfma_f32_16x16x32_bf16 v[224:227], v[88:91], v[48:51], v[224:227]
    v_mfma_f32_16x16x32_bf16 v[228:231], v[88:91], v[52:55], v[228:231]
    v_mfma_f32_16x16x32_bf16 v[232:235], v[88:91], v[56:59], v[232:235]
    v_mfma_f32_16x16x32_bf16 v[236:239], v[88:91], v[60:63], v[236:239]
    s_add_u32 m0, s21, 77824
    s_mov_b32 exec_hi, 0
    global_load_lds_dwordx4 v[8:9], off
    s_mov_b32 exec_hi, -1
    v_add_co_u32 v8, vcc, v8, v12
    v_addc_co_u32 v9, vcc, 0, v9, vcc
    ds_read_b64_tr_b16 v[76:77], v17 offset:0
    ds_read_b64_tr_b16 v[78:79], v17 offset:2560
    v_mfma_f32_16x16x32_bf16 v[240:243], v[92:95], v[48:51], v[240:243]
    v_mfma_f32_16x16x32_bf16 v[244:247], v[92:95], v[52:55], v[244:247]
    v_mfma_f32_16x16x32_bf16 v[248:251], v[92:95], v[56:59], v[248:251]
    v_mfma_f32_16x16x32_bf16 v[252:255], v[92:95], v[60:63], v[252:255]
    ds_read_b64_tr_b16 v[80:81], v18 offset:0
    ds_read_b64_tr_b16 v[82:83], v18 offset:2560
    ds_read_b64_tr_b16 v[84:85], v19 offset:0
    ds_read_b64_tr_b16 v[86:87], v19 offset:2560
    s_waitcnt lgkmcnt(8)
    v_mfma_f32_16x16x32_bf16 v[96:99], v[64:67], v[32:35], v[96:99]
    v_mfma_f32_16x16x32_bf16 v[100:103], v[64:67], v[36:39], v[100:103]
    v_mfma_f32_16x16x32_bf16 v[104:107], v[64:67], v[40:43], v[104:107]
    v_mfma_f32_16x16x32_bf16 v[108:111], v[64:67], v[44:47], v[108:111]
    ds_read_b64_tr_b16 v[88:89], v20 offset:0
    ds_read_b64_tr_b16 v[90:91], v20 offset:2560
    ds_read_b64_tr_b16 v[92:93], v21 offset:0
    ds_read_b64_tr_b16 v[94:95], v21 offset:2560
    v_mfma_f32_16x16x32_bf16 v[112:115], v[68:71], v[32:35], v[112:115]
    v_mfma_f32_16x16x32_bf16 v[116:119], v[68:71], v[36:39], v[116:119]
    v_mfma_f32_16x16x32_bf16 v[120:123], v[68:71], v[40:43], v[120:123]
    v_mfma_f32_16x16x32_bf16 v[124:127], v[68:71], v[44:47], v[124:127]
    ds_read_b64_tr_b16 v[64:65], v22 offset:0
    ds_read_b64_tr_b16 v[66:67], v22 offset:2560
    ds_read_b64_tr_b16 v[68:69], v23 offset:0
    ds_read_b64_tr_b16 v[70:71], v23 offset:2560
    s_waitcnt lgkmcnt(14)
    v_mfma_f32_16x16x32_bf16 v[128:131], v[72:75], v[32:35], v[128:131]
    v_mfma_f32_16x16x32_bf16 v[132:135], v[72:75], v[36:39], v[132:135]
    v_mfma_f32_16x16x32_bf16 v[136:139], v[72:75], v[40:43], v[136:139]
    v_mfma_f32_16x16x32_bf16 v[140:143], v[72:75], v[44:47], v[140:143]
    s_waitcnt lgkmcnt(12)
    v_mfma_f32_16x16x32_bf16 v[144:147], v[76:79], v[32:35], v[144:147]
    v_mfma_f32_16x16x32_bf16 v[148:151], v[76:79], v[36:39], v[148:151]
    v_mfma_f32_16x16x32_bf16 v[152:155], v[76:79], v[40:43], v[152:155]
    v_mfma_f32_16x16x32_bf16 v[156:159], v[76:79], v[44:47], v[156:159]
    s_waitcnt lgkmcnt(10)
    v_mfma_f32_16x16x32_bf16 v[160:163], v[80:83], v[32:35], v[160:163]
    v_mfma_f32_16x16x32_bf16 v[164:167], v[80:83], v[36:39], v[164:167]
    v_mfma_f32_16x16x32_bf16 v[168:171], v[80:83], v[40:43], v[168:171]
    v_mfma_f32_16x16x32_bf16 v[172:175], v[80:83], v[44:47], v[172:175]
    s_waitcnt lgkmcnt(8)
    v_mfma_f32_16x16x32_bf16 v[176:179], v[84:87], v[32:35], v[176:179]
    v_mfma_f32_16x16x32_bf16 v[180:183], v[84:87], v[36:39], v[180:183]
    v_mfma_f32_16x16x32_bf16 v[184:187], v[84:87], v[40:43], v[184:187]
    v_mfma_f32_16x16x32_bf16 v[188:191], v[84:87], v[44:47], v[188:191]
    s_waitcnt vmcnt(10) lgkmcnt(0)
    s_barrier
    s_add_u32 m0, s19, -1792
    s_nop 0
    global_load_lds_dwordx4 v2, s[4:5] offset:1792
    s_add_u32 m0, s19, -768
    s_nop 0
    global_load_lds_dwordx4 v3, s[4:5] offset:1792
    ds_read_b64_tr_b16 v[72:73], v14 offset:20480
    ds_read_b64_tr_b16 v[74:75], v14 offset:23040
    ds_read_b128 v[48:51], v13 offset:16384
    ds_read_b128 v[52:55], v13 offset:17408
    v_mfma_f32_16x16x32_bf16 v[192:195], v[88:91], v[32:35], v[192:195]
    v_mfma_f32_16x16x32_bf16 v[196:199], v[88:91], v[36:39], v[196:199]
    v_mfma_f32_16x16x32_bf16 v[200:203], v[88:91], v[40:43], v[200:203]
    v_mfma_f32_16x16x32_bf16 v[204:207], v[88:91], v[44:47], v[204:207]
    s_add_u32 m0, s20, 0
    s_nop 0
    global_load_lds_dwordx4 v[4:5], off
    v_add_co_u32 v4, vcc, v4, v10
    v_addc_co_u32 v5, vcc, 0, v5, vcc
    ds_read_b64_tr_b16 v[76:77], v15 offset:20480
    ds_read_b64_tr_b16 v[78:79], v15 offset:23040
    ds_read_b128 v[56:59], v13 offset:18432
    ds_read_b128 v[60:63], v13 offset:19456
    v_mfma_f32_16x16x32_bf16 v[208:211], v[92:95], v[32:35], v[208:211]
    v_mfma_f32_16x16x32_bf16 v[212:215], v[92:95], v[36:39], v[212:215]
    v_mfma_f32_16x16x32_bf16 v[216:219], v[92:95], v[40:43], v[216:219]
    v_mfma_f32_16x16x32_bf16 v[220:223], v[92:95], v[44:47], v[220:223]
    s_add_u32 m0, s20, 8192
    s_nop 0
    global_load_lds_dwordx4 v[6:7], off
    v_add_co_u32 v6, vcc, v6, v11
    v_addc_co_u32 v7, vcc, 0, v7, vcc
    ds_read_b64_tr_b16 v[80:81], v16 offset:20480
    ds_read_b64_tr_b16 v[82:83], v16 offset:23040
    v_mfma_f32_16x16x32_bf16 v[224:227], v[64:67], v[32:35], v[224:227]
    v_mfma_f32_16x16x32_bf16 v[228:231], v[64:67], v[36:39], v[228:231]
    v_mfma_f32_16x16x32_bf16 v[232:235], v[64:67], v[40:43], v[232:235]
    v_mfma_f32_16x16x32_bf16 v[236:239], v[64:67], v[44:47], v[236:239]
    s_add_u32 m0, s21, 16384
    s_mov_b32 exec_hi, 0
    global_load_lds_dwordx4 v[8:9], off
    s_mov_b32 exec_hi, -1
    v_add_co_u32 v8, vcc, v8, v12
    v_addc_co_u32 v9, vcc, 0, v9, vcc
    ds_read_b64_tr_b16 v[84:85], v17 offset:20480
    ds_read_b64_tr_b16 v[86:87], v17 offset:23040
    v_mfma_f32_16x16x32_bf16 v[240:243], v[68:71], v[32:35], v[240:243]
    v_mfma_f32_16x16x32_bf16 v[244:247], v[68:71], v[36:39], v[244:247]
    v_mfma_f32_16x16x32_bf16 v[248:251], v[68:71], v[40:43], v[248:251]
    v_mfma_f32_16x16x32_bf16 v[252:255], v[68:71], v[44:47], v[252:255]
    ds_read_b64_tr_b16 v[88:89], v18 offset:20480
    ds_read_b64_tr_b16 v[90:91], v18 offset:23040
    ds_read_b64_tr_b16 v[92:93], v19 offset:20480
    ds_read_b64_tr_b16 v[94:95], v19 offset:23040
    s_waitcnt lgkmcnt(8)
    v_mfma_f32_16x16x32_bf16 v[96:99], v[72:75], v[48:51], v[96:99]
    v_mfma_f32_16x16x32_bf16 v[100:103], v[72:75], v[52:55], v[100:103]
    v_mfma_f32_16x16x32_bf16 v[104:107], v[72:75], v[56:59], v[104:107]
    v_mfma_f32_16x16x32_bf16 v[108:111], v[72:75], v[60:63], v[108:111]
    ds_read_b64_tr_b16 v[64:65], v20 offset:20480
    ds_read_b64_tr_b16 v[66:67], v20 offset:23040
    ds_read_b64_tr_b16 v[68:69], v21 offset:20480
    ds_read_b64_tr_b16 v[70:71], v21 offset:23040
    v_mfma_f32_16x16x32_bf16 v[112:115], v[76:79], v[48:51], v[112:115]
    v_mfma_f32_16x16x32_bf16 v[116:119], v[76:79], v[52:55], v[116:119]
    v_mfma_f32_16x16x32_bf16 v[120:123], v[76:79], v[56:59], v[120:123]
    v_mfma_f32_16x16x32_bf16 v[124:127], v[76:79], v[60:63], v[124:127]
    ds_read_b64_tr_b16 v[72:73], v22 offset:20480
    ds_read_b64_tr_b16 v[74:75], v22 offset:23040
    ds_read_b64_tr_b16 v[76:77], v23 offset:20480
    ds_read_b64_tr_b16 v[78:79], v23 offset:23040
    s_waitcnt lgkmcnt(14)
    v_mfma_f32_16x16x32_bf16 v[128:131], v[80:83], v[48:51], v[128:131]
    v_mfma_f32_16x16x32_bf16 v[132:135], v[80:83], v[52:55], v[132:135]
    v_mfma_f32_16x16x32_bf16 v[136:139], v[80:83], v[56:59], v[136:139]
    v_mfma_f32_16x16x32_bf16 v[140:143], v[80:83], v[60:63], v[140:143]
    s_waitcnt lgkmcnt(12)
    v_mfma_f32_16x16x32_bf16 v[144:147], v[84:87], v[48:51], v[144:147]
    v_mfma_f32_16x16x32_bf16 v[148:151], v[84:87], v[52:55], v[148:151]
    v_mfma_f32_16x16x32_bf16 v[152:155], v[84:87], v[56:59], v[152:155]
    v_mfma_f32_16x16x32_bf16 v[156:159], v[84:87], v[60:63], v[156:159]
    s_waitcnt lgkmcnt(10)
    v_mfma_f32_16x16x32_bf16 v[160:163], v[88:91], v[48:51], v[160:163]
    v_mfma_f32_16x16x32_bf16 v[164:167], v[88:91], v[52:55], v[164:167]
    v_mfma_f32_16x16x32_bf16 v[168:171], v[88:91], v[56:59], v[168:171]
    v_mfma_f32_16x16x32_bf16 v[172:175], v[88:91], v[60:63], v[172:175]
    s_waitcnt lgkmcnt(8)
    v_mfma_f32_16x16x32_bf16 v[176:179], v[92:95], v[48:51], v[176:179]
    v_mfma_f32_16x16x32_bf16 v[180:183], v[92:95], v[52:55], v[180:183]
    v_mfma_f32_16x16x32_bf16 v[184:187], v[92:95], v[56:59], v[184:187]
    v_mfma_f32_16x16x32_bf16 v[188:191], v[92:95], v[60:63], v[188:191]
    s_waitcnt vmcnt(10) lgkmcnt(0)
    s_barrier
    s_add_u32 m0, s19, 14528
    s_nop 0
    global_load_lds_dwordx4 v2, s[4:5] offset:1856
    s_add_u32 m0, s19, 15552
    s_nop 0
    global_load_lds_dwordx4 v3, s[4:5] offset:1856
    ds_read_b64_tr_b16 v[80:81], v14 offset:40960
    ds_read_b64_tr_b16 v[82:83], v14 offset:43520
    ds_read_b128 v[32:35], v13 offset:32768
    ds_read_b128 v[36:39], v13 offset:33792
    v_mfma_f32_16x16x32_bf16 v[192:195], v[64:67], v[48:51], v[192:195]
    v_mfma_f32_16x16x32_bf16 v[196:199], v[64:67], v[52:55], v[196:199]
    v_mfma_f32_16x16x32_bf16 v[200:203], v[64:67], v[56:59], v[200:203]
    v_mfma_f32_16x16x32_bf16 v[204:207], v[64:67], v[60:63], v[204:207]
    s_add_u32 m0, s20, 20480
    s_nop 0
    global_load_lds_dwordx4 v[4:5], off
    v_add_co_u32 v4, vcc, v4, v10
    v_addc_co_u32 v5, vcc, 0, v5, vcc
    ds_read_b64_tr_b16 v[84:85], v15 offset:40960
    ds_read_b64_tr_b16 v[86:87], v15 offset:43520
    ds_read_b128 v[40:43], v13 offset:34816
    ds_read_b128 v[44:47], v13 offset:35840
    v_mfma_f32_16x16x32_bf16 v[208:211], v[68:71], v[48:51], v[208:211]
    v_mfma_f32_16x16x32_bf16 v[212:215], v[68:71], v[52:55], v[212:215]
    v_mfma_f32_16x16x32_bf16 v[216:219], v[68:71], v[56:59], v[216:219]
    v_mfma_f32_16x16x32_bf16 v[220:223], v[68:71], v[60:63], v[220:223]
    s_add_u32 m0, s20, 28672
    s_nop 0
    global_load_lds_dwordx4 v[6:7], off
    v_add_co_u32 v6, vcc, v6, v11
    v_addc_co_u32 v7, vcc, 0, v7, vcc
    ds_read_b64_tr_b16 v[88:89], v16 offset:40960
    ds_read_b64_tr_b16 v[90:91], v16 offset:43520
    v_mfma_f32_16x16x32_bf16 v[224:227], v[72:75], v[48:51], v[224:227]
    v_mfma_f32_16x16x32_bf16 v[228:231], v[72:75], v[52:55], v[228:231]
    v_mfma_f32_16x16x32_bf16 v[232:235], v[72:75], v[56:59], v[232:235]
    v_mfma_f32_16x16x32_bf16 v[236:239], v[72:75], v[60:63], v[236:239]
    s_add_u32 m0, s21, 36864
    s_mov_b32 exec_hi, 0
    global_load_lds_dwordx4 v[8:9], off
    s_mov_b32 exec_hi, -1
    v_add_co_u32 v8, vcc, v8, v12
    v_addc_co_u32 v9, vcc, 0, v9, vcc
    ds_read_b64_tr_b16 v[92:93], v17 offset:40960
    ds_read_b64_tr_b16 v[94:95], v17 offset:43520
    v_mfma_f32_16x16x32_bf16 v[240:243], v[76:79], v[48:51], v[240:243]
    v_mfma_f32_16x16x32_bf16 v[244:247], v[76:79], v[52:55], v[244:247]
    v_mfma_f32_16x16x32_bf16 v[248:251], v[76:79], v[56:59], v[248:251]
    v_mfma_f32_16x16x32_bf16 v[252:255], v[76:79], v[60:63], v[252:255]
    ds_read_b64_tr_b16 v[64:65], v18 offset:40960
    ds_read_b64_tr_b16 v[66:67], v18 offset:43520
    ds_read_b64_tr_b16 v[68:69], v19 offset:40960
    ds_read_b64_tr_b16 v[70:71], v19 offset:43520
    s_waitcnt lgkmcnt(8)
    v_mfma_f32_16x16x32_bf16 v[96:99], v[80:83], v[32:35], v[96:99]
    v_mfma_f32_16x16x32_bf16 v[100:103], v[80:83], v[36:39], v[100:103]
    v_mfma_f32_16x16x32_bf16 v[104:107], v[80:83], v[40:43], v[104:107]
    v_mfma_f32_16x16x32_bf16 v[108:111], v[80:83], v[44:47], v[108:111]
    ds_read_b64_tr_b16 v[72:73], v20 offset:40960
    ds_read_b64_tr_b16 v[74:75], v20 offset:43520
    ds_read_b64_tr_b16 v[76:77], v21 offset:40960
    ds_read_b64_tr_b16 v[78:79], v21 offset:43520
    v_mfma_f32_16x16x32_bf16 v[112:115], v[84:87], v[32:35], v[112:115]
    v_mfma_f32_16x16x32_bf16 v[116:119], v[84:87], v[36:39], v[116:119]
    v_mfma_f32_16x16x32_bf16 v[120:123], v[84:87], v[40:43], v[120:123]
    v_mfma_f32_16x16x32_bf16 v[124:127], v[84:87], v[44:47], v[124:127]
    ds_read_b64_tr_b16 v[80:81], v22 offset:40960
    ds_read_b64_tr_b16 v[82:83], v22 offset:43520
    ds_read_b64_tr_b16 v[84:85], v23 offset:40960
    ds_read_b64_tr_b16 v[86:87], v23 offset:43520
    s_waitcnt lgkmcnt(14)
    v_mfma_f32_16x16x32_bf16 v[128:131], v[88:91], v[32:35], v[128:131]
    v_mfma_f32_16x16x32_bf16 v[132:135], v[88:91], v[36:39], v[132:135]
    v_mfma_f32_16x16x32_bf16 v[136:139], v[88:91], v[40:43], v[136:139]
    v_mfma_f32_16x16x32_bf16 v[140:143], v[88:91], v[44:47], v[140:143]
    s_waitcnt lgkmcnt(12)
    v_mfma_f32_16x16x32_bf16 v[144:147], v[92:95], v[32:35], v[144:147]
    v_mfma_f32_16x16x32_bf16 v[148:151], v[92:95], v[36:39], v[148:151]
    v_mfma_f32_16x16x32_bf16 v[152:155], v[92:95], v[40:43], v[152:155]
    v_mfma_f32_16x16x32_bf16 v[156:159], v[92:95], v[44:47], v[156:159]
    s_waitcnt lgkmcnt(10)
    v_mfma_f32_16x16x32_bf16 v[160:163], v[64:67], v[32:35], v[160:163]
    v_mfma_f32_16x16x32_bf16 v[164:167], v[64:67], v[36:39], v[164:167]
    v_mfma_f32_16x16x32_bf16 v[168:171], v[64:67], v[40:43], v[168:171]
    v_mfma_f32_16x16x32_bf16 v[172:175], v[64:67], v[44:47], v[172:175]
    s_waitcnt lgkmcnt(8)
    v_mfma_f32_16x16x32_bf16 v[176:179], v[68:71], v[32:35], v[176:179]
    v_mfma_f32_16x16x32_bf16 v[180:183], v[68:71], v[36:39], v[180:183]
    v_mfma_f32_16x16x32_bf16 v[184:187], v[68:71], v[40:43], v[184:187]
    v_mfma_f32_16x16x32_bf16 v[188:191], v[68:71], v[44:47], v[188:191]
    s_waitcnt vmcnt(10) lgkmcnt(0)
    s_barrier
    s_add_u32 m0, s19, 30848
    s_nop 0
    global_load_lds_dwordx4 v2, s[4:5] offset:1920
    s_add_u32 m0, s19, 31872
    s_nop 0
    global_load_lds_dwordx4 v3, s[4:5] offset:1920
    ds_read_b64_tr_b16 v[88:89], v14 offset:61440
    ds_read_b64_tr_b16 v[90:91], v14 offset:64000
    ds_read_b128 v[48:51], v13 offset:49152
    ds_read_b128 v[52:55], v13 offset:50176
    v_mfma_f32_16x16x32_bf16 v[192:195], v[72:75], v[32:35], v[192:195]
    v_mfma_f32_16x16x32_bf16 v[196:199], v[72:75], v[36:39], v[196:199]
    v_mfma_f32_16x16x32_bf16 v[200:203], v[72:75], v[40:43], v[200:203]
    v_mfma_f32_16x16x32_bf16 v[204:207], v[72:75], v[44:47], v[204:207]
    s_add_u32 m0, s20, 40960
    s_nop 0
    global_load_lds_dwordx4 v[4:5], off
    v_add_co_u32 v4, vcc, v4, v10
    v_addc_co_u32 v5, vcc, 0, v5, vcc
    ds_read_b64_tr_b16 v[92:93], v15 offset:61440
    ds_read_b64_tr_b16 v[94:95], v15 offset:64000
    ds_read_b128 v[56:59], v13 offset:51200
    ds_read_b128 v[60:63], v13 offset:52224
    v_mfma_f32_16x16x32_bf16 v[208:211], v[76:79], v[32:35], v[208:211]
    v_mfma_f32_16x16x32_bf16 v[212:215], v[76:79], v[36:39], v[212:215]
    v_mfma_f32_16x16x32_bf16 v[216:219], v[76:79], v[40:43], v[216:219]
    v_mfma_f32_16x16x32_bf16 v[220:223], v[76:79], v[44:47], v[220:223]
    s_add_u32 m0, s20, 49152
    s_nop 0
    global_load_lds_dwordx4 v[6:7], off
    v_add_co_u32 v6, vcc, v6, v11
    v_addc_co_u32 v7, vcc, 0, v7, vcc
    ds_read_b64_tr_b16 v[64:65], v16 offset:61440
    ds_read_b64_tr_b16 v[66:67], v16 offset:64000
    v_mfma_f32_16x16x32_bf16 v[224:227], v[80:83], v[32:35], v[224:227]
    v_mfma_f32_16x16x32_bf16 v[228:231], v[80:83], v[36:39], v[228:231]
    v_mfma_f32_16x16x32_bf16 v[232:235], v[80:83], v[40:43], v[232:235]
    v_mfma_f32_16x16x32_bf16 v[236:239], v[80:83], v[44:47], v[236:239]
    s_add_u32 m0, s21, 57344
    s_mov_b32 exec_hi, 0
    global_load_lds_dwordx4 v[8:9], off
    s_mov_b32 exec_hi, -1
    v_add_co_u32 v8, vcc, v8, v12
    v_addc_co_u32 v9, vcc, 0, v9, vcc
    ds_read_b64_tr_b16 v[68:69], v17 offset:61440
    ds_read_b64_tr_b16 v[70:71], v17 offset:64000
    v_mfma_f32_16x16x32_bf16 v[240:243], v[84:87], v[32:35], v[240:243]
    v_mfma_f32_16x16x32_bf16 v[244:247], v[84:87], v[36:39], v[244:247]
    v_mfma_f32_16x16x32_bf16 v[248:251], v[84:87], v[40:43], v[248:251]
    v_mfma_f32_16x16x32_bf16 v[252:255], v[84:87], v[44:47], v[252:255]
    ds_read_b64_tr_b16 v[72:73], v18 offset:61440
    ds_read_b64_tr_b16 v[74:75], v18 offset:64000
    ds_read_b64_tr_b16 v[76:77], v19 offset:61440
    ds_read_b64_tr_b16 v[78:79], v19 offset:64000
    s_waitcnt lgkmcnt(8)
    v_mfma_f32_16x16x32_bf16 v[96:99], v[88:91], v[48:51], v[96:99]
    v_mfma_f32_16x16x32_bf16 v[100:103], v[88:91], v[52:55], v[100:103]
    v_mfma_f32_16x16x32_bf16 v[104:107], v[88:91], v[56:59], v[104:107]
    v_mfma_f32_16x16x32_bf16 v[108:111], v[88:91], v[60:63], v[108:111]
    ds_read_b64_tr_b16 v[80:81], v20 offset:61440
    ds_read_b64_tr_b16 v[82:83], v20 offset:64000
    ds_read_b64_tr_b16 v[84:85], v21 offset:61440
    ds_read_b64_tr_b16 v[86:87], v21 offset:64000
    v_mfma_f32_16x16x32_bf16 v[112:115], v[92:95], v[48:51], v[112:115]
    v_mfma_f32_16x16x32_bf16 v[116:119], v[92:95], v[52:55], v[116:119]
    v_mfma_f32_16x16x32_bf16 v[120:123], v[92:95], v[56:59], v[120:123]
    v_mfma_f32_16x16x32_bf16 v[124:127], v[92:95], v[60:63], v[124:127]
    ds_read_b64_tr_b16 v[88:89], v22 offset:61440
    ds_read_b64_tr_b16 v[90:91], v22 offset:64000
    ds_read_b64_tr_b16 v[92:93], v23 offset:61440
    ds_read_b64_tr_b16 v[94:95], v23 offset:64000
    s_waitcnt lgkmcnt(14)
    v_mfma_f32_16x16x32_bf16 v[128:131], v[64:67], v[48:51], v[128:131]
    v_mfma_f32_16x16x32_bf16 v[132:135], v[64:67], v[52:55], v[132:135]
    v_mfma_f32_16x16x32_bf16 v[136:139], v[64:67], v[56:59], v[136:139]
    v_mfma_f32_16x16x32_bf16 v[140:143], v[64:67], v[60:63], v[140:143]
    s_waitcnt lgkmcnt(12)
    v_mfma_f32_16x16x32_bf16 v[144:147], v[68:71], v[48:51], v[144:147]
    v_mfma_f32_16x16x32_bf16 v[148:151], v[68:71], v[52:55], v[148:151]
    v_mfma_f32_16x16x32_bf16 v[152:155], v[68:71], v[56:59], v[152:155]
    v_mfma_f32_16x16x32_bf16 v[156:159], v[68:71], v[60:63], v[156:159]
    s_waitcnt lgkmcnt(10)
    v_mfma_f32_16x16x32_bf16 v[160:163], v[72:75], v[48:51], v[160:163]
    v_mfma_f32_16x16x32_bf16 v[164:167], v[72:75], v[52:55], v[164:167]
    v_mfma_f32_16x16x32_bf16 v[168:171], v[72:75], v[56:59], v[168:171]
    v_mfma_f32_16x16x32_bf16 v[172:175], v[72:75], v[60:63], v[172:175]
    s_waitcnt lgkmcnt(8)
    v_mfma_f32_16x16x32_bf16 v[176:179], v[76:79], v[48:51], v[176:179]
    v_mfma_f32_16x16x32_bf16 v[180:183], v[76:79], v[52:55], v[180:183]
    v_mfma_f32_16x16x32_bf16 v[184:187], v[76:79], v[56:59], v[184:187]
    v_mfma_f32_16x16x32_bf16 v[188:191], v[76:79], v[60:63], v[188:191]
    s_waitcnt vmcnt(10) lgkmcnt(0)
    s_barrier
    s_add_u32 m0, s19, 47168
    s_nop 0
    global_load_lds_dwordx4 v2, s[4:5] offset:1984
    s_add_u32 m0, s19, 48192
    s_nop 0
    global_load_lds_dwordx4 v3, s[4:5] offset:1984
    ds_read_b64_tr_b16 v[64:65], v14 offset:0
    ds_read_b64_tr_b16 v[66:67], v14 offset:2560
    ds_read_b128 v[32:35], v13 offset:0
    ds_read_b128 v[36:39], v13 offset:1024
    v_mfma_f32_16x16x32_bf16 v[192:195], v[80:83], v[48:51], v[192:195]
    v_mfma_f32_16x16x32_bf16 v[196:199], v[80:83], v[52:55], v[196:199]
    v_mfma_f32_16x16x32_bf16 v[200:203], v[80:83], v[56:59], v[200:203]
    v_mfma_f32_16x16x32_bf16 v[204:207], v[80:83], v[60:63], v[204:207]
    s_add_u32 m0, s20, 61440
    s_nop 0
    global_load_lds_dwordx4 v[4:5], off
    v_add_co_u32 v4, vcc, v4, v10
    v_addc_co_u32 v5, vcc, 0, v5, vcc
    ds_read_b64_tr_b16 v[68:69], v15 offset:0
    ds_read_b64_tr_b16 v[70:71], v15 offset:2560
    ds_read_b128 v[40:43], v13 offset:2048
    ds_read_b128 v[44:47], v13 offset:3072
    v_mfma_f32_16x16x32_bf16 v[208:211], v[84:87], v[48:51], v[208:211]
    v_mfma_f32_16x16x32_bf16 v[212:215], v[84:87], v[52:55], v[212:215]
    v_mfma_f32_16x16x32_bf16 v[216:219], v[84:87], v[56:59], v[216:219]
    v_mfma_f32_16x16x32_bf16 v[220:223], v[84:87], v[60:63], v[220:223]
    s_add_u32 m0, s20, 69632
    s_nop 0
    global_load_lds_dwordx4 v[6:7], off
    v_add_co_u32 v6, vcc, v6, v11
    v_addc_co_u32 v7, vcc, 0, v7, vcc
    ds_read_b64_tr_b16 v[72:73], v16 offset:0
    ds_read_b64_tr_b16 v[74:75], v16 offset:2560
    v_mfma_f32_16x16x32_bf16 v[224:227], v[88:91], v[48:51], v[224:227]
    v_mfma_f32_16x16x32_bf16 v[228:231], v[88:91], v[52:55], v[228:231]
    v_mfma_f32_16x16x32_bf16 v[232:235], v[88:91], v[56:59], v[232:235]
    v_mfma_f32_16x16x32_bf16 v[236:239], v[88:91], v[60:63], v[236:239]
    s_add_u32 m0, s21, 77824
    s_mov_b32 exec_hi, 0
    global_load_lds_dwordx4 v[8:9], off
    s_mov_b32 exec_hi, -1
    v_add_co_u32 v8, vcc, v8, v12
    v_addc_co_u32 v9, vcc, 0, v9, vcc
    ds_read_b64_tr_b16 v[76:77], v17 offset:0
    ds_read_b64_tr_b16 v[78:79], v17 offset:2560
    v_mfma_f32_16x16x32_bf16 v[240:243], v[92:95], v[48:51], v[240:243]
    v_mfma_f32_16x16x32_bf16 v[244:247], v[92:95], v[52:55], v[244:247]
    v_mfma_f32_16x16x32_bf16 v[248:251], v[92:95], v[56:59], v[248:251]
    v_mfma_f32_16x16x32_bf16 v[252:255], v[92:95], v[60:63], v[252:255]
    ds_read_b64_tr_b16 v[80:81], v18 offset:0
    ds_read_b64_tr_b16 v[82:83], v18 offset:2560
    ds_read_b64_tr_b16 v[84:85], v19 offset:0
    ds_read_b64_tr_b16 v[86:87], v19 offset:2560
    s_waitcnt lgkmcnt(8)
    v_mfma_f32_16x16x32_bf16 v[96:99], v[64:67], v[32:35], v[96:99]
    v_mfma_f32_16x16x32_bf16 v[100:103], v[64:67], v[36:39], v[100:103]
    v_mfma_f32_16x16x32_bf16 v[104:107], v[64:67], v[40:43], v[104:107]
    v_mfma_f32_16x16x32_bf16 v[108:111], v[64:67], v[44:47], v[108:111]
    ds_read_b64_tr_b16 v[88:89], v20 offset:0
    ds_read_b64_tr_b16 v[90:91], v20 offset:2560
    ds_read_b64_tr_b16 v[92:93], v21 offset:0
    ds_read_b64_tr_b16 v[94:95], v21 offset:2560
    v_mfma_f32_16x16x32_bf16 v[112:115], v[68:71], v[32:35], v[112:115]
    v_mfma_f32_16x16x32_bf16 v[116:119], v[68:71], v[36:39], v[116:119]
    v_mfma_f32_16x16x32_bf16 v[120:123], v[68:71], v[40:43], v[120:123]
    v_mfma_f32_16x16x32_bf16 v[124:127], v[68:71], v[44:47], v[124:127]
    ds_read_b64_tr_b16 v[64:65], v22 offset:0
    ds_read_b64_tr_b16 v[66:67], v22 offset:2560
    ds_read_b64_tr_b16 v[68:69], v23 offset:0
    ds_read_b64_tr_b16 v[70:71], v23 offset:2560
    s_waitcnt lgkmcnt(14)
    v_mfma_f32_16x16x32_bf16 v[128:131], v[72:75], v[32:35], v[128:131]
    v_mfma_f32_16x16x32_bf16 v[132:135], v[72:75], v[36:39], v[132:135]
    v_mfma_f32_16x16x32_bf16 v[136:139], v[72:75], v[40:43], v[136:139]
    v_mfma_f32_16x16x32_bf16 v[140:143], v[72:75], v[44:47], v[140:143]
    s_waitcnt lgkmcnt(12)
    v_mfma_f32_16x16x32_bf16 v[144:147], v[76:79], v[32:35], v[144:147]
    v_mfma_f32_16x16x32_bf16 v[148:151], v[76:79], v[36:39], v[148:151]
    v_mfma_f32_16x16x32_bf16 v[152:155], v[76:79], v[40:43], v[152:155]
    v_mfma_f32_16x16x32_bf16 v[156:159], v[76:79], v[44:47], v[156:159]
    s_waitcnt lgkmcnt(10)
    v_mfma_f32_16x16x32_bf16 v[160:163], v[80:83], v[32:35], v[160:163]
    v_mfma_f32_16x16x32_bf16 v[164:167], v[80:83], v[36:39], v[164:167]
    v_mfma_f32_16x16x32_bf16 v[168:171], v[80:83], v[40:43], v[168:171]
    v_mfma_f32_16x16x32_bf16 v[172:175], v[80:83], v[44:47], v[172:175]
    s_waitcnt lgkmcnt(8)
    v_mfma_f32_16x16x32_bf16 v[176:179], v[84:87], v[32:35], v[176:179]
    v_mfma_f32_16x16x32_bf16 v[180:183], v[84:87], v[36:39], v[180:183]
    v_mfma_f32_16x16x32_bf16 v[184:187], v[84:87], v[40:43], v[184:187]
    v_mfma_f32_16x16x32_bf16 v[188:191], v[84:87], v[44:47], v[188:191]
    s_waitcnt vmcnt(10) lgkmcnt(0)
    s_barrier
    ds_read_b64_tr_b16 v[72:73], v14 offset:20480
    ds_read_b64_tr_b16 v[74:75], v14 offset:23040
    ds_read_b128 v[48:51], v13 offset:16384
    ds_read_b128 v[52:55], v13 offset:17408
    v_mfma_f32_16x16x32_bf16 v[192:195], v[88:91], v[32:35], v[192:195]
    v_mfma_f32_16x16x32_bf16 v[196:199], v[88:91], v[36:39], v[196:199]
    v_mfma_f32_16x16x32_bf16 v[200:203], v[88:91], v[40:43], v[200:203]
    v_mfma_f32_16x16x32_bf16 v[204:207], v[88:91], v[44:47], v[204:207]
    ds_read_b64_tr_b16 v[76:77], v15 offset:20480
    ds_read_b64_tr_b16 v[78:79], v15 offset:23040
    ds_read_b128 v[56:59], v13 offset:18432
    ds_read_b128 v[60:63], v13 offset:19456
    v_mfma_f32_16x16x32_bf16 v[208:211], v[92:95], v[32:35], v[208:211]
    v_mfma_f32_16x16x32_bf16 v[212:215], v[92:95], v[36:39], v[212:215]
    v_mfma_f32_16x16x32_bf16 v[216:219], v[92:95], v[40:43], v[216:219]
    v_mfma_f32_16x16x32_bf16 v[220:223], v[92:95], v[44:47], v[220:223]
    ds_read_b64_tr_b16 v[80:81], v16 offset:20480
    ds_read_b64_tr_b16 v[82:83], v16 offset:23040
    v_mfma_f32_16x16x32_bf16 v[224:227], v[64:67], v[32:35], v[224:227]
    v_mfma_f32_16x16x32_bf16 v[228:231], v[64:67], v[36:39], v[228:231]
    v_mfma_f32_16x16x32_bf16 v[232:235], v[64:67], v[40:43], v[232:235]
    v_mfma_f32_16x16x32_bf16 v[236:239], v[64:67], v[44:47], v[236:239]
    ds_read_b64_tr_b16 v[84:85], v17 offset:20480
    ds_read_b64_tr_b16 v[86:87], v17 offset:23040
    v_mfma_f32_16x16x32_bf16 v[240:243], v[68:71], v[32:35], v[240:243]
    v_mfma_f32_16x16x32_bf16 v[244:247], v[68:71], v[36:39], v[244:247]
    v_mfma_f32_16x16x32_bf16 v[248:251], v[68:71], v[40:43], v[248:251]
    v_mfma_f32_16x16x32_bf16 v[252:255], v[68:71], v[44:47], v[252:255]
    ds_read_b64_tr_b16 v[88:89], v18 offset:20480
    ds_read_b64_tr_b16 v[90:91], v18 offset:23040
    ds_read_b64_tr_b16 v[92:93], v19 offset:20480
    ds_read_b64_tr_b16 v[94:95], v19 offset:23040
    s_waitcnt lgkmcnt(8)
    v_mfma_f32_16x16x32_bf16 v[96:99], v[72:75], v[48:51], v[96:99]
    v_mfma_f32_16x16x32_bf16 v[100:103], v[72:75], v[52:55], v[100:103]
    v_mfma_f32_16x16x32_bf16 v[104:107], v[72:75], v[56:59], v[104:107]
    v_mfma_f32_16x16x32_bf16 v[108:111], v[72:75], v[60:63], v[108:111]
    ds_read_b64_tr_b16 v[64:65], v20 offset:20480
    ds_read_b64_tr_b16 v[66:67], v20 offset:23040
    ds_read_b64_tr_b16 v[68:69], v21 offset:20480
    ds_read_b64_tr_b16 v[70:71], v21 offset:23040
    v_mfma_f32_16x16x32_bf16 v[112:115], v[76:79], v[48:51], v[112:115]
    v_mfma_f32_16x16x32_bf16 v[116:119], v[76:79], v[52:55], v[116:119]
    v_mfma_f32_16x16x32_bf16 v[120:123], v[76:79], v[56:59], v[120:123]
    v_mfma_f32_16x16x32_bf16 v[124:127], v[76:79], v[60:63], v[124:127]
    ds_read_b64_tr_b16 v[72:73], v22 offset:20480
    ds_read_b64_tr_b16 v[74:75], v22 offset:23040
    ds_read_b64_tr_b16 v[76:77], v23 offset:20480
    ds_read_b64_tr_b16 v[78:79], v23 offset:23040
    s_waitcnt lgkmcnt(14)
    v_mfma_f32_16x16x32_bf16 v[128:131], v[80:83], v[48:51], v[128:131]
    v_mfma_f32_16x16x32_bf16 v[132:135], v[80:83], v[52:55], v[132:135]
    v_mfma_f32_16x16x32_bf16 v[136:139], v[80:83], v[56:59], v[136:139]
    v_mfma_f32_16x16x32_bf16 v[140:143], v[80:83], v[60:63], v[140:143]
    s_waitcnt lgkmcnt(12)
    v_mfma_f32_16x16x32_bf16 v[144:147], v[84:87], v[48:51], v[144:147]
    v_mfma_f32_16x16x32_bf16 v[148:151], v[84:87], v[52:55], v[148:151]
    v_mfma_f32_16x16x32_bf16 v[152:155], v[84:87], v[56:59], v[152:155]
    v_mfma_f32_16x16x32_bf16 v[156:159], v[84:87], v[60:63], v[156:159]
    s_waitcnt lgkmcnt(10)
    v_mfma_f32_16x16x32_bf16 v[160:163], v[88:91], v[48:51], v[160:163]
    v_mfma_f32_16x16x32_bf16 v[164:167], v[88:91], v[52:55], v[164:167]
    v_mfma_f32_16x16x32_bf16 v[168:171], v[88:91], v[56:59], v[168:171]
    v_mfma_f32_16x16x32_bf16 v[172:175], v[88:91], v[60:63], v[172:175]
    s_waitcnt lgkmcnt(8)
    v_mfma_f32_16x16x32_bf16 v[176:179], v[92:95], v[48:51], v[176:179]
    v_mfma_f32_16x16x32_bf16 v[180:183], v[92:95], v[52:55], v[180:183]
    v_mfma_f32_16x16x32_bf16 v[184:187], v[92:95], v[56:59], v[184:187]
    v_mfma_f32_16x16x32_bf16 v[188:191], v[92:95], v[60:63], v[188:191]
    s_waitcnt vmcnt(5) lgkmcnt(0)
    s_barrier
    ds_read_b64_tr_b16 v[80:81], v14 offset:40960
    ds_read_b64_tr_b16 v[82:83], v14 offset:43520
    ds_read_b128 v[32:35], v13 offset:32768
    ds_read_b128 v[36:39], v13 offset:33792
    v_mfma_f32_16x16x32_bf16 v[192:195], v[64:67], v[48:51], v[192:195]
    v_mfma_f32_16x16x32_bf16 v[196:199], v[64:67], v[52:55], v[196:199]
    v_mfma_f32_16x16x32_bf16 v[200:203], v[64:67], v[56:59], v[200:203]
    v_mfma_f32_16x16x32_bf16 v[204:207], v[64:67], v[60:63], v[204:207]
    ds_read_b64_tr_b16 v[84:85], v15 offset:40960
    ds_read_b64_tr_b16 v[86:87], v15 offset:43520
    ds_read_b128 v[40:43], v13 offset:34816
    ds_read_b128 v[44:47], v13 offset:35840
    v_mfma_f32_16x16x32_bf16 v[208:211], v[68:71], v[48:51], v[208:211]
    v_mfma_f32_16x16x32_bf16 v[212:215], v[68:71], v[52:55], v[212:215]
    v_mfma_f32_16x16x32_bf16 v[216:219], v[68:71], v[56:59], v[216:219]
    v_mfma_f32_16x16x32_bf16 v[220:223], v[68:71], v[60:63], v[220:223]
    ds_read_b64_tr_b16 v[88:89], v16 offset:40960
    ds_read_b64_tr_b16 v[90:91], v16 offset:43520
    v_mfma_f32_16x16x32_bf16 v[224:227], v[72:75], v[48:51], v[224:227]
    v_mfma_f32_16x16x32_bf16 v[228:231], v[72:75], v[52:55], v[228:231]
    v_mfma_f32_16x16x32_bf16 v[232:235], v[72:75], v[56:59], v[232:235]
    v_mfma_f32_16x16x32_bf16 v[236:239], v[72:75], v[60:63], v[236:239]
    ds_read_b64_tr_b16 v[92:93], v17 offset:40960
    ds_read_b64_tr_b16 v[94:95], v17 offset:43520
    v_mfma_f32_16x16x32_bf16 v[240:243], v[76:79], v[48:51], v[240:243]
    v_mfma_f32_16x16x32_bf16 v[244:247], v[76:79], v[52:55], v[244:247]
    v_mfma_f32_16x16x32_bf16 v[248:251], v[76:79], v[56:59], v[248:251]
    v_mfma_f32_16x16x32_bf16 v[252:255], v[76:79], v[60:63], v[252:255]
    ds_read_b64_tr_b16 v[64:65], v18 offset:40960
    ds_read_b64_tr_b16 v[66:67], v18 offset:43520
    ds_read_b64_tr_b16 v[68:69], v19 offset:40960
    ds_read_b64_tr_b16 v[70:71], v19 offset:43520
    s_waitcnt lgkmcnt(8)
    v_mfma_f32_16x16x32_bf16 v[96:99], v[80:83], v[32:35], v[96:99]
    v_mfma_f32_16x16x32_bf16 v[100:103], v[80:83], v[36:39], v[100:103]
    v_mfma_f32_16x16x32_bf16 v[104:107], v[80:83], v[40:43], v[104:107]
    v_mfma_f32_16x16x32_bf16 v[108:111], v[80:83], v[44:47], v[108:111]
    ds_read_b64_tr_b16 v[72:73], v20 offset:40960
    ds_read_b64_tr_b16 v[74:75], v20 offset:43520
    ds_read_b64_tr_b16 v[76:77], v21 offset:40960
    ds_read_b64_tr_b16 v[78:79], v21 offset:43520
    v_mfma_f32_16x16x32_bf16 v[112:115], v[84:87], v[32:35], v[112:115]
    v_mfma_f32_16x16x32_bf16 v[116:119], v[84:87], v[36:39], v[116:119]
    v_mfma_f32_16x16x32_bf16 v[120:123], v[84:87], v[40:43], v[120:123]
    v_mfma_f32_16x16x32_bf16 v[124:127], v[84:87], v[44:47], v[124:127]
    ds_read_b64_tr_b16 v[80:81], v22 offset:40960
    ds_read_b64_tr_b16 v[82:83], v22 offset:43520
    ds_read_b64_tr_b16 v[84:85], v23 offset:40960
    ds_read_b64_tr_b16 v[86:87], v23 offset:43520
    s_waitcnt lgkmcnt(14)
    v_mfma_f32_16x16x32_bf16 v[128:131], v[88:91], v[32:35], v[128:131]
    v_mfma_f32_16x16x32_bf16 v[132:135], v[88:91], v[36:39], v[132:135]
    v_mfma_f32_16x16x32_bf16 v[136:139], v[88:91], v[40:43], v[136:139]
    v_mfma_f32_16x16x32_bf16 v[140:143], v[88:91], v[44:47], v[140:143]
    s_waitcnt lgkmcnt(12)
    v_mfma_f32_16x16x32_bf16 v[144:147], v[92:95], v[32:35], v[144:147]
    v_mfma_f32_16x16x32_bf16 v[148:151], v[92:95], v[36:39], v[148:151]
    v_mfma_f32_16x16x32_bf16 v[152:155], v[92:95], v[40:43], v[152:155]
    v_mfma_f32_16x16x32_bf16 v[156:159], v[92:95], v[44:47], v[156:159]
    s_waitcnt lgkmcnt(10)
    v_mfma_f32_16x16x32_bf16 v[160:163], v[64:67], v[32:35], v[160:163]
    v_mfma_f32_16x16x32_bf16 v[164:167], v[64:67], v[36:39], v[164:167]
    v_mfma_f32_16x16x32_bf16 v[168:171], v[64:67], v[40:43], v[168:171]
    v_mfma_f32_16x16x32_bf16 v[172:175], v[64:67], v[44:47], v[172:175]
    s_waitcnt lgkmcnt(8)
    v_mfma_f32_16x16x32_bf16 v[176:179], v[68:71], v[32:35], v[176:179]
    v_mfma_f32_16x16x32_bf16 v[180:183], v[68:71], v[36:39], v[180:183]
    v_mfma_f32_16x16x32_bf16 v[184:187], v[68:71], v[40:43], v[184:187]
    v_mfma_f32_16x16x32_bf16 v[188:191], v[68:71], v[44:47], v[188:191]
    s_waitcnt vmcnt(0) lgkmcnt(0)
    s_barrier
    ds_read_b64_tr_b16 v[88:89], v14 offset:61440
    ds_read_b64_tr_b16 v[90:91], v14 offset:64000
    ds_read_b128 v[48:51], v13 offset:49152
    ds_read_b128 v[52:55], v13 offset:50176
    v_mfma_f32_16x16x32_bf16 v[192:195], v[72:75], v[32:35], v[192:195]
    v_mfma_f32_16x16x32_bf16 v[196:199], v[72:75], v[36:39], v[196:199]
    v_mfma_f32_16x16x32_bf16 v[200:203], v[72:75], v[40:43], v[200:203]
    v_mfma_f32_16x16x32_bf16 v[204:207], v[72:75], v[44:47], v[204:207]
    ds_read_b64_tr_b16 v[92:93], v15 offset:61440
    ds_read_b64_tr_b16 v[94:95], v15 offset:64000
    ds_read_b128 v[56:59], v13 offset:51200
    ds_read_b128 v[60:63], v13 offset:52224
    v_mfma_f32_16x16x32_bf16 v[208:211], v[76:79], v[32:35], v[208:211]
    v_mfma_f32_16x16x32_bf16 v[212:215], v[76:79], v[36:39], v[212:215]
    v_mfma_f32_16x16x32_bf16 v[216:219], v[76:79], v[40:43], v[216:219]
    v_mfma_f32_16x16x32_bf16 v[220:223], v[76:79], v[44:47], v[220:223]
    ds_read_b64_tr_b16 v[64:65], v16 offset:61440
    ds_read_b64_tr_b16 v[66:67], v16 offset:64000
    v_mfma_f32_16x16x32_bf16 v[224:227], v[80:83], v[32:35], v[224:227]
    v_mfma_f32_16x16x32_bf16 v[228:231], v[80:83], v[36:39], v[228:231]
    v_mfma_f32_16x16x32_bf16 v[232:235], v[80:83], v[40:43], v[232:235]
    v_mfma_f32_16x16x32_bf16 v[236:239], v[80:83], v[44:47], v[236:239]
    ds_read_b64_tr_b16 v[68:69], v17 offset:61440
    ds_read_b64_tr_b16 v[70:71], v17 offset:64000
    v_mfma_f32_16x16x32_bf16 v[240:243], v[84:87], v[32:35], v[240:243]
    v_mfma_f32_16x16x32_bf16 v[244:247], v[84:87], v[36:39], v[244:247]
    v_mfma_f32_16x16x32_bf16 v[248:251], v[84:87], v[40:43], v[248:251]
    v_mfma_f32_16x16x32_bf16 v[252:255], v[84:87], v[44:47], v[252:255]
    s_lshl_b32 s26, s2, 3
    s_add_u32 s26, s26, s16
    s_lshl_b32 s27, s26, 10
    v_lshlrev_b32 v28, 7, v0
    v_add_u32 v29, s27, v28
    s_mul_i32 s27, s26, 3584
    v_add_u32 v28, s27, v28
    s_mov_b64 exec, 0xff
    global_load_dword v30, v29, s[56:57]
    s_mov_b64 exec, 0xfffffff
    global_load_dword v31, v28, s[58:59]
    s_mov_b64 exec, -1
    ds_read_b64_tr_b16 v[72:73], v18 offset:61440
    ds_read_b64_tr_b16 v[74:75], v18 offset:64000
    ds_read_b64_tr_b16 v[76:77], v19 offset:61440
    ds_read_b64_tr_b16 v[78:79], v19 offset:64000
    s_waitcnt lgkmcnt(8)
    v_mfma_f32_16x16x32_bf16 v[96:99], v[88:91], v[48:51], v[96:99]
    v_mfma_f32_16x16x32_bf16 v[100:103], v[88:91], v[52:55], v[100:103]
    v_mfma_f32_16x16x32_bf16 v[104:107], v[88:91], v[56:59], v[104:107]
    v_mfma_f32_16x16x32_bf16 v[108:111], v[88:91], v[60:63], v[108:111]
    ds_read_b64_tr_b16 v[80:81], v20 offset:61440
    ds_read_b64_tr_b16 v[82:83], v20 offset:64000
    ds_read_b64_tr_b16 v[84:85], v21 offset:61440
    ds_read_b64_tr_b16 v[86:87], v21 offset:64000
    v_mfma_f32_16x16x32_bf16 v[112:115], v[92:95], v[48:51], v[112:115]
    v_mfma_f32_16x16x32_bf16 v[116:119], v[92:95], v[52:55], v[116:119]
    v_mfma_f32_16x16x32_bf16 v[120:123], v[92:95], v[56:59], v[120:123]
    v_mfma_f32_16x16x32_bf16 v[124:127], v[92:95], v[60:63], v[124:127]
    ds_read_b64_tr_b16 v[88:89], v22 offset:61440
    ds_read_b64_tr_b16 v[90:91], v22 offset:64000
    ds_read_b64_tr_b16 v[92:93], v23 offset:61440
    ds_read_b64_tr_b16 v[94:95], v23 offset:64000
    s_waitcnt lgkmcnt(14)
    v_mfma_f32_16x16x32_bf16 v[128:131], v[64:67], v[48:51], v[128:131]
    v_mfma_f32_16x16x32_bf16 v[132:135], v[64:67], v[52:55], v[132:135]
    v_mfma_f32_16x16x32_bf16 v[136:139], v[64:67], v[56:59], v[136:139]
    v_mfma_f32_16x16x32_bf16 v[140:143], v[64:67], v[60:63], v[140:143]
    s_waitcnt lgkmcnt(12)
    v_mfma_f32_16x16x32_bf16 v[144:147], v[68:71], v[48:51], v[144:147]
    v_mfma_f32_16x16x32_bf16 v[148:151], v[68:71], v[52:55], v[148:151]
    v_mfma_f32_16x16x32_bf16 v[152:155], v[68:71], v[56:59], v[152:155]
    v_mfma_f32_16x16x32_bf16 v[156:159], v[68:71], v[60:63], v[156:159]
    s_waitcnt lgkmcnt(10)
    v_mfma_f32_16x16x32_bf16 v[160:163], v[72:75], v[48:51], v[160:163]
    v_mfma_f32_16x16x32_bf16 v[164:167], v[72:75], v[52:55], v[164:167]
    v_mfma_f32_16x16x32_bf16 v[168:171], v[72:75], v[56:59], v[168:171]
    v_mfma_f32_16x16x32_bf16 v[172:175], v[72:75], v[60:63], v[172:175]
    s_waitcnt lgkmcnt(8)
    v_mfma_f32_16x16x32_bf16 v[176:179], v[76:79], v[48:51], v[176:179]
    v_mfma_f32_16x16x32_bf16 v[180:183], v[76:79], v[52:55], v[180:183]
    v_mfma_f32_16x16x32_bf16 v[184:187], v[76:79], v[56:59], v[184:187]
    v_mfma_f32_16x16x32_bf16 v[188:191], v[76:79], v[60:63], v[188:191]
    s_waitcnt lgkmcnt(6)
    v_mfma_f32_16x16x32_bf16 v[192:195], v[80:83], v[48:51], v[192:195]
    v_mfma_f32_16x16x32_bf16 v[196:199], v[80:83], v[52:55], v[196:199]
    v_mfma_f32_16x16x32_bf16 v[200:203], v[80:83], v[56:59], v[200:203]
    v_mfma_f32_16x16x32_bf16 v[204:207], v[80:83], v[60:63], v[204:207]
    s_waitcnt lgkmcnt(4)
    v_mfma_f32_16x16x32_bf16 v[208:211], v[84:87], v[48:51], v[208:211]
    v_mfma_f32_16x16x32_bf16 v[212:215], v[84:87], v[52:55], v[212:215]
    v_mfma_f32_16x16x32_bf16 v[216:219], v[84:87], v[56:59], v[216:219]
    v_mfma_f32_16x16x32_bf16 v[220:223], v[84:87], v[60:63], v[220:223]
    s_waitcnt lgkmcnt(2)
    v_mfma_f32_16x16x32_bf16 v[224:227], v[88:91], v[48:51], v[224:227]
    v_mfma_f32_16x16x32_bf16 v[228:231], v[88:91], v[52:55], v[228:231]
    v_mfma_f32_16x16x32_bf16 v[232:235], v[88:91], v[56:59], v[232:235]
    v_mfma_f32_16x16x32_bf16 v[236:239], v[88:91], v[60:63], v[236:239]
    s_waitcnt lgkmcnt(0)
    v_mfma_f32_16x16x32_bf16 v[240:243], v[92:95], v[48:51], v[240:243]
    v_mfma_f32_16x16x32_bf16 v[244:247], v[92:95], v[52:55], v[244:247]
    v_mfma_f32_16x16x32_bf16 v[248:251], v[92:95], v[56:59], v[248:251]
    v_mfma_f32_16x16x32_bf16 v[252:255], v[92:95], v[60:63], v[252:255]
    s_mov_b32 s46, 0xbdd2d3e8
    s_mov_b32 s47, 0xbdd2d3e8
    s_mov_b32 s48, 1.0
    s_mov_b32 s49, 1.0
    v_mov_b32 v26, 0xc0135761
    v_mov_b32 v27, 0xc0135761
    s_lshl_b32 s50, s14, 4
    s_lshl_b32 s26, s17, 2
    s_add_u32 s50, s50, s26
    s_lshl_b32 s26, s18, 3
    v_add_u32 v25, s26, v24
    s_nop 7
    s_mul_i32 s51, s18, 3
    s_add_u32 s51, s51, 0
    s_lshl_b32 s26, s51, 2
    s_cmp_lt_u32 s26, s22
    s_cbranch_scc0 K1_Q_3
    s_mul_i32 s26, s15, 5
    s_add_u32 s26, s26, s51
    s_add_u32 s26, s26, 32
    s_mul_i32 s52, s50, 144
    s_add_u32 s52, s52, s26
    s_lshl_b32 s52, s52, 10
    v_cvt_pk_bf16_f32 v96, 0, v96
    v_cvt_pk_bf16_f32 v97, 0, v97
    v_cvt_pk_bf16_f32 v176, 0, v176
    v_cvt_pk_bf16_f32 v177, 0, v177
    v_pk_mul_f32 v[50:51], v[96:97], v[96:97]
    v_pk_fma_f32 v[50:51], v[50:51], s[46:47], v[26:27]
    v_pk_mul_f32 v[50:51], v[50:51], v[96:97]
    v_exp_f32 v50, v50
    v_exp_f32 v51, v51
    s_nop 0
    v_pk_add_f32 v[50:51], v[50:51], s[48:49]
    v_rcp_f32 v50, v50
    v_rcp_f32 v51, v51
    s_nop 0
    v_pk_mul_f32 v[96:97], v[50:51], v[96:97]
    v_cvt_pk_bf16_f32 v96, 0, v96
    v_cvt_pk_bf16_f32 v97, 0, v97
    v_pk_mul_f32 v[96:97], v[96:97], v[176:177]
    v_cvt_pk_bf16_f32 v32, v96, v97
    v_cvt_pk_bf16_f32 v98, 0, v98
    v_cvt_pk_bf16_f32 v99, 0, v99
    v_cvt_pk_bf16_f32 v178, 0, v178
    v_cvt_pk_bf16_f32 v179, 0, v179
    v_pk_mul_f32 v[58:59], v[98:99], v[98:99]
    v_pk_fma_f32 v[58:59], v[58:59], s[46:47], v[26:27]
    v_pk_mul_f32 v[58:59], v[58:59], v[98:99]
    v_exp_f32 v58, v58
    v_exp_f32 v59, v59
    s_nop 0
    v_pk_add_f32 v[58:59], v[58:59], s[48:49]
    v_rcp_f32 v58, v58
    v_rcp_f32 v59, v59
    s_nop 0
    v_pk_mul_f32 v[98:99], v[58:59], v[98:99]
    v_cvt_pk_bf16_f32 v98, 0, v98
    v_cvt_pk_bf16_f32 v99, 0, v99
    v_pk_mul_f32 v[98:99], v[98:99], v[178:179]
    v_cvt_pk_bf16_f32 v33, v98, v99
    v_cvt_pk_bf16_f32 v112, 0, v112
    v_cvt_pk_bf16_f32 v113, 0, v113
    v_cvt_pk_bf16_f32 v192, 0, v192
    v_cvt_pk_bf16_f32 v193, 0, v193
    v_pk_mul_f32 v[50:51], v[112:113], v[112:113]
    v_pk_fma_f32 v[50:51], v[50:51], s[46:47], v[26:27]
    v_pk_mul_f32 v[50:51], v[50:51], v[112:113]
    v_exp_f32 v50, v50
    v_exp_f32 v51, v51
    s_nop 0
    v_pk_add_f32 v[50:51], v[50:51], s[48:49]
    v_rcp_f32 v50, v50
    v_rcp_f32 v51, v51
    s_nop 0
    v_pk_mul_f32 v[112:113], v[50:51], v[112:113]
    v_cvt_pk_bf16_f32 v112, 0, v112
    v_cvt_pk_bf16_f32 v113, 0, v113
    v_pk_mul_f32 v[112:113], v[112:113], v[192:193]
    v_cvt_pk_bf16_f32 v34, v112, v113
    v_cvt_pk_bf16_f32 v114, 0, v114
    v_cvt_pk_bf16_f32 v115, 0, v115
    v_cvt_pk_bf16_f32 v194, 0, v194
    v_cvt_pk_bf16_f32 v195, 0, v195
    v_pk_mul_f32 v[58:59], v[114:115], v[114:115]
    v_pk_fma_f32 v[58:59], v[58:59], s[46:47], v[26:27]
    v_pk_mul_f32 v[58:59], v[58:59], v[114:115]
    v_exp_f32 v58, v58
    v_exp_f32 v59, v59
    s_nop 0
    v_pk_add_f32 v[58:59], v[58:59], s[48:49]
    v_rcp_f32 v58, v58
    v_rcp_f32 v59, v59
    s_nop 0
    v_pk_mul_f32 v[114:115], v[58:59], v[114:115]
    v_cvt_pk_bf16_f32 v114, 0, v114
    v_cvt_pk_bf16_f32 v115, 0, v115
    v_pk_mul_f32 v[114:115], v[114:115], v[194:195]
    v_cvt_pk_bf16_f32 v35, v114, v115
    buffer_store_dwordx4 v[32:35], v24, s[40:43], s52 offen
    s_add_u32 s52, s52, 147456
    v_cvt_pk_bf16_f32 v100, 0, v100
    v_cvt_pk_bf16_f32 v101, 0, v101
    v_cvt_pk_bf16_f32 v180, 0, v180
    v_cvt_pk_bf16_f32 v181, 0, v181
    v_pk_mul_f32 v[50:51], v[100:101], v[100:101]
    v_pk_fma_f32 v[50:51], v[50:51], s[46:47], v[26:27]
    v_pk_mul_f32 v[50:51], v[50:51], v[100:101]
    v_exp_f32 v50, v50
    v_exp_f32 v51, v51
    s_nop 0
    v_pk_add_f32 v[50:51], v[50:51], s[48:49]
    v_rcp_f32 v50, v50
    v_rcp_f32 v51, v51
    s_nop 0
    v_pk_mul_f32 v[100:101], v[50:51], v[100:101]
    v_cvt_pk_bf16_f32 v100, 0, v100
    v_cvt_pk_bf16_f32 v101, 0, v101
    v_pk_mul_f32 v[100:101], v[100:101], v[180:181]
    v_cvt_pk_bf16_f32 v40, v100, v101
    v_cvt_pk_bf16_f32 v102, 0, v102
    v_cvt_pk_bf16_f32 v103, 0, v103
    v_cvt_pk_bf16_f32 v182, 0, v182
    v_cvt_pk_bf16_f32 v183, 0, v183
    v_pk_mul_f32 v[58:59], v[102:103], v[102:103]
    v_pk_fma_f32 v[58:59], v[58:59], s[46:47], v[26:27]
    v_pk_mul_f32 v[58:59], v[58:59], v[102:103]
    v_exp_f32 v58, v58
    v_exp_f32 v59, v59
    s_nop 0
    v_pk_add_f32 v[58:59], v[58:59], s[48:49]
    v_rcp_f32 v58, v58
    v_rcp_f32 v59, v59
    s_nop 0
    v_pk_mul_f32 v[102:103], v[58:59], v[102:103]
    v_cvt_pk_bf16_f32 v102, 0, v102
    v_cvt_pk_bf16_f32 v103, 0, v103
    v_pk_mul_f32 v[102:103], v[102:103], v[182:183]
    v_cvt_pk_bf16_f32 v41, v102, v103
    v_cvt_pk_bf16_f32 v116, 0, v116
    v_cvt_pk_bf16_f32 v117, 0, v117
    v_cvt_pk_bf16_f32 v196, 0, v196
    v_cvt_pk_bf16_f32 v197, 0, v197
    v_pk_mul_f32 v[50:51], v[116:117], v[116:117]
    v_pk_fma_f32 v[50:51], v[50:51], s[46:47], v[26:27]
    v_pk_mul_f32 v[50:51], v[50:51], v[116:117]
    v_exp_f32 v50, v50
    v_exp_f32 v51, v51
    s_nop 0
    v_pk_add_f32 v[50:51], v[50:51], s[48:49]
    v_rcp_f32 v50, v50
    v_rcp_f32 v51, v51
    s_nop 0
    v_pk_mul_f32 v[116:117], v[50:51], v[116:117]
    v_cvt_pk_bf16_f32 v116, 0, v116
    v_cvt_pk_bf16_f32 v117, 0, v117
    v_pk_mul_f32 v[116:117], v[116:117], v[196:197]
    v_cvt_pk_bf16_f32 v42, v116, v117
    v_cvt_pk_bf16_f32 v118, 0, v118
    v_cvt_pk_bf16_f32 v119, 0, v119
    v_cvt_pk_bf16_f32 v198, 0, v198
    v_cvt_pk_bf16_f32 v199, 0, v199
    v_pk_mul_f32 v[58:59], v[118:119], v[118:119]
    v_pk_fma_f32 v[58:59], v[58:59], s[46:47], v[26:27]
    v_pk_mul_f32 v[58:59], v[58:59], v[118:119]
    v_exp_f32 v58, v58
    v_exp_f32 v59, v59
    s_nop 0
    v_pk_add_f32 v[58:59], v[58:59], s[48:49]
    v_rcp_f32 v58, v58
    v_rcp_f32 v59, v59
    s_nop 0
    v_pk_mul_f32 v[118:119], v[58:59], v[118:119]
    v_cvt_pk_bf16_f32 v118, 0, v118
    v_cvt_pk_bf16_f32 v119, 0, v119
    v_pk_mul_f32 v[118:119], v[118:119], v[198:199]
    v_cvt_pk_bf16_f32 v43, v118, v119
    buffer_store_dwordx4 v[40:43], v24, s[40:43], s52 offen
    s_add_u32 s52, s52, 147456
    v_cvt_pk_bf16_f32 v104, 0, v104
    v_cvt_pk_bf16_f32 v105, 0, v105
    v_cvt_pk_bf16_f32 v184, 0, v184
    v_cvt_pk_bf16_f32 v185, 0, v185
    v_pk_mul_f32 v[50:51], v[104:105], v[104:105]
    v_pk_fma_f32 v[50:51], v[50:51], s[46:47], v[26:27]
    v_pk_mul_f32 v[50:51], v[50:51], v[104:105]
    v_exp_f32 v50, v50
    v_exp_f32 v51, v51
    s_nop 0
    v_pk_add_f32 v[50:51], v[50:51], s[48:49]
    v_rcp_f32 v50, v50
    v_rcp_f32 v51, v51
    s_nop 0
    v_pk_mul_f32 v[104:105], v[50:51], v[104:105]
    v_cvt_pk_bf16_f32 v104, 0, v104
    v_cvt_pk_bf16_f32 v105, 0, v105
    v_pk_mul_f32 v[104:105], v[104:105], v[184:185]
    v_cvt_pk_bf16_f32 v32, v104, v105
    v_cvt_pk_bf16_f32 v106, 0, v106
    v_cvt_pk_bf16_f32 v107, 0, v107
    v_cvt_pk_bf16_f32 v186, 0, v186
    v_cvt_pk_bf16_f32 v187, 0, v187
    v_pk_mul_f32 v[58:59], v[106:107], v[106:107]
    v_pk_fma_f32 v[58:59], v[58:59], s[46:47], v[26:27]
    v_pk_mul_f32 v[58:59], v[58:59], v[106:107]
    v_exp_f32 v58, v58
    v_exp_f32 v59, v59
    s_nop 0
    v_pk_add_f32 v[58:59], v[58:59], s[48:49]
    v_rcp_f32 v58, v58
    v_rcp_f32 v59, v59
    s_nop 0
    v_pk_mul_f32 v[106:107], v[58:59], v[106:107]
    v_cvt_pk_bf16_f32 v106, 0, v106
    v_cvt_pk_bf16_f32 v107, 0, v107
    v_pk_mul_f32 v[106:107], v[106:107], v[186:187]
    v_cvt_pk_bf16_f32 v33, v106, v107
    v_cvt_pk_bf16_f32 v120, 0, v120
    v_cvt_pk_bf16_f32 v121, 0, v121
    v_cvt_pk_bf16_f32 v200, 0, v200
    v_cvt_pk_bf16_f32 v201, 0, v201
    v_pk_mul_f32 v[50:51], v[120:121], v[120:121]
    v_pk_fma_f32 v[50:51], v[50:51], s[46:47], v[26:27]
    v_pk_mul_f32 v[50:51], v[50:51], v[120:121]
    v_exp_f32 v50, v50
    v_exp_f32 v51, v51
    s_nop 0
    v_pk_add_f32 v[50:51], v[50:51], s[48:49]
    v_rcp_f32 v50, v50
    v_rcp_f32 v51, v51
    s_nop 0
    v_pk_mul_f32 v[120:121], v[50:51], v[120:121]
    v_cvt_pk_bf16_f32 v120, 0, v120
    v_cvt_pk_bf16_f32 v121, 0, v121
    v_pk_mul_f32 v[120:121], v[120:121], v[200:201]
    v_cvt_pk_bf16_f32 v34, v120, v121
    v_cvt_pk_bf16_f32 v122, 0, v122
    v_cvt_pk_bf16_f32 v123, 0, v123
    v_cvt_pk_bf16_f32 v202, 0, v202
    v_cvt_pk_bf16_f32 v203, 0, v203
    v_pk_mul_f32 v[58:59], v[122:123], v[122:123]
    v_pk_fma_f32 v[58:59], v[58:59], s[46:47], v[26:27]
    v_pk_mul_f32 v[58:59], v[58:59], v[122:123]
    v_exp_f32 v58, v58
    v_exp_f32 v59, v59
    s_nop 0
    v_pk_add_f32 v[58:59], v[58:59], s[48:49]
    v_rcp_f32 v58, v58
    v_rcp_f32 v59, v59
    s_nop 0
    v_pk_mul_f32 v[122:123], v[58:59], v[122:123]
    v_cvt_pk_bf16_f32 v122, 0, v122
    v_cvt_pk_bf16_f32 v123, 0, v123
    v_pk_mul_f32 v[122:123], v[122:123], v[202:203]
    v_cvt_pk_bf16_f32 v35, v122, v123
    buffer_store_dwordx4 v[32:35], v24, s[40:43], s52 offen
    s_add_u32 s52, s52, 147456
    v_cvt_pk_bf16_f32 v108, 0, v108
    v_cvt_pk_bf16_f32 v109, 0, v109
    v_cvt_pk_bf16_f32 v188, 0, v188
    v_cvt_pk_bf16_f32 v189, 0, v189
    v_pk_mul_f32 v[50:51], v[108:109], v[108:109]
    v_pk_fma_f32 v[50:51], v[50:51], s[46:47], v[26:27]
    v_pk_mul_f32 v[50:51], v[50:51], v[108:109]
    v_exp_f32 v50, v50
    v_exp_f32 v51, v51
    s_nop 0
    v_pk_add_f32 v[50:51], v[50:51], s[48:49]
    v_rcp_f32 v50, v50
    v_rcp_f32 v51, v51
    s_nop 0
    v_pk_mul_f32 v[108:109], v[50:51], v[108:109]
    v_cvt_pk_bf16_f32 v108, 0, v108
    v_cvt_pk_bf16_f32 v109, 0, v109
    v_pk_mul_f32 v[108:109], v[108:109], v[188:189]
    v_cvt_pk_bf16_f32 v40, v108, v109
    v_cvt_pk_bf16_f32 v110, 0, v110
    v_cvt_pk_bf16_f32 v111, 0, v111
    v_cvt_pk_bf16_f32 v190, 0, v190
    v_cvt_pk_bf16_f32 v191, 0, v191
    v_pk_mul_f32 v[58:59], v[110:111], v[110:111]
    v_pk_fma_f32 v[58:59], v[58:59], s[46:47], v[26:27]
    v_pk_mul_f32 v[58:59], v[58:59], v[110:111]
    v_exp_f32 v58, v58
    v_exp_f32 v59, v59
    s_nop 0
    v_pk_add_f32 v[58:59], v[58:59], s[48:49]
    v_rcp_f32 v58, v58
    v_rcp_f32 v59, v59
    s_nop 0
    v_pk_mul_f32 v[110:111], v[58:59], v[110:111]
    v_cvt_pk_bf16_f32 v110, 0, v110
    v_cvt_pk_bf16_f32 v111, 0, v111
    v_pk_mul_f32 v[110:111], v[110:111], v[190:191]
    v_cvt_pk_bf16_f32 v41, v110, v111
    v_cvt_pk_bf16_f32 v124, 0, v124
    v_cvt_pk_bf16_f32 v125, 0, v125
    v_cvt_pk_bf16_f32 v204, 0, v204
    v_cvt_pk_bf16_f32 v205, 0, v205
    v_pk_mul_f32 v[50:51], v[124:125], v[124:125]
    v_pk_fma_f32 v[50:51], v[50:51], s[46:47], v[26:27]
    v_pk_mul_f32 v[50:51], v[50:51], v[124:125]
    v_exp_f32 v50, v50
    v_exp_f32 v51, v51
    s_nop 0
    v_pk_add_f32 v[50:51], v[50:51], s[48:49]
    v_rcp_f32 v50, v50
    v_rcp_f32 v51, v51
    s_nop 0
    v_pk_mul_f32 v[124:125], v[50:51], v[124:125]
    v_cvt_pk_bf16_f32 v124, 0, v124
    v_cvt_pk_bf16_f32 v125, 0, v125
    v_pk_mul_f32 v[124:125], v[124:125], v[204:205]
    v_cvt_pk_bf16_f32 v42, v124, v125
    v_cvt_pk_bf16_f32 v126, 0, v126
    v_cvt_pk_bf16_f32 v127, 0, v127
    v_cvt_pk_bf16_f32 v206, 0, v206
    v_cvt_pk_bf16_f32 v207, 0, v207
    v_pk_mul_f32 v[58:59], v[126:127], v[126:127]
    v_pk_fma_f32 v[58:59], v[58:59], s[46:47], v[26:27]
    v_pk_mul_f32 v[58:59], v[58:59], v[126:127]
    v_exp_f32 v58, v58
    v_exp_f32 v59, v59
    s_nop 0
    v_pk_add_f32 v[58:59], v[58:59], s[48:49]
    v_rcp_f32 v58, v58
    v_rcp_f32 v59, v59
    s_nop 0
    v_pk_mul_f32 v[126:127], v[58:59], v[126:127]
    v_cvt_pk_bf16_f32 v126, 0, v126
    v_cvt_pk_bf16_f32 v127, 0, v127
    v_pk_mul_f32 v[126:127], v[126:127], v[206:207]
    v_cvt_pk_bf16_f32 v43, v126, v127
    buffer_store_dwordx4 v[40:43], v24, s[40:43], s52 offen
    s_branch K1_D_4
K1_Q_3:
    s_ashr_i32 s26, s24, 5
    s_add_u32 s26, s26, s51
    s_lshl_b32 s26, s26, 7
    s_add_u32 s26, s26, s50
    s_lshl_b32 s26, s26, 10
    s_add_u32 s52, s26, 0x1400000
    s_ashr_i32 s26, s25, 5
    s_add_u32 s26, s26, s51
    s_lshl_b32 s26, s26, 7
    s_add_u32 s26, s26, s50
    s_lshl_b32 s26, s26, 10
    s_add_u32 s53, s26, 0x1400000
    v_cvt_pk_bf16_f32 v32, v96, v97
    v_cvt_pk_bf16_f32 v33, v98, v99
    v_cvt_pk_bf16_f32 v34, v112, v113
    v_cvt_pk_bf16_f32 v35, v114, v115
    buffer_store_dwordx4 v[32:35], v24, s[40:43], s52 offen offset:0
    v_cvt_pk_bf16_f32 v36, v176, v177
    v_cvt_pk_bf16_f32 v37, v178, v179
    v_cvt_pk_bf16_f32 v38, v192, v193
    v_cvt_pk_bf16_f32 v39, v194, v195
    buffer_store_dwordx4 v[36:39], v24, s[40:43], s53 offen offset:0
    v_cvt_pk_bf16_f32 v40, v100, v101
    v_cvt_pk_bf16_f32 v41, v102, v103
    v_cvt_pk_bf16_f32 v42, v116, v117
    v_cvt_pk_bf16_f32 v43, v118, v119
    buffer_store_dwordx4 v[40:43], v24, s[40:43], s52 offen offset:1024
    v_cvt_pk_bf16_f32 v44, v180, v181
    v_cvt_pk_bf16_f32 v45, v182, v183
    v_cvt_pk_bf16_f32 v46, v196, v197
    v_cvt_pk_bf16_f32 v47, v198, v199
    buffer_store_dwordx4 v[44:47], v24, s[40:43], s53 offen offset:1024
    v_cvt_pk_bf16_f32 v48, v104, v105
    v_cvt_pk_bf16_f32 v49, v106, v107
    v_cvt_pk_bf16_f32 v50, v120, v121
    v_cvt_pk_bf16_f32 v51, v122, v123
    buffer_store_dwordx4 v[48:51], v24, s[40:43], s52 offen offset:2048
    v_cvt_pk_bf16_f32 v52, v184, v185
    v_cvt_pk_bf16_f32 v53, v186, v187
    v_cvt_pk_bf16_f32 v54, v200, v201
    v_cvt_pk_bf16_f32 v55, v202, v203
    buffer_store_dwordx4 v[52:55], v24, s[40:43], s53 offen offset:2048
    v_cvt_pk_bf16_f32 v56, v108, v109
    v_cvt_pk_bf16_f32 v57, v110, v111
    v_cvt_pk_bf16_f32 v58, v124, v125
    v_cvt_pk_bf16_f32 v59, v126, v127
    buffer_store_dwordx4 v[56:59], v24, s[40:43], s52 offen offset:3072
    v_cvt_pk_bf16_f32 v60, v188, v189
    v_cvt_pk_bf16_f32 v61, v190, v191
    v_cvt_pk_bf16_f32 v62, v204, v205
    v_cvt_pk_bf16_f32 v63, v206, v207
    buffer_store_dwordx4 v[60:63], v24, s[40:43], s53 offen offset:3072
K1_D_4:
    s_nop 1
    s_mul_i32 s51, s18, 3
    s_add_u32 s51, s51, 1
    s_lshl_b32 s26, s51, 2
    s_cmp_lt_u32 s26, s22
    s_cbranch_scc0 K1_Q_5
    s_mul_i32 s26, s15, 5
    s_add_u32 s26, s26, s51
    s_add_u32 s26, s26, 32
    s_mul_i32 s52, s50, 144
    s_add_u32 s52, s52, s26
    s_lshl_b32 s52, s52, 10
    v_cvt_pk_bf16_f32 v128, 0, v128
    v_cvt_pk_bf16_f32 v129, 0, v129
    v_cvt_pk_bf16_f32 v208, 0, v208
    v_cvt_pk_bf16_f32 v209, 0, v209
    v_pk_mul_f32 v[50:51], v[128:129], v[128:129]
    v_pk_fma_f32 v[50:51], v[50:51], s[46:47], v[26:27]
    v_pk_mul_f32 v[50:51], v[50:51], v[128:129]
    v_exp_f32 v50, v50
    v_exp_f32 v51, v51
    s_nop 0
    v_pk_add_f32 v[50:51], v[50:51], s[48:49]
    v_rcp_f32 v50, v50
    v_rcp_f32 v51, v51
    s_nop 0
    v_pk_mul_f32 v[128:129], v[50:51], v[128:129]
    v_cvt_pk_bf16_f32 v128, 0, v128
    v_cvt_pk_bf16_f32 v129, 0, v129
    v_pk_mul_f32 v[128:129], v[128:129], v[208:209]
    v_cvt_pk_bf16_f32 v32, v128, v129
    v_cvt_pk_bf16_f32 v130, 0, v130
    v_cvt_pk_bf16_f32 v131, 0, v131
    v_cvt_pk_bf16_f32 v210, 0, v210
    v_cvt_pk_bf16_f32 v211, 0, v211
    v_pk_mul_f32 v[58:59], v[130:131], v[130:131]
    v_pk_fma_f32 v[58:59], v[58:59], s[46:47], v[26:27]
    v_pk_mul_f32 v[58:59], v[58:59], v[130:131]
    v_exp_f32 v58, v58
    v_exp_f32 v59, v59
    s_nop 0
    v_pk_add_f32 v[58:59], v[58:59], s[48:49]
    v_rcp_f32 v58, v58
    v_rcp_f32 v59, v59
    s_nop 0
    v_pk_mul_f32 v[130:131], v[58:59], v[130:131]
    v_cvt_pk_bf16_f32 v130, 0, v130
    v_cvt_pk_bf16_f32 v131, 0, v131
    v_pk_mul_f32 v[130:131], v[130:131], v[210:211]
    v_cvt_pk_bf16_f32 v33, v130, v131
    v_cvt_pk_bf16_f32 v144, 0, v144
    v_cvt_pk_bf16_f32 v145, 0, v145
    v_cvt_pk_bf16_f32 v224, 0, v224
    v_cvt_pk_bf16_f32 v225, 0, v225
    v_pk_mul_f32 v[50:51], v[144:145], v[144:145]
    v_pk_fma_f32 v[50:51], v[50:51], s[46:47], v[26:27]
    v_pk_mul_f32 v[50:51], v[50:51], v[144:145]
    v_exp_f32 v50, v50
    v_exp_f32 v51, v51
    s_nop 0
    v_pk_add_f32 v[50:51], v[50:51], s[48:49]
    v_rcp_f32 v50, v50
    v_rcp_f32 v51, v51
    s_nop 0
    v_pk_mul_f32 v[144:145], v[50:51], v[144:145]
    v_cvt_pk_bf16_f32 v144, 0, v144
    v_cvt_pk_bf16_f32 v145, 0, v145
    v_pk_mul_f32 v[144:145], v[144:145], v[224:225]
    v_cvt_pk_bf16_f32 v34, v144, v145
    v_cvt_pk_bf16_f32 v146, 0, v146
    v_cvt_pk_bf16_f32 v147, 0, v147
    v_cvt_pk_bf16_f32 v226, 0, v226
    v_cvt_pk_bf16_f32 v227, 0, v227
    v_pk_mul_f32 v[58:59], v[146:147], v[146:147]
    v_pk_fma_f32 v[58:59], v[58:59], s[46:47], v[26:27]
    v_pk_mul_f32 v[58:59], v[58:59], v[146:147]
    v_exp_f32 v58, v58
    v_exp_f32 v59, v59
    s_nop 0
    v_pk_add_f32 v[58:59], v[58:59], s[48:49]
    v_rcp_f32 v58, v58
    v_rcp_f32 v59, v59
    s_nop 0
    v_pk_mul_f32 v[146:147], v[58:59], v[146:147]
    v_cvt_pk_bf16_f32 v146, 0, v146
    v_cvt_pk_bf16_f32 v147, 0, v147
    v_pk_mul_f32 v[146:147], v[146:147], v[226:227]
    v_cvt_pk_bf16_f32 v35, v146, v147
    buffer_store_dwordx4 v[32:35], v24, s[40:43], s52 offen
    s_add_u32 s52, s52, 147456
    v_cvt_pk_bf16_f32 v132, 0, v132
    v_cvt_pk_bf16_f32 v133, 0, v133
    v_cvt_pk_bf16_f32 v212, 0, v212
    v_cvt_pk_bf16_f32 v213, 0, v213
    v_pk_mul_f32 v[50:51], v[132:133], v[132:133]
    v_pk_fma_f32 v[50:51], v[50:51], s[46:47], v[26:27]
    v_pk_mul_f32 v[50:51], v[50:51], v[132:133]
    v_exp_f32 v50, v50
    v_exp_f32 v51, v51
    s_nop 0
    v_pk_add_f32 v[50:51], v[50:51], s[48:49]
    v_rcp_f32 v50, v50
    v_rcp_f32 v51, v51
    s_nop 0
    v_pk_mul_f32 v[132:133], v[50:51], v[132:133]
    v_cvt_pk_bf16_f32 v132, 0, v132
    v_cvt_pk_bf16_f32 v133, 0, v133
    v_pk_mul_f32 v[132:133], v[132:133], v[212:213]
    v_cvt_pk_bf16_f32 v40, v132, v133
    v_cvt_pk_bf16_f32 v134, 0, v134
    v_cvt_pk_bf16_f32 v135, 0, v135
    v_cvt_pk_bf16_f32 v214, 0, v214
    v_cvt_pk_bf16_f32 v215, 0, v215
    v_pk_mul_f32 v[58:59], v[134:135], v[134:135]
    v_pk_fma_f32 v[58:59], v[58:59], s[46:47], v[26:27]
    v_pk_mul_f32 v[58:59], v[58:59], v[134:135]
    v_exp_f32 v58, v58
    v_exp_f32 v59, v59
    s_nop 0
    v_pk_add_f32 v[58:59], v[58:59], s[48:49]
    v_rcp_f32 v58, v58
    v_rcp_f32 v59, v59
    s_nop 0
    v_pk_mul_f32 v[134:135], v[58:59], v[134:135]
    v_cvt_pk_bf16_f32 v134, 0, v134
    v_cvt_pk_bf16_f32 v135, 0, v135
    v_pk_mul_f32 v[134:135], v[134:135], v[214:215]
    v_cvt_pk_bf16_f32 v41, v134, v135
    v_cvt_pk_bf16_f32 v148, 0, v148
    v_cvt_pk_bf16_f32 v149, 0, v149
    v_cvt_pk_bf16_f32 v228, 0, v228
    v_cvt_pk_bf16_f32 v229, 0, v229
    v_pk_mul_f32 v[50:51], v[148:149], v[148:149]
    v_pk_fma_f32 v[50:51], v[50:51], s[46:47], v[26:27]
    v_pk_mul_f32 v[50:51], v[50:51], v[148:149]
    v_exp_f32 v50, v50
    v_exp_f32 v51, v51
    s_nop 0
    v_pk_add_f32 v[50:51], v[50:51], s[48:49]
    v_rcp_f32 v50, v50
    v_rcp_f32 v51, v51
    s_nop 0
    v_pk_mul_f32 v[148:149], v[50:51], v[148:149]
    v_cvt_pk_bf16_f32 v148, 0, v148
    v_cvt_pk_bf16_f32 v149, 0, v149
    v_pk_mul_f32 v[148:149], v[148:149], v[228:229]
    v_cvt_pk_bf16_f32 v42, v148, v149
    v_cvt_pk_bf16_f32 v150, 0, v150
    v_cvt_pk_bf16_f32 v151, 0, v151
    v_cvt_pk_bf16_f32 v230, 0, v230
    v_cvt_pk_bf16_f32 v231, 0, v231
    v_pk_mul_f32 v[58:59], v[150:151], v[150:151]
    v_pk_fma_f32 v[58:59], v[58:59], s[46:47], v[26:27]
    v_pk_mul_f32 v[58:59], v[58:59], v[150:151]
    v_exp_f32 v58, v58
    v_exp_f32 v59, v59
    s_nop 0
    v_pk_add_f32 v[58:59], v[58:59], s[48:49]
    v_rcp_f32 v58, v58
    v_rcp_f32 v59, v59
    s_nop 0
    v_pk_mul_f32 v[150:151], v[58:59], v[150:151]
    v_cvt_pk_bf16_f32 v150, 0, v150
    v_cvt_pk_bf16_f32 v151, 0, v151
    v_pk_mul_f32 v[150:151], v[150:151], v[230:231]
    v_cvt_pk_bf16_f32 v43, v150, v151
    buffer_store_dwordx4 v[40:43], v24, s[40:43], s52 offen
    s_add_u32 s52, s52, 147456
    v_cvt_pk_bf16_f32 v136, 0, v136
    v_cvt_pk_bf16_f32 v137, 0, v137
    v_cvt_pk_bf16_f32 v216, 0, v216
    v_cvt_pk_bf16_f32 v217, 0, v217
    v_pk_mul_f32 v[50:51], v[136:137], v[136:137]
    v_pk_fma_f32 v[50:51], v[50:51], s[46:47], v[26:27]
    v_pk_mul_f32 v[50:51], v[50:51], v[136:137]
    v_exp_f32 v50, v50
    v_exp_f32 v51, v51
    s_nop 0
    v_pk_add_f32 v[50:51], v[50:51], s[48:49]
    v_rcp_f32 v50, v50
    v_rcp_f32 v51, v51
    s_nop 0
    v_pk_mul_f32 v[136:137], v[50:51], v[136:137]
    v_cvt_pk_bf16_f32 v136, 0, v136
    v_cvt_pk_bf16_f32 v137, 0, v137
    v_pk_mul_f32 v[136:137], v[136:137], v[216:217]
    v_cvt_pk_bf16_f32 v32, v136, v137
    v_cvt_pk_bf16_f32 v138, 0, v138
    v_cvt_pk_bf16_f32 v139, 0, v139
    v_cvt_pk_bf16_f32 v218, 0, v218
    v_cvt_pk_bf16_f32 v219, 0, v219
    v_pk_mul_f32 v[58:59], v[138:139], v[138:139]
    v_pk_fma_f32 v[58:59], v[58:59], s[46:47], v[26:27]
    v_pk_mul_f32 v[58:59], v[58:59], v[138:139]
    v_exp_f32 v58, v58
    v_exp_f32 v59, v59
    s_nop 0
    v_pk_add_f32 v[58:59], v[58:59], s[48:49]
    v_rcp_f32 v58, v58
    v_rcp_f32 v59, v59
    s_nop 0
    v_pk_mul_f32 v[138:139], v[58:59], v[138:139]
    v_cvt_pk_bf16_f32 v138, 0, v138
    v_cvt_pk_bf16_f32 v139, 0, v139
    v_pk_mul_f32 v[138:139], v[138:139], v[218:219]
    v_cvt_pk_bf16_f32 v33, v138, v139
    v_cvt_pk_bf16_f32 v152, 0, v152
    v_cvt_pk_bf16_f32 v153, 0, v153
    v_cvt_pk_bf16_f32 v232, 0, v232
    v_cvt_pk_bf16_f32 v233, 0, v233
    v_pk_mul_f32 v[50:51], v[152:153], v[152:153]
    v_pk_fma_f32 v[50:51], v[50:51], s[46:47], v[26:27]
    v_pk_mul_f32 v[50:51], v[50:51], v[152:153]
    v_exp_f32 v50, v50
    v_exp_f32 v51, v51
    s_nop 0
    v_pk_add_f32 v[50:51], v[50:51], s[48:49]
    v_rcp_f32 v50, v50
    v_rcp_f32 v51, v51
    s_nop 0
    v_pk_mul_f32 v[152:153], v[50:51], v[152:153]
    v_cvt_pk_bf16_f32 v152, 0, v152
    v_cvt_pk_bf16_f32 v153, 0, v153
    v_pk_mul_f32 v[152:153], v[152:153], v[232:233]
    v_cvt_pk_bf16_f32 v34, v152, v153
    v_cvt_pk_bf16_f32 v154, 0, v154
    v_cvt_pk_bf16_f32 v155, 0, v155
    v_cvt_pk_bf16_f32 v234, 0, v234
    v_cvt_pk_bf16_f32 v235, 0, v235
    v_pk_mul_f32 v[58:59], v[154:155], v[154:155]
    v_pk_fma_f32 v[58:59], v[58:59], s[46:47], v[26:27]
    v_pk_mul_f32 v[58:59], v[58:59], v[154:155]
    v_exp_f32 v58, v58
    v_exp_f32 v59, v59
    s_nop 0
    v_pk_add_f32 v[58:59], v[58:59], s[48:49]
    v_rcp_f32 v58, v58
    v_rcp_f32 v59, v59
    s_nop 0
    v_pk_mul_f32 v[154:155], v[58:59], v[154:155]
    v_cvt_pk_bf16_f32 v154, 0, v154
    v_cvt_pk_bf16_f32 v155, 0, v155
    v_pk_mul_f32 v[154:155], v[154:155], v[234:235]
    v_cvt_pk_bf16_f32 v35, v154, v155
    buffer_store_dwordx4 v[32:35], v24, s[40:43], s52 offen
    s_add_u32 s52, s52, 147456
    v_cvt_pk_bf16_f32 v140, 0, v140
    v_cvt_pk_bf16_f32 v141, 0, v141
    v_cvt_pk_bf16_f32 v220, 0, v220
    v_cvt_pk_bf16_f32 v221, 0, v221
    v_pk_mul_f32 v[50:51], v[140:141], v[140:141]
    v_pk_fma_f32 v[50:51], v[50:51], s[46:47], v[26:27]
    v_pk_mul_f32 v[50:51], v[50:51], v[140:141]
    v_exp_f32 v50, v50
    v_exp_f32 v51, v51
    s_nop 0
    v_pk_add_f32 v[50:51], v[50:51], s[48:49]
    v_rcp_f32 v50, v50
    v_rcp_f32 v51, v51
    s_nop 0
    v_pk_mul_f32 v[140:141], v[50:51], v[140:141]
    v_cvt_pk_bf16_f32 v140, 0, v140
    v_cvt_pk_bf16_f32 v141, 0, v141
    v_pk_mul_f32 v[140:141], v[140:141], v[220:221]
    v_cvt_pk_bf16_f32 v40, v140, v141
    v_cvt_pk_bf16_f32 v142, 0, v142
    v_cvt_pk_bf16_f32 v143, 0, v143
    v_cvt_pk_bf16_f32 v222, 0, v222
    v_cvt_pk_bf16_f32 v223, 0, v223
    v_pk_mul_f32 v[58:59], v[142:143], v[142:143]
    v_pk_fma_f32 v[58:59], v[58:59], s[46:47], v[26:27]
    v_pk_mul_f32 v[58:59], v[58:59], v[142:143]
    v_exp_f32 v58, v58
    v_exp_f32 v59, v59
    s_nop 0
    v_pk_add_f32 v[58:59], v[58:59], s[48:49]
    v_rcp_f32 v58, v58
    v_rcp_f32 v59, v59
    s_nop 0
    v_pk_mul_f32 v[142:143], v[58:59], v[142:143]
    v_cvt_pk_bf16_f32 v142, 0, v142
    v_cvt_pk_bf16_f32 v143, 0, v143
    v_pk_mul_f32 v[142:143], v[142:143], v[222:223]
    v_cvt_pk_bf16_f32 v41, v142, v143
    v_cvt_pk_bf16_f32 v156, 0, v156
    v_cvt_pk_bf16_f32 v157, 0, v157
    v_cvt_pk_bf16_f32 v236, 0, v236
    v_cvt_pk_bf16_f32 v237, 0, v237
    v_pk_mul_f32 v[50:51], v[156:157], v[156:157]
    v_pk_fma_f32 v[50:51], v[50:51], s[46:47], v[26:27]
    v_pk_mul_f32 v[50:51], v[50:51], v[156:157]
    v_exp_f32 v50, v50
    v_exp_f32 v51, v51
    s_nop 0
    v_pk_add_f32 v[50:51], v[50:51], s[48:49]
    v_rcp_f32 v50, v50
    v_rcp_f32 v51, v51
    s_nop 0
    v_pk_mul_f32 v[156:157], v[50:51], v[156:157]
    v_cvt_pk_bf16_f32 v156, 0, v156
    v_cvt_pk_bf16_f32 v157, 0, v157
    v_pk_mul_f32 v[156:157], v[156:157], v[236:237]
    v_cvt_pk_bf16_f32 v42, v156, v157
    v_cvt_pk_bf16_f32 v158, 0, v158
    v_cvt_pk_bf16_f32 v159, 0, v159
    v_cvt_pk_bf16_f32 v238, 0, v238
    v_cvt_pk_bf16_f32 v239, 0, v239
    v_pk_mul_f32 v[58:59], v[158:159], v[158:159]
    v_pk_fma_f32 v[58:59], v[58:59], s[46:47], v[26:27]
    v_pk_mul_f32 v[58:59], v[58:59], v[158:159]
    v_exp_f32 v58, v58
    v_exp_f32 v59, v59
    s_nop 0
    v_pk_add_f32 v[58:59], v[58:59], s[48:49]
    v_rcp_f32 v58, v58
    v_rcp_f32 v59, v59
    s_nop 0
    v_pk_mul_f32 v[158:159], v[58:59], v[158:159]
    v_cvt_pk_bf16_f32 v158, 0, v158
    v_cvt_pk_bf16_f32 v159, 0, v159
    v_pk_mul_f32 v[158:159], v[158:159], v[238:239]
    v_cvt_pk_bf16_f32 v43, v158, v159
    buffer_store_dwordx4 v[40:43], v24, s[40:43], s52 offen
    s_branch K1_D_6
K1_Q_5:
    s_ashr_i32 s26, s24, 5
    s_add_u32 s26, s26, s51
    s_lshl_b32 s26, s26, 7
    s_add_u32 s26, s26, s50
    s_lshl_b32 s26, s26, 10
    s_add_u32 s52, s26, 0x1400000
    s_ashr_i32 s26, s25, 5
    s_add_u32 s26, s26, s51
    s_lshl_b32 s26, s26, 7
    s_add_u32 s26, s26, s50
    s_lshl_b32 s26, s26, 10
    s_add_u32 s53, s26, 0x1400000
    v_cvt_pk_bf16_f32 v32, v128, v129
    v_cvt_pk_bf16_f32 v33, v130, v131
    v_cvt_pk_bf16_f32 v34, v144, v145
    v_cvt_pk_bf16_f32 v35, v146, v147
    buffer_store_dwordx4 v[32:35], v24, s[40:43], s52 offen offset:0
    v_cvt_pk_bf16_f32 v36, v208, v209
    v_cvt_pk_bf16_f32 v37, v210, v211
    v_cvt_pk_bf16_f32 v38, v224, v225
    v_cvt_pk_bf16_f32 v39, v226, v227
    buffer_store_dwordx4 v[36:39], v24, s[40:43], s53 offen offset:0
    v_cvt_pk_bf16_f32 v40, v132, v133
    v_cvt_pk_bf16_f32 v41, v134, v135
    v_cvt_pk_bf16_f32 v42, v148, v149
    v_cvt_pk_bf16_f32 v43, v150, v151
    buffer_store_dwordx4 v[40:43], v24, s[40:43], s52 offen offset:1024
    v_cvt_pk_bf16_f32 v44, v212, v213
    v_cvt_pk_bf16_f32 v45, v214, v215
    v_cvt_pk_bf16_f32 v46, v228, v229
    v_cvt_pk_bf16_f32 v47, v230, v231
    buffer_store_dwordx4 v[44:47], v24, s[40:43], s53 offen offset:1024
    v_cvt_pk_bf16_f32 v48, v136, v137
    v_cvt_pk_bf16_f32 v49, v138, v139
    v_cvt_pk_bf16_f32 v50, v152, v153
    v_cvt_pk_bf16_f32 v51, v154, v155
    buffer_store_dwordx4 v[48:51], v24, s[40:43], s52 offen offset:2048
    v_cvt_pk_bf16_f32 v52, v216, v217
    v_cvt_pk_bf16_f32 v53, v218, v219
    v_cvt_pk_bf16_f32 v54, v232, v233
    v_cvt_pk_bf16_f32 v55, v234, v235
    buffer_store_dwordx4 v[52:55], v24, s[40:43], s53 offen offset:2048
    v_cvt_pk_bf16_f32 v56, v140, v141
    v_cvt_pk_bf16_f32 v57, v142, v143
    v_cvt_pk_bf16_f32 v58, v156, v157
    v_cvt_pk_bf16_f32 v59, v158, v159
    buffer_store_dwordx4 v[56:59], v24, s[40:43], s52 offen offset:3072
    v_cvt_pk_bf16_f32 v60, v220, v221
    v_cvt_pk_bf16_f32 v61, v222, v223
    v_cvt_pk_bf16_f32 v62, v236, v237
    v_cvt_pk_bf16_f32 v63, v238, v239
    buffer_store_dwordx4 v[60:63], v24, s[40:43], s53 offen offset:3072
K1_D_6:
    s_nop 1
    s_mov_b32 s51, 2
    s_lshl_b32 s26, s51, 2
    s_cmp_lt_u32 s26, s22
    s_cbranch_scc0 K1_Q_7
    s_mul_i32 s26, s15, 5
    s_add_u32 s26, s26, s51
    s_add_u32 s26, s26, 32
    s_mul_i32 s52, s50, 144
    s_add_u32 s52, s52, s26
    s_lshl_b32 s52, s52, 10
    v_cvt_pk_bf16_f32 v160, 0, v160
    v_cvt_pk_bf16_f32 v161, 0, v161
    v_cvt_pk_bf16_f32 v240, 0, v240
    v_cvt_pk_bf16_f32 v241, 0, v241
    v_pk_mul_f32 v[50:51], v[160:161], v[160:161]
    v_pk_fma_f32 v[50:51], v[50:51], s[46:47], v[26:27]
    v_pk_mul_f32 v[50:51], v[50:51], v[160:161]
    v_exp_f32 v50, v50
    v_exp_f32 v51, v51
    s_nop 0
    v_pk_add_f32 v[50:51], v[50:51], s[48:49]
    v_rcp_f32 v50, v50
    v_rcp_f32 v51, v51
    s_nop 0
    v_pk_mul_f32 v[160:161], v[50:51], v[160:161]
    v_cvt_pk_bf16_f32 v160, 0, v160
    v_cvt_pk_bf16_f32 v161, 0, v161
    v_pk_mul_f32 v[160:161], v[160:161], v[240:241]
    v_cvt_pk_bf16_f32 v32, v160, v161
    v_cvt_pk_bf16_f32 v162, 0, v162
    v_cvt_pk_bf16_f32 v163, 0, v163
    v_cvt_pk_bf16_f32 v242, 0, v242
    v_cvt_pk_bf16_f32 v243, 0, v243
    v_pk_mul_f32 v[58:59], v[162:163], v[162:163]
    v_pk_fma_f32 v[58:59], v[58:59], s[46:47], v[26:27]
    v_pk_mul_f32 v[58:59], v[58:59], v[162:163]
    v_exp_f32 v58, v58
    v_exp_f32 v59, v59
    s_nop 0
    v_pk_add_f32 v[58:59], v[58:59], s[48:49]
    v_rcp_f32 v58, v58
    v_rcp_f32 v59, v59
    s_nop 0
    v_pk_mul_f32 v[162:163], v[58:59], v[162:163]
    v_cvt_pk_bf16_f32 v162, 0, v162
    v_cvt_pk_bf16_f32 v163, 0, v163
    v_pk_mul_f32 v[162:163], v[162:163], v[242:243]
    v_cvt_pk_bf16_f32 v33, v162, v163
    buffer_store_dwordx2 v[32:33], v25, s[40:43], s52 offen
    s_add_u32 s52, s52, 147456
    v_cvt_pk_bf16_f32 v164, 0, v164
    v_cvt_pk_bf16_f32 v165, 0, v165
    v_cvt_pk_bf16_f32 v244, 0, v244
    v_cvt_pk_bf16_f32 v245, 0, v245
    v_pk_mul_f32 v[50:51], v[164:165], v[164:165]
    v_pk_fma_f32 v[50:51], v[50:51], s[46:47], v[26:27]
    v_pk_mul_f32 v[50:51], v[50:51], v[164:165]
    v_exp_f32 v50, v50
    v_exp_f32 v51, v51
    s_nop 0
    v_pk_add_f32 v[50:51], v[50:51], s[48:49]
    v_rcp_f32 v50, v50
    v_rcp_f32 v51, v51
    s_nop 0
    v_pk_mul_f32 v[164:165], v[50:51], v[164:165]
    v_cvt_pk_bf16_f32 v164, 0, v164
    v_cvt_pk_bf16_f32 v165, 0, v165
    v_pk_mul_f32 v[164:165], v[164:165], v[244:245]
    v_cvt_pk_bf16_f32 v40, v164, v165
    v_cvt_pk_bf16_f32 v166, 0, v166
    v_cvt_pk_bf16_f32 v167, 0, v167
    v_cvt_pk_bf16_f32 v246, 0, v246
    v_cvt_pk_bf16_f32 v247, 0, v247
    v_pk_mul_f32 v[58:59], v[166:167], v[166:167]
    v_pk_fma_f32 v[58:59], v[58:59], s[46:47], v[26:27]
    v_pk_mul_f32 v[58:59], v[58:59], v[166:167]
    v_exp_f32 v58, v58
    v_exp_f32 v59, v59
    s_nop 0
    v_pk_add_f32 v[58:59], v[58:59], s[48:49]
    v_rcp_f32 v58, v58
    v_rcp_f32 v59, v59
    s_nop 0
    v_pk_mul_f32 v[166:167], v[58:59], v[166:167]
    v_cvt_pk_bf16_f32 v166, 0, v166
    v_cvt_pk_bf16_f32 v167, 0, v167
    v_pk_mul_f32 v[166:167], v[166:167], v[246:247]
    v_cvt_pk_bf16_f32 v41, v166, v167
    buffer_store_dwordx2 v[40:41], v25, s[40:43], s52 offen
    s_add_u32 s52, s52, 147456
    v_cvt_pk_bf16_f32 v168, 0, v168
    v_cvt_pk_bf16_f32 v169, 0, v169
    v_cvt_pk_bf16_f32 v248, 0, v248
    v_cvt_pk_bf16_f32 v249, 0, v249
    v_pk_mul_f32 v[50:51], v[168:169], v[168:169]
    v_pk_fma_f32 v[50:51], v[50:51], s[46:47], v[26:27]
    v_pk_mul_f32 v[50:51], v[50:51], v[168:169]
    v_exp_f32 v50, v50
    v_exp_f32 v51, v51
    s_nop 0
    v_pk_add_f32 v[50:51], v[50:51], s[48:49]
    v_rcp_f32 v50, v50
    v_rcp_f32 v51, v51
    s_nop 0
    v_pk_mul_f32 v[168:169], v[50:51], v[168:169]
    v_cvt_pk_bf16_f32 v168, 0, v168
    v_cvt_pk_bf16_f32 v169, 0, v169
    v_pk_mul_f32 v[168:169], v[168:169], v[248:249]
    v_cvt_pk_bf16_f32 v32, v168, v169
    v_cvt_pk_bf16_f32 v170, 0, v170
    v_cvt_pk_bf16_f32 v171, 0, v171
    v_cvt_pk_bf16_f32 v250, 0, v250
    v_cvt_pk_bf16_f32 v251, 0, v251
    v_pk_mul_f32 v[58:59], v[170:171], v[170:171]
    v_pk_fma_f32 v[58:59], v[58:59], s[46:47], v[26:27]
    v_pk_mul_f32 v[58:59], v[58:59], v[170:171]
    v_exp_f32 v58, v58
    v_exp_f32 v59, v59
    s_nop 0
    v_pk_add_f32 v[58:59], v[58:59], s[48:49]
    v_rcp_f32 v58, v58
    v_rcp_f32 v59, v59
    s_nop 0
    v_pk_mul_f32 v[170:171], v[58:59], v[170:171]
    v_cvt_pk_bf16_f32 v170, 0, v170
    v_cvt_pk_bf16_f32 v171, 0, v171
    v_pk_mul_f32 v[170:171], v[170:171], v[250:251]
    v_cvt_pk_bf16_f32 v33, v170, v171
    buffer_store_dwordx2 v[32:33], v25, s[40:43], s52 offen
    s_add_u32 s52, s52, 147456
    v_cvt_pk_bf16_f32 v172, 0, v172
    v_cvt_pk_bf16_f32 v173, 0, v173
    v_cvt_pk_bf16_f32 v252, 0, v252
    v_cvt_pk_bf16_f32 v253, 0, v253
    v_pk_mul_f32 v[50:51], v[172:173], v[172:173]
    v_pk_fma_f32 v[50:51], v[50:51], s[46:47], v[26:27]
    v_pk_mul_f32 v[50:51], v[50:51], v[172:173]
    v_exp_f32 v50, v50
    v_exp_f32 v51, v51
    s_nop 0
    v_pk_add_f32 v[50:51], v[50:51], s[48:49]
    v_rcp_f32 v50, v50
    v_rcp_f32 v51, v51
    s_nop 0
    v_pk_mul_f32 v[172:173], v[50:51], v[172:173]
    v_cvt_pk_bf16_f32 v172, 0, v172
    v_cvt_pk_bf16_f32 v173, 0, v173
    v_pk_mul_f32 v[172:173], v[172:173], v[252:253]
    v_cvt_pk_bf16_f32 v40, v172, v173
    v_cvt_pk_bf16_f32 v174, 0, v174
    v_cvt_pk_bf16_f32 v175, 0, v175
    v_cvt_pk_bf16_f32 v254, 0, v254
    v_cvt_pk_bf16_f32 v255, 0, v255
    v_pk_mul_f32 v[58:59], v[174:175], v[174:175]
    v_pk_fma_f32 v[58:59], v[58:59], s[46:47], v[26:27]
    v_pk_mul_f32 v[58:59], v[58:59], v[174:175]
    v_exp_f32 v58, v58
    v_exp_f32 v59, v59
    s_nop 0
    v_pk_add_f32 v[58:59], v[58:59], s[48:49]
    v_rcp_f32 v58, v58
    v_rcp_f32 v59, v59
    s_nop 0
    v_pk_mul_f32 v[174:175], v[58:59], v[174:175]
    v_cvt_pk_bf16_f32 v174, 0, v174
    v_cvt_pk_bf16_f32 v175, 0, v175
    v_pk_mul_f32 v[174:175], v[174:175], v[254:255]
    v_cvt_pk_bf16_f32 v41, v174, v175
    buffer_store_dwordx2 v[40:41], v25, s[40:43], s52 offen
    s_branch K1_D_8
K1_Q_7:
    s_ashr_i32 s26, s24, 5
    s_add_u32 s26, s26, s51
    s_lshl_b32 s26, s26, 7
    s_add_u32 s26, s26, s50
    s_lshl_b32 s26, s26, 10
    s_add_u32 s52, s26, 0x1400000
    s_ashr_i32 s26, s25, 5
    s_add_u32 s26, s26, s51
    s_lshl_b32 s26, s26, 7
    s_add_u32 s26, s26, s50
    s_lshl_b32 s26, s26, 10
    s_add_u32 s53, s26, 0x1400000
    v_cvt_pk_bf16_f32 v32, v160, v161
    v_cvt_pk_bf16_f32 v33, v162, v163
    buffer_store_dwordx2 v[32:33], v25, s[40:43], s52 offen offset:0
    v_cvt_pk_bf16_f32 v36, v240, v241
    v_cvt_pk_bf16_f32 v37, v242, v243
    buffer_store_dwordx2 v[36:37], v25, s[40:43], s53 offen offset:0
    v_cvt_pk_bf16_f32 v40, v164, v165
    v_cvt_pk_bf16_f32 v41, v166, v167
    buffer_store_dwordx2 v[40:41], v25, s[40:43], s52 offen offset:1024
    v_cvt_pk_bf16_f32 v44, v244, v245
    v_cvt_pk_bf16_f32 v45, v246, v247
    buffer_store_dwordx2 v[44:45], v25, s[40:43], s53 offen offset:1024
    v_cvt_pk_bf16_f32 v48, v168, v169
    v_cvt_pk_bf16_f32 v49, v170, v171
    buffer_store_dwordx2 v[48:49], v25, s[40:43], s52 offen offset:2048
    v_cvt_pk_bf16_f32 v52, v248, v249
    v_cvt_pk_bf16_f32 v53, v250, v251
    buffer_store_dwordx2 v[52:53], v25, s[40:43], s53 offen offset:2048
    v_cvt_pk_bf16_f32 v56, v172, v173
    v_cvt_pk_bf16_f32 v57, v174, v175
    buffer_store_dwordx2 v[56:57], v25, s[40:43], s52 offen offset:3072
    v_cvt_pk_bf16_f32 v60, v252, v253
    v_cvt_pk_bf16_f32 v61, v254, v255
    buffer_store_dwordx2 v[60:61], v25, s[40:43], s53 offen offset:3072
K1_D_8:
K1_END:
    s_endpgm
.globl k23_kernel
.p2align 8
.type k23_kernel,@function
k23_kernel:
    s_cmp_ge_u32 s2, 256
    s_cbranch_scc1 K23_END
    s_load_dwordx2 s[4:5], s[0:1], 80
    s_load_dwordx2 s[6:7], s[0:1], 16
    s_load_dwordx2 s[8:9], s[0:1], 48
    s_load_dwordx2 s[10:11], s[0:1], 64
    s_load_dwordx2 s[12:13], s[0:1], 0
    s_load_dwordx2 s[14:15], s[0:1], 56
    s_load_dwordx2 s[16:17], s[0:1], 72
    v_lshrrev_b32 v1, 6, v0
    v_and_b32 v0, 63, v0
    v_readfirstlane_b32 s18, v1
    s_waitcnt lgkmcnt(0)
    s_mov_b32 s28, s4
    s_and_b32 s29, s5, 0xffff
    s_mov_b32 s30, 0x10000000
    s_mov_b32 s31, 0x00020000
    s_cmp_ge_u32 s18, 4
    s_cbranch_scc1 K23_ATT
    s_mov_b32 s32, s10
    s_and_b32 s33, s11, 0xffff
    s_mov_b32 s34, 0x400000
    s_mov_b32 s35, 0x00020000
    s_and_b32 s19, s2, 7
    s_lshr_b32 s20, s2, 3
    s_lshr_b32 s36, s19, 1
    s_lshl_b32 s36, s36, 2
    s_and_b32 s21, s20, 3
    s_add_u32 s36, s36, s21
    s_and_b32 s37, s19, 1
    s_lshl_b32 s37, s37, 3
    s_lshr_b32 s21, s20, 2
    s_add_u32 s37, s37, s21
    v_lshlrev_b32 v1, 4, v0
    s_lshl_b32 s19, s36, 3
    s_lshl_b32 s20, s18, 1
    s_add_u32 s21, s20, 0
    s_and_b32 s21, s21, 7
    s_add_u32 s21, s21, s19
    s_mul_i32 s44, s21, 147456
    s_add_u32 s21, s20, 1
    s_and_b32 s21, s21, 7
    s_add_u32 s21, s21, s19
    s_mul_i32 s45, s21, 147456
    s_add_u32 s21, s20, 2
    s_and_b32 s21, s21, 7
    s_add_u32 s21, s21, s19
    s_mul_i32 s46, s21, 147456
    s_add_u32 s21, s20, 3
    s_and_b32 s21, s21, 7
    s_add_u32 s21, s21, s19
    s_mul_i32 s47, s21, 147456
    s_add_u32 s21, s20, 4
    s_and_b32 s21, s21, 7
    s_add_u32 s21, s21, s19
    s_mul_i32 s48, s21, 147456
    s_add_u32 s21, s20, 5
    s_and_b32 s21, s21, 7
    s_add_u32 s21, s21, s19
    s_mul_i32 s49, s21, 147456
    s_add_u32 s21, s20, 6
    s_and_b32 s21, s21, 7
    s_add_u32 s21, s21, s19
    s_mul_i32 s50, s21, 147456
    s_add_u32 s21, s20, 7
    s_and_b32 s21, s21, 7
    s_add_u32 s21, s21, s19
    s_mul_i32 s51, s21, 147456
    s_lshl_b32 s38, s18, 10
    s_add_u32 s38, s38, 32768
    v_lshrrev_b32 v49, 3, v0
    v_and_b32 v50, 6, v49
    v_and_b32 v51, 7, v0
    v_xor_b32 v51, v51, v50
    s_lshl_b32 s19, s18, 5
    v_add_u32 v49, s19, v49
    v_lshlrev_b32 v49, 11, v49
    v_lshl_add_u32 v49, v51, 4, v49
    s_lshl_b32 s19, s37, 7
    v_add_u32 v2, s19, v49
    v_add_u32 v3, 32768, v2
    s_lshl_b32 s42, s18, 14
    s_add_u32 s42, s42, 98304
    v_and_b32 v48, 15, v0
    v_lshrrev_b32 v49, 4, v0
    v_lshrrev_b32 v50, 2, v48
    v_lshl_add_u32 v50, v49, 2, v50
    v_bfe_u32 v51, v50, 1, 2
    v_lshlrev_b32 v50, 7, v50
    v_and_b32 v52, 3, v48
    v_lshl_add_u32 v50, v52, 3, v50
    v_add_u32 v50, s42, v50
    v_xor_b32 v52, 0, v51
    v_lshl_add_u32 v4, v52, 5, v50
    v_xor_b32 v52, 1, v51
    v_lshl_add_u32 v5, v52, 5, v50
    v_xor_b32 v52, 2, v51
    v_lshl_add_u32 v6, v52, 5, v50
    v_xor_b32 v52, 3, v51
    v_lshl_add_u32 v7, v52, 5, v50
    s_lshl_b32 s19, s36, 7
    s_lshl_b32 s20, s18, 5
    s_add_u32 s19, s19, s20
    v_add_u32 v50, s19, v48
    v_lshlrev_b32 v15, 2, v50
    v_lshlrev_b32 v50, 11, v50
    v_lshl_add_u32 v50, v49, 3, v50
    s_lshl_b32 s19, s37, 7
    v_add_u32 v10, s19, v50
    s_lshl_b32 s19, s36, 9
    s_add_u32 s19, s19, 0x2404000
    v_lshlrev_b32 v11, 3, v0
    v_add_u32 v11, s19, v11
    s_add_u32 s19, s18, 1
    s_and_b32 s19, s19, 3
    s_mul_i32 s19, s19, 3
    s_add_u32 s19, s19, 0
    s_lshl_b32 s52, s19, 13
    s_add_u32 s19, s18, 2
    s_and_b32 s19, s19, 3
    s_mul_i32 s19, s19, 3
    s_add_u32 s19, s19, 1
    s_lshl_b32 s53, s19, 13
    s_add_u32 s19, s18, 3
    s_and_b32 s19, s19, 3
    s_mul_i32 s19, s19, 3
    s_add_u32 s19, s19, 2
    s_lshl_b32 s54, s19, 13
    s_mul_i32 s19, s18, 24576
    v_add_u32 v14, s19, v1
    s_lshr_b32 s19, s2, 3
    s_mul_i32 s19, s19, 0
    s_mul_hi_u32 s20, s19, 153391690
    s_mul_i32 s20, s20, 28
    s_sub_u32 s58, s19, s20
    s_mov_b32 s59, s58
    s_mov_b32 s60, s38
    s_lshl_b32 s38, s58, 12
    s_add_u32 s38, s38, s60
    s_lshl_b32 s56, s59, 18
    s_add_u32 s40, s8, s56
    s_addc_u32 s41, s9, 0
    s_add_u32 s56, s40, 16384
    s_addc_u32 s57, s41, 0
    s_add_u32 m0, s42, 0
    s_nop 0
    global_load_lds_dwordx4 v2, s[40:41]
    s_add_u32 m0, s42, 1024
    s_nop 0
    global_load_lds_dwordx4 v2, s[56:57]
    s_add_u32 m0, s42, 2048
    s_nop 0
    global_load_lds_dwordx4 v3, s[40:41]
    s_add_u32 m0, s42, 3072
    s_nop 0
    global_load_lds_dwordx4 v3, s[56:57]
    s_add_u32 s59, s59, 1
    s_cmp_eq_u32 s59, 28
    s_cselect_b32 s59, 0, s59
    s_lshl_b32 s56, s59, 18
    s_add_u32 s40, s8, s56
    s_addc_u32 s41, s9, 0
    s_add_u32 s56, s40, 16384
    s_addc_u32 s57, s41, 0
    s_add_u32 s19, s38, s44
    buffer_load_dwordx4 v[124:127], v1, s[28:31], s19 offen
    s_add_u32 s20, s38, s45
    buffer_load_dwordx4 v[120:123], v1, s[28:31], s20 offen
    s_add_u32 s19, s38, s46
    buffer_load_dwordx4 v[116:119], v1, s[28:31], s19 offen
    s_add_u32 s20, s38, s47
    buffer_load_dwordx4 v[112:115], v1, s[28:31], s20 offen
    s_add_u32 s19, s38, s48
    buffer_load_dwordx4 v[108:111], v1, s[28:31], s19 offen
    s_add_u32 s20, s38, s49
    buffer_load_dwordx4 v[104:107], v1, s[28:31], s20 offen
    s_add_u32 s19, s38, s50
    buffer_load_dwordx4 v[100:103], v1, s[28:31], s19 offen
    s_add_u32 s20, s38, s51
    buffer_load_dwordx4 v[96:99], v1, s[28:31], s20 offen
    s_add_u32 s58, s58, 1
    s_cmp_eq_u32 s58, 28
    s_cselect_b32 s58, 0, s58
    s_lshl_b32 s38, s58, 12
    s_add_u32 s38, s38, s60
    s_add_u32 s19, s38, s44
    buffer_load_dwordx4 v[92:95], v1, s[28:31], s19 offen
    s_add_u32 s20, s38, s45
    buffer_load_dwordx4 v[88:91], v1, s[28:31], s20 offen
    s_add_u32 s19, s38, s46
    buffer_load_dwordx4 v[84:87], v1, s[28:31], s19 offen
    s_add_u32 s20, s38, s47
    buffer_load_dwordx4 v[80:83], v1, s[28:31], s20 offen
    s_add_u32 s19, s38, s48
    buffer_load_dwordx4 v[76:79], v1, s[28:31], s19 offen
    s_add_u32 s20, s38, s49
    buffer_load_dwordx4 v[72:75], v1, s[28:31], s20 offen
    s_add_u32 s19, s38, s50
    buffer_load_dwordx4 v[68:71], v1, s[28:31], s19 offen
    s_add_u32 s20, s38, s51
    buffer_load_dwordx4 v[64:67], v1, s[28:31], s20 offen
    s_add_u32 s58, s58, 1
    s_cmp_eq_u32 s58, 28
    s_cselect_b32 s58, 0, s58
    s_lshl_b32 s38, s58, 12
    s_add_u32 s38, s38, s60
    s_add_u32 s19, s38, s44
    buffer_load_dwordx4 v[60:63], v1, s[28:31], s19 offen
    s_add_u32 s20, s38, s45
    buffer_load_dwordx4 v[56:59], v1, s[28:31], s20 offen
    s_add_u32 s19, s38, s46
    buffer_load_dwordx4 v[52:55], v1, s[28:31], s19 offen
    s_add_u32 s20, s38, s47
    buffer_load_dwordx4 v[48:51], v1, s[28:31], s20 offen
    s_add_u32 m0, s42, 4096
    s_nop 0
    global_load_lds_dwordx4 v2, s[40:41]
    s_add_u32 m0, s42, 5120
    s_nop 0
    global_load_lds_dwordx4 v2, s[56:57]
    s_add_u32 m0, s42, 6144
    s_nop 0
    global_load_lds_dwordx4 v3, s[40:41]
    s_add_u32 m0, s42, 7168
    s_nop 0
    global_load_lds_dwordx4 v3, s[56:57]
    s_add_u32 s59, s59, 1
    s_cmp_eq_u32 s59, 28
    s_cselect_b32 s59, 0, s59
    s_lshl_b32 s56, s59, 18
    s_add_u32 s40, s8, s56
    s_addc_u32 s41, s9, 0
    s_add_u32 s56, s40, 16384
    s_addc_u32 s57, s41, 0
    s_add_u32 m0, s42, 8192
    s_nop 0
    global_load_lds_dwordx4 v2, s[40:41]
    s_add_u32 m0, s42, 9216
    s_nop 0
    global_load_lds_dwordx4 v2, s[56:57]
    s_add_u32 m0, s42, 10240
    s_nop 0
    global_load_lds_dwordx4 v3, s[40:41]
    s_add_u32 m0, s42, 11264
    s_nop 0
    global_load_lds_dwordx4 v3, s[56:57]
    s_add_u32 s59, s59, 1
    s_cmp_eq_u32 s59, 28
    s_cselect_b32 s59, 0, s59
    s_lshl_b32 s56, s59, 18
    s_add_u32 s40, s8, s56
    s_addc_u32 s41, s9, 0
    s_add_u32 s56, s40, 16384
    s_addc_u32 s57, s41, 0
    s_barrier
    s_waitcnt vmcnt(28)
    ds_read_b64_tr_b16 v[16:17], v4 offset:0
    ds_read_b64_tr_b16 v[18:19], v4 offset:2048
    ds_read_b64_tr_b16 v[20:21], v5 offset:0
    ds_read_b64_tr_b16 v[22:23], v5 offset:2048
    ds_read_b64_tr_b16 v[24:25], v6 offset:0
    ds_read_b64_tr_b16 v[26:27], v6 offset:2048
    ds_read_b64_tr_b16 v[28:29], v7 offset:0
    ds_read_b64_tr_b16 v[30:31], v7 offset:2048
    s_waitcnt lgkmcnt(0)
    s_waitcnt vmcnt(27)
    v_mfma_f32_16x16x32_bf16 v[128:131], v[16:19], v[124:127], 0
    s_add_u32 m0, s42, 12288
    s_nop 0
    global_load_lds_dwordx4 v2, s[40:41]
    v_mfma_f32_16x16x32_bf16 v[132:135], v[20:23], v[124:127], 0
    s_add_u32 m0, s42, 13312
    s_nop 0
    global_load_lds_dwordx4 v2, s[56:57]
    v_mfma_f32_16x16x32_bf16 v[136:139], v[24:27], v[124:127], 0
    s_add_u32 m0, s42, 14336
    s_nop 0
    global_load_lds_dwordx4 v3, s[40:41]
    v_mfma_f32_16x16x32_bf16 v[140:143], v[28:31], v[124:127], 0
    s_add_u32 m0, s42, 15360
    s_nop 0
    global_load_lds_dwordx4 v3, s[56:57]
    s_add_u32 s59, s59, 1
    s_cmp_eq_u32 s59, 28
    s_cselect_b32 s59, 0, s59
    s_lshl_b32 s56, s59, 18
    s_add_u32 s40, s8, s56
    s_addc_u32 s41, s9, 0
    s_add_u32 s56, s40, 16384
    s_addc_u32 s57, s41, 0
    s_add_u32 s19, s38, s48
    buffer_load_dwordx4 v[124:127], v1, s[28:31], s19 offen
    s_waitcnt vmcnt(31)
    v_mfma_f32_16x16x32_bf16 v[144:147], v[16:19], v[120:123], 0
    v_mfma_f32_16x16x32_bf16 v[148:151], v[20:23], v[120:123], 0
    v_mfma_f32_16x16x32_bf16 v[152:155], v[24:27], v[120:123], 0
    v_mfma_f32_16x16x32_bf16 v[156:159], v[28:31], v[120:123], 0
    s_add_u32 s20, s38, s49
    buffer_load_dwordx4 v[120:123], v1, s[28:31], s20 offen
    s_waitcnt vmcnt(31)
    v_mfma_f32_16x16x32_bf16 v[160:163], v[16:19], v[116:119], 0
    v_mfma_f32_16x16x32_bf16 v[164:167], v[20:23], v[116:119], 0
    v_mfma_f32_16x16x32_bf16 v[168:171], v[24:27], v[116:119], 0
    v_mfma_f32_16x16x32_bf16 v[172:175], v[28:31], v[116:119], 0
    s_add_u32 s19, s38, s50
    buffer_load_dwordx4 v[116:119], v1, s[28:31], s19 offen
    s_waitcnt vmcnt(31)
    v_mfma_f32_16x16x32_bf16 v[176:179], v[16:19], v[112:115], 0
    v_mfma_f32_16x16x32_bf16 v[180:183], v[20:23], v[112:115], 0
    v_mfma_f32_16x16x32_bf16 v[184:187], v[24:27], v[112:115], 0
    v_mfma_f32_16x16x32_bf16 v[188:191], v[28:31], v[112:115], 0
    s_add_u32 s20, s38, s51
    buffer_load_dwordx4 v[112:115], v1, s[28:31], s20 offen
    s_add_u32 s58, s58, 1
    s_cmp_eq_u32 s58, 28
    s_cselect_b32 s58, 0, s58
    s_lshl_b32 s38, s58, 12
    s_add_u32 s38, s38, s60
    s_waitcnt vmcnt(31)
    v_mfma_f32_16x16x32_bf16 v[192:195], v[16:19], v[108:111], 0
    s_waitcnt vmcnt(12)
    v_mfma_f32_16x16x32_bf16 v[196:199], v[20:23], v[108:111], 0
    ds_read_b64_tr_b16 v[32:33], v4 offset:4096
    v_mfma_f32_16x16x32_bf16 v[200:203], v[24:27], v[108:111], 0
    ds_read_b64_tr_b16 v[34:35], v4 offset:6144
    v_mfma_f32_16x16x32_bf16 v[204:207], v[28:31], v[108:111], 0
    ds_read_b64_tr_b16 v[36:37], v5 offset:4096
    s_add_u32 s19, s38, s44
    buffer_load_dwordx4 v[108:111], v1, s[28:31], s19 offen
    v_mfma_f32_16x16x32_bf16 v[208:211], v[16:19], v[104:107], 0
    ds_read_b64_tr_b16 v[38:39], v5 offset:6144
    v_mfma_f32_16x16x32_bf16 v[212:215], v[20:23], v[104:107], 0
    ds_read_b64_tr_b16 v[40:41], v6 offset:4096
    v_mfma_f32_16x16x32_bf16 v[216:219], v[24:27], v[104:107], 0
    ds_read_b64_tr_b16 v[42:43], v6 offset:6144
    v_mfma_f32_16x16x32_bf16 v[220:223], v[28:31], v[104:107], 0
    ds_read_b64_tr_b16 v[44:45], v7 offset:4096
    s_add_u32 s20, s38, s45
    buffer_load_dwordx4 v[104:107], v1, s[28:31], s20 offen
    v_mfma_f32_16x16x32_bf16 v[224:227], v[16:19], v[100:103], 0
    ds_read_b64_tr_b16 v[46:47], v7 offset:6144
    v_mfma_f32_16x16x32_bf16 v[228:231], v[20:23], v[100:103], 0
    v_mfma_f32_16x16x32_bf16 v[232:235], v[24:27], v[100:103], 0
    v_mfma_f32_16x16x32_bf16 v[236:239], v[28:31], v[100:103], 0
    s_add_u32 s19, s38, s46
    buffer_load_dwordx4 v[100:103], v1, s[28:31], s19 offen
    v_mfma_f32_16x16x32_bf16 v[240:243], v[16:19], v[96:99], 0
    v_mfma_f32_16x16x32_bf16 v[244:247], v[20:23], v[96:99], 0
    v_mfma_f32_16x16x32_bf16 v[248:251], v[24:27], v[96:99], 0
    v_mfma_f32_16x16x32_bf16 v[252:255], v[28:31], v[96:99], 0
    s_waitcnt lgkmcnt(0)
    s_add_u32 s20, s38, s47
    buffer_load_dwordx4 v[96:99], v1, s[28:31], s20 offen
    v_mfma_f32_16x16x32_bf16 v[128:131], v[32:35], v[92:95], v[128:131]
    s_add_u32 m0, s42, 0
    s_nop 0
    global_load_lds_dwordx4 v2, s[40:41]
    v_mfma_f32_16x16x32_bf16 v[132:135], v[36:39], v[92:95], v[132:135]
    s_add_u32 m0, s42, 1024
    s_nop 0
    global_load_lds_dwordx4 v2, s[56:57]
    v_mfma_f32_16x16x32_bf16 v[136:139], v[40:43], v[92:95], v[136:139]
    s_add_u32 m0, s42, 2048
    s_nop 0
    global_load_lds_dwordx4 v3, s[40:41]
    v_mfma_f32_16x16x32_bf16 v[140:143], v[44:47], v[92:95], v[140:143]
    s_add_u32 m0, s42, 3072
    s_nop 0
    global_load_lds_dwordx4 v3, s[56:57]
    s_add_u32 s59, s59, 1
    s_cmp_eq_u32 s59, 28
    s_cselect_b32 s59, 0, s59
    s_lshl_b32 s56, s59, 18
    s_add_u32 s40, s8, s56
    s_addc_u32 s41, s9, 0
    s_add_u32 s56, s40, 16384
    s_addc_u32 s57, s41, 0
    s_add_u32 s19, s38, s48
    buffer_load_dwordx4 v[92:95], v1, s[28:31], s19 offen
    v_mfma_f32_16x16x32_bf16 v[144:147], v[32:35], v[88:91], v[144:147]
    v_mfma_f32_16x16x32_bf16 v[148:151], v[36:39], v[88:91], v[148:151]
    v_mfma_f32_16x16x32_bf16 v[152:155], v[40:43], v[88:91], v[152:155]
    v_mfma_f32_16x16x32_bf16 v[156:159], v[44:47], v[88:91], v[156:159]
    s_add_u32 s20, s38, s49
    buffer_load_dwordx4 v[88:91], v1, s[28:31], s20 offen
    v_mfma_f32_16x16x32_bf16 v[160:163], v[32:35], v[84:87], v[160:163]
    v_mfma_f32_16x16x32_bf16 v[164:167], v[36:39], v[84:87], v[164:167]
    v_mfma_f32_16x16x32_bf16 v[168:171], v[40:43], v[84:87], v[168:171]
    v_mfma_f32_16x16x32_bf16 v[172:175], v[44:47], v[84:87], v[172:175]
    s_add_u32 s19, s38, s50
    buffer_load_dwordx4 v[84:87], v1, s[28:31], s19 offen
    v_mfma_f32_16x16x32_bf16 v[176:179], v[32:35], v[80:83], v[176:179]
    v_mfma_f32_16x16x32_bf16 v[180:183], v[36:39], v[80:83], v[180:183]
    v_mfma_f32_16x16x32_bf16 v[184:187], v[40:43], v[80:83], v[184:187]
    v_mfma_f32_16x16x32_bf16 v[188:191], v[44:47], v[80:83], v[188:191]
    s_add_u32 s20, s38, s51
    buffer_load_dwordx4 v[80:83], v1, s[28:31], s20 offen
    s_add_u32 s58, s58, 1
    s_cmp_eq_u32 s58, 28
    s_cselect_b32 s58, 0, s58
    s_lshl_b32 s38, s58, 12
    s_add_u32 s38, s38, s60
    v_mfma_f32_16x16x32_bf16 v[192:195], v[32:35], v[76:79], v[192:195]
    s_waitcnt vmcnt(20)
    v_mfma_f32_16x16x32_bf16 v[196:199], v[36:39], v[76:79], v[196:199]
    ds_read_b64_tr_b16 v[16:17], v4 offset:8192
    v_mfma_f32_16x16x32_bf16 v[200:203], v[40:43], v[76:79], v[200:203]
    ds_read_b64_tr_b16 v[18:19], v4 offset:10240
    v_mfma_f32_16x16x32_bf16 v[204:207], v[44:47], v[76:79], v[204:207]
    ds_read_b64_tr_b16 v[20:21], v5 offset:8192
    s_add_u32 s19, s38, s44
    buffer_load_dwordx4 v[76:79], v1, s[28:31], s19 offen
    v_mfma_f32_16x16x32_bf16 v[208:211], v[32:35], v[72:75], v[208:211]
    ds_read_b64_tr_b16 v[22:23], v5 offset:10240
    v_mfma_f32_16x16x32_bf16 v[212:215], v[36:39], v[72:75], v[212:215]
    ds_read_b64_tr_b16 v[24:25], v6 offset:8192
    v_mfma_f32_16x16x32_bf16 v[216:219], v[40:43], v[72:75], v[216:219]
    ds_read_b64_tr_b16 v[26:27], v6 offset:10240
    v_mfma_f32_16x16x32_bf16 v[220:223], v[44:47], v[72:75], v[220:223]
    ds_read_b64_tr_b16 v[28:29], v7 offset:8192
    s_add_u32 s20, s38, s45
    buffer_load_dwordx4 v[72:75], v1, s[28:31], s20 offen
    v_mfma_f32_16x16x32_bf16 v[224:227], v[32:35], v[68:71], v[224:227]
    ds_read_b64_tr_b16 v[30:31], v7 offset:10240
    v_mfma_f32_16x16x32_bf16 v[228:231], v[36:39], v[68:71], v[228:231]
    v_mfma_f32_16x16x32_bf16 v[232:235], v[40:43], v[68:71], v[232:235]
    v_mfma_f32_16x16x32_bf16 v[236:239], v[44:47], v[68:71], v[236:239]
    s_add_u32 s19, s38, s46
    buffer_load_dwordx4 v[68:71], v1, s[28:31], s19 offen
    v_mfma_f32_16x16x32_bf16 v[240:243], v[32:35], v[64:67], v[240:243]
    v_mfma_f32_16x16x32_bf16 v[244:247], v[36:39], v[64:67], v[244:247]
    v_mfma_f32_16x16x32_bf16 v[248:251], v[40:43], v[64:67], v[248:251]
    v_mfma_f32_16x16x32_bf16 v[252:255], v[44:47], v[64:67], v[252:255]
    s_waitcnt lgkmcnt(0)
    s_add_u32 s20, s38, s47
    buffer_load_dwordx4 v[64:67], v1, s[28:31], s20 offen
    v_mfma_f32_16x16x32_bf16 v[128:131], v[16:19], v[60:63], v[128:131]
    s_add_u32 m0, s42, 4096
    s_nop 0
    global_load_lds_dwordx4 v2, s[40:41]
    v_mfma_f32_16x16x32_bf16 v[132:135], v[20:23], v[60:63], v[132:135]
    s_add_u32 m0, s42, 5120
    s_nop 0
    global_load_lds_dwordx4 v2, s[56:57]
    v_mfma_f32_16x16x32_bf16 v[136:139], v[24:27], v[60:63], v[136:139]
    s_add_u32 m0, s42, 6144
    s_nop 0
    global_load_lds_dwordx4 v3, s[40:41]
    v_mfma_f32_16x16x32_bf16 v[140:143], v[28:31], v[60:63], v[140:143]
    s_add_u32 m0, s42, 7168
    s_nop 0
    global_load_lds_dwordx4 v3, s[56:57]
    s_add_u32 s59, s59, 1
    s_cmp_eq_u32 s59, 28
    s_cselect_b32 s59, 0, s59
    s_lshl_b32 s56, s59, 18
    s_add_u32 s40, s8, s56
    s_addc_u32 s41, s9, 0
    s_add_u32 s56, s40, 16384
    s_addc_u32 s57, s41, 0
    s_add_u32 s19, s38, s48
    buffer_load_dwordx4 v[60:63], v1, s[28:31], s19 offen
    v_mfma_f32_16x16x32_bf16 v[144:147], v[16:19], v[56:59], v[144:147]
    v_mfma_f32_16x16x32_bf16 v[148:151], v[20:23], v[56:59], v[148:151]
    v_mfma_f32_16x16x32_bf16 v[152:155], v[24:27], v[56:59], v[152:155]
    v_mfma_f32_16x16x32_bf16 v[156:159], v[28:31], v[56:59], v[156:159]
    s_add_u32 s20, s38, s49
    buffer_load_dwordx4 v[56:59], v1, s[28:31], s20 offen
    v_mfma_f32_16x16x32_bf16 v[160:163], v[16:19], v[52:55], v[160:163]
    v_mfma_f32_16x16x32_bf16 v[164:167], v[20:23], v[52:55], v[164:167]
    v_mfma_f32_16x16x32_bf16 v[168:171], v[24:27], v[52:55], v[168:171]
    v_mfma_f32_16x16x32_bf16 v[172:175], v[28:31], v[52:55], v[172:175]
    s_add_u32 s19, s38, s50
    buffer_load_dwordx4 v[52:55], v1, s[28:31], s19 offen
    v_mfma_f32_16x16x32_bf16 v[176:179], v[16:19], v[48:51], v[176:179]
    v_mfma_f32_16x16x32_bf16 v[180:183], v[20:23], v[48:51], v[180:183]
    v_mfma_f32_16x16x32_bf16 v[184:187], v[24:27], v[48:51], v[184:187]
    v_mfma_f32_16x16x32_bf16 v[188:191], v[28:31], v[48:51], v[188:191]
    s_add_u32 s20, s38, s51
    buffer_load_dwordx4 v[48:51], v1, s[28:31], s20 offen
    s_add_u32 s58, s58, 1
    s_cmp_eq_u32 s58, 28
    s_cselect_b32 s58, 0, s58
    s_lshl_b32 s38, s58, 12
    s_add_u32 s38, s38, s60
    s_waitcnt vmcnt(27)
    v_mfma_f32_16x16x32_bf16 v[192:195], v[16:19], v[124:127], v[192:195]
    v_mfma_f32_16x16x32_bf16 v[196:199], v[20:23], v[124:127], v[196:199]
    ds_read_b64_tr_b16 v[32:33], v4 offset:12288
    v_mfma_f32_16x16x32_bf16 v[200:203], v[24:27], v[124:127], v[200:203]
    ds_read_b64_tr_b16 v[34:35], v4 offset:14336
    v_mfma_f32_16x16x32_bf16 v[204:207], v[28:31], v[124:127], v[204:207]
    ds_read_b64_tr_b16 v[36:37], v5 offset:12288
    s_add_u32 s19, s38, s44
    buffer_load_dwordx4 v[124:127], v1, s[28:31], s19 offen
    s_waitcnt vmcnt(27)
    v_mfma_f32_16x16x32_bf16 v[208:211], v[16:19], v[120:123], v[208:211]
    ds_read_b64_tr_b16 v[38:39], v5 offset:14336
    v_mfma_f32_16x16x32_bf16 v[212:215], v[20:23], v[120:123], v[212:215]
    ds_read_b64_tr_b16 v[40:41], v6 offset:12288
    v_mfma_f32_16x16x32_bf16 v[216:219], v[24:27], v[120:123], v[216:219]
    ds_read_b64_tr_b16 v[42:43], v6 offset:14336
    v_mfma_f32_16x16x32_bf16 v[220:223], v[28:31], v[120:123], v[220:223]
    ds_read_b64_tr_b16 v[44:45], v7 offset:12288
    s_add_u32 s20, s38, s45
    buffer_load_dwordx4 v[120:123], v1, s[28:31], s20 offen
    s_waitcnt vmcnt(27)
    v_mfma_f32_16x16x32_bf16 v[224:227], v[16:19], v[116:119], v[224:227]
    ds_read_b64_tr_b16 v[46:47], v7 offset:14336
    v_mfma_f32_16x16x32_bf16 v[228:231], v[20:23], v[116:119], v[228:231]
    v_mfma_f32_16x16x32_bf16 v[232:235], v[24:27], v[116:119], v[232:235]
    v_mfma_f32_16x16x32_bf16 v[236:239], v[28:31], v[116:119], v[236:239]
    s_add_u32 s19, s38, s46
    buffer_load_dwordx4 v[116:119], v1, s[28:31], s19 offen
    s_waitcnt vmcnt(27)
    v_mfma_f32_16x16x32_bf16 v[240:243], v[16:19], v[112:115], v[240:243]
    v_mfma_f32_16x16x32_bf16 v[244:247], v[20:23], v[112:115], v[244:247]
    v_mfma_f32_16x16x32_bf16 v[248:251], v[24:27], v[112:115], v[248:251]
    v_mfma_f32_16x16x32_bf16 v[252:255], v[28:31], v[112:115], v[252:255]
    s_waitcnt lgkmcnt(0)
    s_add_u32 s20, s38, s47
    buffer_load_dwordx4 v[112:115], v1, s[28:31], s20 offen
    s_waitcnt vmcnt(27)
    v_mfma_f32_16x16x32_bf16 v[128:131], v[32:35], v[108:111], v[128:131]
    s_add_u32 m0, s42, 8192
    s_nop 0
    global_load_lds_dwordx4 v2, s[40:41]
    v_mfma_f32_16x16x32_bf16 v[132:135], v[36:39], v[108:111], v[132:135]
    s_add_u32 m0, s42, 9216
    s_nop 0
    global_load_lds_dwordx4 v2, s[56:57]
    v_mfma_f32_16x16x32_bf16 v[136:139], v[40:43], v[108:111], v[136:139]
    s_add_u32 m0, s42, 10240
    s_nop 0
    global_load_lds_dwordx4 v3, s[40:41]
    v_mfma_f32_16x16x32_bf16 v[140:143], v[44:47], v[108:111], v[140:143]
    s_add_u32 m0, s42, 11264
    s_nop 0
    global_load_lds_dwordx4 v3, s[56:57]
    s_add_u32 s59, s59, 1
    s_cmp_eq_u32 s59, 28
    s_cselect_b32 s59, 0, s59
    s_lshl_b32 s56, s59, 18
    s_add_u32 s40, s8, s56
    s_addc_u32 s41, s9, 0
    s_add_u32 s56, s40, 16384
    s_addc_u32 s57, s41, 0
    s_add_u32 s19, s38, s48
    buffer_load_dwordx4 v[108:111], v1, s[28:31], s19 offen
    s_waitcnt vmcnt(31)
    v_mfma_f32_16x16x32_bf16 v[144:147], v[32:35], v[104:107], v[144:147]
    v_mfma_f32_16x16x32_bf16 v[148:151], v[36:39], v[104:107], v[148:151]
    v_mfma_f32_16x16x32_bf16 v[152:155], v[40:43], v[104:107], v[152:155]
    v_mfma_f32_16x16x32_bf16 v[156:159], v[44:47], v[104:107], v[156:159]
    s_add_u32 s20, s38, s49
    buffer_load_dwordx4 v[104:107], v1, s[28:31], s20 offen
    s_waitcnt vmcnt(31)
    v_mfma_f32_16x16x32_bf16 v[160:163], v[32:35], v[100:103], v[160:163]
    v_mfma_f32_16x16x32_bf16 v[164:167], v[36:39], v[100:103], v[164:167]
    v_mfma_f32_16x16x32_bf16 v[168:171], v[40:43], v[100:103], v[168:171]
    v_mfma_f32_16x16x32_bf16 v[172:175], v[44:47], v[100:103], v[172:175]
    s_add_u32 s19, s38, s50
    buffer_load_dwordx4 v[100:103], v1, s[28:31], s19 offen
    s_waitcnt vmcnt(31)
    v_mfma_f32_16x16x32_bf16 v[176:179], v[32:35], v[96:99], v[176:179]
    v_mfma_f32_16x16x32_bf16 v[180:183], v[36:39], v[96:99], v[180:183]
    v_mfma_f32_16x16x32_bf16 v[184:187], v[40:43], v[96:99], v[184:187]
    v_mfma_f32_16x16x32_bf16 v[188:191], v[44:47], v[96:99], v[188:191]
    s_add_u32 s20, s38, s51
    buffer_load_dwordx4 v[96:99], v1, s[28:31], s20 offen
    s_add_u32 s58, s58, 1
    s_cmp_eq_u32 s58, 28
    s_cselect_b32 s58, 0, s58
    s_lshl_b32 s38, s58, 12
    s_add_u32 s38, s38, s60
    s_waitcnt vmcnt(27)
    v_mfma_f32_16x16x32_bf16 v[192:195], v[32:35], v[92:95], v[192:195]
    v_mfma_f32_16x16x32_bf16 v[196:199], v[36:39], v[92:95], v[196:199]
    ds_read_b64_tr_b16 v[16:17], v4 offset:0
    v_mfma_f32_16x16x32_bf16 v[200:203], v[40:43], v[92:95], v[200:203]
    ds_read_b64_tr_b16 v[18:19], v4 offset:2048
    v_mfma_f32_16x16x32_bf16 v[204:207], v[44:47], v[92:95], v[204:207]
    ds_read_b64_tr_b16 v[20:21], v5 offset:0
    s_add_u32 s19, s38, s44
    buffer_load_dwordx4 v[92:95], v1, s[28:31], s19 offen
    s_waitcnt vmcnt(27)
    v_mfma_f32_16x16x32_bf16 v[208:211], v[32:35], v[88:91], v[208:211]
    ds_read_b64_tr_b16 v[22:23], v5 offset:2048
    v_mfma_f32_16x16x32_bf16 v[212:215], v[36:39], v[88:91], v[212:215]
    ds_read_b64_tr_b16 v[24:25], v6 offset:0
    v_mfma_f32_16x16x32_bf16 v[216:219], v[40:43], v[88:91], v[216:219]
    ds_read_b64_tr_b16 v[26:27], v6 offset:2048
    v_mfma_f32_16x16x32_bf16 v[220:223], v[44:47], v[88:91], v[220:223]
    ds_read_b64_tr_b16 v[28:29], v7 offset:0
    s_add_u32 s20, s38, s45
    buffer_load_dwordx4 v[88:91], v1, s[28:31], s20 offen
    s_waitcnt vmcnt(27)
    v_mfma_f32_16x16x32_bf16 v[224:227], v[32:35], v[84:87], v[224:227]
    ds_read_b64_tr_b16 v[30:31], v7 offset:2048
    v_mfma_f32_16x16x32_bf16 v[228:231], v[36:39], v[84:87], v[228:231]
    v_mfma_f32_16x16x32_bf16 v[232:235], v[40:43], v[84:87], v[232:235]
    v_mfma_f32_16x16x32_bf16 v[236:239], v[44:47], v[84:87], v[236:239]
    s_add_u32 s19, s38, s46
    buffer_load_dwordx4 v[84:87], v1, s[28:31], s19 offen
    s_waitcnt vmcnt(27)
    v_mfma_f32_16x16x32_bf16 v[240:243], v[32:35], v[80:83], v[240:243]
    v_mfma_f32_16x16x32_bf16 v[244:247], v[36:39], v[80:83], v[244:247]
    v_mfma_f32_16x16x32_bf16 v[248:251], v[40:43], v[80:83], v[248:251]
    v_mfma_f32_16x16x32_bf16 v[252:255], v[44:47], v[80:83], v[252:255]
    s_waitcnt lgkmcnt(0)
    s_add_u32 s20, s38, s47
    buffer_load_dwordx4 v[80:83], v1, s[28:31], s20 offen
    s_waitcnt vmcnt(27)
    v_mfma_f32_16x16x32_bf16 v[128:131], v[16:19], v[76:79], v[128:131]
    s_add_u32 m0, s42, 12288
    s_nop 0
    global_load_lds_dwordx4 v2, s[40:41]
    v_mfma_f32_16x16x32_bf16 v[132:135], v[20:23], v[76:79], v[132:135]
    s_add_u32 m0, s42, 13312
    s_nop 0
    global_load_lds_dwordx4 v2, s[56:57]
    v_mfma_f32_16x16x32_bf16 v[136:139], v[24:27], v[76:79], v[136:139]
    s_add_u32 m0, s42, 14336
    s_nop 0
    global_load_lds_dwordx4 v3, s[40:41]
    v_mfma_f32_16x16x32_bf16 v[140:143], v[28:31], v[76:79], v[140:143]
    s_add_u32 m0, s42, 15360
    s_nop 0
    global_load_lds_dwordx4 v3, s[56:57]
    s_add_u32 s59, s59, 1
    s_cmp_eq_u32 s59, 28
    s_cselect_b32 s59, 0, s59
    s_lshl_b32 s56, s59, 18
    s_add_u32 s40, s8, s56
    s_addc_u32 s41, s9, 0
    s_add_u32 s56, s40, 16384
    s_addc_u32 s57, s41, 0
    s_add_u32 s19, s38, s48
    buffer_load_dwordx4 v[76:79], v1, s[28:31], s19 offen
    s_waitcnt vmcnt(31)
    v_mfma_f32_16x16x32_bf16 v[144:147], v[16:19], v[72:75], v[144:147]
    v_mfma_f32_16x16x32_bf16 v[148:151], v[20:23], v[72:75], v[148:151]
    v_mfma_f32_16x16x32_bf16 v[152:155], v[24:27], v[72:75], v[152:155]
    v_mfma_f32_16x16x32_bf16 v[156:159], v[28:31], v[72:75], v[156:159]
    s_add_u32 s20, s38, s49
    buffer_load_dwordx4 v[72:75], v1, s[28:31], s20 offen
    s_waitcnt vmcnt(31)
    v_mfma_f32_16x16x32_bf16 v[160:163], v[16:19], v[68:71], v[160:163]
    v_mfma_f32_16x16x32_bf16 v[164:167], v[20:23], v[68:71], v[164:167]
    v_mfma_f32_16x16x32_bf16 v[168:171], v[24:27], v[68:71], v[168:171]
    v_mfma_f32_16x16x32_bf16 v[172:175], v[28:31], v[68:71], v[172:175]
    s_add_u32 s19, s38, s50
    buffer_load_dwordx4 v[68:71], v1, s[28:31], s19 offen
    s_waitcnt vmcnt(31)
    v_mfma_f32_16x16x32_bf16 v[176:179], v[16:19], v[64:67], v[176:179]
    v_mfma_f32_16x16x32_bf16 v[180:183], v[20:23], v[64:67], v[180:183]
    v_mfma_f32_16x16x32_bf16 v[184:187], v[24:27], v[64:67], v[184:187]
    v_mfma_f32_16x16x32_bf16 v[188:191], v[28:31], v[64:67], v[188:191]
    s_add_u32 s20, s38, s51
    buffer_load_dwordx4 v[64:67], v1, s[28:31], s20 offen
    s_add_u32 s58, s58, 1
    s_cmp_eq_u32 s58, 28
    s_cselect_b32 s58, 0, s58
    s_lshl_b32 s38, s58, 12
    s_add_u32 s38, s38, s60
    s_waitcnt vmcnt(27)
    v_mfma_f32_16x16x32_bf16 v[192:195], v[16:19], v[60:63], v[192:195]
    v_mfma_f32_16x16x32_bf16 v[196:199], v[20:23], v[60:63], v[196:199]
    ds_read_b64_tr_b16 v[32:33], v4 offset:4096
    v_mfma_f32_16x16x32_bf16 v[200:203], v[24:27], v[60:63], v[200:203]
    ds_read_b64_tr_b16 v[34:35], v4 offset:6144
    v_mfma_f32_16x16x32_bf16 v[204:207], v[28:31], v[60:63], v[204:207]
    ds_read_b64_tr_b16 v[36:37], v5 offset:4096
    s_add_u32 s19, s38, s44
    buffer_load_dwordx4 v[60:63], v1, s[28:31], s19 offen
    s_waitcnt vmcnt(27)
    v_mfma_f32_16x16x32_bf16 v[208:211], v[16:19], v[56:59], v[208:211]
    ds_read_b64_tr_b16 v[38:39], v5 offset:6144
    v_mfma_f32_16x16x32_bf16 v[212:215], v[20:23], v[56:59], v[212:215]
    ds_read_b64_tr_b16 v[40:41], v6 offset:4096
    v_mfma_f32_16x16x32_bf16 v[216:219], v[24:27], v[56:59], v[216:219]
    ds_read_b64_tr_b16 v[42:43], v6 offset:6144
    v_mfma_f32_16x16x32_bf16 v[220:223], v[28:31], v[56:59], v[220:223]
    ds_read_b64_tr_b16 v[44:45], v7 offset:4096
    s_add_u32 s20, s38, s45
    buffer_load_dwordx4 v[56:59], v1, s[28:31], s20 offen
    s_waitcnt vmcnt(27)
    v_mfma_f32_16x16x32_bf16 v[224:227], v[16:19], v[52:55], v[224:227]
    ds_read_b64_tr_b16 v[46:47], v7 offset:6144
    v_mfma_f32_16x16x32_bf16 v[228:231], v[20:23], v[52:55], v[228:231]
    v_mfma_f32_16x16x32_bf16 v[232:235], v[24:27], v[52:55], v[232:235]
    v_mfma_f32_16x16x32_bf16 v[236:239], v[28:31], v[52:55], v[236:239]
    s_add_u32 s19, s38, s46
    buffer_load_dwordx4 v[52:55], v1, s[28:31], s19 offen
    s_waitcnt vmcnt(27)
    v_mfma_f32_16x16x32_bf16 v[240:243], v[16:19], v[48:51], v[240:243]
    v_mfma_f32_16x16x32_bf16 v[244:247], v[20:23], v[48:51], v[244:247]
    v_mfma_f32_16x16x32_bf16 v[248:251], v[24:27], v[48:51], v[248:251]
    v_mfma_f32_16x16x32_bf16 v[252:255], v[28:31], v[48:51], v[252:255]
    s_waitcnt lgkmcnt(0)
    s_add_u32 s20, s38, s47
    buffer_load_dwordx4 v[48:51], v1, s[28:31], s20 offen
    s_waitcnt vmcnt(27)
    v_mfma_f32_16x16x32_bf16 v[128:131], v[32:35], v[124:127], v[128:131]
    s_add_u32 m0, s42, 0
    s_nop 0
    global_load_lds_dwordx4 v2, s[40:41]
    v_mfma_f32_16x16x32_bf16 v[132:135], v[36:39], v[124:127], v[132:135]
    s_add_u32 m0, s42, 1024
    s_nop 0
    global_load_lds_dwordx4 v2, s[56:57]
    v_mfma_f32_16x16x32_bf16 v[136:139], v[40:43], v[124:127], v[136:139]
    s_add_u32 m0, s42, 2048
    s_nop 0
    global_load_lds_dwordx4 v3, s[40:41]
    v_mfma_f32_16x16x32_bf16 v[140:143], v[44:47], v[124:127], v[140:143]
    s_add_u32 m0, s42, 3072
    s_nop 0
    global_load_lds_dwordx4 v3, s[56:57]
    s_add_u32 s59, s59, 1
    s_cmp_eq_u32 s59, 28
    s_cselect_b32 s59, 0, s59
    s_lshl_b32 s56, s59, 18
    s_add_u32 s40, s8, s56
    s_addc_u32 s41, s9, 0
    s_add_u32 s56, s40, 16384
    s_addc_u32 s57, s41, 0
    s_add_u32 s19, s38, s48
    buffer_load_dwordx4 v[124:127], v1, s[28:31], s19 offen
    s_waitcnt vmcnt(31)
    v_mfma_f32_16x16x32_bf16 v[144:147], v[32:35], v[120:123], v[144:147]
    v_mfma_f32_16x16x32_bf16 v[148:151], v[36:39], v[120:123], v[148:151]
    v_mfma_f32_16x16x32_bf16 v[152:155], v[40:43], v[120:123], v[152:155]
    v_mfma_f32_16x16x32_bf16 v[156:159], v[44:47], v[120:123], v[156:159]
    s_add_u32 s20, s38, s49
    buffer_load_dwordx4 v[120:123], v1, s[28:31], s20 offen
    s_waitcnt vmcnt(31)
    v_mfma_f32_16x16x32_bf16 v[160:163], v[32:35], v[116:119], v[160:163]
    v_mfma_f32_16x16x32_bf16 v[164:167], v[36:39], v[116:119], v[164:167]
    v_mfma_f32_16x16x32_bf16 v[168:171], v[40:43], v[116:119], v[168:171]
    v_mfma_f32_16x16x32_bf16 v[172:175], v[44:47], v[116:119], v[172:175]
    s_add_u32 s19, s38, s50
    buffer_load_dwordx4 v[116:119], v1, s[28:31], s19 offen
    s_waitcnt vmcnt(31)
    v_mfma_f32_16x16x32_bf16 v[176:179], v[32:35], v[112:115], v[176:179]
    v_mfma_f32_16x16x32_bf16 v[180:183], v[36:39], v[112:115], v[180:183]
    v_mfma_f32_16x16x32_bf16 v[184:187], v[40:43], v[112:115], v[184:187]
    v_mfma_f32_16x16x32_bf16 v[188:191], v[44:47], v[112:115], v[188:191]
    s_add_u32 s20, s38, s51
    buffer_load_dwordx4 v[112:115], v1, s[28:31], s20 offen
    s_add_u32 s58, s58, 1
    s_cmp_eq_u32 s58, 28
    s_cselect_b32 s58, 0, s58
    s_lshl_b32 s38, s58, 12
    s_add_u32 s38, s38, s60
    s_waitcnt vmcnt(27)
    v_mfma_f32_16x16x32_bf16 v[192:195], v[32:35], v[108:111], v[192:195]
    v_mfma_f32_16x16x32_bf16 v[196:199], v[36:39], v[108:111], v[196:199]
    ds_read_b64_tr_b16 v[16:17], v4 offset:8192
    v_mfma_f32_16x16x32_bf16 v[200:203], v[40:43], v[108:111], v[200:203]
    ds_read_b64_tr_b16 v[18:19], v4 offset:10240
    v_mfma_f32_16x16x32_bf16 v[204:207], v[44:47], v[108:111], v[204:207]
    ds_read_b64_tr_b16 v[20:21], v5 offset:8192
    s_add_u32 s19, s38, s44
    buffer_load_dwordx4 v[108:111], v1, s[28:31], s19 offen
    s_waitcnt vmcnt(27)
    v_mfma_f32_16x16x32_bf16 v[208:211], v[32:35], v[104:107], v[208:211]
    ds_read_b64_tr_b16 v[22:23], v5 offset:10240
    v_mfma_f32_16x16x32_bf16 v[212:215], v[36:39], v[104:107], v[212:215]
    ds_read_b64_tr_b16 v[24:25], v6 offset:8192
    v_mfma_f32_16x16x32_bf16 v[216:219], v[40:43], v[104:107], v[216:219]
    ds_read_b64_tr_b16 v[26:27], v6 offset:10240
    v_mfma_f32_16x16x32_bf16 v[220:223], v[44:47], v[104:107], v[220:223]
    ds_read_b64_tr_b16 v[28:29], v7 offset:8192
    s_add_u32 s20, s38, s45
    buffer_load_dwordx4 v[104:107], v1, s[28:31], s20 offen
    s_waitcnt vmcnt(27)
    v_mfma_f32_16x16x32_bf16 v[224:227], v[32:35], v[100:103], v[224:227]
    ds_read_b64_tr_b16 v[30:31], v7 offset:10240
    v_mfma_f32_16x16x32_bf16 v[228:231], v[36:39], v[100:103], v[228:231]
    v_mfma_f32_16x16x32_bf16 v[232:235], v[40:43], v[100:103], v[232:235]
    v_mfma_f32_16x16x32_bf16 v[236:239], v[44:47], v[100:103], v[236:239]
    s_add_u32 s19, s38, s46
    buffer_load_dwordx4 v[100:103], v1, s[28:31], s19 offen
    s_waitcnt vmcnt(27)
    v_mfma_f32_16x16x32_bf16 v[240:243], v[32:35], v[96:99], v[240:243]
    v_mfma_f32_16x16x32_bf16 v[244:247], v[36:39], v[96:99], v[244:247]
    v_mfma_f32_16x16x32_bf16 v[248:251], v[40:43], v[96:99], v[248:251]
    v_mfma_f32_16x16x32_bf16 v[252:255], v[44:47], v[96:99], v[252:255]
    s_waitcnt lgkmcnt(0)
    s_add_u32 s20, s38, s47
    buffer_load_dwordx4 v[96:99], v1, s[28:31], s20 offen
    s_waitcnt vmcnt(27)
    v_mfma_f32_16x16x32_bf16 v[128:131], v[16:19], v[92:95], v[128:131]
    s_add_u32 m0, s42, 4096
    s_nop 0
    global_load_lds_dwordx4 v2, s[40:41]
    v_mfma_f32_16x16x32_bf16 v[132:135], v[20:23], v[92:95], v[132:135]
    s_add_u32 m0, s42, 5120
    s_nop 0
    global_load_lds_dwordx4 v2, s[56:57]
    v_mfma_f32_16x16x32_bf16 v[136:139], v[24:27], v[92:95], v[136:139]
    s_add_u32 m0, s42, 6144
    s_nop 0
    global_load_lds_dwordx4 v3, s[40:41]
    v_mfma_f32_16x16x32_bf16 v[140:143], v[28:31], v[92:95], v[140:143]
    s_add_u32 m0, s42, 7168
    s_nop 0
    global_load_lds_dwordx4 v3, s[56:57]
    s_add_u32 s59, s59, 1
    s_cmp_eq_u32 s59, 28
    s_cselect_b32 s59, 0, s59
    s_lshl_b32 s56, s59, 18
    s_add_u32 s40, s8, s56
    s_addc_u32 s41, s9, 0
    s_add_u32 s56, s40, 16384
    s_addc_u32 s57, s41, 0
    s_add_u32 s19, s38, s48
    buffer_load_dwordx4 v[92:95], v1, s[28:31], s19 offen
    s_waitcnt vmcnt(31)
    v_mfma_f32_16x16x32_bf16 v[144:147], v[16:19], v[88:91], v[144:147]
    v_mfma_f32_16x16x32_bf16 v[148:151], v[20:23], v[88:91], v[148:151]
    v_mfma_f32_16x16x32_bf16 v[152:155], v[24:27], v[88:91], v[152:155]
    v_mfma_f32_16x16x32_bf16 v[156:159], v[28:31], v[88:91], v[156:159]
    s_add_u32 s20, s38, s49
    buffer_load_dwordx4 v[88:91], v1, s[28:31], s20 offen
    s_waitcnt vmcnt(31)
    v_mfma_f32_16x16x32_bf16 v[160:163], v[16:19], v[84:87], v[160:163]
    v_mfma_f32_16x16x32_bf16 v[164:167], v[20:23], v[84:87], v[164:167]
    v_mfma_f32_16x16x32_bf16 v[168:171], v[24:27], v[84:87], v[168:171]
    v_mfma_f32_16x16x32_bf16 v[172:175], v[28:31], v[84:87], v[172:175]
    s_add_u32 s19, s38, s50
    buffer_load_dwordx4 v[84:87], v1, s[28:31], s19 offen
    s_waitcnt vmcnt(31)
    v_mfma_f32_16x16x32_bf16 v[176:179], v[16:19], v[80:83], v[176:179]
    v_mfma_f32_16x16x32_bf16 v[180:183], v[20:23], v[80:83], v[180:183]
    v_mfma_f32_16x16x32_bf16 v[184:187], v[24:27], v[80:83], v[184:187]
    v_mfma_f32_16x16x32_bf16 v[188:191], v[28:31], v[80:83], v[188:191]
    s_add_u32 s20, s38, s51
    buffer_load_dwordx4 v[80:83], v1, s[28:31], s20 offen
    s_add_u32 s58, s58, 1
    s_cmp_eq_u32 s58, 28
    s_cselect_b32 s58, 0, s58
    s_lshl_b32 s38, s58, 12
    s_add_u32 s38, s38, s60
    s_waitcnt vmcnt(27)
    v_mfma_f32_16x16x32_bf16 v[192:195], v[16:19], v[76:79], v[192:195]
    v_mfma_f32_16x16x32_bf16 v[196:199], v[20:23], v[76:79], v[196:199]
    ds_read_b64_tr_b16 v[32:33], v4 offset:12288
    v_mfma_f32_16x16x32_bf16 v[200:203], v[24:27], v[76:79], v[200:203]
    ds_read_b64_tr_b16 v[34:35], v4 offset:14336
    v_mfma_f32_16x16x32_bf16 v[204:207], v[28:31], v[76:79], v[204:207]
    ds_read_b64_tr_b16 v[36:37], v5 offset:12288
    s_add_u32 s19, s38, s44
    buffer_load_dwordx4 v[76:79], v1, s[28:31], s19 offen
    s_waitcnt vmcnt(27)
    v_mfma_f32_16x16x32_bf16 v[208:211], v[16:19], v[72:75], v[208:211]
    ds_read_b64_tr_b16 v[38:39], v5 offset:14336
    v_mfma_f32_16x16x32_bf16 v[212:215], v[20:23], v[72:75], v[212:215]
    ds_read_b64_tr_b16 v[40:41], v6 offset:12288
    v_mfma_f32_16x16x32_bf16 v[216:219], v[24:27], v[72:75], v[216:219]
    ds_read_b64_tr_b16 v[42:43], v6 offset:14336
    v_mfma_f32_16x16x32_bf16 v[220:223], v[28:31], v[72:75], v[220:223]
    ds_read_b64_tr_b16 v[44:45], v7 offset:12288
    s_add_u32 s20, s38, s45
    buffer_load_dwordx4 v[72:75], v1, s[28:31], s20 offen
    s_waitcnt vmcnt(27)
    v_mfma_f32_16x16x32_bf16 v[224:227], v[16:19], v[68:71], v[224:227]
    ds_read_b64_tr_b16 v[46:47], v7 offset:14336
    v_mfma_f32_16x16x32_bf16 v[228:231], v[20:23], v[68:71], v[228:231]
    v_mfma_f32_16x16x32_bf16 v[232:235], v[24:27], v[68:71], v[232:235]
    v_mfma_f32_16x16x32_bf16 v[236:239], v[28:31], v[68:71], v[236:239]
    s_add_u32 s19, s38, s46
    buffer_load_dwordx4 v[68:71], v1, s[28:31], s19 offen
    s_waitcnt vmcnt(27)
    v_mfma_f32_16x16x32_bf16 v[240:243], v[16:19], v[64:67], v[240:243]
    v_mfma_f32_16x16x32_bf16 v[244:247], v[20:23], v[64:67], v[244:247]
    v_mfma_f32_16x16x32_bf16 v[248:251], v[24:27], v[64:67], v[248:251]
    v_mfma_f32_16x16x32_bf16 v[252:255], v[28:31], v[64:67], v[252:255]
    s_waitcnt lgkmcnt(0)
    s_add_u32 s20, s38, s47
    buffer_load_dwordx4 v[64:67], v1, s[28:31], s20 offen
    s_waitcnt vmcnt(27)
    v_mfma_f32_16x16x32_bf16 v[128:131], v[32:35], v[60:63], v[128:131]
    s_add_u32 m0, s42, 8192
    s_nop 0
    global_load_lds_dwordx4 v2, s[40:41]
    v_mfma_f32_16x16x32_bf16 v[132:135], v[36:39], v[60:63], v[132:135]
    s_add_u32 m0, s42, 9216
    s_nop 0
    global_load_lds_dwordx4 v2, s[56:57]
    v_mfma_f32_16x16x32_bf16 v[136:139], v[40:43], v[60:63], v[136:139]
    s_add_u32 m0, s42, 10240
    s_nop 0
    global_load_lds_dwordx4 v3, s[40:41]
    v_mfma_f32_16x16x32_bf16 v[140:143], v[44:47], v[60:63], v[140:143]
    s_add_u32 m0, s42, 11264
    s_nop 0
    global_load_lds_dwordx4 v3, s[56:57]
    s_add_u32 s59, s59, 1
    s_cmp_eq_u32 s59, 28
    s_cselect_b32 s59, 0, s59
    s_lshl_b32 s56, s59, 18
    s_add_u32 s40, s8, s56
    s_addc_u32 s41, s9, 0
    s_add_u32 s56, s40, 16384
    s_addc_u32 s57, s41, 0
    s_add_u32 s19, s38, s48
    buffer_load_dwordx4 v[60:63], v1, s[28:31], s19 offen
    s_waitcnt vmcnt(31)
    v_mfma_f32_16x16x32_bf16 v[144:147], v[32:35], v[56:59], v[144:147]
    v_mfma_f32_16x16x32_bf16 v[148:151], v[36:39], v[56:59], v[148:151]
    v_mfma_f32_16x16x32_bf16 v[152:155], v[40:43], v[56:59], v[152:155]
    v_mfma_f32_16x16x32_bf16 v[156:159], v[44:47], v[56:59], v[156:159]
    s_add_u32 s20, s38, s49
    buffer_load_dwordx4 v[56:59], v1, s[28:31], s20 offen
    s_waitcnt vmcnt(31)
    v_mfma_f32_16x16x32_bf16 v[160:163], v[32:35], v[52:55], v[160:163]
    v_mfma_f32_16x16x32_bf16 v[164:167], v[36:39], v[52:55], v[164:167]
    v_mfma_f32_16x16x32_bf16 v[168:171], v[40:43], v[52:55], v[168:171]
    v_mfma_f32_16x16x32_bf16 v[172:175], v[44:47], v[52:55], v[172:175]
    s_add_u32 s19, s38, s50
    buffer_load_dwordx4 v[52:55], v1, s[28:31], s19 offen
    s_waitcnt vmcnt(31)
    v_mfma_f32_16x16x32_bf16 v[176:179], v[32:35], v[48:51], v[176:179]
    v_mfma_f32_16x16x32_bf16 v[180:183], v[36:39], v[48:51], v[180:183]
    v_mfma_f32_16x16x32_bf16 v[184:187], v[40:43], v[48:51], v[184:187]
    v_mfma_f32_16x16x32_bf16 v[188:191], v[44:47], v[48:51], v[188:191]
    s_add_u32 s20, s38, s51
    buffer_load_dwordx4 v[48:51], v1, s[28:31], s20 offen
    s_add_u32 s58, s58, 1
    s_cmp_eq_u32 s58, 28
    s_cselect_b32 s58, 0, s58
    s_lshl_b32 s38, s58, 12
    s_add_u32 s38, s38, s60
    s_waitcnt vmcnt(27)
    v_mfma_f32_16x16x32_bf16 v[192:195], v[32:35], v[124:127], v[192:195]
    v_mfma_f32_16x16x32_bf16 v[196:199], v[36:39], v[124:127], v[196:199]
    ds_read_b64_tr_b16 v[16:17], v4 offset:0
    v_mfma_f32_16x16x32_bf16 v[200:203], v[40:43], v[124:127], v[200:203]
    ds_read_b64_tr_b16 v[18:19], v4 offset:2048
    v_mfma_f32_16x16x32_bf16 v[204:207], v[44:47], v[124:127], v[204:207]
    ds_read_b64_tr_b16 v[20:21], v5 offset:0
    s_add_u32 s19, s38, s44
    buffer_load_dwordx4 v[124:127], v1, s[28:31], s19 offen
    s_waitcnt vmcnt(27)
    v_mfma_f32_16x16x32_bf16 v[208:211], v[32:35], v[120:123], v[208:211]
    ds_read_b64_tr_b16 v[22:23], v5 offset:2048
    v_mfma_f32_16x16x32_bf16 v[212:215], v[36:39], v[120:123], v[212:215]
    ds_read_b64_tr_b16 v[24:25], v6 offset:0
    v_mfma_f32_16x16x32_bf16 v[216:219], v[40:43], v[120:123], v[216:219]
    ds_read_b64_tr_b16 v[26:27], v6 offset:2048
    v_mfma_f32_16x16x32_bf16 v[220:223], v[44:47], v[120:123], v[220:223]
    ds_read_b64_tr_b16 v[28:29], v7 offset:0
    s_add_u32 s20, s38, s45
    buffer_load_dwordx4 v[120:123], v1, s[28:31], s20 offen
    s_waitcnt vmcnt(27)
    v_mfma_f32_16x16x32_bf16 v[224:227], v[32:35], v[116:119], v[224:227]
    ds_read_b64_tr_b16 v[30:31], v7 offset:2048
    v_mfma_f32_16x16x32_bf16 v[228:231], v[36:39], v[116:119], v[228:231]
    v_mfma_f32_16x16x32_bf16 v[232:235], v[40:43], v[116:119], v[232:235]
    v_mfma_f32_16x16x32_bf16 v[236:239], v[44:47], v[116:119], v[236:239]
    s_add_u32 s19, s38, s46
    buffer_load_dwordx4 v[116:119], v1, s[28:31], s19 offen
    s_waitcnt vmcnt(27)
    v_mfma_f32_16x16x32_bf16 v[240:243], v[32:35], v[112:115], v[240:243]
    v_mfma_f32_16x16x32_bf16 v[244:247], v[36:39], v[112:115], v[244:247]
    v_mfma_f32_16x16x32_bf16 v[248:251], v[40:43], v[112:115], v[248:251]
    v_mfma_f32_16x16x32_bf16 v[252:255], v[44:47], v[112:115], v[252:255]
    s_waitcnt lgkmcnt(0)
    s_add_u32 s20, s38, s47
    buffer_load_dwordx4 v[112:115], v1, s[28:31], s20 offen
    s_waitcnt vmcnt(27)
    v_mfma_f32_16x16x32_bf16 v[128:131], v[16:19], v[108:111], v[128:131]
    s_add_u32 m0, s42, 12288
    s_nop 0
    global_load_lds_dwordx4 v2, s[40:41]
    v_mfma_f32_16x16x32_bf16 v[132:135], v[20:23], v[108:111], v[132:135]
    s_add_u32 m0, s42, 13312
    s_nop 0
    global_load_lds_dwordx4 v2, s[56:57]
    v_mfma_f32_16x16x32_bf16 v[136:139], v[24:27], v[108:111], v[136:139]
    s_add_u32 m0, s42, 14336
    s_nop 0
    global_load_lds_dwordx4 v3, s[40:41]
    v_mfma_f32_16x16x32_bf16 v[140:143], v[28:31], v[108:111], v[140:143]
    s_add_u32 m0, s42, 15360
    s_nop 0
    global_load_lds_dwordx4 v3, s[56:57]
    s_add_u32 s59, s59, 1
    s_cmp_eq_u32 s59, 28
    s_cselect_b32 s59, 0, s59
    s_lshl_b32 s56, s59, 18
    s_add_u32 s40, s8, s56
    s_addc_u32 s41, s9, 0
    s_add_u32 s56, s40, 16384
    s_addc_u32 s57, s41, 0
    s_add_u32 s19, s38, s48
    buffer_load_dwordx4 v[108:111], v1, s[28:31], s19 offen
    s_waitcnt vmcnt(31)
    v_mfma_f32_16x16x32_bf16 v[144:147], v[16:19], v[104:107], v[144:147]
    v_mfma_f32_16x16x32_bf16 v[148:151], v[20:23], v[104:107], v[148:151]
    v_mfma_f32_16x16x32_bf16 v[152:155], v[24:27], v[104:107], v[152:155]
    v_mfma_f32_16x16x32_bf16 v[156:159], v[28:31], v[104:107], v[156:159]
    s_add_u32 s20, s38, s49
    buffer_load_dwordx4 v[104:107], v1, s[28:31], s20 offen
    s_waitcnt vmcnt(31)
    v_mfma_f32_16x16x32_bf16 v[160:163], v[16:19], v[100:103], v[160:163]
    v_mfma_f32_16x16x32_bf16 v[164:167], v[20:23], v[100:103], v[164:167]
    v_mfma_f32_16x16x32_bf16 v[168:171], v[24:27], v[100:103], v[168:171]
    v_mfma_f32_16x16x32_bf16 v[172:175], v[28:31], v[100:103], v[172:175]
    s_add_u32 s19, s38, s50
    buffer_load_dwordx4 v[100:103], v1, s[28:31], s19 offen
    s_waitcnt vmcnt(31)
    v_mfma_f32_16x16x32_bf16 v[176:179], v[16:19], v[96:99], v[176:179]
    v_mfma_f32_16x16x32_bf16 v[180:183], v[20:23], v[96:99], v[180:183]
    v_mfma_f32_16x16x32_bf16 v[184:187], v[24:27], v[96:99], v[184:187]
    v_mfma_f32_16x16x32_bf16 v[188:191], v[28:31], v[96:99], v[188:191]
    s_add_u32 s20, s38, s51
    buffer_load_dwordx4 v[96:99], v1, s[28:31], s20 offen
    s_add_u32 s58, s58, 1
    s_cmp_eq_u32 s58, 28
    s_cselect_b32 s58, 0, s58
    s_lshl_b32 s38, s58, 12
    s_add_u32 s38, s38, s60
    s_waitcnt vmcnt(27)
    v_mfma_f32_16x16x32_bf16 v[192:195], v[16:19], v[92:95], v[192:195]
    v_mfma_f32_16x16x32_bf16 v[196:199], v[20:23], v[92:95], v[196:199]
    ds_read_b64_tr_b16 v[32:33], v4 offset:4096
    v_mfma_f32_16x16x32_bf16 v[200:203], v[24:27], v[92:95], v[200:203]
    ds_read_b64_tr_b16 v[34:35], v4 offset:6144
    v_mfma_f32_16x16x32_bf16 v[204:207], v[28:31], v[92:95], v[204:207]
    ds_read_b64_tr_b16 v[36:37], v5 offset:4096
    s_add_u32 s19, s38, s44
    buffer_load_dwordx4 v[92:95], v1, s[28:31], s19 offen
    s_waitcnt vmcnt(27)
    v_mfma_f32_16x16x32_bf16 v[208:211], v[16:19], v[88:91], v[208:211]
    ds_read_b64_tr_b16 v[38:39], v5 offset:6144
    v_mfma_f32_16x16x32_bf16 v[212:215], v[20:23], v[88:91], v[212:215]
    ds_read_b64_tr_b16 v[40:41], v6 offset:4096
    v_mfma_f32_16x16x32_bf16 v[216:219], v[24:27], v[88:91], v[216:219]
    ds_read_b64_tr_b16 v[42:43], v6 offset:6144
    v_mfma_f32_16x16x32_bf16 v[220:223], v[28:31], v[88:91], v[220:223]
    ds_read_b64_tr_b16 v[44:45], v7 offset:4096
    s_add_u32 s20, s38, s45
    buffer_load_dwordx4 v[88:91], v1, s[28:31], s20 offen
    s_waitcnt vmcnt(27)
    v_mfma_f32_16x16x32_bf16 v[224:227], v[16:19], v[84:87], v[224:227]
    ds_read_b64_tr_b16 v[46:47], v7 offset:6144
    v_mfma_f32_16x16x32_bf16 v[228:231], v[20:23], v[84:87], v[228:231]
    v_mfma_f32_16x16x32_bf16 v[232:235], v[24:27], v[84:87], v[232:235]
    v_mfma_f32_16x16x32_bf16 v[236:239], v[28:31], v[84:87], v[236:239]
    s_add_u32 s19, s38, s46
    buffer_load_dwordx4 v[84:87], v1, s[28:31], s19 offen
    s_waitcnt vmcnt(27)
    v_mfma_f32_16x16x32_bf16 v[240:243], v[16:19], v[80:83], v[240:243]
    v_mfma_f32_16x16x32_bf16 v[244:247], v[20:23], v[80:83], v[244:247]
    v_mfma_f32_16x16x32_bf16 v[248:251], v[24:27], v[80:83], v[248:251]
    v_mfma_f32_16x16x32_bf16 v[252:255], v[28:31], v[80:83], v[252:255]
    s_waitcnt lgkmcnt(0)
    s_add_u32 s20, s38, s47
    buffer_load_dwordx4 v[80:83], v1, s[28:31], s20 offen
    s_waitcnt vmcnt(27)
    v_mfma_f32_16x16x32_bf16 v[128:131], v[32:35], v[76:79], v[128:131]
    s_add_u32 m0, s42, 0
    s_nop 0
    global_load_lds_dwordx4 v2, s[40:41]
    v_mfma_f32_16x16x32_bf16 v[132:135], v[36:39], v[76:79], v[132:135]
    s_add_u32 m0, s42, 1024
    s_nop 0
    global_load_lds_dwordx4 v2, s[56:57]
    v_mfma_f32_16x16x32_bf16 v[136:139], v[40:43], v[76:79], v[136:139]
    s_add_u32 m0, s42, 2048
    s_nop 0
    global_load_lds_dwordx4 v3, s[40:41]
    v_mfma_f32_16x16x32_bf16 v[140:143], v[44:47], v[76:79], v[140:143]
    s_add_u32 m0, s42, 3072
    s_nop 0
    global_load_lds_dwordx4 v3, s[56:57]
    s_add_u32 s59, s59, 1
    s_cmp_eq_u32 s59, 28
    s_cselect_b32 s59, 0, s59
    s_lshl_b32 s56, s59, 18
    s_add_u32 s40, s8, s56
    s_addc_u32 s41, s9, 0
    s_add_u32 s56, s40, 16384
    s_addc_u32 s57, s41, 0
    s_add_u32 s19, s38, s48
    buffer_load_dwordx4 v[76:79], v1, s[28:31], s19 offen
    s_waitcnt vmcnt(31)
    v_mfma_f32_16x16x32_bf16 v[144:147], v[32:35], v[72:75], v[144:147]
    v_mfma_f32_16x16x32_bf16 v[148:151], v[36:39], v[72:75], v[148:151]
    v_mfma_f32_16x16x32_bf16 v[152:155], v[40:43], v[72:75], v[152:155]
    v_mfma_f32_16x16x32_bf16 v[156:159], v[44:47], v[72:75], v[156:159]
    s_add_u32 s20, s38, s49
    buffer_load_dwordx4 v[72:75], v1, s[28:31], s20 offen
    s_waitcnt vmcnt(31)
    v_mfma_f32_16x16x32_bf16 v[160:163], v[32:35], v[68:71], v[160:163]
    v_mfma_f32_16x16x32_bf16 v[164:167], v[36:39], v[68:71], v[164:167]
    v_mfma_f32_16x16x32_bf16 v[168:171], v[40:43], v[68:71], v[168:171]
    v_mfma_f32_16x16x32_bf16 v[172:175], v[44:47], v[68:71], v[172:175]
    s_add_u32 s19, s38, s50
    buffer_load_dwordx4 v[68:71], v1, s[28:31], s19 offen
    s_waitcnt vmcnt(31)
    v_mfma_f32_16x16x32_bf16 v[176:179], v[32:35], v[64:67], v[176:179]
    v_mfma_f32_16x16x32_bf16 v[180:183], v[36:39], v[64:67], v[180:183]
    v_mfma_f32_16x16x32_bf16 v[184:187], v[40:43], v[64:67], v[184:187]
    v_mfma_f32_16x16x32_bf16 v[188:191], v[44:47], v[64:67], v[188:191]
    s_add_u32 s20, s38, s51
    buffer_load_dwordx4 v[64:67], v1, s[28:31], s20 offen
    s_add_u32 s58, s58, 1
    s_cmp_eq_u32 s58, 28
    s_cselect_b32 s58, 0, s58
    s_lshl_b32 s38, s58, 12
    s_add_u32 s38, s38, s60
    s_waitcnt vmcnt(27)
    v_mfma_f32_16x16x32_bf16 v[192:195], v[32:35], v[60:63], v[192:195]
    v_mfma_f32_16x16x32_bf16 v[196:199], v[36:39], v[60:63], v[196:199]
    ds_read_b64_tr_b16 v[16:17], v4 offset:8192
    v_mfma_f32_16x16x32_bf16 v[200:203], v[40:43], v[60:63], v[200:203]
    ds_read_b64_tr_b16 v[18:19], v4 offset:10240
    v_mfma_f32_16x16x32_bf16 v[204:207], v[44:47], v[60:63], v[204:207]
    ds_read_b64_tr_b16 v[20:21], v5 offset:8192
    s_add_u32 s19, s38, s44
    buffer_load_dwordx4 v[60:63], v1, s[28:31], s19 offen
    s_waitcnt vmcnt(27)
    v_mfma_f32_16x16x32_bf16 v[208:211], v[32:35], v[56:59], v[208:211]
    ds_read_b64_tr_b16 v[22:23], v5 offset:10240
    v_mfma_f32_16x16x32_bf16 v[212:215], v[36:39], v[56:59], v[212:215]
    ds_read_b64_tr_b16 v[24:25], v6 offset:8192
    v_mfma_f32_16x16x32_bf16 v[216:219], v[40:43], v[56:59], v[216:219]
    ds_read_b64_tr_b16 v[26:27], v6 offset:10240
    v_mfma_f32_16x16x32_bf16 v[220:223], v[44:47], v[56:59], v[220:223]
    ds_read_b64_tr_b16 v[28:29], v7 offset:8192
    s_add_u32 s20, s38, s45
    buffer_load_dwordx4 v[56:59], v1, s[28:31], s20 offen
    s_waitcnt vmcnt(27)
    v_mfma_f32_16x16x32_bf16 v[224:227], v[32:35], v[52:55], v[224:227]
    ds_read_b64_tr_b16 v[30:31], v7 offset:10240
    v_mfma_f32_16x16x32_bf16 v[228:231], v[36:39], v[52:55], v[228:231]
    v_mfma_f32_16x16x32_bf16 v[232:235], v[40:43], v[52:55], v[232:235]
    v_mfma_f32_16x16x32_bf16 v[236:239], v[44:47], v[52:55], v[236:239]
    s_add_u32 s19, s38, s46
    buffer_load_dwordx4 v[52:55], v1, s[28:31], s19 offen
    s_waitcnt vmcnt(27)
    v_mfma_f32_16x16x32_bf16 v[240:243], v[32:35], v[48:51], v[240:243]
    v_mfma_f32_16x16x32_bf16 v[244:247], v[36:39], v[48:51], v[244:247]
    v_mfma_f32_16x16x32_bf16 v[248:251], v[40:43], v[48:51], v[248:251]
    v_mfma_f32_16x16x32_bf16 v[252:255], v[44:47], v[48:51], v[252:255]
    s_waitcnt lgkmcnt(0)
    s_add_u32 s20, s38, s47
    buffer_load_dwordx4 v[48:51], v1, s[28:31], s20 offen
    s_waitcnt vmcnt(27)
    v_mfma_f32_16x16x32_bf16 v[128:131], v[16:19], v[124:127], v[128:131]
    s_add_u32 m0, s42, 4096
    s_nop 0
    global_load_lds_dwordx4 v2, s[40:41]
    v_mfma_f32_16x16x32_bf16 v[132:135], v[20:23], v[124:127], v[132:135]
    s_add_u32 m0, s42, 5120
    s_nop 0
    global_load_lds_dwordx4 v2, s[56:57]
    v_mfma_f32_16x16x32_bf16 v[136:139], v[24:27], v[124:127], v[136:139]
    s_add_u32 m0, s42, 6144
    s_nop 0
    global_load_lds_dwordx4 v3, s[40:41]
    v_mfma_f32_16x16x32_bf16 v[140:143], v[28:31], v[124:127], v[140:143]
    s_add_u32 m0, s42, 7168
    s_nop 0
    global_load_lds_dwordx4 v3, s[56:57]
    s_add_u32 s59, s59, 1
    s_cmp_eq_u32 s59, 28
    s_cselect_b32 s59, 0, s59
    s_lshl_b32 s56, s59, 18
    s_add_u32 s40, s8, s56
    s_addc_u32 s41, s9, 0
    s_add_u32 s56, s40, 16384
    s_addc_u32 s57, s41, 0
    s_add_u32 s19, s38, s48
    buffer_load_dwordx4 v[124:127], v1, s[28:31], s19 offen
    s_waitcnt vmcnt(31)
    v_mfma_f32_16x16x32_bf16 v[144:147], v[16:19], v[120:123], v[144:147]
    v_mfma_f32_16x16x32_bf16 v[148:151], v[20:23], v[120:123], v[148:151]
    v_mfma_f32_16x16x32_bf16 v[152:155], v[24:27], v[120:123], v[152:155]
    v_mfma_f32_16x16x32_bf16 v[156:159], v[28:31], v[120:123], v[156:159]
    s_add_u32 s20, s38, s49
    buffer_load_dwordx4 v[120:123], v1, s[28:31], s20 offen
    s_waitcnt vmcnt(31)
    v_mfma_f32_16x16x32_bf16 v[160:163], v[16:19], v[116:119], v[160:163]
    v_mfma_f32_16x16x32_bf16 v[164:167], v[20:23], v[116:119], v[164:167]
    v_mfma_f32_16x16x32_bf16 v[168:171], v[24:27], v[116:119], v[168:171]
    v_mfma_f32_16x16x32_bf16 v[172:175], v[28:31], v[116:119], v[172:175]
    s_add_u32 s19, s38, s50
    buffer_load_dwordx4 v[116:119], v1, s[28:31], s19 offen
    s_waitcnt vmcnt(31)
    v_mfma_f32_16x16x32_bf16 v[176:179], v[16:19], v[112:115], v[176:179]
    v_mfma_f32_16x16x32_bf16 v[180:183], v[20:23], v[112:115], v[180:183]
    v_mfma_f32_16x16x32_bf16 v[184:187], v[24:27], v[112:115], v[184:187]
    v_mfma_f32_16x16x32_bf16 v[188:191], v[28:31], v[112:115], v[188:191]
    s_add_u32 s20, s38, s51
    buffer_load_dwordx4 v[112:115], v1, s[28:31], s20 offen
    s_add_u32 s58, s58, 1
    s_cmp_eq_u32 s58, 28
    s_cselect_b32 s58, 0, s58
    s_lshl_b32 s38, s58, 12
    s_add_u32 s38, s38, s60
    s_waitcnt vmcnt(27)
    v_mfma_f32_16x16x32_bf16 v[192:195], v[16:19], v[108:111], v[192:195]
    v_mfma_f32_16x16x32_bf16 v[196:199], v[20:23], v[108:111], v[196:199]
    ds_read_b64_tr_b16 v[32:33], v4 offset:12288
    v_mfma_f32_16x16x32_bf16 v[200:203], v[24:27], v[108:111], v[200:203]
    ds_read_b64_tr_b16 v[34:35], v4 offset:14336
    v_mfma_f32_16x16x32_bf16 v[204:207], v[28:31], v[108:111], v[204:207]
    ds_read_b64_tr_b16 v[36:37], v5 offset:12288
    s_add_u32 s19, s38, s44
    buffer_load_dwordx4 v[108:111], v1, s[28:31], s19 offen
    s_waitcnt vmcnt(27)
    v_mfma_f32_16x16x32_bf16 v[208:211], v[16:19], v[104:107], v[208:211]
    ds_read_b64_tr_b16 v[38:39], v5 offset:14336
    v_mfma_f32_16x16x32_bf16 v[212:215], v[20:23], v[104:107], v[212:215]
    ds_read_b64_tr_b16 v[40:41], v6 offset:12288
    v_mfma_f32_16x16x32_bf16 v[216:219], v[24:27], v[104:107], v[216:219]
    ds_read_b64_tr_b16 v[42:43], v6 offset:14336
    v_mfma_f32_16x16x32_bf16 v[220:223], v[28:31], v[104:107], v[220:223]
    ds_read_b64_tr_b16 v[44:45], v7 offset:12288
    s_add_u32 s20, s38, s45
    buffer_load_dwordx4 v[104:107], v1, s[28:31], s20 offen
    s_waitcnt vmcnt(27)
    v_mfma_f32_16x16x32_bf16 v[224:227], v[16:19], v[100:103], v[224:227]
    ds_read_b64_tr_b16 v[46:47], v7 offset:14336
    v_mfma_f32_16x16x32_bf16 v[228:231], v[20:23], v[100:103], v[228:231]
    v_mfma_f32_16x16x32_bf16 v[232:235], v[24:27], v[100:103], v[232:235]
    v_mfma_f32_16x16x32_bf16 v[236:239], v[28:31], v[100:103], v[236:239]
    s_add_u32 s19, s38, s46
    buffer_load_dwordx4 v[100:103], v1, s[28:31], s19 offen
    s_waitcnt vmcnt(27)
    v_mfma_f32_16x16x32_bf16 v[240:243], v[16:19], v[96:99], v[240:243]
    v_mfma_f32_16x16x32_bf16 v[244:247], v[20:23], v[96:99], v[244:247]
    v_mfma_f32_16x16x32_bf16 v[248:251], v[24:27], v[96:99], v[248:251]
    v_mfma_f32_16x16x32_bf16 v[252:255], v[28:31], v[96:99], v[252:255]
    s_waitcnt lgkmcnt(0)
    s_add_u32 s20, s38, s47
    buffer_load_dwordx4 v[96:99], v1, s[28:31], s20 offen
    s_waitcnt vmcnt(27)
    v_mfma_f32_16x16x32_bf16 v[128:131], v[32:35], v[92:95], v[128:131]
    s_add_u32 m0, s42, 8192
    s_nop 0
    global_load_lds_dwordx4 v2, s[40:41]
    v_mfma_f32_16x16x32_bf16 v[132:135], v[36:39], v[92:95], v[132:135]
    s_add_u32 m0, s42, 9216
    s_nop 0
    global_load_lds_dwordx4 v2, s[56:57]
    v_mfma_f32_16x16x32_bf16 v[136:139], v[40:43], v[92:95], v[136:139]
    s_add_u32 m0, s42, 10240
    s_nop 0
    global_load_lds_dwordx4 v3, s[40:41]
    v_mfma_f32_16x16x32_bf16 v[140:143], v[44:47], v[92:95], v[140:143]
    s_add_u32 m0, s42, 11264
    s_nop 0
    global_load_lds_dwordx4 v3, s[56:57]
    s_add_u32 s59, s59, 1
    s_cmp_eq_u32 s59, 28
    s_cselect_b32 s59, 0, s59
    s_lshl_b32 s56, s59, 18
    s_add_u32 s40, s8, s56
    s_addc_u32 s41, s9, 0
    s_add_u32 s56, s40, 16384
    s_addc_u32 s57, s41, 0
    s_add_u32 s19, s38, s48
    buffer_load_dwordx4 v[92:95], v1, s[28:31], s19 offen
    s_waitcnt vmcnt(31)
    v_mfma_f32_16x16x32_bf16 v[144:147], v[32:35], v[88:91], v[144:147]
    v_mfma_f32_16x16x32_bf16 v[148:151], v[36:39], v[88:91], v[148:151]
    v_mfma_f32_16x16x32_bf16 v[152:155], v[40:43], v[88:91], v[152:155]
    v_mfma_f32_16x16x32_bf16 v[156:159], v[44:47], v[88:91], v[156:159]
    s_add_u32 s20, s38, s49
    buffer_load_dwordx4 v[88:91], v1, s[28:31], s20 offen
    s_waitcnt vmcnt(31)
    v_mfma_f32_16x16x32_bf16 v[160:163], v[32:35], v[84:87], v[160:163]
    v_mfma_f32_16x16x32_bf16 v[164:167], v[36:39], v[84:87], v[164:167]
    v_mfma_f32_16x16x32_bf16 v[168:171], v[40:43], v[84:87], v[168:171]
    v_mfma_f32_16x16x32_bf16 v[172:175], v[44:47], v[84:87], v[172:175]
    s_add_u32 s19, s38, s50
    buffer_load_dwordx4 v[84:87], v1, s[28:31], s19 offen
    s_waitcnt vmcnt(31)
    v_mfma_f32_16x16x32_bf16 v[176:179], v[32:35], v[80:83], v[176:179]
    v_mfma_f32_16x16x32_bf16 v[180:183], v[36:39], v[80:83], v[180:183]
    v_mfma_f32_16x16x32_bf16 v[184:187], v[40:43], v[80:83], v[184:187]
    v_mfma_f32_16x16x32_bf16 v[188:191], v[44:47], v[80:83], v[188:191]
    s_add_u32 s20, s38, s51
    buffer_load_dwordx4 v[80:83], v1, s[28:31], s20 offen
    s_add_u32 s58, s58, 1
    s_cmp_eq_u32 s58, 28
    s_cselect_b32 s58, 0, s58
    s_lshl_b32 s38, s58, 12
    s_add_u32 s38, s38, s60
    s_waitcnt vmcnt(27)
    v_mfma_f32_16x16x32_bf16 v[192:195], v[32:35], v[76:79], v[192:195]
    v_mfma_f32_16x16x32_bf16 v[196:199], v[36:39], v[76:79], v[196:199]
    ds_read_b64_tr_b16 v[16:17], v4 offset:0
    v_mfma_f32_16x16x32_bf16 v[200:203], v[40:43], v[76:79], v[200:203]
    ds_read_b64_tr_b16 v[18:19], v4 offset:2048
    v_mfma_f32_16x16x32_bf16 v[204:207], v[44:47], v[76:79], v[204:207]
    ds_read_b64_tr_b16 v[20:21], v5 offset:0
    s_add_u32 s19, s38, s44
    buffer_load_dwordx4 v[76:79], v1, s[28:31], s19 offen
    s_waitcnt vmcnt(27)
    v_mfma_f32_16x16x32_bf16 v[208:211], v[32:35], v[72:75], v[208:211]
    ds_read_b64_tr_b16 v[22:23], v5 offset:2048
    v_mfma_f32_16x16x32_bf16 v[212:215], v[36:39], v[72:75], v[212:215]
    ds_read_b64_tr_b16 v[24:25], v6 offset:0
    v_mfma_f32_16x16x32_bf16 v[216:219], v[40:43], v[72:75], v[216:219]
    ds_read_b64_tr_b16 v[26:27], v6 offset:2048
    v_mfma_f32_16x16x32_bf16 v[220:223], v[44:47], v[72:75], v[220:223]
    ds_read_b64_tr_b16 v[28:29], v7 offset:0
    s_add_u32 s20, s38, s45
    buffer_load_dwordx4 v[72:75], v1, s[28:31], s20 offen
    s_waitcnt vmcnt(27)
    v_mfma_f32_16x16x32_bf16 v[224:227], v[32:35], v[68:71], v[224:227]
    ds_read_b64_tr_b16 v[30:31], v7 offset:2048
    v_mfma_f32_16x16x32_bf16 v[228:231], v[36:39], v[68:71], v[228:231]
    v_mfma_f32_16x16x32_bf16 v[232:235], v[40:43], v[68:71], v[232:235]
    v_mfma_f32_16x16x32_bf16 v[236:239], v[44:47], v[68:71], v[236:239]
    s_add_u32 s19, s38, s46
    buffer_load_dwordx4 v[68:71], v1, s[28:31], s19 offen
    s_waitcnt vmcnt(27)
    v_mfma_f32_16x16x32_bf16 v[240:243], v[32:35], v[64:67], v[240:243]
    v_mfma_f32_16x16x32_bf16 v[244:247], v[36:39], v[64:67], v[244:247]
    v_mfma_f32_16x16x32_bf16 v[248:251], v[40:43], v[64:67], v[248:251]
    v_mfma_f32_16x16x32_bf16 v[252:255], v[44:47], v[64:67], v[252:255]
    s_waitcnt lgkmcnt(0)
    s_add_u32 s20, s38, s47
    buffer_load_dwordx4 v[64:67], v1, s[28:31], s20 offen
    s_waitcnt vmcnt(27)
    v_mfma_f32_16x16x32_bf16 v[128:131], v[16:19], v[60:63], v[128:131]
    s_add_u32 m0, s42, 12288
    s_nop 0
    global_load_lds_dwordx4 v2, s[40:41]
    v_mfma_f32_16x16x32_bf16 v[132:135], v[20:23], v[60:63], v[132:135]
    s_add_u32 m0, s42, 13312
    s_nop 0
    global_load_lds_dwordx4 v2, s[56:57]
    v_mfma_f32_16x16x32_bf16 v[136:139], v[24:27], v[60:63], v[136:139]
    s_add_u32 m0, s42, 14336
    s_nop 0
    global_load_lds_dwordx4 v3, s[40:41]
    v_mfma_f32_16x16x32_bf16 v[140:143], v[28:31], v[60:63], v[140:143]
    s_add_u32 m0, s42, 15360
    s_nop 0
    global_load_lds_dwordx4 v3, s[56:57]
    s_add_u32 s59, s59, 1
    s_cmp_eq_u32 s59, 28
    s_cselect_b32 s59, 0, s59
    s_lshl_b32 s56, s59, 18
    s_add_u32 s40, s8, s56
    s_addc_u32 s41, s9, 0
    s_add_u32 s56, s40, 16384
    s_addc_u32 s57, s41, 0
    s_add_u32 s19, s38, s48
    buffer_load_dwordx4 v[60:63], v1, s[28:31], s19 offen
    s_waitcnt vmcnt(31)
    v_mfma_f32_16x16x32_bf16 v[144:147], v[16:19], v[56:59], v[144:147]
    v_mfma_f32_16x16x32_bf16 v[148:151], v[20:23], v[56:59], v[148:151]
    v_mfma_f32_16x16x32_bf16 v[152:155], v[24:27], v[56:59], v[152:155]
    v_mfma_f32_16x16x32_bf16 v[156:159], v[28:31], v[56:59], v[156:159]
    s_add_u32 s20, s38, s49
    buffer_load_dwordx4 v[56:59], v1, s[28:31], s20 offen
    s_waitcnt vmcnt(31)
    v_mfma_f32_16x16x32_bf16 v[160:163], v[16:19], v[52:55], v[160:163]
    v_mfma_f32_16x16x32_bf16 v[164:167], v[20:23], v[52:55], v[164:167]
    v_mfma_f32_16x16x32_bf16 v[168:171], v[24:27], v[52:55], v[168:171]
    v_mfma_f32_16x16x32_bf16 v[172:175], v[28:31], v[52:55], v[172:175]
    s_add_u32 s19, s38, s50
    buffer_load_dwordx4 v[52:55], v1, s[28:31], s19 offen
    s_waitcnt vmcnt(31)
    v_mfma_f32_16x16x32_bf16 v[176:179], v[16:19], v[48:51], v[176:179]
    v_mfma_f32_16x16x32_bf16 v[180:183], v[20:23], v[48:51], v[180:183]
    v_mfma_f32_16x16x32_bf16 v[184:187], v[24:27], v[48:51], v[184:187]
    v_mfma_f32_16x16x32_bf16 v[188:191], v[28:31], v[48:51], v[188:191]
    s_add_u32 s20, s38, s51
    buffer_load_dwordx4 v[48:51], v1, s[28:31], s20 offen
    s_add_u32 s58, s58, 1
    s_cmp_eq_u32 s58, 28
    s_cselect_b32 s58, 0, s58
    s_lshl_b32 s38, s58, 12
    s_add_u32 s38, s38, s60
    s_waitcnt vmcnt(27)
    v_mfma_f32_16x16x32_bf16 v[192:195], v[16:19], v[124:127], v[192:195]
    v_mfma_f32_16x16x32_bf16 v[196:199], v[20:23], v[124:127], v[196:199]
    ds_read_b64_tr_b16 v[32:33], v4 offset:4096
    v_mfma_f32_16x16x32_bf16 v[200:203], v[24:27], v[124:127], v[200:203]
    ds_read_b64_tr_b16 v[34:35], v4 offset:6144
    v_mfma_f32_16x16x32_bf16 v[204:207], v[28:31], v[124:127], v[204:207]
    ds_read_b64_tr_b16 v[36:37], v5 offset:4096
    s_add_u32 s19, s38, s44
    buffer_load_dwordx4 v[124:127], v1, s[28:31], s19 offen
    s_waitcnt vmcnt(27)
    v_mfma_f32_16x16x32_bf16 v[208:211], v[16:19], v[120:123], v[208:211]
    ds_read_b64_tr_b16 v[38:39], v5 offset:6144
    v_mfma_f32_16x16x32_bf16 v[212:215], v[20:23], v[120:123], v[212:215]
    ds_read_b64_tr_b16 v[40:41], v6 offset:4096
    v_mfma_f32_16x16x32_bf16 v[216:219], v[24:27], v[120:123], v[216:219]
    ds_read_b64_tr_b16 v[42:43], v6 offset:6144
    v_mfma_f32_16x16x32_bf16 v[220:223], v[28:31], v[120:123], v[220:223]
    ds_read_b64_tr_b16 v[44:45], v7 offset:4096
    s_add_u32 s20, s38, s45
    buffer_load_dwordx4 v[120:123], v1, s[28:31], s20 offen
    s_waitcnt vmcnt(27)
    v_mfma_f32_16x16x32_bf16 v[224:227], v[16:19], v[116:119], v[224:227]
    ds_read_b64_tr_b16 v[46:47], v7 offset:6144
    v_mfma_f32_16x16x32_bf16 v[228:231], v[20:23], v[116:119], v[228:231]
    v_mfma_f32_16x16x32_bf16 v[232:235], v[24:27], v[116:119], v[232:235]
    v_mfma_f32_16x16x32_bf16 v[236:239], v[28:31], v[116:119], v[236:239]
    s_add_u32 s19, s38, s46
    buffer_load_dwordx4 v[116:119], v1, s[28:31], s19 offen
    s_waitcnt vmcnt(27)
    v_mfma_f32_16x16x32_bf16 v[240:243], v[16:19], v[112:115], v[240:243]
    v_mfma_f32_16x16x32_bf16 v[244:247], v[20:23], v[112:115], v[244:247]
    v_mfma_f32_16x16x32_bf16 v[248:251], v[24:27], v[112:115], v[248:251]
    v_mfma_f32_16x16x32_bf16 v[252:255], v[28:31], v[112:115], v[252:255]
    s_waitcnt lgkmcnt(0)
    s_add_u32 s20, s38, s47
    buffer_load_dwordx4 v[112:115], v1, s[28:31], s20 offen
    s_waitcnt vmcnt(27)
    v_mfma_f32_16x16x32_bf16 v[128:131], v[32:35], v[108:111], v[128:131]
    s_add_u32 m0, s42, 0
    s_nop 0
    global_load_lds_dwordx4 v2, s[40:41]
    v_mfma_f32_16x16x32_bf16 v[132:135], v[36:39], v[108:111], v[132:135]
    s_add_u32 m0, s42, 1024
    s_nop 0
    global_load_lds_dwordx4 v2, s[56:57]
    v_mfma_f32_16x16x32_bf16 v[136:139], v[40:43], v[108:111], v[136:139]
    s_add_u32 m0, s42, 2048
    s_nop 0
    global_load_lds_dwordx4 v3, s[40:41]
    v_mfma_f32_16x16x32_bf16 v[140:143], v[44:47], v[108:111], v[140:143]
    s_add_u32 m0, s42, 3072
    s_nop 0
    global_load_lds_dwordx4 v3, s[56:57]
    s_add_u32 s59, s59, 1
    s_cmp_eq_u32 s59, 28
    s_cselect_b32 s59, 0, s59
    s_lshl_b32 s56, s59, 18
    s_add_u32 s40, s8, s56
    s_addc_u32 s41, s9, 0
    s_add_u32 s56, s40, 16384
    s_addc_u32 s57, s41, 0
    s_add_u32 s19, s38, s48
    buffer_load_dwordx4 v[108:111], v1, s[28:31], s19 offen
    s_waitcnt vmcnt(31)
    v_mfma_f32_16x16x32_bf16 v[144:147], v[32:35], v[104:107], v[144:147]
    v_mfma_f32_16x16x32_bf16 v[148:151], v[36:39], v[104:107], v[148:151]
    v_mfma_f32_16x16x32_bf16 v[152:155], v[40:43], v[104:107], v[152:155]
    v_mfma_f32_16x16x32_bf16 v[156:159], v[44:47], v[104:107], v[156:159]
    s_add_u32 s20, s38, s49
    buffer_load_dwordx4 v[104:107], v1, s[28:31], s20 offen
    s_waitcnt vmcnt(31)
    v_mfma_f32_16x16x32_bf16 v[160:163], v[32:35], v[100:103], v[160:163]
    v_mfma_f32_16x16x32_bf16 v[164:167], v[36:39], v[100:103], v[164:167]
    v_mfma_f32_16x16x32_bf16 v[168:171], v[40:43], v[100:103], v[168:171]
    v_mfma_f32_16x16x32_bf16 v[172:175], v[44:47], v[100:103], v[172:175]
    s_add_u32 s19, s38, s50
    buffer_load_dwordx4 v[100:103], v1, s[28:31], s19 offen
    s_waitcnt vmcnt(31)
    v_mfma_f32_16x16x32_bf16 v[176:179], v[32:35], v[96:99], v[176:179]
    v_mfma_f32_16x16x32_bf16 v[180:183], v[36:39], v[96:99], v[180:183]
    v_mfma_f32_16x16x32_bf16 v[184:187], v[40:43], v[96:99], v[184:187]
    v_mfma_f32_16x16x32_bf16 v[188:191], v[44:47], v[96:99], v[188:191]
    s_add_u32 s20, s38, s51
    buffer_load_dwordx4 v[96:99], v1, s[28:31], s20 offen
    s_add_u32 s58, s58, 1
    s_cmp_eq_u32 s58, 28
    s_cselect_b32 s58, 0, s58
    s_lshl_b32 s38, s58, 12
    s_add_u32 s38, s38, s60
    s_waitcnt vmcnt(27)
    v_mfma_f32_16x16x32_bf16 v[192:195], v[32:35], v[92:95], v[192:195]
    v_mfma_f32_16x16x32_bf16 v[196:199], v[36:39], v[92:95], v[196:199]
    ds_read_b64_tr_b16 v[16:17], v4 offset:8192
    v_mfma_f32_16x16x32_bf16 v[200:203], v[40:43], v[92:95], v[200:203]
    ds_read_b64_tr_b16 v[18:19], v4 offset:10240
    v_mfma_f32_16x16x32_bf16 v[204:207], v[44:47], v[92:95], v[204:207]
    ds_read_b64_tr_b16 v[20:21], v5 offset:8192
    s_add_u32 s19, s38, s44
    buffer_load_dwordx4 v[92:95], v1, s[28:31], s19 offen
    s_waitcnt vmcnt(27)
    v_mfma_f32_16x16x32_bf16 v[208:211], v[32:35], v[88:91], v[208:211]
    ds_read_b64_tr_b16 v[22:23], v5 offset:10240
    v_mfma_f32_16x16x32_bf16 v[212:215], v[36:39], v[88:91], v[212:215]
    ds_read_b64_tr_b16 v[24:25], v6 offset:8192
    v_mfma_f32_16x16x32_bf16 v[216:219], v[40:43], v[88:91], v[216:219]
    ds_read_b64_tr_b16 v[26:27], v6 offset:10240
    v_mfma_f32_16x16x32_bf16 v[220:223], v[44:47], v[88:91], v[220:223]
    ds_read_b64_tr_b16 v[28:29], v7 offset:8192
    s_add_u32 s20, s38, s45
    buffer_load_dwordx4 v[88:91], v1, s[28:31], s20 offen
    s_waitcnt vmcnt(27)
    v_mfma_f32_16x16x32_bf16 v[224:227], v[32:35], v[84:87], v[224:227]
    ds_read_b64_tr_b16 v[30:31], v7 offset:10240
    v_mfma_f32_16x16x32_bf16 v[228:231], v[36:39], v[84:87], v[228:231]
    v_mfma_f32_16x16x32_bf16 v[232:235], v[40:43], v[84:87], v[232:235]
    v_mfma_f32_16x16x32_bf16 v[236:239], v[44:47], v[84:87], v[236:239]
    s_add_u32 s19, s38, s46
    buffer_load_dwordx4 v[84:87], v1, s[28:31], s19 offen
    s_waitcnt vmcnt(27)
    v_mfma_f32_16x16x32_bf16 v[240:243], v[32:35], v[80:83], v[240:243]
    v_mfma_f32_16x16x32_bf16 v[244:247], v[36:39], v[80:83], v[244:247]
    v_mfma_f32_16x16x32_bf16 v[248:251], v[40:43], v[80:83], v[248:251]
    v_mfma_f32_16x16x32_bf16 v[252:255], v[44:47], v[80:83], v[252:255]
    s_waitcnt lgkmcnt(0)
    s_add_u32 s20, s38, s47
    buffer_load_dwordx4 v[80:83], v1, s[28:31], s20 offen
    s_waitcnt vmcnt(27)
    v_mfma_f32_16x16x32_bf16 v[128:131], v[16:19], v[76:79], v[128:131]
    s_add_u32 m0, s42, 4096
    s_nop 0
    global_load_lds_dwordx4 v2, s[40:41]
    v_mfma_f32_16x16x32_bf16 v[132:135], v[20:23], v[76:79], v[132:135]
    s_add_u32 m0, s42, 5120
    s_nop 0
    global_load_lds_dwordx4 v2, s[56:57]
    v_mfma_f32_16x16x32_bf16 v[136:139], v[24:27], v[76:79], v[136:139]
    s_add_u32 m0, s42, 6144
    s_nop 0
    global_load_lds_dwordx4 v3, s[40:41]
    v_mfma_f32_16x16x32_bf16 v[140:143], v[28:31], v[76:79], v[140:143]
    s_add_u32 m0, s42, 7168
    s_nop 0
    global_load_lds_dwordx4 v3, s[56:57]
    s_add_u32 s59, s59, 1
    s_cmp_eq_u32 s59, 28
    s_cselect_b32 s59, 0, s59
    s_lshl_b32 s56, s59, 18
    s_add_u32 s40, s8, s56
    s_addc_u32 s41, s9, 0
    s_add_u32 s56, s40, 16384
    s_addc_u32 s57, s41, 0
    s_add_u32 s19, s38, s48
    buffer_load_dwordx4 v[76:79], v1, s[28:31], s19 offen
    s_waitcnt vmcnt(31)
    v_mfma_f32_16x16x32_bf16 v[144:147], v[16:19], v[72:75], v[144:147]
    v_mfma_f32_16x16x32_bf16 v[148:151], v[20:23], v[72:75], v[148:151]
    v_mfma_f32_16x16x32_bf16 v[152:155], v[24:27], v[72:75], v[152:155]
    v_mfma_f32_16x16x32_bf16 v[156:159], v[28:31], v[72:75], v[156:159]
    s_add_u32 s20, s38, s49
    buffer_load_dwordx4 v[72:75], v1, s[28:31], s20 offen
    s_waitcnt vmcnt(31)
    v_mfma_f32_16x16x32_bf16 v[160:163], v[16:19], v[68:71], v[160:163]
    v_mfma_f32_16x16x32_bf16 v[164:167], v[20:23], v[68:71], v[164:167]
    v_mfma_f32_16x16x32_bf16 v[168:171], v[24:27], v[68:71], v[168:171]
    v_mfma_f32_16x16x32_bf16 v[172:175], v[28:31], v[68:71], v[172:175]
    s_add_u32 s19, s38, s50
    buffer_load_dwordx4 v[68:71], v1, s[28:31], s19 offen
    s_waitcnt vmcnt(31)
    v_mfma_f32_16x16x32_bf16 v[176:179], v[16:19], v[64:67], v[176:179]
    v_mfma_f32_16x16x32_bf16 v[180:183], v[20:23], v[64:67], v[180:183]
    v_mfma_f32_16x16x32_bf16 v[184:187], v[24:27], v[64:67], v[184:187]
    v_mfma_f32_16x16x32_bf16 v[188:191], v[28:31], v[64:67], v[188:191]
    s_add_u32 s20, s38, s51
    buffer_load_dwordx4 v[64:67], v1, s[28:31], s20 offen
    s_add_u32 s58, s58, 1
    s_cmp_eq_u32 s58, 28
    s_cselect_b32 s58, 0, s58
    s_lshl_b32 s38, s58, 12
    s_add_u32 s38, s38, s60
    s_waitcnt vmcnt(27)
    v_mfma_f32_16x16x32_bf16 v[192:195], v[16:19], v[60:63], v[192:195]
    v_mfma_f32_16x16x32_bf16 v[196:199], v[20:23], v[60:63], v[196:199]
    ds_read_b64_tr_b16 v[32:33], v4 offset:12288
    v_mfma_f32_16x16x32_bf16 v[200:203], v[24:27], v[60:63], v[200:203]
    ds_read_b64_tr_b16 v[34:35], v4 offset:14336
    v_mfma_f32_16x16x32_bf16 v[204:207], v[28:31], v[60:63], v[204:207]
    ds_read_b64_tr_b16 v[36:37], v5 offset:12288
    s_add_u32 s19, s38, s44
    buffer_load_dwordx4 v[60:63], v1, s[28:31], s19 offen
    s_waitcnt vmcnt(27)
    v_mfma_f32_16x16x32_bf16 v[208:211], v[16:19], v[56:59], v[208:211]
    ds_read_b64_tr_b16 v[38:39], v5 offset:14336
    v_mfma_f32_16x16x32_bf16 v[212:215], v[20:23], v[56:59], v[212:215]
    ds_read_b64_tr_b16 v[40:41], v6 offset:12288
    v_mfma_f32_16x16x32_bf16 v[216:219], v[24:27], v[56:59], v[216:219]
    ds_read_b64_tr_b16 v[42:43], v6 offset:14336
    v_mfma_f32_16x16x32_bf16 v[220:223], v[28:31], v[56:59], v[220:223]
    ds_read_b64_tr_b16 v[44:45], v7 offset:12288
    s_add_u32 s20, s38, s45
    buffer_load_dwordx4 v[56:59], v1, s[28:31], s20 offen
    s_waitcnt vmcnt(27)
    v_mfma_f32_16x16x32_bf16 v[224:227], v[16:19], v[52:55], v[224:227]
    ds_read_b64_tr_b16 v[46:47], v7 offset:14336
    v_mfma_f32_16x16x32_bf16 v[228:231], v[20:23], v[52:55], v[228:231]
    v_mfma_f32_16x16x32_bf16 v[232:235], v[24:27], v[52:55], v[232:235]
    v_mfma_f32_16x16x32_bf16 v[236:239], v[28:31], v[52:55], v[236:239]
    s_add_u32 s19, s38, s46
    buffer_load_dwordx4 v[52:55], v1, s[28:31], s19 offen
    s_waitcnt vmcnt(27)
    v_mfma_f32_16x16x32_bf16 v[240:243], v[16:19], v[48:51], v[240:243]
    v_mfma_f32_16x16x32_bf16 v[244:247], v[20:23], v[48:51], v[244:247]
    v_mfma_f32_16x16x32_bf16 v[248:251], v[24:27], v[48:51], v[248:251]
    v_mfma_f32_16x16x32_bf16 v[252:255], v[28:31], v[48:51], v[252:255]
    s_waitcnt lgkmcnt(0)
    s_add_u32 s20, s38, s47
    buffer_load_dwordx4 v[48:51], v1, s[28:31], s20 offen
    s_waitcnt vmcnt(27)
    v_mfma_f32_16x16x32_bf16 v[128:131], v[32:35], v[124:127], v[128:131]
    s_add_u32 m0, s42, 8192
    s_nop 0
    global_load_lds_dwordx4 v2, s[40:41]
    v_mfma_f32_16x16x32_bf16 v[132:135], v[36:39], v[124:127], v[132:135]
    s_add_u32 m0, s42, 9216
    s_nop 0
    global_load_lds_dwordx4 v2, s[56:57]
    v_mfma_f32_16x16x32_bf16 v[136:139], v[40:43], v[124:127], v[136:139]
    s_add_u32 m0, s42, 10240
    s_nop 0
    global_load_lds_dwordx4 v3, s[40:41]
    v_mfma_f32_16x16x32_bf16 v[140:143], v[44:47], v[124:127], v[140:143]
    s_add_u32 m0, s42, 11264
    s_nop 0
    global_load_lds_dwordx4 v3, s[56:57]
    s_add_u32 s59, s59, 1
    s_cmp_eq_u32 s59, 28
    s_cselect_b32 s59, 0, s59
    s_lshl_b32 s56, s59, 18
    s_add_u32 s40, s8, s56
    s_addc_u32 s41, s9, 0
    s_add_u32 s56, s40, 16384
    s_addc_u32 s57, s41, 0
    s_add_u32 s19, s38, s48
    buffer_load_dwordx4 v[124:127], v1, s[28:31], s19 offen
    s_waitcnt vmcnt(31)
    v_mfma_f32_16x16x32_bf16 v[144:147], v[32:35], v[120:123], v[144:147]
    v_mfma_f32_16x16x32_bf16 v[148:151], v[36:39], v[120:123], v[148:151]
    v_mfma_f32_16x16x32_bf16 v[152:155], v[40:43], v[120:123], v[152:155]
    v_mfma_f32_16x16x32_bf16 v[156:159], v[44:47], v[120:123], v[156:159]
    s_add_u32 s20, s38, s49
    buffer_load_dwordx4 v[120:123], v1, s[28:31], s20 offen
    s_waitcnt vmcnt(31)
    v_mfma_f32_16x16x32_bf16 v[160:163], v[32:35], v[116:119], v[160:163]
    v_mfma_f32_16x16x32_bf16 v[164:167], v[36:39], v[116:119], v[164:167]
    v_mfma_f32_16x16x32_bf16 v[168:171], v[40:43], v[116:119], v[168:171]
    v_mfma_f32_16x16x32_bf16 v[172:175], v[44:47], v[116:119], v[172:175]
    s_add_u32 s19, s38, s50
    buffer_load_dwordx4 v[116:119], v1, s[28:31], s19 offen
    s_waitcnt vmcnt(31)
    v_mfma_f32_16x16x32_bf16 v[176:179], v[32:35], v[112:115], v[176:179]
    v_mfma_f32_16x16x32_bf16 v[180:183], v[36:39], v[112:115], v[180:183]
    v_mfma_f32_16x16x32_bf16 v[184:187], v[40:43], v[112:115], v[184:187]
    v_mfma_f32_16x16x32_bf16 v[188:191], v[44:47], v[112:115], v[188:191]
    s_add_u32 s20, s38, s51
    buffer_load_dwordx4 v[112:115], v1, s[28:31], s20 offen
    s_add_u32 s58, s58, 1
    s_cmp_eq_u32 s58, 28
    s_cselect_b32 s58, 0, s58
    s_lshl_b32 s38, s58, 12
    s_add_u32 s38, s38, s60
    s_waitcnt vmcnt(27)
    v_mfma_f32_16x16x32_bf16 v[192:195], v[32:35], v[108:111], v[192:195]
    v_mfma_f32_16x16x32_bf16 v[196:199], v[36:39], v[108:111], v[196:199]
    ds_read_b64_tr_b16 v[16:17], v4 offset:0
    v_mfma_f32_16x16x32_bf16 v[200:203], v[40:43], v[108:111], v[200:203]
    ds_read_b64_tr_b16 v[18:19], v4 offset:2048
    v_mfma_f32_16x16x32_bf16 v[204:207], v[44:47], v[108:111], v[204:207]
    ds_read_b64_tr_b16 v[20:21], v5 offset:0
    s_add_u32 s19, s38, s44
    buffer_load_dwordx4 v[108:111], v1, s[28:31], s19 offen
    s_waitcnt vmcnt(27)
    v_mfma_f32_16x16x32_bf16 v[208:211], v[32:35], v[104:107], v[208:211]
    ds_read_b64_tr_b16 v[22:23], v5 offset:2048
    v_mfma_f32_16x16x32_bf16 v[212:215], v[36:39], v[104:107], v[212:215]
    ds_read_b64_tr_b16 v[24:25], v6 offset:0
    v_mfma_f32_16x16x32_bf16 v[216:219], v[40:43], v[104:107], v[216:219]
    ds_read_b64_tr_b16 v[26:27], v6 offset:2048
    v_mfma_f32_16x16x32_bf16 v[220:223], v[44:47], v[104:107], v[220:223]
    ds_read_b64_tr_b16 v[28:29], v7 offset:0
    s_add_u32 s20, s38, s45
    buffer_load_dwordx4 v[104:107], v1, s[28:31], s20 offen
    s_waitcnt vmcnt(27)
    v_mfma_f32_16x16x32_bf16 v[224:227], v[32:35], v[100:103], v[224:227]
    ds_read_b64_tr_b16 v[30:31], v7 offset:2048
    v_mfma_f32_16x16x32_bf16 v[228:231], v[36:39], v[100:103], v[228:231]
    v_mfma_f32_16x16x32_bf16 v[232:235], v[40:43], v[100:103], v[232:235]
    v_mfma_f32_16x16x32_bf16 v[236:239], v[44:47], v[100:103], v[236:239]
    s_add_u32 s19, s38, s46
    buffer_load_dwordx4 v[100:103], v1, s[28:31], s19 offen
    s_waitcnt vmcnt(27)
    v_mfma_f32_16x16x32_bf16 v[240:243], v[32:35], v[96:99], v[240:243]
    v_mfma_f32_16x16x32_bf16 v[244:247], v[36:39], v[96:99], v[244:247]
    v_mfma_f32_16x16x32_bf16 v[248:251], v[40:43], v[96:99], v[248:251]
    v_mfma_f32_16x16x32_bf16 v[252:255], v[44:47], v[96:99], v[252:255]
    s_waitcnt lgkmcnt(0)
    s_add_u32 s20, s38, s47
    buffer_load_dwordx4 v[96:99], v1, s[28:31], s20 offen
    s_waitcnt vmcnt(27)
    v_mfma_f32_16x16x32_bf16 v[128:131], v[16:19], v[92:95], v[128:131]
    s_add_u32 m0, s42, 12288
    s_nop 0
    global_load_lds_dwordx4 v2, s[40:41]
    v_mfma_f32_16x16x32_bf16 v[132:135], v[20:23], v[92:95], v[132:135]
    s_add_u32 m0, s42, 13312
    s_nop 0
    global_load_lds_dwordx4 v2, s[56:57]
    v_mfma_f32_16x16x32_bf16 v[136:139], v[24:27], v[92:95], v[136:139]
    s_add_u32 m0, s42, 14336
    s_nop 0
    global_load_lds_dwordx4 v3, s[40:41]
    v_mfma_f32_16x16x32_bf16 v[140:143], v[28:31], v[92:95], v[140:143]
    s_add_u32 m0, s42, 15360
    s_nop 0
    global_load_lds_dwordx4 v3, s[56:57]
    s_add_u32 s59, s59, 1
    s_cmp_eq_u32 s59, 28
    s_cselect_b32 s59, 0, s59
    s_lshl_b32 s56, s59, 18
    s_add_u32 s40, s8, s56
    s_addc_u32 s41, s9, 0
    s_add_u32 s56, s40, 16384
    s_addc_u32 s57, s41, 0
    s_add_u32 s19, s38, s48
    buffer_load_dwordx4 v[92:95], v1, s[28:31], s19 offen
    s_waitcnt vmcnt(31)
    v_mfma_f32_16x16x32_bf16 v[144:147], v[16:19], v[88:91], v[144:147]
    v_mfma_f32_16x16x32_bf16 v[148:151], v[20:23], v[88:91], v[148:151]
    v_mfma_f32_16x16x32_bf16 v[152:155], v[24:27], v[88:91], v[152:155]
    v_mfma_f32_16x16x32_bf16 v[156:159], v[28:31], v[88:91], v[156:159]
    s_add_u32 s20, s38, s49
    buffer_load_dwordx4 v[88:91], v1, s[28:31], s20 offen
    s_waitcnt vmcnt(31)
    v_mfma_f32_16x16x32_bf16 v[160:163], v[16:19], v[84:87], v[160:163]
    v_mfma_f32_16x16x32_bf16 v[164:167], v[20:23], v[84:87], v[164:167]
    v_mfma_f32_16x16x32_bf16 v[168:171], v[24:27], v[84:87], v[168:171]
    v_mfma_f32_16x16x32_bf16 v[172:175], v[28:31], v[84:87], v[172:175]
    s_add_u32 s19, s38, s50
    buffer_load_dwordx4 v[84:87], v1, s[28:31], s19 offen
    s_waitcnt vmcnt(31)
    v_mfma_f32_16x16x32_bf16 v[176:179], v[16:19], v[80:83], v[176:179]
    v_mfma_f32_16x16x32_bf16 v[180:183], v[20:23], v[80:83], v[180:183]
    v_mfma_f32_16x16x32_bf16 v[184:187], v[24:27], v[80:83], v[184:187]
    v_mfma_f32_16x16x32_bf16 v[188:191], v[28:31], v[80:83], v[188:191]
    s_add_u32 s20, s38, s51
    buffer_load_dwordx4 v[80:83], v1, s[28:31], s20 offen
    s_add_u32 s58, s58, 1
    s_cmp_eq_u32 s58, 28
    s_cselect_b32 s58, 0, s58
    s_lshl_b32 s38, s58, 12
    s_add_u32 s38, s38, s60
    s_waitcnt vmcnt(27)
    v_mfma_f32_16x16x32_bf16 v[192:195], v[16:19], v[76:79], v[192:195]
    v_mfma_f32_16x16x32_bf16 v[196:199], v[20:23], v[76:79], v[196:199]
    ds_read_b64_tr_b16 v[32:33], v4 offset:4096
    v_mfma_f32_16x16x32_bf16 v[200:203], v[24:27], v[76:79], v[200:203]
    ds_read_b64_tr_b16 v[34:35], v4 offset:6144
    v_mfma_f32_16x16x32_bf16 v[204:207], v[28:31], v[76:79], v[204:207]
    ds_read_b64_tr_b16 v[36:37], v5 offset:4096
    s_add_u32 s19, s38, s44
    buffer_load_dwordx4 v[76:79], v1, s[28:31], s19 offen
    s_waitcnt vmcnt(27)
    v_mfma_f32_16x16x32_bf16 v[208:211], v[16:19], v[72:75], v[208:211]
    ds_read_b64_tr_b16 v[38:39], v5 offset:6144
    v_mfma_f32_16x16x32_bf16 v[212:215], v[20:23], v[72:75], v[212:215]
    ds_read_b64_tr_b16 v[40:41], v6 offset:4096
    v_mfma_f32_16x16x32_bf16 v[216:219], v[24:27], v[72:75], v[216:219]
    ds_read_b64_tr_b16 v[42:43], v6 offset:6144
    v_mfma_f32_16x16x32_bf16 v[220:223], v[28:31], v[72:75], v[220:223]
    ds_read_b64_tr_b16 v[44:45], v7 offset:4096
    s_add_u32 s20, s38, s45
    buffer_load_dwordx4 v[72:75], v1, s[28:31], s20 offen
    s_waitcnt vmcnt(27)
    v_mfma_f32_16x16x32_bf16 v[224:227], v[16:19], v[68:71], v[224:227]
    ds_read_b64_tr_b16 v[46:47], v7 offset:6144
    v_mfma_f32_16x16x32_bf16 v[228:231], v[20:23], v[68:71], v[228:231]
    v_mfma_f32_16x16x32_bf16 v[232:235], v[24:27], v[68:71], v[232:235]
    v_mfma_f32_16x16x32_bf16 v[236:239], v[28:31], v[68:71], v[236:239]
    s_add_u32 s19, s38, s46
    buffer_load_dwordx4 v[68:71], v1, s[28:31], s19 offen
    s_waitcnt vmcnt(27)
    v_mfma_f32_16x16x32_bf16 v[240:243], v[16:19], v[64:67], v[240:243]
    v_mfma_f32_16x16x32_bf16 v[244:247], v[20:23], v[64:67], v[244:247]
    v_mfma_f32_16x16x32_bf16 v[248:251], v[24:27], v[64:67], v[248:251]
    v_mfma_f32_16x16x32_bf16 v[252:255], v[28:31], v[64:67], v[252:255]
    s_waitcnt lgkmcnt(0)
    s_add_u32 s20, s38, s47
    buffer_load_dwordx4 v[64:67], v1, s[28:31], s20 offen
    s_waitcnt vmcnt(27)
    v_mfma_f32_16x16x32_bf16 v[128:131], v[32:35], v[60:63], v[128:131]
    s_add_u32 m0, s42, 0
    s_nop 0
    global_load_lds_dwordx4 v2, s[40:41]
    v_mfma_f32_16x16x32_bf16 v[132:135], v[36:39], v[60:63], v[132:135]
    s_add_u32 m0, s42, 1024
    s_nop 0
    global_load_lds_dwordx4 v2, s[56:57]
    v_mfma_f32_16x16x32_bf16 v[136:139], v[40:43], v[60:63], v[136:139]
    s_add_u32 m0, s42, 2048
    s_nop 0
    global_load_lds_dwordx4 v3, s[40:41]
    v_mfma_f32_16x16x32_bf16 v[140:143], v[44:47], v[60:63], v[140:143]
    s_add_u32 m0, s42, 3072
    s_nop 0
    global_load_lds_dwordx4 v3, s[56:57]
    s_add_u32 s59, s59, 1
    s_cmp_eq_u32 s59, 28
    s_cselect_b32 s59, 0, s59
    s_lshl_b32 s56, s59, 18
    s_add_u32 s40, s8, s56
    s_addc_u32 s41, s9, 0
    s_add_u32 s56, s40, 16384
    s_addc_u32 s57, s41, 0
    s_add_u32 s19, s38, s48
    buffer_load_dwordx4 v[60:63], v1, s[28:31], s19 offen
    s_waitcnt vmcnt(31)
    v_mfma_f32_16x16x32_bf16 v[144:147], v[32:35], v[56:59], v[144:147]
    v_mfma_f32_16x16x32_bf16 v[148:151], v[36:39], v[56:59], v[148:151]
    v_mfma_f32_16x16x32_bf16 v[152:155], v[40:43], v[56:59], v[152:155]
    v_mfma_f32_16x16x32_bf16 v[156:159], v[44:47], v[56:59], v[156:159]
    s_add_u32 s20, s38, s49
    buffer_load_dwordx4 v[56:59], v1, s[28:31], s20 offen
    s_waitcnt vmcnt(31)
    v_mfma_f32_16x16x32_bf16 v[160:163], v[32:35], v[52:55], v[160:163]
    v_mfma_f32_16x16x32_bf16 v[164:167], v[36:39], v[52:55], v[164:167]
    v_mfma_f32_16x16x32_bf16 v[168:171], v[40:43], v[52:55], v[168:171]
    v_mfma_f32_16x16x32_bf16 v[172:175], v[44:47], v[52:55], v[172:175]
    s_add_u32 s19, s38, s50
    buffer_load_dwordx4 v[52:55], v1, s[28:31], s19 offen
    s_waitcnt vmcnt(31)
    v_mfma_f32_16x16x32_bf16 v[176:179], v[32:35], v[48:51], v[176:179]
    v_mfma_f32_16x16x32_bf16 v[180:183], v[36:39], v[48:51], v[180:183]
    v_mfma_f32_16x16x32_bf16 v[184:187], v[40:43], v[48:51], v[184:187]
    v_mfma_f32_16x16x32_bf16 v[188:191], v[44:47], v[48:51], v[188:191]
    s_add_u32 s20, s38, s51
    buffer_load_dwordx4 v[48:51], v1, s[28:31], s20 offen
    s_add_u32 s58, s58, 1
    s_cmp_eq_u32 s58, 28
    s_cselect_b32 s58, 0, s58
    s_lshl_b32 s38, s58, 12
    s_add_u32 s38, s38, s60
    s_waitcnt vmcnt(27)
    v_mfma_f32_16x16x32_bf16 v[192:195], v[32:35], v[124:127], v[192:195]
    v_mfma_f32_16x16x32_bf16 v[196:199], v[36:39], v[124:127], v[196:199]
    ds_read_b64_tr_b16 v[16:17], v4 offset:8192
    v_mfma_f32_16x16x32_bf16 v[200:203], v[40:43], v[124:127], v[200:203]
    ds_read_b64_tr_b16 v[18:19], v4 offset:10240
    v_mfma_f32_16x16x32_bf16 v[204:207], v[44:47], v[124:127], v[204:207]
    ds_read_b64_tr_b16 v[20:21], v5 offset:8192
    s_add_u32 s19, s38, s44
    buffer_load_dwordx4 v[124:127], v1, s[28:31], s19 offen
    s_waitcnt vmcnt(27)
    v_mfma_f32_16x16x32_bf16 v[208:211], v[32:35], v[120:123], v[208:211]
    ds_read_b64_tr_b16 v[22:23], v5 offset:10240
    v_mfma_f32_16x16x32_bf16 v[212:215], v[36:39], v[120:123], v[212:215]
    ds_read_b64_tr_b16 v[24:25], v6 offset:8192
    v_mfma_f32_16x16x32_bf16 v[216:219], v[40:43], v[120:123], v[216:219]
    ds_read_b64_tr_b16 v[26:27], v6 offset:10240
    v_mfma_f32_16x16x32_bf16 v[220:223], v[44:47], v[120:123], v[220:223]
    ds_read_b64_tr_b16 v[28:29], v7 offset:8192
    s_add_u32 s20, s38, s45
    buffer_load_dwordx4 v[120:123], v1, s[28:31], s20 offen
    s_waitcnt vmcnt(27)
    v_mfma_f32_16x16x32_bf16 v[224:227], v[32:35], v[116:119], v[224:227]
    ds_read_b64_tr_b16 v[30:31], v7 offset:10240
    v_mfma_f32_16x16x32_bf16 v[228:231], v[36:39], v[116:119], v[228:231]
    v_mfma_f32_16x16x32_bf16 v[232:235], v[40:43], v[116:119], v[232:235]
    v_mfma_f32_16x16x32_bf16 v[236:239], v[44:47], v[116:119], v[236:239]
    s_add_u32 s19, s38, s46
    buffer_load_dwordx4 v[116:119], v1, s[28:31], s19 offen
    s_waitcnt vmcnt(27)
    v_mfma_f32_16x16x32_bf16 v[240:243], v[32:35], v[112:115], v[240:243]
    v_mfma_f32_16x16x32_bf16 v[244:247], v[36:39], v[112:115], v[244:247]
    v_mfma_f32_16x16x32_bf16 v[248:251], v[40:43], v[112:115], v[248:251]
    v_mfma_f32_16x16x32_bf16 v[252:255], v[44:47], v[112:115], v[252:255]
    s_waitcnt lgkmcnt(0)
    s_add_u32 s20, s38, s47
    buffer_load_dwordx4 v[112:115], v1, s[28:31], s20 offen
    s_waitcnt vmcnt(27)
    v_mfma_f32_16x16x32_bf16 v[128:131], v[16:19], v[108:111], v[128:131]
    s_add_u32 m0, s42, 4096
    s_nop 0
    global_load_lds_dwordx4 v2, s[40:41]
    v_mfma_f32_16x16x32_bf16 v[132:135], v[20:23], v[108:111], v[132:135]
    s_add_u32 m0, s42, 5120
    s_nop 0
    global_load_lds_dwordx4 v2, s[56:57]
    v_mfma_f32_16x16x32_bf16 v[136:139], v[24:27], v[108:111], v[136:139]
    s_add_u32 m0, s42, 6144
    s_nop 0
    global_load_lds_dwordx4 v3, s[40:41]
    v_mfma_f32_16x16x32_bf16 v[140:143], v[28:31], v[108:111], v[140:143]
    s_add_u32 m0, s42, 7168
    s_nop 0
    global_load_lds_dwordx4 v3, s[56:57]
    s_add_u32 s59, s59, 1
    s_cmp_eq_u32 s59, 28
    s_cselect_b32 s59, 0, s59
    s_lshl_b32 s56, s59, 18
    s_add_u32 s40, s8, s56
    s_addc_u32 s41, s9, 0
    s_add_u32 s56, s40, 16384
    s_addc_u32 s57, s41, 0
    s_add_u32 s19, s38, s48
    buffer_load_dwordx4 v[108:111], v1, s[28:31], s19 offen
    s_waitcnt vmcnt(31)
    v_mfma_f32_16x16x32_bf16 v[144:147], v[16:19], v[104:107], v[144:147]
    v_mfma_f32_16x16x32_bf16 v[148:151], v[20:23], v[104:107], v[148:151]
    v_mfma_f32_16x16x32_bf16 v[152:155], v[24:27], v[104:107], v[152:155]
    v_mfma_f32_16x16x32_bf16 v[156:159], v[28:31], v[104:107], v[156:159]
    s_add_u32 s20, s38, s49
    buffer_load_dwordx4 v[104:107], v1, s[28:31], s20 offen
    s_waitcnt vmcnt(31)
    v_mfma_f32_16x16x32_bf16 v[160:163], v[16:19], v[100:103], v[160:163]
    v_mfma_f32_16x16x32_bf16 v[164:167], v[20:23], v[100:103], v[164:167]
    v_mfma_f32_16x16x32_bf16 v[168:171], v[24:27], v[100:103], v[168:171]
    v_mfma_f32_16x16x32_bf16 v[172:175], v[28:31], v[100:103], v[172:175]
    s_add_u32 s19, s38, s50
    buffer_load_dwordx4 v[100:103], v1, s[28:31], s19 offen
    s_waitcnt vmcnt(31)
    v_mfma_f32_16x16x32_bf16 v[176:179], v[16:19], v[96:99], v[176:179]
    v_mfma_f32_16x16x32_bf16 v[180:183], v[20:23], v[96:99], v[180:183]
    v_mfma_f32_16x16x32_bf16 v[184:187], v[24:27], v[96:99], v[184:187]
    v_mfma_f32_16x16x32_bf16 v[188:191], v[28:31], v[96:99], v[188:191]
    s_add_u32 s20, s38, s51
    buffer_load_dwordx4 v[96:99], v1, s[28:31], s20 offen
    s_add_u32 s58, s58, 1
    s_cmp_eq_u32 s58, 28
    s_cselect_b32 s58, 0, s58
    s_lshl_b32 s38, s58, 12
    s_add_u32 s38, s38, s60
    s_waitcnt vmcnt(27)
    v_mfma_f32_16x16x32_bf16 v[192:195], v[16:19], v[92:95], v[192:195]
    v_mfma_f32_16x16x32_bf16 v[196:199], v[20:23], v[92:95], v[196:199]
    ds_read_b64_tr_b16 v[32:33], v4 offset:12288
    v_mfma_f32_16x16x32_bf16 v[200:203], v[24:27], v[92:95], v[200:203]
    ds_read_b64_tr_b16 v[34:35], v4 offset:14336
    v_mfma_f32_16x16x32_bf16 v[204:207], v[28:31], v[92:95], v[204:207]
    ds_read_b64_tr_b16 v[36:37], v5 offset:12288
    s_add_u32 s19, s38, s44
    buffer_load_dwordx4 v[92:95], v1, s[28:31], s19 offen
    s_waitcnt vmcnt(27)
    v_mfma_f32_16x16x32_bf16 v[208:211], v[16:19], v[88:91], v[208:211]
    ds_read_b64_tr_b16 v[38:39], v5 offset:14336
    v_mfma_f32_16x16x32_bf16 v[212:215], v[20:23], v[88:91], v[212:215]
    ds_read_b64_tr_b16 v[40:41], v6 offset:12288
    v_mfma_f32_16x16x32_bf16 v[216:219], v[24:27], v[88:91], v[216:219]
    ds_read_b64_tr_b16 v[42:43], v6 offset:14336
    v_mfma_f32_16x16x32_bf16 v[220:223], v[28:31], v[88:91], v[220:223]
    ds_read_b64_tr_b16 v[44:45], v7 offset:12288
    s_add_u32 s20, s38, s45
    buffer_load_dwordx4 v[88:91], v1, s[28:31], s20 offen
    s_waitcnt vmcnt(27)
    v_mfma_f32_16x16x32_bf16 v[224:227], v[16:19], v[84:87], v[224:227]
    ds_read_b64_tr_b16 v[46:47], v7 offset:14336
    v_mfma_f32_16x16x32_bf16 v[228:231], v[20:23], v[84:87], v[228:231]
    v_mfma_f32_16x16x32_bf16 v[232:235], v[24:27], v[84:87], v[232:235]
    v_mfma_f32_16x16x32_bf16 v[236:239], v[28:31], v[84:87], v[236:239]
    s_add_u32 s19, s38, s46
    buffer_load_dwordx4 v[84:87], v1, s[28:31], s19 offen
    s_waitcnt vmcnt(27)
    v_mfma_f32_16x16x32_bf16 v[240:243], v[16:19], v[80:83], v[240:243]
    v_mfma_f32_16x16x32_bf16 v[244:247], v[20:23], v[80:83], v[244:247]
    v_mfma_f32_16x16x32_bf16 v[248:251], v[24:27], v[80:83], v[248:251]
    v_mfma_f32_16x16x32_bf16 v[252:255], v[28:31], v[80:83], v[252:255]
    s_waitcnt lgkmcnt(0)
    s_add_u32 s20, s38, s47
    buffer_load_dwordx4 v[80:83], v1, s[28:31], s20 offen
    s_waitcnt vmcnt(27)
    v_mfma_f32_16x16x32_bf16 v[128:131], v[32:35], v[76:79], v[128:131]
    s_add_u32 m0, s42, 8192
    s_nop 0
    global_load_lds_dwordx4 v2, s[40:41]
    v_mfma_f32_16x16x32_bf16 v[132:135], v[36:39], v[76:79], v[132:135]
    s_add_u32 m0, s42, 9216
    s_nop 0
    global_load_lds_dwordx4 v2, s[56:57]
    v_mfma_f32_16x16x32_bf16 v[136:139], v[40:43], v[76:79], v[136:139]
    s_add_u32 m0, s42, 10240
    s_nop 0
    global_load_lds_dwordx4 v3, s[40:41]
    v_mfma_f32_16x16x32_bf16 v[140:143], v[44:47], v[76:79], v[140:143]
    s_add_u32 m0, s42, 11264
    s_nop 0
    global_load_lds_dwordx4 v3, s[56:57]
    s_add_u32 s59, s59, 1
    s_cmp_eq_u32 s59, 28
    s_cselect_b32 s59, 0, s59
    s_lshl_b32 s56, s59, 18
    s_add_u32 s40, s8, s56
    s_addc_u32 s41, s9, 0
    s_add_u32 s56, s40, 16384
    s_addc_u32 s57, s41, 0
    s_add_u32 s19, s38, s48
    buffer_load_dwordx4 v[76:79], v1, s[28:31], s19 offen
    s_waitcnt vmcnt(31)
    v_mfma_f32_16x16x32_bf16 v[144:147], v[32:35], v[72:75], v[144:147]
    v_mfma_f32_16x16x32_bf16 v[148:151], v[36:39], v[72:75], v[148:151]
    v_mfma_f32_16x16x32_bf16 v[152:155], v[40:43], v[72:75], v[152:155]
    v_mfma_f32_16x16x32_bf16 v[156:159], v[44:47], v[72:75], v[156:159]
    s_add_u32 s20, s38, s49
    buffer_load_dwordx4 v[72:75], v1, s[28:31], s20 offen
    s_waitcnt vmcnt(31)
    v_mfma_f32_16x16x32_bf16 v[160:163], v[32:35], v[68:71], v[160:163]
    v_mfma_f32_16x16x32_bf16 v[164:167], v[36:39], v[68:71], v[164:167]
    v_mfma_f32_16x16x32_bf16 v[168:171], v[40:43], v[68:71], v[168:171]
    v_mfma_f32_16x16x32_bf16 v[172:175], v[44:47], v[68:71], v[172:175]
    s_add_u32 s19, s38, s50
    buffer_load_dwordx4 v[68:71], v1, s[28:31], s19 offen
    s_waitcnt vmcnt(31)
    v_mfma_f32_16x16x32_bf16 v[176:179], v[32:35], v[64:67], v[176:179]
    v_mfma_f32_16x16x32_bf16 v[180:183], v[36:39], v[64:67], v[180:183]
    v_mfma_f32_16x16x32_bf16 v[184:187], v[40:43], v[64:67], v[184:187]
    v_mfma_f32_16x16x32_bf16 v[188:191], v[44:47], v[64:67], v[188:191]
    s_add_u32 s20, s38, s51
    buffer_load_dwordx4 v[64:67], v1, s[28:31], s20 offen
    s_add_u32 s58, s58, 1
    s_cmp_eq_u32 s58, 28
    s_cselect_b32 s58, 0, s58
    s_lshl_b32 s38, s58, 12
    s_add_u32 s38, s38, s60
    s_waitcnt vmcnt(27)
    v_mfma_f32_16x16x32_bf16 v[192:195], v[32:35], v[60:63], v[192:195]
    v_mfma_f32_16x16x32_bf16 v[196:199], v[36:39], v[60:63], v[196:199]
    ds_read_b64_tr_b16 v[16:17], v4 offset:0
    v_mfma_f32_16x16x32_bf16 v[200:203], v[40:43], v[60:63], v[200:203]
    ds_read_b64_tr_b16 v[18:19], v4 offset:2048
    v_mfma_f32_16x16x32_bf16 v[204:207], v[44:47], v[60:63], v[204:207]
    ds_read_b64_tr_b16 v[20:21], v5 offset:0
    s_add_u32 s19, s38, s44
    buffer_load_dwordx4 v[60:63], v1, s[28:31], s19 offen
    s_waitcnt vmcnt(27)
    v_mfma_f32_16x16x32_bf16 v[208:211], v[32:35], v[56:59], v[208:211]
    ds_read_b64_tr_b16 v[22:23], v5 offset:2048
    v_mfma_f32_16x16x32_bf16 v[212:215], v[36:39], v[56:59], v[212:215]
    ds_read_b64_tr_b16 v[24:25], v6 offset:0
    v_mfma_f32_16x16x32_bf16 v[216:219], v[40:43], v[56:59], v[216:219]
    ds_read_b64_tr_b16 v[26:27], v6 offset:2048
    v_mfma_f32_16x16x32_bf16 v[220:223], v[44:47], v[56:59], v[220:223]
    ds_read_b64_tr_b16 v[28:29], v7 offset:0
    s_add_u32 s20, s38, s45
    buffer_load_dwordx4 v[56:59], v1, s[28:31], s20 offen
    s_waitcnt vmcnt(27)
    v_mfma_f32_16x16x32_bf16 v[224:227], v[32:35], v[52:55], v[224:227]
    ds_read_b64_tr_b16 v[30:31], v7 offset:2048
    v_mfma_f32_16x16x32_bf16 v[228:231], v[36:39], v[52:55], v[228:231]
    v_mfma_f32_16x16x32_bf16 v[232:235], v[40:43], v[52:55], v[232:235]
    v_mfma_f32_16x16x32_bf16 v[236:239], v[44:47], v[52:55], v[236:239]
    s_add_u32 s19, s38, s46
    buffer_load_dwordx4 v[52:55], v1, s[28:31], s19 offen
    s_waitcnt vmcnt(27)
    v_mfma_f32_16x16x32_bf16 v[240:243], v[32:35], v[48:51], v[240:243]
    v_mfma_f32_16x16x32_bf16 v[244:247], v[36:39], v[48:51], v[244:247]
    v_mfma_f32_16x16x32_bf16 v[248:251], v[40:43], v[48:51], v[248:251]
    v_mfma_f32_16x16x32_bf16 v[252:255], v[44:47], v[48:51], v[252:255]
    s_waitcnt lgkmcnt(0)
    s_add_u32 s20, s38, s47
    buffer_load_dwordx4 v[48:51], v1, s[28:31], s20 offen
    s_waitcnt vmcnt(27)
    v_mfma_f32_16x16x32_bf16 v[128:131], v[16:19], v[124:127], v[128:131]
    s_add_u32 m0, s42, 12288
    s_nop 0
    global_load_lds_dwordx4 v2, s[40:41]
    v_mfma_f32_16x16x32_bf16 v[132:135], v[20:23], v[124:127], v[132:135]
    s_add_u32 m0, s42, 13312
    s_nop 0
    global_load_lds_dwordx4 v2, s[56:57]
    v_mfma_f32_16x16x32_bf16 v[136:139], v[24:27], v[124:127], v[136:139]
    s_add_u32 m0, s42, 14336
    s_nop 0
    global_load_lds_dwordx4 v3, s[40:41]
    v_mfma_f32_16x16x32_bf16 v[140:143], v[28:31], v[124:127], v[140:143]
    s_add_u32 m0, s42, 15360
    s_nop 0
    global_load_lds_dwordx4 v3, s[56:57]
    s_add_u32 s59, s59, 1
    s_cmp_eq_u32 s59, 28
    s_cselect_b32 s59, 0, s59
    s_lshl_b32 s56, s59, 18
    s_add_u32 s40, s8, s56
    s_addc_u32 s41, s9, 0
    s_add_u32 s56, s40, 16384
    s_addc_u32 s57, s41, 0
    s_add_u32 s19, s38, s48
    buffer_load_dwordx4 v[124:127], v1, s[28:31], s19 offen
    s_waitcnt vmcnt(31)
    v_mfma_f32_16x16x32_bf16 v[144:147], v[16:19], v[120:123], v[144:147]
    v_mfma_f32_16x16x32_bf16 v[148:151], v[20:23], v[120:123], v[148:151]
    v_mfma_f32_16x16x32_bf16 v[152:155], v[24:27], v[120:123], v[152:155]
    v_mfma_f32_16x16x32_bf16 v[156:159], v[28:31], v[120:123], v[156:159]
    s_add_u32 s20, s38, s49
    buffer_load_dwordx4 v[120:123], v1, s[28:31], s20 offen
    s_waitcnt vmcnt(31)
    v_mfma_f32_16x16x32_bf16 v[160:163], v[16:19], v[116:119], v[160:163]
    v_mfma_f32_16x16x32_bf16 v[164:167], v[20:23], v[116:119], v[164:167]
    v_mfma_f32_16x16x32_bf16 v[168:171], v[24:27], v[116:119], v[168:171]
    v_mfma_f32_16x16x32_bf16 v[172:175], v[28:31], v[116:119], v[172:175]
    s_add_u32 s19, s38, s50
    buffer_load_dwordx4 v[116:119], v1, s[28:31], s19 offen
    s_waitcnt vmcnt(31)
    v_mfma_f32_16x16x32_bf16 v[176:179], v[16:19], v[112:115], v[176:179]
    v_mfma_f32_16x16x32_bf16 v[180:183], v[20:23], v[112:115], v[180:183]
    v_mfma_f32_16x16x32_bf16 v[184:187], v[24:27], v[112:115], v[184:187]
    v_mfma_f32_16x16x32_bf16 v[188:191], v[28:31], v[112:115], v[188:191]
    s_add_u32 s20, s38, s51
    buffer_load_dwordx4 v[112:115], v1, s[28:31], s20 offen
    s_add_u32 s58, s58, 1
    s_cmp_eq_u32 s58, 28
    s_cselect_b32 s58, 0, s58
    s_lshl_b32 s38, s58, 12
    s_add_u32 s38, s38, s60
    s_waitcnt vmcnt(27)
    v_mfma_f32_16x16x32_bf16 v[192:195], v[16:19], v[108:111], v[192:195]
    v_mfma_f32_16x16x32_bf16 v[196:199], v[20:23], v[108:111], v[196:199]
    ds_read_b64_tr_b16 v[32:33], v4 offset:4096
    v_mfma_f32_16x16x32_bf16 v[200:203], v[24:27], v[108:111], v[200:203]
    ds_read_b64_tr_b16 v[34:35], v4 offset:6144
    v_mfma_f32_16x16x32_bf16 v[204:207], v[28:31], v[108:111], v[204:207]
    ds_read_b64_tr_b16 v[36:37], v5 offset:4096
    s_add_u32 s19, s38, s44
    buffer_load_dwordx4 v[108:111], v1, s[28:31], s19 offen
    s_waitcnt vmcnt(27)
    v_mfma_f32_16x16x32_bf16 v[208:211], v[16:19], v[104:107], v[208:211]
    ds_read_b64_tr_b16 v[38:39], v5 offset:6144
    v_mfma_f32_16x16x32_bf16 v[212:215], v[20:23], v[104:107], v[212:215]
    ds_read_b64_tr_b16 v[40:41], v6 offset:4096
    v_mfma_f32_16x16x32_bf16 v[216:219], v[24:27], v[104:107], v[216:219]
    ds_read_b64_tr_b16 v[42:43], v6 offset:6144
    v_mfma_f32_16x16x32_bf16 v[220:223], v[28:31], v[104:107], v[220:223]
    ds_read_b64_tr_b16 v[44:45], v7 offset:4096
    s_add_u32 s20, s38, s45
    buffer_load_dwordx4 v[104:107], v1, s[28:31], s20 offen
    s_waitcnt vmcnt(27)
    v_mfma_f32_16x16x32_bf16 v[224:227], v[16:19], v[100:103], v[224:227]
    ds_read_b64_tr_b16 v[46:47], v7 offset:6144
    v_mfma_f32_16x16x32_bf16 v[228:231], v[20:23], v[100:103], v[228:231]
    v_mfma_f32_16x16x32_bf16 v[232:235], v[24:27], v[100:103], v[232:235]
    v_mfma_f32_16x16x32_bf16 v[236:239], v[28:31], v[100:103], v[236:239]
    s_add_u32 s19, s38, s46
    buffer_load_dwordx4 v[100:103], v1, s[28:31], s19 offen
    s_waitcnt vmcnt(27)
    v_mfma_f32_16x16x32_bf16 v[240:243], v[16:19], v[96:99], v[240:243]
    v_mfma_f32_16x16x32_bf16 v[244:247], v[20:23], v[96:99], v[244:247]
    v_mfma_f32_16x16x32_bf16 v[248:251], v[24:27], v[96:99], v[248:251]
    v_mfma_f32_16x16x32_bf16 v[252:255], v[28:31], v[96:99], v[252:255]
    s_waitcnt lgkmcnt(0)
    s_add_u32 s20, s38, s47
    buffer_load_dwordx4 v[96:99], v1, s[28:31], s20 offen
    s_waitcnt vmcnt(27)
    v_mfma_f32_16x16x32_bf16 v[128:131], v[32:35], v[92:95], v[128:131]
    s_add_u32 m0, s42, 0
    s_nop 0
    global_load_lds_dwordx4 v2, s[40:41]
    v_mfma_f32_16x16x32_bf16 v[132:135], v[36:39], v[92:95], v[132:135]
    s_add_u32 m0, s42, 1024
    s_nop 0
    global_load_lds_dwordx4 v2, s[56:57]
    v_mfma_f32_16x16x32_bf16 v[136:139], v[40:43], v[92:95], v[136:139]
    s_add_u32 m0, s42, 2048
    s_nop 0
    global_load_lds_dwordx4 v3, s[40:41]
    v_mfma_f32_16x16x32_bf16 v[140:143], v[44:47], v[92:95], v[140:143]
    s_add_u32 m0, s42, 3072
    s_nop 0
    global_load_lds_dwordx4 v3, s[56:57]
    s_add_u32 s59, s59, 1
    s_cmp_eq_u32 s59, 28
    s_cselect_b32 s59, 0, s59
    s_lshl_b32 s56, s59, 18
    s_add_u32 s40, s8, s56
    s_addc_u32 s41, s9, 0
    s_add_u32 s56, s40, 16384
    s_addc_u32 s57, s41, 0
    s_add_u32 s19, s38, s48
    buffer_load_dwordx4 v[92:95], v1, s[28:31], s19 offen
    s_waitcnt vmcnt(31)
    v_mfma_f32_16x16x32_bf16 v[144:147], v[32:35], v[88:91], v[144:147]
    v_mfma_f32_16x16x32_bf16 v[148:151], v[36:39], v[88:91], v[148:151]
    v_mfma_f32_16x16x32_bf16 v[152:155], v[40:43], v[88:91], v[152:155]
    v_mfma_f32_16x16x32_bf16 v[156:159], v[44:47], v[88:91], v[156:159]
    s_add_u32 s20, s38, s49
    buffer_load_dwordx4 v[88:91], v1, s[28:31], s20 offen
    s_waitcnt vmcnt(31)
    v_mfma_f32_16x16x32_bf16 v[160:163], v[32:35], v[84:87], v[160:163]
    v_mfma_f32_16x16x32_bf16 v[164:167], v[36:39], v[84:87], v[164:167]
    v_mfma_f32_16x16x32_bf16 v[168:171], v[40:43], v[84:87], v[168:171]
    v_mfma_f32_16x16x32_bf16 v[172:175], v[44:47], v[84:87], v[172:175]
    s_add_u32 s19, s38, s50
    buffer_load_dwordx4 v[84:87], v1, s[28:31], s19 offen
    s_waitcnt vmcnt(31)
    v_mfma_f32_16x16x32_bf16 v[176:179], v[32:35], v[80:83], v[176:179]
    v_mfma_f32_16x16x32_bf16 v[180:183], v[36:39], v[80:83], v[180:183]
    v_mfma_f32_16x16x32_bf16 v[184:187], v[40:43], v[80:83], v[184:187]
    v_mfma_f32_16x16x32_bf16 v[188:191], v[44:47], v[80:83], v[188:191]
    s_add_u32 s20, s38, s51
    buffer_load_dwordx4 v[80:83], v1, s[28:31], s20 offen
    s_add_u32 s58, s58, 1
    s_cmp_eq_u32 s58, 28
    s_cselect_b32 s58, 0, s58
    s_lshl_b32 s38, s58, 12
    s_add_u32 s38, s38, s60
    s_waitcnt vmcnt(27)
    v_mfma_f32_16x16x32_bf16 v[192:195], v[32:35], v[76:79], v[192:195]
    v_mfma_f32_16x16x32_bf16 v[196:199], v[36:39], v[76:79], v[196:199]
    ds_read_b64_tr_b16 v[16:17], v4 offset:8192
    v_mfma_f32_16x16x32_bf16 v[200:203], v[40:43], v[76:79], v[200:203]
    ds_read_b64_tr_b16 v[18:19], v4 offset:10240
    v_mfma_f32_16x16x32_bf16 v[204:207], v[44:47], v[76:79], v[204:207]
    ds_read_b64_tr_b16 v[20:21], v5 offset:8192
    s_add_u32 s19, s38, s44
    buffer_load_dwordx4 v[76:79], v1, s[28:31], s19 offen
    s_waitcnt vmcnt(27)
    v_mfma_f32_16x16x32_bf16 v[208:211], v[32:35], v[72:75], v[208:211]
    ds_read_b64_tr_b16 v[22:23], v5 offset:10240
    v_mfma_f32_16x16x32_bf16 v[212:215], v[36:39], v[72:75], v[212:215]
    ds_read_b64_tr_b16 v[24:25], v6 offset:8192
    v_mfma_f32_16x16x32_bf16 v[216:219], v[40:43], v[72:75], v[216:219]
    ds_read_b64_tr_b16 v[26:27], v6 offset:10240
    v_mfma_f32_16x16x32_bf16 v[220:223], v[44:47], v[72:75], v[220:223]
    ds_read_b64_tr_b16 v[28:29], v7 offset:8192
    s_add_u32 s20, s38, s45
    buffer_load_dwordx4 v[72:75], v1, s[28:31], s20 offen
    s_waitcnt vmcnt(27)
    v_mfma_f32_16x16x32_bf16 v[224:227], v[32:35], v[68:71], v[224:227]
    ds_read_b64_tr_b16 v[30:31], v7 offset:10240
    v_mfma_f32_16x16x32_bf16 v[228:231], v[36:39], v[68:71], v[228:231]
    v_mfma_f32_16x16x32_bf16 v[232:235], v[40:43], v[68:71], v[232:235]
    v_mfma_f32_16x16x32_bf16 v[236:239], v[44:47], v[68:71], v[236:239]
    s_add_u32 s19, s38, s46
    buffer_load_dwordx4 v[68:71], v1, s[28:31], s19 offen
    s_waitcnt vmcnt(27)
    v_mfma_f32_16x16x32_bf16 v[240:243], v[32:35], v[64:67], v[240:243]
    v_mfma_f32_16x16x32_bf16 v[244:247], v[36:39], v[64:67], v[244:247]
    v_mfma_f32_16x16x32_bf16 v[248:251], v[40:43], v[64:67], v[248:251]
    v_mfma_f32_16x16x32_bf16 v[252:255], v[44:47], v[64:67], v[252:255]
    s_waitcnt lgkmcnt(0)
    s_add_u32 s20, s38, s47
    buffer_load_dwordx4 v[64:67], v1, s[28:31], s20 offen
    s_waitcnt vmcnt(27)
    v_mfma_f32_16x16x32_bf16 v[128:131], v[16:19], v[60:63], v[128:131]
    s_add_u32 m0, s42, 4096
    s_nop 0
    global_load_lds_dwordx4 v2, s[40:41]
    v_mfma_f32_16x16x32_bf16 v[132:135], v[20:23], v[60:63], v[132:135]
    s_add_u32 m0, s42, 5120
    s_nop 0
    global_load_lds_dwordx4 v2, s[56:57]
    v_mfma_f32_16x16x32_bf16 v[136:139], v[24:27], v[60:63], v[136:139]
    s_add_u32 m0, s42, 6144
    s_nop 0
    global_load_lds_dwordx4 v3, s[40:41]
    v_mfma_f32_16x16x32_bf16 v[140:143], v[28:31], v[60:63], v[140:143]
    s_add_u32 m0, s42, 7168
    s_nop 0
    global_load_lds_dwordx4 v3, s[56:57]
    s_add_u32 s59, s59, 1
    s_cmp_eq_u32 s59, 28
    s_cselect_b32 s59, 0, s59
    s_lshl_b32 s56, s59, 18
    s_add_u32 s40, s8, s56
    s_addc_u32 s41, s9, 0
    s_add_u32 s56, s40, 16384
    s_addc_u32 s57, s41, 0
    s_add_u32 s19, s38, s48
    buffer_load_dwordx4 v[60:63], v1, s[28:31], s19 offen
    s_waitcnt vmcnt(31)
    v_mfma_f32_16x16x32_bf16 v[144:147], v[16:19], v[56:59], v[144:147]
    v_mfma_f32_16x16x32_bf16 v[148:151], v[20:23], v[56:59], v[148:151]
    v_mfma_f32_16x16x32_bf16 v[152:155], v[24:27], v[56:59], v[152:155]
    v_mfma_f32_16x16x32_bf16 v[156:159], v[28:31], v[56:59], v[156:159]
    s_add_u32 s20, s38, s49
    buffer_load_dwordx4 v[56:59], v1, s[28:31], s20 offen
    s_waitcnt vmcnt(31)
    v_mfma_f32_16x16x32_bf16 v[160:163], v[16:19], v[52:55], v[160:163]
    v_mfma_f32_16x16x32_bf16 v[164:167], v[20:23], v[52:55], v[164:167]
    v_mfma_f32_16x16x32_bf16 v[168:171], v[24:27], v[52:55], v[168:171]
    v_mfma_f32_16x16x32_bf16 v[172:175], v[28:31], v[52:55], v[172:175]
    s_add_u32 s19, s38, s50
    buffer_load_dwordx4 v[52:55], v1, s[28:31], s19 offen
    s_waitcnt vmcnt(31)
    v_mfma_f32_16x16x32_bf16 v[176:179], v[16:19], v[48:51], v[176:179]
    v_mfma_f32_16x16x32_bf16 v[180:183], v[20:23], v[48:51], v[180:183]
    v_mfma_f32_16x16x32_bf16 v[184:187], v[24:27], v[48:51], v[184:187]
    v_mfma_f32_16x16x32_bf16 v[188:191], v[28:31], v[48:51], v[188:191]
    s_add_u32 s20, s38, s51
    buffer_load_dwordx4 v[48:51], v1, s[28:31], s20 offen
    s_add_u32 s58, s58, 1
    s_cmp_eq_u32 s58, 28
    s_cselect_b32 s58, 0, s58
    s_lshl_b32 s38, s58, 12
    s_add_u32 s38, s38, s60
    s_waitcnt vmcnt(27)
    v_mfma_f32_16x16x32_bf16 v[192:195], v[16:19], v[124:127], v[192:195]
    v_mfma_f32_16x16x32_bf16 v[196:199], v[20:23], v[124:127], v[196:199]
    ds_read_b64_tr_b16 v[32:33], v4 offset:12288
    v_mfma_f32_16x16x32_bf16 v[200:203], v[24:27], v[124:127], v[200:203]
    ds_read_b64_tr_b16 v[34:35], v4 offset:14336
    v_mfma_f32_16x16x32_bf16 v[204:207], v[28:31], v[124:127], v[204:207]
    ds_read_b64_tr_b16 v[36:37], v5 offset:12288
    s_add_u32 s19, s38, s44
    buffer_load_dwordx4 v[124:127], v1, s[28:31], s19 offen
    s_waitcnt vmcnt(27)
    v_mfma_f32_16x16x32_bf16 v[208:211], v[16:19], v[120:123], v[208:211]
    ds_read_b64_tr_b16 v[38:39], v5 offset:14336
    v_mfma_f32_16x16x32_bf16 v[212:215], v[20:23], v[120:123], v[212:215]
    ds_read_b64_tr_b16 v[40:41], v6 offset:12288
    v_mfma_f32_16x16x32_bf16 v[216:219], v[24:27], v[120:123], v[216:219]
    ds_read_b64_tr_b16 v[42:43], v6 offset:14336
    v_mfma_f32_16x16x32_bf16 v[220:223], v[28:31], v[120:123], v[220:223]
    ds_read_b64_tr_b16 v[44:45], v7 offset:12288
    s_add_u32 s20, s38, s45
    buffer_load_dwordx4 v[120:123], v1, s[28:31], s20 offen
    s_waitcnt vmcnt(27)
    v_mfma_f32_16x16x32_bf16 v[224:227], v[16:19], v[116:119], v[224:227]
    ds_read_b64_tr_b16 v[46:47], v7 offset:14336
    v_mfma_f32_16x16x32_bf16 v[228:231], v[20:23], v[116:119], v[228:231]
    v_mfma_f32_16x16x32_bf16 v[232:235], v[24:27], v[116:119], v[232:235]
    v_mfma_f32_16x16x32_bf16 v[236:239], v[28:31], v[116:119], v[236:239]
    s_add_u32 s19, s38, s46
    buffer_load_dwordx4 v[116:119], v1, s[28:31], s19 offen
    s_waitcnt vmcnt(27)
    v_mfma_f32_16x16x32_bf16 v[240:243], v[16:19], v[112:115], v[240:243]
    v_mfma_f32_16x16x32_bf16 v[244:247], v[20:23], v[112:115], v[244:247]
    v_mfma_f32_16x16x32_bf16 v[248:251], v[24:27], v[112:115], v[248:251]
    v_mfma_f32_16x16x32_bf16 v[252:255], v[28:31], v[112:115], v[252:255]
    s_waitcnt lgkmcnt(0)
    s_add_u32 s20, s38, s47
    buffer_load_dwordx4 v[112:115], v1, s[28:31], s20 offen
    s_waitcnt vmcnt(27)
    v_mfma_f32_16x16x32_bf16 v[128:131], v[32:35], v[108:111], v[128:131]
    s_add_u32 m0, s42, 8192
    s_nop 0
    global_load_lds_dwordx4 v2, s[40:41]
    v_mfma_f32_16x16x32_bf16 v[132:135], v[36:39], v[108:111], v[132:135]
    s_add_u32 m0, s42, 9216
    s_nop 0
    global_load_lds_dwordx4 v2, s[56:57]
    v_mfma_f32_16x16x32_bf16 v[136:139], v[40:43], v[108:111], v[136:139]
    s_add_u32 m0, s42, 10240
    s_nop 0
    global_load_lds_dwordx4 v3, s[40:41]
    v_mfma_f32_16x16x32_bf16 v[140:143], v[44:47], v[108:111], v[140:143]
    s_add_u32 m0, s42, 11264
    s_nop 0
    global_load_lds_dwordx4 v3, s[56:57]
    s_add_u32 s59, s59, 1
    s_cmp_eq_u32 s59, 28
    s_cselect_b32 s59, 0, s59
    s_lshl_b32 s56, s59, 18
    s_add_u32 s40, s8, s56
    s_addc_u32 s41, s9, 0
    s_add_u32 s56, s40, 16384
    s_addc_u32 s57, s41, 0
    s_add_u32 s19, s38, s48
    buffer_load_dwordx4 v[108:111], v1, s[28:31], s19 offen
    s_waitcnt vmcnt(31)
    v_mfma_f32_16x16x32_bf16 v[144:147], v[32:35], v[104:107], v[144:147]
    v_mfma_f32_16x16x32_bf16 v[148:151], v[36:39], v[104:107], v[148:151]
    v_mfma_f32_16x16x32_bf16 v[152:155], v[40:43], v[104:107], v[152:155]
    v_mfma_f32_16x16x32_bf16 v[156:159], v[44:47], v[104:107], v[156:159]
    s_add_u32 s20, s38, s49
    buffer_load_dwordx4 v[104:107], v1, s[28:31], s20 offen
    s_waitcnt vmcnt(31)
    v_mfma_f32_16x16x32_bf16 v[160:163], v[32:35], v[100:103], v[160:163]
    v_mfma_f32_16x16x32_bf16 v[164:167], v[36:39], v[100:103], v[164:167]
    v_mfma_f32_16x16x32_bf16 v[168:171], v[40:43], v[100:103], v[168:171]
    v_mfma_f32_16x16x32_bf16 v[172:175], v[44:47], v[100:103], v[172:175]
    s_add_u32 s19, s38, s50
    buffer_load_dwordx4 v[100:103], v1, s[28:31], s19 offen
    s_waitcnt vmcnt(31)
    v_mfma_f32_16x16x32_bf16 v[176:179], v[32:35], v[96:99], v[176:179]
    v_mfma_f32_16x16x32_bf16 v[180:183], v[36:39], v[96:99], v[180:183]
    v_mfma_f32_16x16x32_bf16 v[184:187], v[40:43], v[96:99], v[184:187]
    v_mfma_f32_16x16x32_bf16 v[188:191], v[44:47], v[96:99], v[188:191]
    s_add_u32 s20, s38, s51
    buffer_load_dwordx4 v[96:99], v1, s[28:31], s20 offen
    s_add_u32 s58, s58, 1
    s_cmp_eq_u32 s58, 28
    s_cselect_b32 s58, 0, s58
    s_lshl_b32 s38, s58, 12
    s_add_u32 s38, s38, s60
    s_waitcnt vmcnt(27)
    v_mfma_f32_16x16x32_bf16 v[192:195], v[32:35], v[92:95], v[192:195]
    v_mfma_f32_16x16x32_bf16 v[196:199], v[36:39], v[92:95], v[196:199]
    ds_read_b64_tr_b16 v[16:17], v4 offset:0
    v_mfma_f32_16x16x32_bf16 v[200:203], v[40:43], v[92:95], v[200:203]
    ds_read_b64_tr_b16 v[18:19], v4 offset:2048
    v_mfma_f32_16x16x32_bf16 v[204:207], v[44:47], v[92:95], v[204:207]
    ds_read_b64_tr_b16 v[20:21], v5 offset:0
    s_add_u32 s19, s38, s44
    buffer_load_dwordx4 v[92:95], v1, s[28:31], s19 offen
    s_waitcnt vmcnt(27)
    v_mfma_f32_16x16x32_bf16 v[208:211], v[32:35], v[88:91], v[208:211]
    ds_read_b64_tr_b16 v[22:23], v5 offset:2048
    v_mfma_f32_16x16x32_bf16 v[212:215], v[36:39], v[88:91], v[212:215]
    ds_read_b64_tr_b16 v[24:25], v6 offset:0
    v_mfma_f32_16x16x32_bf16 v[216:219], v[40:43], v[88:91], v[216:219]
    ds_read_b64_tr_b16 v[26:27], v6 offset:2048
    v_mfma_f32_16x16x32_bf16 v[220:223], v[44:47], v[88:91], v[220:223]
    ds_read_b64_tr_b16 v[28:29], v7 offset:0
    s_add_u32 s20, s38, s45
    buffer_load_dwordx4 v[88:91], v1, s[28:31], s20 offen
    s_waitcnt vmcnt(27)
    v_mfma_f32_16x16x32_bf16 v[224:227], v[32:35], v[84:87], v[224:227]
    ds_read_b64_tr_b16 v[30:31], v7 offset:2048
    v_mfma_f32_16x16x32_bf16 v[228:231], v[36:39], v[84:87], v[228:231]
    v_mfma_f32_16x16x32_bf16 v[232:235], v[40:43], v[84:87], v[232:235]
    v_mfma_f32_16x16x32_bf16 v[236:239], v[44:47], v[84:87], v[236:239]
    s_add_u32 s19, s38, s46
    buffer_load_dwordx4 v[84:87], v1, s[28:31], s19 offen
    s_waitcnt vmcnt(27)
    v_mfma_f32_16x16x32_bf16 v[240:243], v[32:35], v[80:83], v[240:243]
    v_mfma_f32_16x16x32_bf16 v[244:247], v[36:39], v[80:83], v[244:247]
    v_mfma_f32_16x16x32_bf16 v[248:251], v[40:43], v[80:83], v[248:251]
    v_mfma_f32_16x16x32_bf16 v[252:255], v[44:47], v[80:83], v[252:255]
    s_waitcnt lgkmcnt(0)
    s_add_u32 s20, s38, s47
    buffer_load_dwordx4 v[80:83], v1, s[28:31], s20 offen
    s_waitcnt vmcnt(27)
    v_mfma_f32_16x16x32_bf16 v[128:131], v[16:19], v[76:79], v[128:131]
    s_add_u32 m0, s42, 12288
    s_nop 0
    global_load_lds_dwordx4 v2, s[40:41]
    v_mfma_f32_16x16x32_bf16 v[132:135], v[20:23], v[76:79], v[132:135]
    s_add_u32 m0, s42, 13312
    s_nop 0
    global_load_lds_dwordx4 v2, s[56:57]
    v_mfma_f32_16x16x32_bf16 v[136:139], v[24:27], v[76:79], v[136:139]
    s_add_u32 m0, s42, 14336
    s_nop 0
    global_load_lds_dwordx4 v3, s[40:41]
    v_mfma_f32_16x16x32_bf16 v[140:143], v[28:31], v[76:79], v[140:143]
    s_add_u32 m0, s42, 15360
    s_nop 0
    global_load_lds_dwordx4 v3, s[56:57]
    s_mov_b64 s[40:41], s[6:7]
    s_add_u32 s56, s6, 16384
    s_addc_u32 s57, s7, 0
    s_add_u32 s19, s38, s48
    buffer_load_dwordx4 v[76:79], v1, s[28:31], s19 offen
    s_waitcnt vmcnt(31)
    v_mfma_f32_16x16x32_bf16 v[144:147], v[16:19], v[72:75], v[144:147]
    v_mfma_f32_16x16x32_bf16 v[148:151], v[20:23], v[72:75], v[148:151]
    v_mfma_f32_16x16x32_bf16 v[152:155], v[24:27], v[72:75], v[152:155]
    v_mfma_f32_16x16x32_bf16 v[156:159], v[28:31], v[72:75], v[156:159]
    s_add_u32 s20, s38, s49
    buffer_load_dwordx4 v[72:75], v1, s[28:31], s20 offen
    s_waitcnt vmcnt(31)
    v_mfma_f32_16x16x32_bf16 v[160:163], v[16:19], v[68:71], v[160:163]
    v_mfma_f32_16x16x32_bf16 v[164:167], v[20:23], v[68:71], v[164:167]
    v_mfma_f32_16x16x32_bf16 v[168:171], v[24:27], v[68:71], v[168:171]
    v_mfma_f32_16x16x32_bf16 v[172:175], v[28:31], v[68:71], v[172:175]
    s_add_u32 s19, s38, s50
    buffer_load_dwordx4 v[68:71], v1, s[28:31], s19 offen
    s_waitcnt vmcnt(31)
    v_mfma_f32_16x16x32_bf16 v[176:179], v[16:19], v[64:67], v[176:179]
    v_mfma_f32_16x16x32_bf16 v[180:183], v[20:23], v[64:67], v[180:183]
    v_mfma_f32_16x16x32_bf16 v[184:187], v[24:27], v[64:67], v[184:187]
    v_mfma_f32_16x16x32_bf16 v[188:191], v[28:31], v[64:67], v[188:191]
    s_add_u32 s20, s38, s51
    buffer_load_dwordx4 v[64:67], v1, s[28:31], s20 offen
    s_add_u32 s58, s58, 1
    s_cmp_eq_u32 s58, 28
    s_cselect_b32 s58, 0, s58
    s_lshl_b32 s38, s58, 12
    s_add_u32 s38, s38, s60
    s_waitcnt vmcnt(27)
    v_mfma_f32_16x16x32_bf16 v[192:195], v[16:19], v[60:63], v[192:195]
    v_mfma_f32_16x16x32_bf16 v[196:199], v[20:23], v[60:63], v[196:199]
    ds_read_b64_tr_b16 v[32:33], v4 offset:4096
    v_mfma_f32_16x16x32_bf16 v[200:203], v[24:27], v[60:63], v[200:203]
    ds_read_b64_tr_b16 v[34:35], v4 offset:6144
    v_mfma_f32_16x16x32_bf16 v[204:207], v[28:31], v[60:63], v[204:207]
    ds_read_b64_tr_b16 v[36:37], v5 offset:4096
    s_add_u32 s19, s38, s44
    buffer_load_dwordx4 v[60:63], v1, s[28:31], s19 offen
    s_waitcnt vmcnt(27)
    v_mfma_f32_16x16x32_bf16 v[208:211], v[16:19], v[56:59], v[208:211]
    ds_read_b64_tr_b16 v[38:39], v5 offset:6144
    v_mfma_f32_16x16x32_bf16 v[212:215], v[20:23], v[56:59], v[212:215]
    ds_read_b64_tr_b16 v[40:41], v6 offset:4096
    v_mfma_f32_16x16x32_bf16 v[216:219], v[24:27], v[56:59], v[216:219]
    ds_read_b64_tr_b16 v[42:43], v6 offset:6144
    v_mfma_f32_16x16x32_bf16 v[220:223], v[28:31], v[56:59], v[220:223]
    ds_read_b64_tr_b16 v[44:45], v7 offset:4096
    s_add_u32 s20, s38, s45
    buffer_load_dwordx4 v[56:59], v1, s[28:31], s20 offen
    s_waitcnt vmcnt(27)
    v_mfma_f32_16x16x32_bf16 v[224:227], v[16:19], v[52:55], v[224:227]
    ds_read_b64_tr_b16 v[46:47], v7 offset:6144
    v_mfma_f32_16x16x32_bf16 v[228:231], v[20:23], v[52:55], v[228:231]
    v_mfma_f32_16x16x32_bf16 v[232:235], v[24:27], v[52:55], v[232:235]
    v_mfma_f32_16x16x32_bf16 v[236:239], v[28:31], v[52:55], v[236:239]
    s_add_u32 s19, s38, s46
    buffer_load_dwordx4 v[52:55], v1, s[28:31], s19 offen
    s_waitcnt vmcnt(27)
    v_mfma_f32_16x16x32_bf16 v[240:243], v[16:19], v[48:51], v[240:243]
    v_mfma_f32_16x16x32_bf16 v[244:247], v[20:23], v[48:51], v[244:247]
    v_mfma_f32_16x16x32_bf16 v[248:251], v[24:27], v[48:51], v[248:251]
    v_mfma_f32_16x16x32_bf16 v[252:255], v[28:31], v[48:51], v[252:255]
    global_load_dwordx2 v[12:13], v11, s[4:5] sc1
    s_waitcnt lgkmcnt(0)
    s_add_u32 s20, s38, s47
    buffer_load_dwordx4 v[48:51], v1, s[28:31], s20 offen
    s_waitcnt vmcnt(28)
    v_mfma_f32_16x16x32_bf16 v[128:131], v[32:35], v[124:127], v[128:131]
    s_add_u32 m0, s42, 0
    s_nop 0
    global_load_lds_dwordx4 v2, s[40:41]
    v_mfma_f32_16x16x32_bf16 v[132:135], v[36:39], v[124:127], v[132:135]
    s_add_u32 m0, s42, 1024
    s_nop 0
    global_load_lds_dwordx4 v2, s[56:57]
    v_mfma_f32_16x16x32_bf16 v[136:139], v[40:43], v[124:127], v[136:139]
    s_add_u32 m0, s42, 2048
    s_nop 0
    global_load_lds_dwordx4 v3, s[40:41]
    v_mfma_f32_16x16x32_bf16 v[140:143], v[44:47], v[124:127], v[140:143]
    s_add_u32 m0, s42, 3072
    s_nop 0
    global_load_lds_dwordx4 v3, s[56:57]
    s_add_u32 s40, s40, 262144
    s_addc_u32 s41, s41, 0
    s_add_u32 s56, s56, 262144
    s_addc_u32 s57, s57, 0
    s_add_u32 s19, s38, s48
    buffer_load_dwordx4 v[124:127], v1, s[28:31], s19 offen
    s_waitcnt vmcnt(32)
    v_mfma_f32_16x16x32_bf16 v[144:147], v[32:35], v[120:123], v[144:147]
    v_mfma_f32_16x16x32_bf16 v[148:151], v[36:39], v[120:123], v[148:151]
    v_mfma_f32_16x16x32_bf16 v[152:155], v[40:43], v[120:123], v[152:155]
    v_mfma_f32_16x16x32_bf16 v[156:159], v[44:47], v[120:123], v[156:159]
    s_add_u32 s20, s38, s49
    buffer_load_dwordx4 v[120:123], v1, s[28:31], s20 offen
    s_waitcnt vmcnt(32)
    v_mfma_f32_16x16x32_bf16 v[160:163], v[32:35], v[116:119], v[160:163]
    v_mfma_f32_16x16x32_bf16 v[164:167], v[36:39], v[116:119], v[164:167]
    v_mfma_f32_16x16x32_bf16 v[168:171], v[40:43], v[116:119], v[168:171]
    v_mfma_f32_16x16x32_bf16 v[172:175], v[44:47], v[116:119], v[172:175]
    s_add_u32 s19, s38, s50
    buffer_load_dwordx4 v[116:119], v1, s[28:31], s19 offen
    s_waitcnt vmcnt(32)
    v_mfma_f32_16x16x32_bf16 v[176:179], v[32:35], v[112:115], v[176:179]
    v_mfma_f32_16x16x32_bf16 v[180:183], v[36:39], v[112:115], v[180:183]
    v_mfma_f32_16x16x32_bf16 v[184:187], v[40:43], v[112:115], v[184:187]
    v_mfma_f32_16x16x32_bf16 v[188:191], v[44:47], v[112:115], v[188:191]
    s_add_u32 s20, s38, s51
    buffer_load_dwordx4 v[112:115], v1, s[28:31], s20 offen
    s_lshl_b32 s38, s18, 10
    s_waitcnt vmcnt(28)
    v_mfma_f32_16x16x32_bf16 v[192:195], v[32:35], v[108:111], v[192:195]
    v_mfma_f32_16x16x32_bf16 v[196:199], v[36:39], v[108:111], v[196:199]
    ds_read_b64_tr_b16 v[16:17], v4 offset:8192
    v_mfma_f32_16x16x32_bf16 v[200:203], v[40:43], v[108:111], v[200:203]
    ds_read_b64_tr_b16 v[18:19], v4 offset:10240
    v_mfma_f32_16x16x32_bf16 v[204:207], v[44:47], v[108:111], v[204:207]
    ds_read_b64_tr_b16 v[20:21], v5 offset:8192
    s_waitcnt vmcnt(27)
    v_mfma_f32_16x16x32_bf16 v[208:211], v[32:35], v[104:107], v[208:211]
    ds_read_b64_tr_b16 v[22:23], v5 offset:10240
    v_mfma_f32_16x16x32_bf16 v[212:215], v[36:39], v[104:107], v[212:215]
    ds_read_b64_tr_b16 v[24:25], v6 offset:8192
    v_mfma_f32_16x16x32_bf16 v[216:219], v[40:43], v[104:107], v[216:219]
    ds_read_b64_tr_b16 v[26:27], v6 offset:10240
    v_mfma_f32_16x16x32_bf16 v[220:223], v[44:47], v[104:107], v[220:223]
    ds_read_b64_tr_b16 v[28:29], v7 offset:8192
    s_waitcnt vmcnt(26)
    v_mfma_f32_16x16x32_bf16 v[224:227], v[32:35], v[100:103], v[224:227]
    ds_read_b64_tr_b16 v[30:31], v7 offset:10240
    v_mfma_f32_16x16x32_bf16 v[228:231], v[36:39], v[100:103], v[228:231]
    v_mfma_f32_16x16x32_bf16 v[232:235], v[40:43], v[100:103], v[232:235]
    v_mfma_f32_16x16x32_bf16 v[236:239], v[44:47], v[100:103], v[236:239]
    s_waitcnt vmcnt(25)
    v_mfma_f32_16x16x32_bf16 v[240:243], v[32:35], v[96:99], v[240:243]
    v_mfma_f32_16x16x32_bf16 v[244:247], v[36:39], v[96:99], v[244:247]
    v_mfma_f32_16x16x32_bf16 v[248:251], v[40:43], v[96:99], v[248:251]
    v_mfma_f32_16x16x32_bf16 v[252:255], v[44:47], v[96:99], v[252:255]
    s_waitcnt lgkmcnt(0)
    s_waitcnt vmcnt(24)
    v_mfma_f32_16x16x32_bf16 v[128:131], v[16:19], v[92:95], v[128:131]
    s_add_u32 m0, s42, 4096
    s_nop 0
    global_load_lds_dwordx4 v2, s[40:41]
    v_mfma_f32_16x16x32_bf16 v[132:135], v[20:23], v[92:95], v[132:135]
    s_add_u32 m0, s42, 5120
    s_nop 0
    global_load_lds_dwordx4 v2, s[56:57]
    v_mfma_f32_16x16x32_bf16 v[136:139], v[24:27], v[92:95], v[136:139]
    s_add_u32 m0, s42, 6144
    s_nop 0
    global_load_lds_dwordx4 v3, s[40:41]
    v_mfma_f32_16x16x32_bf16 v[140:143], v[28:31], v[92:95], v[140:143]
    s_add_u32 m0, s42, 7168
    s_nop 0
    global_load_lds_dwordx4 v3, s[56:57]
    s_add_u32 s40, s40, 262144
    s_addc_u32 s41, s41, 0
    s_add_u32 s56, s56, 262144
    s_addc_u32 s57, s57, 0
    s_waitcnt vmcnt(27)
    v_mfma_f32_16x16x32_bf16 v[144:147], v[16:19], v[88:91], v[144:147]
    v_mfma_f32_16x16x32_bf16 v[148:151], v[20:23], v[88:91], v[148:151]
    v_mfma_f32_16x16x32_bf16 v[152:155], v[24:27], v[88:91], v[152:155]
    v_mfma_f32_16x16x32_bf16 v[156:159], v[28:31], v[88:91], v[156:159]
    s_waitcnt vmcnt(26)
    v_mfma_f32_16x16x32_bf16 v[160:163], v[16:19], v[84:87], v[160:163]
    v_mfma_f32_16x16x32_bf16 v[164:167], v[20:23], v[84:87], v[164:167]
    v_mfma_f32_16x16x32_bf16 v[168:171], v[24:27], v[84:87], v[168:171]
    v_mfma_f32_16x16x32_bf16 v[172:175], v[28:31], v[84:87], v[172:175]
    s_waitcnt vmcnt(25)
    v_mfma_f32_16x16x32_bf16 v[176:179], v[16:19], v[80:83], v[176:179]
    v_mfma_f32_16x16x32_bf16 v[180:183], v[20:23], v[80:83], v[180:183]
    v_mfma_f32_16x16x32_bf16 v[184:187], v[24:27], v[80:83], v[184:187]
    v_mfma_f32_16x16x32_bf16 v[188:191], v[28:31], v[80:83], v[188:191]
    s_waitcnt vmcnt(13)
    v_cmp_ne_u32 vcc, 0, v12
    v_cmp_ne_u32 s[22:23], 0, v13
    s_and_b64 s[22:23], s[22:23], vcc
    s_cmp_eq_u64 s[22:23], -1
    s_cbranch_scc1 K23_OK_9
    s_mov_b32 s21, 0
K23_SL_10:
    s_add_u32 s21, s21, 1
    s_cmp_ge_u32 s21, 0x40000
    s_cbranch_scc1 K23_OK_9
    s_sleep 4
    global_load_dwordx2 v[12:13], v11, s[4:5] sc1
    s_waitcnt vmcnt(0)
    v_cmp_ne_u32 vcc, 0, v12
    v_cmp_ne_u32 s[22:23], 0, v13
    s_and_b64 s[22:23], s[22:23], vcc
    s_cmp_eq_u64 s[22:23], -1
    s_cbranch_scc0 K23_SL_10
K23_OK_9:
    s_mov_b32 s21, 0x2400000
    buffer_load_dword v8, v15, s[28:31], s21 offen offset:0 sc1
    buffer_load_dword v9, v15, s[28:31], s21 offen offset:64 sc1
    s_add_u32 s19, s38, s44
    buffer_load_dwordx4 v[92:95], v1, s[28:31], s19 offen sc1
    s_add_u32 s20, s38, s45
    buffer_load_dwordx4 v[88:91], v1, s[28:31], s20 offen sc1
    s_add_u32 s19, s38, s46
    buffer_load_dwordx4 v[84:87], v1, s[28:31], s19 offen sc1
    s_add_u32 s20, s38, s47
    buffer_load_dwordx4 v[80:83], v1, s[28:31], s20 offen sc1
    v_mfma_f32_16x16x32_bf16 v[192:195], v[16:19], v[76:79], v[192:195]
    v_mfma_f32_16x16x32_bf16 v[196:199], v[20:23], v[76:79], v[196:199]
    ds_read_b64_tr_b16 v[32:33], v4 offset:12288
    v_mfma_f32_16x16x32_bf16 v[200:203], v[24:27], v[76:79], v[200:203]
    ds_read_b64_tr_b16 v[34:35], v4 offset:14336
    v_mfma_f32_16x16x32_bf16 v[204:207], v[28:31], v[76:79], v[204:207]
    ds_read_b64_tr_b16 v[36:37], v5 offset:12288
    s_add_u32 s19, s38, s48
    buffer_load_dwordx4 v[76:79], v1, s[28:31], s19 offen sc1
    v_mfma_f32_16x16x32_bf16 v[208:211], v[16:19], v[72:75], v[208:211]
    ds_read_b64_tr_b16 v[38:39], v5 offset:14336
    v_mfma_f32_16x16x32_bf16 v[212:215], v[20:23], v[72:75], v[212:215]
    ds_read_b64_tr_b16 v[40:41], v6 offset:12288
    v_mfma_f32_16x16x32_bf16 v[216:219], v[24:27], v[72:75], v[216:219]
    ds_read_b64_tr_b16 v[42:43], v6 offset:14336
    v_mfma_f32_16x16x32_bf16 v[220:223], v[28:31], v[72:75], v[220:223]
    ds_read_b64_tr_b16 v[44:45], v7 offset:12288
    s_add_u32 s20, s38, s49
    buffer_load_dwordx4 v[72:75], v1, s[28:31], s20 offen sc1
    v_mfma_f32_16x16x32_bf16 v[224:227], v[16:19], v[68:71], v[224:227]
    ds_read_b64_tr_b16 v[46:47], v7 offset:14336
    v_mfma_f32_16x16x32_bf16 v[228:231], v[20:23], v[68:71], v[228:231]
    v_mfma_f32_16x16x32_bf16 v[232:235], v[24:27], v[68:71], v[232:235]
    v_mfma_f32_16x16x32_bf16 v[236:239], v[28:31], v[68:71], v[236:239]
    s_add_u32 s19, s38, s50
    buffer_load_dwordx4 v[68:71], v1, s[28:31], s19 offen sc1
    v_mfma_f32_16x16x32_bf16 v[240:243], v[16:19], v[64:67], v[240:243]
    v_mfma_f32_16x16x32_bf16 v[244:247], v[20:23], v[64:67], v[244:247]
    v_mfma_f32_16x16x32_bf16 v[248:251], v[24:27], v[64:67], v[248:251]
    v_mfma_f32_16x16x32_bf16 v[252:255], v[28:31], v[64:67], v[252:255]
    s_waitcnt lgkmcnt(0)
    s_add_u32 s20, s38, s51
    buffer_load_dwordx4 v[64:67], v1, s[28:31], s20 offen sc1
    s_add_u32 s38, s38, 4096
    v_mfma_f32_16x16x32_bf16 v[128:131], v[32:35], v[60:63], v[128:131]
    s_add_u32 m0, s42, 8192
    s_nop 0
    global_load_lds_dwordx4 v2, s[40:41]
    v_mfma_f32_16x16x32_bf16 v[132:135], v[36:39], v[60:63], v[132:135]
    s_add_u32 m0, s42, 9216
    s_nop 0
    global_load_lds_dwordx4 v2, s[56:57]
    v_mfma_f32_16x16x32_bf16 v[136:139], v[40:43], v[60:63], v[136:139]
    s_add_u32 m0, s42, 10240
    s_nop 0
    global_load_lds_dwordx4 v3, s[40:41]
    v_mfma_f32_16x16x32_bf16 v[140:143], v[44:47], v[60:63], v[140:143]
    s_add_u32 m0, s42, 11264
    s_nop 0
    global_load_lds_dwordx4 v3, s[56:57]
    s_add_u32 s40, s40, 262144
    s_addc_u32 s41, s41, 0
    s_add_u32 s56, s56, 262144
    s_addc_u32 s57, s57, 0
    s_add_u32 s19, s38, s44
    buffer_load_dwordx4 v[60:63], v1, s[28:31], s19 offen sc1
    v_mfma_f32_16x16x32_bf16 v[144:147], v[32:35], v[56:59], v[144:147]
    v_mfma_f32_16x16x32_bf16 v[148:151], v[36:39], v[56:59], v[148:151]
    v_mfma_f32_16x16x32_bf16 v[152:155], v[40:43], v[56:59], v[152:155]
    v_mfma_f32_16x16x32_bf16 v[156:159], v[44:47], v[56:59], v[156:159]
    s_add_u32 s20, s38, s45
    buffer_load_dwordx4 v[56:59], v1, s[28:31], s20 offen sc1
    v_mfma_f32_16x16x32_bf16 v[160:163], v[32:35], v[52:55], v[160:163]
    v_mfma_f32_16x16x32_bf16 v[164:167], v[36:39], v[52:55], v[164:167]
    v_mfma_f32_16x16x32_bf16 v[168:171], v[40:43], v[52:55], v[168:171]
    v_mfma_f32_16x16x32_bf16 v[172:175], v[44:47], v[52:55], v[172:175]
    s_add_u32 s19, s38, s46
    buffer_load_dwordx4 v[52:55], v1, s[28:31], s19 offen sc1
    s_waitcnt vmcnt(29)
    v_mfma_f32_16x16x32_bf16 v[176:179], v[32:35], v[48:51], v[176:179]
    v_mfma_f32_16x16x32_bf16 v[180:183], v[36:39], v[48:51], v[180:183]
    v_mfma_f32_16x16x32_bf16 v[184:187], v[40:43], v[48:51], v[184:187]
    v_mfma_f32_16x16x32_bf16 v[188:191], v[44:47], v[48:51], v[188:191]
    s_add_u32 s20, s38, s47
    buffer_load_dwordx4 v[48:51], v1, s[28:31], s20 offen sc1
    s_waitcnt vmcnt(25)
    v_mfma_f32_16x16x32_bf16 v[192:195], v[32:35], v[124:127], v[192:195]
    v_mfma_f32_16x16x32_bf16 v[196:199], v[36:39], v[124:127], v[196:199]
    ds_read_b64_tr_b16 v[16:17], v4 offset:0
    v_mfma_f32_16x16x32_bf16 v[200:203], v[40:43], v[124:127], v[200:203]
    ds_read_b64_tr_b16 v[18:19], v4 offset:2048
    v_mfma_f32_16x16x32_bf16 v[204:207], v[44:47], v[124:127], v[204:207]
    ds_read_b64_tr_b16 v[20:21], v5 offset:0
    s_waitcnt vmcnt(24)
    v_mfma_f32_16x16x32_bf16 v[208:211], v[32:35], v[120:123], v[208:211]
    ds_read_b64_tr_b16 v[22:23], v5 offset:2048
    v_mfma_f32_16x16x32_bf16 v[212:215], v[36:39], v[120:123], v[212:215]
    ds_read_b64_tr_b16 v[24:25], v6 offset:0
    v_mfma_f32_16x16x32_bf16 v[216:219], v[40:43], v[120:123], v[216:219]
    ds_read_b64_tr_b16 v[26:27], v6 offset:2048
    v_mfma_f32_16x16x32_bf16 v[220:223], v[44:47], v[120:123], v[220:223]
    ds_read_b64_tr_b16 v[28:29], v7 offset:0
    s_waitcnt vmcnt(23)
    v_mfma_f32_16x16x32_bf16 v[224:227], v[32:35], v[116:119], v[224:227]
    ds_read_b64_tr_b16 v[30:31], v7 offset:2048
    v_mfma_f32_16x16x32_bf16 v[228:231], v[36:39], v[116:119], v[228:231]
    v_mfma_f32_16x16x32_bf16 v[232:235], v[40:43], v[116:119], v[232:235]
    v_mfma_f32_16x16x32_bf16 v[236:239], v[44:47], v[116:119], v[236:239]
    s_waitcnt vmcnt(22)
    v_mfma_f32_16x16x32_bf16 v[240:243], v[32:35], v[112:115], v[240:243]
    v_mfma_f32_16x16x32_bf16 v[244:247], v[36:39], v[112:115], v[244:247]
    v_mfma_f32_16x16x32_bf16 v[248:251], v[40:43], v[112:115], v[248:251]
    v_mfma_f32_16x16x32_bf16 v[252:255], v[44:47], v[112:115], v[252:255]
    s_nop 7
    s_barrier
    v_add_u32 v12, s52, v1
    ds_write_b128 v12, v[160:163] offset:0
    ds_write_b128 v12, v[164:167] offset:1024
    ds_write_b128 v12, v[168:171] offset:2048
    ds_write_b128 v12, v[172:175] offset:3072
    ds_write_b128 v12, v[176:179] offset:4096
    ds_write_b128 v12, v[180:183] offset:5120
    ds_write_b128 v12, v[184:187] offset:6144
    ds_write_b128 v12, v[188:191] offset:7168
    v_add_u32 v12, s53, v1
    ds_write_b128 v12, v[192:195] offset:0
    ds_write_b128 v12, v[196:199] offset:1024
    ds_write_b128 v12, v[200:203] offset:2048
    ds_write_b128 v12, v[204:207] offset:3072
    ds_write_b128 v12, v[208:211] offset:4096
    ds_write_b128 v12, v[212:215] offset:5120
    ds_write_b128 v12, v[216:219] offset:6144
    ds_write_b128 v12, v[220:223] offset:7168
    v_add_u32 v12, s54, v1
    ds_write_b128 v12, v[224:227] offset:0
    ds_write_b128 v12, v[228:231] offset:1024
    ds_write_b128 v12, v[232:235] offset:2048
    ds_write_b128 v12, v[236:239] offset:3072
    ds_write_b128 v12, v[240:243] offset:4096
    ds_write_b128 v12, v[244:247] offset:5120
    ds_write_b128 v12, v[248:251] offset:6144
    ds_write_b128 v12, v[252:255] offset:7168
    s_waitcnt lgkmcnt(0)
    s_barrier
    ds_read_b128 v[160:163], v14 offset:0
    ds_read_b128 v[164:167], v14 offset:1024
    ds_read_b128 v[168:171], v14 offset:2048
    ds_read_b128 v[172:175], v14 offset:3072
    ds_read_b128 v[176:179], v14 offset:4096
    ds_read_b128 v[180:183], v14 offset:5120
    ds_read_b128 v[184:187], v14 offset:6144
    ds_read_b128 v[188:191], v14 offset:7168
    ds_read_b128 v[192:195], v14 offset:8192
    ds_read_b128 v[196:199], v14 offset:9216
    ds_read_b128 v[200:203], v14 offset:10240
    ds_read_b128 v[204:207], v14 offset:11264
    ds_read_b128 v[208:211], v14 offset:12288
    ds_read_b128 v[212:215], v14 offset:13312
    ds_read_b128 v[216:219], v14 offset:14336
    ds_read_b128 v[220:223], v14 offset:15360
    ds_read_b128 v[224:227], v14 offset:16384
    ds_read_b128 v[228:231], v14 offset:17408
    ds_read_b128 v[232:235], v14 offset:18432
    ds_read_b128 v[236:239], v14 offset:19456
    ds_read_b128 v[240:243], v14 offset:20480
    ds_read_b128 v[244:247], v14 offset:21504
    ds_read_b128 v[248:251], v14 offset:22528
    ds_read_b128 v[252:255], v14 offset:23552
    s_waitcnt lgkmcnt(15)
    v_pk_add_f32 v[96:97], v[128:129], v[160:161]
    v_pk_add_f32 v[98:99], v[130:131], v[162:163]
    v_pk_add_f32 v[100:101], v[132:133], v[164:165]
    v_pk_add_f32 v[102:103], v[134:135], v[166:167]
    v_pk_add_f32 v[104:105], v[136:137], v[168:169]
    v_pk_add_f32 v[106:107], v[138:139], v[170:171]
    v_pk_add_f32 v[108:109], v[140:141], v[172:173]
    v_pk_add_f32 v[110:111], v[142:143], v[174:175]
    v_pk_add_f32 v[112:113], v[144:145], v[176:177]
    v_pk_add_f32 v[114:115], v[146:147], v[178:179]
    v_pk_add_f32 v[116:117], v[148:149], v[180:181]
    v_pk_add_f32 v[118:119], v[150:151], v[182:183]
    v_pk_add_f32 v[120:121], v[152:153], v[184:185]
    v_pk_add_f32 v[122:123], v[154:155], v[186:187]
    v_pk_add_f32 v[124:125], v[156:157], v[188:189]
    v_pk_add_f32 v[126:127], v[158:159], v[190:191]
    s_waitcnt lgkmcnt(8)
    v_pk_add_f32 v[96:97], v[96:97], v[192:193]
    v_pk_add_f32 v[98:99], v[98:99], v[194:195]
    v_pk_add_f32 v[100:101], v[100:101], v[196:197]
    v_pk_add_f32 v[102:103], v[102:103], v[198:199]
    v_pk_add_f32 v[104:105], v[104:105], v[200:201]
    v_pk_add_f32 v[106:107], v[106:107], v[202:203]
    v_pk_add_f32 v[108:109], v[108:109], v[204:205]
    v_pk_add_f32 v[110:111], v[110:111], v[206:207]
    v_pk_add_f32 v[112:113], v[112:113], v[208:209]
    v_pk_add_f32 v[114:115], v[114:115], v[210:211]
    v_pk_add_f32 v[116:117], v[116:117], v[212:213]
    v_pk_add_f32 v[118:119], v[118:119], v[214:215]
    v_pk_add_f32 v[120:121], v[120:121], v[216:217]
    v_pk_add_f32 v[122:123], v[122:123], v[218:219]
    v_pk_add_f32 v[124:125], v[124:125], v[220:221]
    v_pk_add_f32 v[126:127], v[126:127], v[222:223]
    s_waitcnt lgkmcnt(0)
    v_pk_add_f32 v[96:97], v[96:97], v[224:225]
    v_pk_add_f32 v[98:99], v[98:99], v[226:227]
    v_pk_add_f32 v[100:101], v[100:101], v[228:229]
    v_pk_add_f32 v[102:103], v[102:103], v[230:231]
    v_pk_add_f32 v[104:105], v[104:105], v[232:233]
    v_pk_add_f32 v[106:107], v[106:107], v[234:235]
    v_pk_add_f32 v[108:109], v[108:109], v[236:237]
    v_pk_add_f32 v[110:111], v[110:111], v[238:239]
    v_pk_add_f32 v[112:113], v[112:113], v[240:241]
    v_pk_add_f32 v[114:115], v[114:115], v[242:243]
    v_pk_add_f32 v[116:117], v[116:117], v[244:245]
    v_pk_add_f32 v[118:119], v[118:119], v[246:247]
    v_pk_add_f32 v[120:121], v[120:121], v[248:249]
    v_pk_add_f32 v[122:123], v[122:123], v[250:251]
    v_pk_add_f32 v[124:125], v[124:125], v[252:253]
    v_pk_add_f32 v[126:127], v[126:127], v[254:255]
    s_waitcnt vmcnt(15)
    v_mfma_f32_16x16x32_bf16 v[128:131], v[16:19], v[92:95], 0
    s_add_u32 m0, s42, 12288
    s_nop 0
    global_load_lds_dwordx4 v2, s[40:41]
    v_mfma_f32_16x16x32_bf16 v[132:135], v[20:23], v[92:95], 0
    s_add_u32 m0, s42, 13312
    s_nop 0
    global_load_lds_dwordx4 v2, s[56:57]
    v_mfma_f32_16x16x32_bf16 v[136:139], v[24:27], v[92:95], 0
    s_add_u32 m0, s42, 14336
    s_nop 0
    global_load_lds_dwordx4 v3, s[40:41]
    v_mfma_f32_16x16x32_bf16 v[140:143], v[28:31], v[92:95], 0
    s_add_u32 m0, s42, 15360
    s_nop 0
    global_load_lds_dwordx4 v3, s[56:57]
    s_add_u32 s40, s40, 262144
    s_addc_u32 s41, s41, 0
    s_add_u32 s56, s56, 262144
    s_addc_u32 s57, s57, 0
    s_add_u32 s19, s38, s48
    buffer_load_dwordx4 v[92:95], v1, s[28:31], s19 offen sc1
    s_waitcnt vmcnt(19)
    v_mfma_f32_16x16x32_bf16 v[144:147], v[16:19], v[88:91], 0
    v_mfma_f32_16x16x32_bf16 v[148:151], v[20:23], v[88:91], 0
    v_mfma_f32_16x16x32_bf16 v[152:155], v[24:27], v[88:91], 0
    v_mfma_f32_16x16x32_bf16 v[156:159], v[28:31], v[88:91], 0
    s_add_u32 s20, s38, s49
    buffer_load_dwordx4 v[88:91], v1, s[28:31], s20 offen sc1
    s_waitcnt vmcnt(19)
    v_mfma_f32_16x16x32_bf16 v[160:163], v[16:19], v[84:87], 0
    v_mfma_f32_16x16x32_bf16 v[164:167], v[20:23], v[84:87], 0
    v_mfma_f32_16x16x32_bf16 v[168:171], v[24:27], v[84:87], 0
    v_mfma_f32_16x16x32_bf16 v[172:175], v[28:31], v[84:87], 0
    s_add_u32 s19, s38, s50
    buffer_load_dwordx4 v[84:87], v1, s[28:31], s19 offen sc1
    s_waitcnt vmcnt(19)
    v_mfma_f32_16x16x32_bf16 v[176:179], v[16:19], v[80:83], 0
    v_mfma_f32_16x16x32_bf16 v[180:183], v[20:23], v[80:83], 0
    v_mfma_f32_16x16x32_bf16 v[184:187], v[24:27], v[80:83], 0
    v_mfma_f32_16x16x32_bf16 v[188:191], v[28:31], v[80:83], 0
    s_add_u32 s20, s38, s51
    buffer_load_dwordx4 v[80:83], v1, s[28:31], s20 offen sc1
    s_add_u32 s38, s38, 4096
    s_waitcnt vmcnt(19)
    v_mfma_f32_16x16x32_bf16 v[192:195], v[16:19], v[76:79], 0
    v_mfma_f32_16x16x32_bf16 v[196:199], v[20:23], v[76:79], 0
    ds_read_b64_tr_b16 v[32:33], v4 offset:4096
    v_mfma_f32_16x16x32_bf16 v[200:203], v[24:27], v[76:79], 0
    ds_read_b64_tr_b16 v[34:35], v4 offset:6144
    v_mfma_f32_16x16x32_bf16 v[204:207], v[28:31], v[76:79], 0
    ds_read_b64_tr_b16 v[36:37], v5 offset:4096
    s_add_u32 s19, s38, s44
    buffer_load_dwordx4 v[76:79], v1, s[28:31], s19 offen sc1
    s_waitcnt vmcnt(19)
    v_mfma_f32_16x16x32_bf16 v[208:211], v[16:19], v[72:75], 0
    ds_read_b64_tr_b16 v[38:39], v5 offset:6144
    v_mfma_f32_16x16x32_bf16 v[212:215], v[20:23], v[72:75], 0
    ds_read_b64_tr_b16 v[40:41], v6 offset:4096
    v_mfma_f32_16x16x32_bf16 v[216:219], v[24:27], v[72:75], 0
    ds_read_b64_tr_b16 v[42:43], v6 offset:6144
    v_mfma_f32_16x16x32_bf16 v[220:223], v[28:31], v[72:75], 0
    ds_read_b64_tr_b16 v[44:45], v7 offset:4096
    s_add_u32 s20, s38, s45
    buffer_load_dwordx4 v[72:75], v1, s[28:31], s20 offen sc1
    s_waitcnt vmcnt(19)
    v_mfma_f32_16x16x32_bf16 v[224:227], v[16:19], v[68:71], 0
    ds_read_b64_tr_b16 v[46:47], v7 offset:6144
    v_mfma_f32_16x16x32_bf16 v[228:231], v[20:23], v[68:71], 0
    v_mfma_f32_16x16x32_bf16 v[232:235], v[24:27], v[68:71], 0
    v_mfma_f32_16x16x32_bf16 v[236:239], v[28:31], v[68:71], 0
    s_add_u32 s19, s38, s46
    buffer_load_dwordx4 v[68:71], v1, s[28:31], s19 offen sc1
    s_waitcnt vmcnt(19)
    v_mfma_f32_16x16x32_bf16 v[240:243], v[16:19], v[64:67], 0
    v_mfma_f32_16x16x32_bf16 v[244:247], v[20:23], v[64:67], 0
    v_mfma_f32_16x16x32_bf16 v[248:251], v[24:27], v[64:67], 0
    v_mfma_f32_16x16x32_bf16 v[252:255], v[28:31], v[64:67], 0
    s_waitcnt lgkmcnt(0)
    s_add_u32 s20, s38, s47
    buffer_load_dwordx4 v[64:67], v1, s[28:31], s20 offen sc1
    s_waitcnt vmcnt(15)
    v_mfma_f32_16x16x32_bf16 v[128:131], v[32:35], v[60:63], v[128:131]
    s_add_u32 m0, s42, 0
    s_nop 0
    global_load_lds_dwordx4 v2, s[40:41]
    v_mfma_f32_16x16x32_bf16 v[132:135], v[36:39], v[60:63], v[132:135]
    s_add_u32 m0, s42, 1024
    s_nop 0
    global_load_lds_dwordx4 v2, s[56:57]
    v_mfma_f32_16x16x32_bf16 v[136:139], v[40:43], v[60:63], v[136:139]
    s_add_u32 m0, s42, 2048
    s_nop 0
    global_load_lds_dwordx4 v3, s[40:41]
    v_mfma_f32_16x16x32_bf16 v[140:143], v[44:47], v[60:63], v[140:143]
    s_add_u32 m0, s42, 3072
    s_nop 0
    global_load_lds_dwordx4 v3, s[56:57]
    s_add_u32 s40, s40, 262144
    s_addc_u32 s41, s41, 0
    s_add_u32 s56, s56, 262144
    s_addc_u32 s57, s57, 0
    s_add_u32 s19, s38, s48
    buffer_load_dwordx4 v[60:63], v1, s[28:31], s19 offen sc1
    s_waitcnt vmcnt(19)
    v_mfma_f32_16x16x32_bf16 v[144:147], v[32:35], v[56:59], v[144:147]
    v_mfma_f32_16x16x32_bf16 v[148:151], v[36:39], v[56:59], v[148:151]
    v_mfma_f32_16x16x32_bf16 v[152:155], v[40:43], v[56:59], v[152:155]
    v_mfma_f32_16x16x32_bf16 v[156:159], v[44:47], v[56:59], v[156:159]
    s_add_u32 s20, s38, s49
    buffer_load_dwordx4 v[56:59], v1, s[28:31], s20 offen sc1
    s_waitcnt vmcnt(19)
    v_mfma_f32_16x16x32_bf16 v[160:163], v[32:35], v[52:55], v[160:163]
    v_mfma_f32_16x16x32_bf16 v[164:167], v[36:39], v[52:55], v[164:167]
    v_mfma_f32_16x16x32_bf16 v[168:171], v[40:43], v[52:55], v[168:171]
    v_mfma_f32_16x16x32_bf16 v[172:175], v[44:47], v[52:55], v[172:175]
    s_add_u32 s19, s38, s50
    buffer_load_dwordx4 v[52:55], v1, s[28:31], s19 offen sc1
    s_waitcnt vmcnt(19)
    v_mfma_f32_16x16x32_bf16 v[176:179], v[32:35], v[48:51], v[176:179]
    v_mfma_f32_16x16x32_bf16 v[180:183], v[36:39], v[48:51], v[180:183]
    v_mfma_f32_16x16x32_bf16 v[184:187], v[40:43], v[48:51], v[184:187]
    v_mfma_f32_16x16x32_bf16 v[188:191], v[44:47], v[48:51], v[188:191]
    s_add_u32 s20, s38, s51
    buffer_load_dwordx4 v[48:51], v1, s[28:31], s20 offen sc1
    s_add_u32 s38, s38, 4096
    s_waitcnt vmcnt(15)
    v_mfma_f32_16x16x32_bf16 v[192:195], v[32:35], v[92:95], v[192:195]
    v_mfma_f32_16x16x32_bf16 v[196:199], v[36:39], v[92:95], v[196:199]
    ds_read_b64_tr_b16 v[16:17], v4 offset:8192
    v_mfma_f32_16x16x32_bf16 v[200:203], v[40:43], v[92:95], v[200:203]
    ds_read_b64_tr_b16 v[18:19], v4 offset:10240
    v_mfma_f32_16x16x32_bf16 v[204:207], v[44:47], v[92:95], v[204:207]
    ds_read_b64_tr_b16 v[20:21], v5 offset:8192
    s_add_u32 s19, s38, s44
    buffer_load_dwordx4 v[92:95], v1, s[28:31], s19 offen sc1
    s_waitcnt vmcnt(15)
    v_mfma_f32_16x16x32_bf16 v[208:211], v[32:35], v[88:91], v[208:211]
    ds_read_b64_tr_b16 v[22:23], v5 offset:10240
    v_mfma_f32_16x16x32_bf16 v[212:215], v[36:39], v[88:91], v[212:215]
    ds_read_b64_tr_b16 v[24:25], v6 offset:8192
    v_mfma_f32_16x16x32_bf16 v[216:219], v[40:43], v[88:91], v[216:219]
    ds_read_b64_tr_b16 v[26:27], v6 offset:10240
    v_mfma_f32_16x16x32_bf16 v[220:223], v[44:47], v[88:91], v[220:223]
    ds_read_b64_tr_b16 v[28:29], v7 offset:8192
    s_add_u32 s20, s38, s45
    buffer_load_dwordx4 v[88:91], v1, s[28:31], s20 offen sc1
    s_waitcnt vmcnt(15)
    v_mfma_f32_16x16x32_bf16 v[224:227], v[32:35], v[84:87], v[224:227]
    ds_read_b64_tr_b16 v[30:31], v7 offset:10240
    v_mfma_f32_16x16x32_bf16 v[228:231], v[36:39], v[84:87], v[228:231]
    v_mfma_f32_16x16x32_bf16 v[232:235], v[40:43], v[84:87], v[232:235]
    v_mfma_f32_16x16x32_bf16 v[236:239], v[44:47], v[84:87], v[236:239]
    s_add_u32 s19, s38, s46
    buffer_load_dwordx4 v[84:87], v1, s[28:31], s19 offen sc1
    s_waitcnt vmcnt(15)
    v_mfma_f32_16x16x32_bf16 v[240:243], v[32:35], v[80:83], v[240:243]
    v_mfma_f32_16x16x32_bf16 v[244:247], v[36:39], v[80:83], v[244:247]
    v_mfma_f32_16x16x32_bf16 v[248:251], v[40:43], v[80:83], v[248:251]
    v_mfma_f32_16x16x32_bf16 v[252:255], v[44:47], v[80:83], v[252:255]
    s_waitcnt lgkmcnt(0)
    s_add_u32 s20, s38, s47
    buffer_load_dwordx4 v[80:83], v1, s[28:31], s20 offen sc1
    s_waitcnt vmcnt(15)
    v_mfma_f32_16x16x32_bf16 v[128:131], v[16:19], v[76:79], v[128:131]
    s_add_u32 m0, s42, 4096
    s_nop 0
    global_load_lds_dwordx4 v2, s[40:41]
    v_mfma_f32_16x16x32_bf16 v[132:135], v[20:23], v[76:79], v[132:135]
    s_add_u32 m0, s42, 5120
    s_nop 0
    global_load_lds_dwordx4 v2, s[56:57]
    v_mfma_f32_16x16x32_bf16 v[136:139], v[24:27], v[76:79], v[136:139]
    s_add_u32 m0, s42, 6144
    s_nop 0
    global_load_lds_dwordx4 v3, s[40:41]
    v_mfma_f32_16x16x32_bf16 v[140:143], v[28:31], v[76:79], v[140:143]
    s_add_u32 m0, s42, 7168
    s_nop 0
    global_load_lds_dwordx4 v3, s[56:57]
    s_add_u32 s40, s40, 262144
    s_addc_u32 s41, s41, 0
    s_add_u32 s56, s56, 262144
    s_addc_u32 s57, s57, 0
    s_add_u32 s19, s38, s48
    buffer_load_dwordx4 v[76:79], v1, s[28:31], s19 offen sc1
    s_waitcnt vmcnt(19)
    v_mfma_f32_16x16x32_bf16 v[144:147], v[16:19], v[72:75], v[144:147]
    v_mfma_f32_16x16x32_bf16 v[148:151], v[20:23], v[72:75], v[148:151]
    v_mfma_f32_16x16x32_bf16 v[152:155], v[24:27], v[72:75], v[152:155]
    v_mfma_f32_16x16x32_bf16 v[156:159], v[28:31], v[72:75], v[156:159]
    s_add_u32 s20, s38, s49
    buffer_load_dwordx4 v[72:75], v1, s[28:31], s20 offen sc1
    s_waitcnt vmcnt(19)
    v_mfma_f32_16x16x32_bf16 v[160:163], v[16:19], v[68:71], v[160:163]
    v_mfma_f32_16x16x32_bf16 v[164:167], v[20:23], v[68:71], v[164:167]
    v_mfma_f32_16x16x32_bf16 v[168:171], v[24:27], v[68:71], v[168:171]
    v_mfma_f32_16x16x32_bf16 v[172:175], v[28:31], v[68:71], v[172:175]
    s_add_u32 s19, s38, s50
    buffer_load_dwordx4 v[68:71], v1, s[28:31], s19 offen sc1
    s_waitcnt vmcnt(19)
    v_mfma_f32_16x16x32_bf16 v[176:179], v[16:19], v[64:67], v[176:179]
    v_mfma_f32_16x16x32_bf16 v[180:183], v[20:23], v[64:67], v[180:183]
    v_mfma_f32_16x16x32_bf16 v[184:187], v[24:27], v[64:67], v[184:187]
    v_mfma_f32_16x16x32_bf16 v[188:191], v[28:31], v[64:67], v[188:191]
    s_add_u32 s20, s38, s51
    buffer_load_dwordx4 v[64:67], v1, s[28:31], s20 offen sc1
    s_add_u32 s38, s38, 4096
    s_waitcnt vmcnt(15)
    v_mfma_f32_16x16x32_bf16 v[192:195], v[16:19], v[60:63], v[192:195]
    v_mfma_f32_16x16x32_bf16 v[196:199], v[20:23], v[60:63], v[196:199]
    ds_read_b64_tr_b16 v[32:33], v4 offset:12288
    v_mfma_f32_16x16x32_bf16 v[200:203], v[24:27], v[60:63], v[200:203]
    ds_read_b64_tr_b16 v[34:35], v4 offset:14336
    v_mfma_f32_16x16x32_bf16 v[204:207], v[28:31], v[60:63], v[204:207]
    ds_read_b64_tr_b16 v[36:37], v5 offset:12288
    s_add_u32 s19, s38, s44
    buffer_load_dwordx4 v[60:63], v1, s[28:31], s19 offen sc1
    s_waitcnt vmcnt(15)
    v_mfma_f32_16x16x32_bf16 v[208:211], v[16:19], v[56:59], v[208:211]
    ds_read_b64_tr_b16 v[38:39], v5 offset:14336
    v_mfma_f32_16x16x32_bf16 v[212:215], v[20:23], v[56:59], v[212:215]
    ds_read_b64_tr_b16 v[40:41], v6 offset:12288
    v_mfma_f32_16x16x32_bf16 v[216:219], v[24:27], v[56:59], v[216:219]
    ds_read_b64_tr_b16 v[42:43], v6 offset:14336
    v_mfma_f32_16x16x32_bf16 v[220:223], v[28:31], v[56:59], v[220:223]
    ds_read_b64_tr_b16 v[44:45], v7 offset:12288
    s_add_u32 s20, s38, s45
    buffer_load_dwordx4 v[56:59], v1, s[28:31], s20 offen sc1
    s_waitcnt vmcnt(15)
    v_mfma_f32_16x16x32_bf16 v[224:227], v[16:19], v[52:55], v[224:227]
    ds_read_b64_tr_b16 v[46:47], v7 offset:14336
    v_mfma_f32_16x16x32_bf16 v[228:231], v[20:23], v[52:55], v[228:231]
    v_mfma_f32_16x16x32_bf16 v[232:235], v[24:27], v[52:55], v[232:235]
    v_mfma_f32_16x16x32_bf16 v[236:239], v[28:31], v[52:55], v[236:239]
    s_add_u32 s19, s38, s46
    buffer_load_dwordx4 v[52:55], v1, s[28:31], s19 offen sc1
    s_waitcnt vmcnt(15)
    v_mfma_f32_16x16x32_bf16 v[240:243], v[16:19], v[48:51], v[240:243]
    v_mfma_f32_16x16x32_bf16 v[244:247], v[20:23], v[48:51], v[244:247]
    v_mfma_f32_16x16x32_bf16 v[248:251], v[24:27], v[48:51], v[248:251]
    v_mfma_f32_16x16x32_bf16 v[252:255], v[28:31], v[48:51], v[252:255]
    s_waitcnt lgkmcnt(0)
    s_add_u32 s20, s38, s47
    buffer_load_dwordx4 v[48:51], v1, s[28:31], s20 offen sc1
    s_waitcnt vmcnt(15)
    v_mfma_f32_16x16x32_bf16 v[128:131], v[32:35], v[92:95], v[128:131]
    s_add_u32 m0, s42, 8192
    s_nop 0
    global_load_lds_dwordx4 v2, s[40:41]
    v_mfma_f32_16x16x32_bf16 v[132:135], v[36:39], v[92:95], v[132:135]
    s_add_u32 m0, s42, 9216
    s_nop 0
    global_load_lds_dwordx4 v2, s[56:57]
    v_mfma_f32_16x16x32_bf16 v[136:139], v[40:43], v[92:95], v[136:139]
    s_add_u32 m0, s42, 10240
    s_nop 0
    global_load_lds_dwordx4 v3, s[40:41]
    v_mfma_f32_16x16x32_bf16 v[140:143], v[44:47], v[92:95], v[140:143]
    s_add_u32 m0, s42, 11264
    s_nop 0
    global_load_lds_dwordx4 v3, s[56:57]
    s_add_u32 s40, s40, 262144
    s_addc_u32 s41, s41, 0
    s_add_u32 s56, s56, 262144
    s_addc_u32 s57, s57, 0
    s_add_u32 s19, s38, s48
    buffer_load_dwordx4 v[92:95], v1, s[28:31], s19 offen sc1
    s_waitcnt vmcnt(19)
    v_mfma_f32_16x16x32_bf16 v[144:147], v[32:35], v[88:91], v[144:147]
    v_mfma_f32_16x16x32_bf16 v[148:151], v[36:39], v[88:91], v[148:151]
    v_mfma_f32_16x16x32_bf16 v[152:155], v[40:43], v[88:91], v[152:155]
    v_mfma_f32_16x16x32_bf16 v[156:159], v[44:47], v[88:91], v[156:159]
    s_add_u32 s20, s38, s49
    buffer_load_dwordx4 v[88:91], v1, s[28:31], s20 offen sc1
    s_waitcnt vmcnt(19)
    v_mfma_f32_16x16x32_bf16 v[160:163], v[32:35], v[84:87], v[160:163]
    v_mfma_f32_16x16x32_bf16 v[164:167], v[36:39], v[84:87], v[164:167]
    v_mfma_f32_16x16x32_bf16 v[168:171], v[40:43], v[84:87], v[168:171]
    v_mfma_f32_16x16x32_bf16 v[172:175], v[44:47], v[84:87], v[172:175]
    s_add_u32 s19, s38, s50
    buffer_load_dwordx4 v[84:87], v1, s[28:31], s19 offen sc1
    s_waitcnt vmcnt(19)
    v_mfma_f32_16x16x32_bf16 v[176:179], v[32:35], v[80:83], v[176:179]
    v_mfma_f32_16x16x32_bf16 v[180:183], v[36:39], v[80:83], v[180:183]
    v_mfma_f32_16x16x32_bf16 v[184:187], v[40:43], v[80:83], v[184:187]
    v_mfma_f32_16x16x32_bf16 v[188:191], v[44:47], v[80:83], v[188:191]
    s_add_u32 s20, s38, s51
    buffer_load_dwordx4 v[80:83], v1, s[28:31], s20 offen sc1
    s_add_u32 s38, s38, 4096
    s_waitcnt vmcnt(15)
    v_mfma_f32_16x16x32_bf16 v[192:195], v[32:35], v[76:79], v[192:195]
    v_mfma_f32_16x16x32_bf16 v[196:199], v[36:39], v[76:79], v[196:199]
    ds_read_b64_tr_b16 v[16:17], v4 offset:0
    v_mfma_f32_16x16x32_bf16 v[200:203], v[40:43], v[76:79], v[200:203]
    ds_read_b64_tr_b16 v[18:19], v4 offset:2048
    v_mfma_f32_16x16x32_bf16 v[204:207], v[44:47], v[76:79], v[204:207]
    ds_read_b64_tr_b16 v[20:21], v5 offset:0
    s_add_u32 s19, s38, s44
    buffer_load_dwordx4 v[76:79], v1, s[28:31], s19 offen sc1
    s_waitcnt vmcnt(15)
    v_mfma_f32_16x16x32_bf16 v[208:211], v[32:35], v[72:75], v[208:211]
    ds_read_b64_tr_b16 v[22:23], v5 offset:2048
    v_mfma_f32_16x16x32_bf16 v[212:215], v[36:39], v[72:75], v[212:215]
    ds_read_b64_tr_b16 v[24:25], v6 offset:0
    v_mfma_f32_16x16x32_bf16 v[216:219], v[40:43], v[72:75], v[216:219]
    ds_read_b64_tr_b16 v[26:27], v6 offset:2048
    v_mfma_f32_16x16x32_bf16 v[220:223], v[44:47], v[72:75], v[220:223]
    ds_read_b64_tr_b16 v[28:29], v7 offset:0
    s_add_u32 s20, s38, s45
    buffer_load_dwordx4 v[72:75], v1, s[28:31], s20 offen sc1
    s_waitcnt vmcnt(15)
    v_mfma_f32_16x16x32_bf16 v[224:227], v[32:35], v[68:71], v[224:227]
    ds_read_b64_tr_b16 v[30:31], v7 offset:2048
    v_mfma_f32_16x16x32_bf16 v[228:231], v[36:39], v[68:71], v[228:231]
    v_mfma_f32_16x16x32_bf16 v[232:235], v[40:43], v[68:71], v[232:235]
    v_mfma_f32_16x16x32_bf16 v[236:239], v[44:47], v[68:71], v[236:239]
    s_add_u32 s19, s38, s46
    buffer_load_dwordx4 v[68:71], v1, s[28:31], s19 offen sc1
    s_waitcnt vmcnt(15)
    v_mfma_f32_16x16x32_bf16 v[240:243], v[32:35], v[64:67], v[240:243]
    v_mfma_f32_16x16x32_bf16 v[244:247], v[36:39], v[64:67], v[244:247]
    v_mfma_f32_16x16x32_bf16 v[248:251], v[40:43], v[64:67], v[248:251]
    v_mfma_f32_16x16x32_bf16 v[252:255], v[44:47], v[64:67], v[252:255]
    s_waitcnt lgkmcnt(0)
    s_add_u32 s20, s38, s47
    buffer_load_dwordx4 v[64:67], v1, s[28:31], s20 offen sc1
    s_waitcnt vmcnt(15)
    v_mfma_f32_16x16x32_bf16 v[128:131], v[16:19], v[60:63], v[128:131]
    s_add_u32 m0, s42, 12288
    s_nop 0
    global_load_lds_dwordx4 v2, s[40:41]
    v_mfma_f32_16x16x32_bf16 v[132:135], v[20:23], v[60:63], v[132:135]
    s_add_u32 m0, s42, 13312
    s_nop 0
    global_load_lds_dwordx4 v2, s[56:57]
    v_mfma_f32_16x16x32_bf16 v[136:139], v[24:27], v[60:63], v[136:139]
    s_add_u32 m0, s42, 14336
    s_nop 0
    global_load_lds_dwordx4 v3, s[40:41]
    v_mfma_f32_16x16x32_bf16 v[140:143], v[28:31], v[60:63], v[140:143]
    s_add_u32 m0, s42, 15360
    s_nop 0
    global_load_lds_dwordx4 v3, s[56:57]
    s_add_u32 s40, s40, 262144
    s_addc_u32 s41, s41, 0
    s_add_u32 s56, s56, 262144
    s_addc_u32 s57, s57, 0
    s_add_u32 s19, s38, s48
    buffer_load_dwordx4 v[60:63], v1, s[28:31], s19 offen sc1
    s_waitcnt vmcnt(19)
    v_mfma_f32_16x16x32_bf16 v[144:147], v[16:19], v[56:59], v[144:147]
    v_mfma_f32_16x16x32_bf16 v[148:151], v[20:23], v[56:59], v[148:151]
    v_mfma_f32_16x16x32_bf16 v[152:155], v[24:27], v[56:59], v[152:155]
    v_mfma_f32_16x16x32_bf16 v[156:159], v[28:31], v[56:59], v[156:159]
    s_add_u32 s20, s38, s49
    buffer_load_dwordx4 v[56:59], v1, s[28:31], s20 offen sc1
    s_waitcnt vmcnt(19)
    v_mfma_f32_16x16x32_bf16 v[160:163], v[16:19], v[52:55], v[160:163]
    v_mfma_f32_16x16x32_bf16 v[164:167], v[20:23], v[52:55], v[164:167]
    v_mfma_f32_16x16x32_bf16 v[168:171], v[24:27], v[52:55], v[168:171]
    v_mfma_f32_16x16x32_bf16 v[172:175], v[28:31], v[52:55], v[172:175]
    s_add_u32 s19, s38, s50
    buffer_load_dwordx4 v[52:55], v1, s[28:31], s19 offen sc1
    s_waitcnt vmcnt(19)
    v_mfma_f32_16x16x32_bf16 v[176:179], v[16:19], v[48:51], v[176:179]
    v_mfma_f32_16x16x32_bf16 v[180:183], v[20:23], v[48:51], v[180:183]
    v_mfma_f32_16x16x32_bf16 v[184:187], v[24:27], v[48:51], v[184:187]
    v_mfma_f32_16x16x32_bf16 v[188:191], v[28:31], v[48:51], v[188:191]
    s_add_u32 s20, s38, s51
    buffer_load_dwordx4 v[48:51], v1, s[28:31], s20 offen sc1
    s_add_u32 s38, s38, 4096
    s_waitcnt vmcnt(15)
    v_mfma_f32_16x16x32_bf16 v[192:195], v[16:19], v[92:95], v[192:195]
    v_mfma_f32_16x16x32_bf16 v[196:199], v[20:23], v[92:95], v[196:199]
    ds_read_b64_tr_b16 v[32:33], v4 offset:4096
    v_mfma_f32_16x16x32_bf16 v[200:203], v[24:27], v[92:95], v[200:203]
    ds_read_b64_tr_b16 v[34:35], v4 offset:6144
    v_mfma_f32_16x16x32_bf16 v[204:207], v[28:31], v[92:95], v[204:207]
    ds_read_b64_tr_b16 v[36:37], v5 offset:4096
    s_add_u32 s19, s38, s44
    buffer_load_dwordx4 v[92:95], v1, s[28:31], s19 offen sc1
    s_waitcnt vmcnt(15)
    v_mfma_f32_16x16x32_bf16 v[208:211], v[16:19], v[88:91], v[208:211]
    ds_read_b64_tr_b16 v[38:39], v5 offset:6144
    v_mfma_f32_16x16x32_bf16 v[212:215], v[20:23], v[88:91], v[212:215]
    ds_read_b64_tr_b16 v[40:41], v6 offset:4096
    v_mfma_f32_16x16x32_bf16 v[216:219], v[24:27], v[88:91], v[216:219]
    ds_read_b64_tr_b16 v[42:43], v6 offset:6144
    v_mfma_f32_16x16x32_bf16 v[220:223], v[28:31], v[88:91], v[220:223]
    ds_read_b64_tr_b16 v[44:45], v7 offset:4096
    s_add_u32 s20, s38, s45
    buffer_load_dwordx4 v[88:91], v1, s[28:31], s20 offen sc1
    s_waitcnt vmcnt(15)
    v_mfma_f32_16x16x32_bf16 v[224:227], v[16:19], v[84:87], v[224:227]
    ds_read_b64_tr_b16 v[46:47], v7 offset:6144
    v_mfma_f32_16x16x32_bf16 v[228:231], v[20:23], v[84:87], v[228:231]
    v_mfma_f32_16x16x32_bf16 v[232:235], v[24:27], v[84:87], v[232:235]
    v_mfma_f32_16x16x32_bf16 v[236:239], v[28:31], v[84:87], v[236:239]
    s_add_u32 s19, s38, s46
    buffer_load_dwordx4 v[84:87], v1, s[28:31], s19 offen sc1
    s_waitcnt vmcnt(15)
    v_mfma_f32_16x16x32_bf16 v[240:243], v[16:19], v[80:83], v[240:243]
    v_mfma_f32_16x16x32_bf16 v[244:247], v[20:23], v[80:83], v[244:247]
    v_mfma_f32_16x16x32_bf16 v[248:251], v[24:27], v[80:83], v[248:251]
    v_mfma_f32_16x16x32_bf16 v[252:255], v[28:31], v[80:83], v[252:255]
    s_waitcnt lgkmcnt(0)
    s_add_u32 s20, s38, s47
    buffer_load_dwordx4 v[80:83], v1, s[28:31], s20 offen sc1
    s_waitcnt vmcnt(15)
    v_mfma_f32_16x16x32_bf16 v[128:131], v[32:35], v[76:79], v[128:131]
    v_mfma_f32_16x16x32_bf16 v[132:135], v[36:39], v[76:79], v[132:135]
    v_mfma_f32_16x16x32_bf16 v[136:139], v[40:43], v[76:79], v[136:139]
    v_mfma_f32_16x16x32_bf16 v[140:143], v[44:47], v[76:79], v[140:143]
    s_add_u32 s19, s38, s48
    buffer_load_dwordx4 v[76:79], v1, s[28:31], s19 offen sc1
    s_waitcnt vmcnt(15)
    v_mfma_f32_16x16x32_bf16 v[144:147], v[32:35], v[72:75], v[144:147]
    v_mfma_f32_16x16x32_bf16 v[148:151], v[36:39], v[72:75], v[148:151]
    v_mfma_f32_16x16x32_bf16 v[152:155], v[40:43], v[72:75], v[152:155]
    v_mfma_f32_16x16x32_bf16 v[156:159], v[44:47], v[72:75], v[156:159]
    s_add_u32 s20, s38, s49
    buffer_load_dwordx4 v[72:75], v1, s[28:31], s20 offen sc1
    s_waitcnt vmcnt(15)
    v_mfma_f32_16x16x32_bf16 v[160:163], v[32:35], v[68:71], v[160:163]
    v_mfma_f32_16x16x32_bf16 v[164:167], v[36:39], v[68:71], v[164:167]
    v_mfma_f32_16x16x32_bf16 v[168:171], v[40:43], v[68:71], v[168:171]
    v_mfma_f32_16x16x32_bf16 v[172:175], v[44:47], v[68:71], v[172:175]
    s_add_u32 s19, s38, s50
    buffer_load_dwordx4 v[68:71], v1, s[28:31], s19 offen sc1
    s_waitcnt vmcnt(15)
    v_mfma_f32_16x16x32_bf16 v[176:179], v[32:35], v[64:67], v[176:179]
    v_mfma_f32_16x16x32_bf16 v[180:183], v[36:39], v[64:67], v[180:183]
    v_mfma_f32_16x16x32_bf16 v[184:187], v[40:43], v[64:67], v[184:187]
    v_mfma_f32_16x16x32_bf16 v[188:191], v[44:47], v[64:67], v[188:191]
    s_add_u32 s20, s38, s51
    buffer_load_dwordx4 v[64:67], v1, s[28:31], s20 offen sc1
    s_add_u32 s38, s38, 4096
    s_waitcnt vmcnt(11)
    v_mfma_f32_16x16x32_bf16 v[192:195], v[32:35], v[60:63], v[192:195]
    v_mfma_f32_16x16x32_bf16 v[196:199], v[36:39], v[60:63], v[196:199]
    ds_read_b64_tr_b16 v[16:17], v4 offset:8192
    v_mfma_f32_16x16x32_bf16 v[200:203], v[40:43], v[60:63], v[200:203]
    ds_read_b64_tr_b16 v[18:19], v4 offset:10240
    v_mfma_f32_16x16x32_bf16 v[204:207], v[44:47], v[60:63], v[204:207]
    ds_read_b64_tr_b16 v[20:21], v5 offset:8192
    s_add_u32 s19, s38, s44
    buffer_load_dwordx4 v[60:63], v1, s[28:31], s19 offen sc1
    s_waitcnt vmcnt(11)
    v_mfma_f32_16x16x32_bf16 v[208:211], v[32:35], v[56:59], v[208:211]
    ds_read_b64_tr_b16 v[22:23], v5 offset:10240
    v_mfma_f32_16x16x32_bf16 v[212:215], v[36:39], v[56:59], v[212:215]
    ds_read_b64_tr_b16 v[24:25], v6 offset:8192
    v_mfma_f32_16x16x32_bf16 v[216:219], v[40:43], v[56:59], v[216:219]
    ds_read_b64_tr_b16 v[26:27], v6 offset:10240
    v_mfma_f32_16x16x32_bf16 v[220:223], v[44:47], v[56:59], v[220:223]
    ds_read_b64_tr_b16 v[28:29], v7 offset:8192
    s_add_u32 s20, s38, s45
    buffer_load_dwordx4 v[56:59], v1, s[28:31], s20 offen sc1
    s_waitcnt vmcnt(11)
    v_mfma_f32_16x16x32_bf16 v[224:227], v[32:35], v[52:55], v[224:227]
    ds_read_b64_tr_b16 v[30:31], v7 offset:10240
    v_mfma_f32_16x16x32_bf16 v[228:231], v[36:39], v[52:55], v[228:231]
    v_mfma_f32_16x16x32_bf16 v[232:235], v[40:43], v[52:55], v[232:235]
    v_mfma_f32_16x16x32_bf16 v[236:239], v[44:47], v[52:55], v[236:239]
    s_add_u32 s19, s38, s46
    buffer_load_dwordx4 v[52:55], v1, s[28:31], s19 offen sc1
    s_waitcnt vmcnt(11)
    v_mfma_f32_16x16x32_bf16 v[240:243], v[32:35], v[48:51], v[240:243]
    v_mfma_f32_16x16x32_bf16 v[244:247], v[36:39], v[48:51], v[244:247]
    v_mfma_f32_16x16x32_bf16 v[248:251], v[40:43], v[48:51], v[248:251]
    v_mfma_f32_16x16x32_bf16 v[252:255], v[44:47], v[48:51], v[252:255]
    s_waitcnt lgkmcnt(0)
    s_add_u32 s20, s38, s47
    buffer_load_dwordx4 v[48:51], v1, s[28:31], s20 offen sc1
    s_waitcnt vmcnt(11)
    v_mfma_f32_16x16x32_bf16 v[128:131], v[16:19], v[92:95], v[128:131]
    v_mfma_f32_16x16x32_bf16 v[132:135], v[20:23], v[92:95], v[132:135]
    v_mfma_f32_16x16x32_bf16 v[136:139], v[24:27], v[92:95], v[136:139]
    v_mfma_f32_16x16x32_bf16 v[140:143], v[28:31], v[92:95], v[140:143]
    s_add_u32 s19, s38, s48
    buffer_load_dwordx4 v[92:95], v1, s[28:31], s19 offen sc1
    s_waitcnt vmcnt(11)
    v_mfma_f32_16x16x32_bf16 v[144:147], v[16:19], v[88:91], v[144:147]
    v_mfma_f32_16x16x32_bf16 v[148:151], v[20:23], v[88:91], v[148:151]
    v_mfma_f32_16x16x32_bf16 v[152:155], v[24:27], v[88:91], v[152:155]
    v_mfma_f32_16x16x32_bf16 v[156:159], v[28:31], v[88:91], v[156:159]
    s_add_u32 s20, s38, s49
    buffer_load_dwordx4 v[88:91], v1, s[28:31], s20 offen sc1
    s_waitcnt vmcnt(11)
    v_mfma_f32_16x16x32_bf16 v[160:163], v[16:19], v[84:87], v[160:163]
    v_mfma_f32_16x16x32_bf16 v[164:167], v[20:23], v[84:87], v[164:167]
    v_mfma_f32_16x16x32_bf16 v[168:171], v[24:27], v[84:87], v[168:171]
    v_mfma_f32_16x16x32_bf16 v[172:175], v[28:31], v[84:87], v[172:175]
    s_add_u32 s19, s38, s50
    buffer_load_dwordx4 v[84:87], v1, s[28:31], s19 offen sc1
    s_waitcnt vmcnt(11)
    v_mfma_f32_16x16x32_bf16 v[176:179], v[16:19], v[80:83], v[176:179]
    v_mfma_f32_16x16x32_bf16 v[180:183], v[20:23], v[80:83], v[180:183]
    v_mfma_f32_16x16x32_bf16 v[184:187], v[24:27], v[80:83], v[184:187]
    v_mfma_f32_16x16x32_bf16 v[188:191], v[28:31], v[80:83], v[188:191]
    s_add_u32 s20, s38, s51
    buffer_load_dwordx4 v[80:83], v1, s[28:31], s20 offen sc1
    s_add_u32 s38, s38, 4096
    s_waitcnt vmcnt(11)
    v_mfma_f32_16x16x32_bf16 v[192:195], v[16:19], v[76:79], v[192:195]
    v_mfma_f32_16x16x32_bf16 v[196:199], v[20:23], v[76:79], v[196:199]
    ds_read_b64_tr_b16 v[32:33], v4 offset:12288
    v_mfma_f32_16x16x32_bf16 v[200:203], v[24:27], v[76:79], v[200:203]
    ds_read_b64_tr_b16 v[34:35], v4 offset:14336
    v_mfma_f32_16x16x32_bf16 v[204:207], v[28:31], v[76:79], v[204:207]
    ds_read_b64_tr_b16 v[36:37], v5 offset:12288
    s_waitcnt vmcnt(10)
    v_mfma_f32_16x16x32_bf16 v[208:211], v[16:19], v[72:75], v[208:211]
    ds_read_b64_tr_b16 v[38:39], v5 offset:14336
    v_mfma_f32_16x16x32_bf16 v[212:215], v[20:23], v[72:75], v[212:215]
    ds_read_b64_tr_b16 v[40:41], v6 offset:12288
    v_mfma_f32_16x16x32_bf16 v[216:219], v[24:27], v[72:75], v[216:219]
    ds_read_b64_tr_b16 v[42:43], v6 offset:14336
    v_mfma_f32_16x16x32_bf16 v[220:223], v[28:31], v[72:75], v[220:223]
    ds_read_b64_tr_b16 v[44:45], v7 offset:12288
    s_waitcnt vmcnt(9)
    v_mfma_f32_16x16x32_bf16 v[224:227], v[16:19], v[68:71], v[224:227]
    ds_read_b64_tr_b16 v[46:47], v7 offset:14336
    v_mfma_f32_16x16x32_bf16 v[228:231], v[20:23], v[68:71], v[228:231]
    v_mfma_f32_16x16x32_bf16 v[232:235], v[24:27], v[68:71], v[232:235]
    v_mfma_f32_16x16x32_bf16 v[236:239], v[28:31], v[68:71], v[236:239]
    s_waitcnt vmcnt(8)
    v_mfma_f32_16x16x32_bf16 v[240:243], v[16:19], v[64:67], v[240:243]
    v_mfma_f32_16x16x32_bf16 v[244:247], v[20:23], v[64:67], v[244:247]
    v_mfma_f32_16x16x32_bf16 v[248:251], v[24:27], v[64:67], v[248:251]
    v_mfma_f32_16x16x32_bf16 v[252:255], v[28:31], v[64:67], v[252:255]
    s_waitcnt lgkmcnt(0)
    s_waitcnt vmcnt(7)
    v_mfma_f32_16x16x32_bf16 v[128:131], v[32:35], v[60:63], v[128:131]
    v_mfma_f32_16x16x32_bf16 v[132:135], v[36:39], v[60:63], v[132:135]
    v_mfma_f32_16x16x32_bf16 v[136:139], v[40:43], v[60:63], v[136:139]
    v_mfma_f32_16x16x32_bf16 v[140:143], v[44:47], v[60:63], v[140:143]
    s_waitcnt vmcnt(6)
    v_mfma_f32_16x16x32_bf16 v[144:147], v[32:35], v[56:59], v[144:147]
    v_mfma_f32_16x16x32_bf16 v[148:151], v[36:39], v[56:59], v[148:151]
    v_mfma_f32_16x16x32_bf16 v[152:155], v[40:43], v[56:59], v[152:155]
    v_mfma_f32_16x16x32_bf16 v[156:159], v[44:47], v[56:59], v[156:159]
    s_waitcnt vmcnt(5)
    v_mfma_f32_16x16x32_bf16 v[160:163], v[32:35], v[52:55], v[160:163]
    v_mfma_f32_16x16x32_bf16 v[164:167], v[36:39], v[52:55], v[164:167]
    v_mfma_f32_16x16x32_bf16 v[168:171], v[40:43], v[52:55], v[168:171]
    v_mfma_f32_16x16x32_bf16 v[172:175], v[44:47], v[52:55], v[172:175]
    s_waitcnt vmcnt(4)
    v_mfma_f32_16x16x32_bf16 v[176:179], v[32:35], v[48:51], v[176:179]
    v_mfma_f32_16x16x32_bf16 v[180:183], v[36:39], v[48:51], v[180:183]
    v_mfma_f32_16x16x32_bf16 v[184:187], v[40:43], v[48:51], v[184:187]
    v_mfma_f32_16x16x32_bf16 v[188:191], v[44:47], v[48:51], v[188:191]
    s_waitcnt vmcnt(3)
    v_mfma_f32_16x16x32_bf16 v[192:195], v[32:35], v[92:95], v[192:195]
    v_mfma_f32_16x16x32_bf16 v[196:199], v[36:39], v[92:95], v[196:199]
    v_mfma_f32_16x16x32_bf16 v[200:203], v[40:43], v[92:95], v[200:203]
    v_mfma_f32_16x16x32_bf16 v[204:207], v[44:47], v[92:95], v[204:207]
    s_waitcnt vmcnt(2)
    v_mfma_f32_16x16x32_bf16 v[208:211], v[32:35], v[88:91], v[208:211]
    v_mfma_f32_16x16x32_bf16 v[212:215], v[36:39], v[88:91], v[212:215]
    v_mfma_f32_16x16x32_bf16 v[216:219], v[40:43], v[88:91], v[216:219]
    v_mfma_f32_16x16x32_bf16 v[220:223], v[44:47], v[88:91], v[220:223]
    s_waitcnt vmcnt(1)
    v_mfma_f32_16x16x32_bf16 v[224:227], v[32:35], v[84:87], v[224:227]
    v_mfma_f32_16x16x32_bf16 v[228:231], v[36:39], v[84:87], v[228:231]
    v_mfma_f32_16x16x32_bf16 v[232:235], v[40:43], v[84:87], v[232:235]
    v_mfma_f32_16x16x32_bf16 v[236:239], v[44:47], v[84:87], v[236:239]
    s_waitcnt vmcnt(0)
    v_mfma_f32_16x16x32_bf16 v[240:243], v[32:35], v[80:83], v[240:243]
    v_mfma_f32_16x16x32_bf16 v[244:247], v[36:39], v[80:83], v[244:247]
    v_mfma_f32_16x16x32_bf16 v[248:251], v[40:43], v[80:83], v[248:251]
    v_mfma_f32_16x16x32_bf16 v[252:255], v[44:47], v[80:83], v[252:255]
    s_nop 7
    s_barrier
    v_add_u32 v12, s52, v1
    ds_write_b128 v12, v[160:163] offset:0
    ds_write_b128 v12, v[164:167] offset:1024
    ds_write_b128 v12, v[168:171] offset:2048
    ds_write_b128 v12, v[172:175] offset:3072
    ds_write_b128 v12, v[176:179] offset:4096
    ds_write_b128 v12, v[180:183] offset:5120
    ds_write_b128 v12, v[184:187] offset:6144
    ds_write_b128 v12, v[188:191] offset:7168
    v_add_u32 v12, s53, v1
    ds_write_b128 v12, v[192:195] offset:0
    ds_write_b128 v12, v[196:199] offset:1024
    ds_write_b128 v12, v[200:203] offset:2048
    ds_write_b128 v12, v[204:207] offset:3072
    ds_write_b128 v12, v[208:211] offset:4096
    ds_write_b128 v12, v[212:215] offset:5120
    ds_write_b128 v12, v[216:219] offset:6144
    ds_write_b128 v12, v[220:223] offset:7168
    v_add_u32 v12, s54, v1
    ds_write_b128 v12, v[224:227] offset:0
    ds_write_b128 v12, v[228:231] offset:1024
    ds_write_b128 v12, v[232:235] offset:2048
    ds_write_b128 v12, v[236:239] offset:3072
    ds_write_b128 v12, v[240:243] offset:4096
    ds_write_b128 v12, v[244:247] offset:5120
    ds_write_b128 v12, v[248:251] offset:6144
    ds_write_b128 v12, v[252:255] offset:7168
    s_waitcnt lgkmcnt(0)
    s_barrier
    ds_read_b128 v[160:163], v14 offset:0
    ds_read_b128 v[164:167], v14 offset:1024
    ds_read_b128 v[168:171], v14 offset:2048
    ds_read_b128 v[172:175], v14 offset:3072
    ds_read_b128 v[176:179], v14 offset:4096
    ds_read_b128 v[180:183], v14 offset:5120
    ds_read_b128 v[184:187], v14 offset:6144
    ds_read_b128 v[188:191], v14 offset:7168
    ds_read_b128 v[192:195], v14 offset:8192
    ds_read_b128 v[196:199], v14 offset:9216
    ds_read_b128 v[200:203], v14 offset:10240
    ds_read_b128 v[204:207], v14 offset:11264
    ds_read_b128 v[208:211], v14 offset:12288
    ds_read_b128 v[212:215], v14 offset:13312
    ds_read_b128 v[216:219], v14 offset:14336
    ds_read_b128 v[220:223], v14 offset:15360
    ds_read_b128 v[224:227], v14 offset:16384
    ds_read_b128 v[228:231], v14 offset:17408
    ds_read_b128 v[232:235], v14 offset:18432
    ds_read_b128 v[236:239], v14 offset:19456
    ds_read_b128 v[240:243], v14 offset:20480
    ds_read_b128 v[244:247], v14 offset:21504
    ds_read_b128 v[248:251], v14 offset:22528
    ds_read_b128 v[252:255], v14 offset:23552
    s_waitcnt lgkmcnt(15)
    v_pk_add_f32 v[48:49], v[128:129], v[160:161]
    v_pk_add_f32 v[50:51], v[130:131], v[162:163]
    v_pk_add_f32 v[52:53], v[132:133], v[164:165]
    v_pk_add_f32 v[54:55], v[134:135], v[166:167]
    v_pk_add_f32 v[56:57], v[136:137], v[168:169]
    v_pk_add_f32 v[58:59], v[138:139], v[170:171]
    v_pk_add_f32 v[60:61], v[140:141], v[172:173]
    v_pk_add_f32 v[62:63], v[142:143], v[174:175]
    v_pk_add_f32 v[64:65], v[144:145], v[176:177]
    v_pk_add_f32 v[66:67], v[146:147], v[178:179]
    v_pk_add_f32 v[68:69], v[148:149], v[180:181]
    v_pk_add_f32 v[70:71], v[150:151], v[182:183]
    v_pk_add_f32 v[72:73], v[152:153], v[184:185]
    v_pk_add_f32 v[74:75], v[154:155], v[186:187]
    v_pk_add_f32 v[76:77], v[156:157], v[188:189]
    v_pk_add_f32 v[78:79], v[158:159], v[190:191]
    s_waitcnt lgkmcnt(8)
    v_pk_add_f32 v[48:49], v[48:49], v[192:193]
    v_pk_add_f32 v[50:51], v[50:51], v[194:195]
    v_pk_add_f32 v[52:53], v[52:53], v[196:197]
    v_pk_add_f32 v[54:55], v[54:55], v[198:199]
    v_pk_add_f32 v[56:57], v[56:57], v[200:201]
    v_pk_add_f32 v[58:59], v[58:59], v[202:203]
    v_pk_add_f32 v[60:61], v[60:61], v[204:205]
    v_pk_add_f32 v[62:63], v[62:63], v[206:207]
    v_pk_add_f32 v[64:65], v[64:65], v[208:209]
    v_pk_add_f32 v[66:67], v[66:67], v[210:211]
    v_pk_add_f32 v[68:69], v[68:69], v[212:213]
    v_pk_add_f32 v[70:71], v[70:71], v[214:215]
    v_pk_add_f32 v[72:73], v[72:73], v[216:217]
    v_pk_add_f32 v[74:75], v[74:75], v[218:219]
    v_pk_add_f32 v[76:77], v[76:77], v[220:221]
    v_pk_add_f32 v[78:79], v[78:79], v[222:223]
    s_waitcnt lgkmcnt(0)
    v_pk_add_f32 v[48:49], v[48:49], v[224:225]
    v_pk_add_f32 v[50:51], v[50:51], v[226:227]
    v_pk_add_f32 v[52:53], v[52:53], v[228:229]
    v_pk_add_f32 v[54:55], v[54:55], v[230:231]
    v_pk_add_f32 v[56:57], v[56:57], v[232:233]
    v_pk_add_f32 v[58:59], v[58:59], v[234:235]
    v_pk_add_f32 v[60:61], v[60:61], v[236:237]
    v_pk_add_f32 v[62:63], v[62:63], v[238:239]
    v_pk_add_f32 v[64:65], v[64:65], v[240:241]
    v_pk_add_f32 v[66:67], v[66:67], v[242:243]
    v_pk_add_f32 v[68:69], v[68:69], v[244:245]
    v_pk_add_f32 v[70:71], v[70:71], v[246:247]
    v_pk_add_f32 v[72:73], v[72:73], v[248:249]
    v_pk_add_f32 v[74:75], v[74:75], v[250:251]
    v_pk_add_f32 v[76:77], v[76:77], v[252:253]
    v_pk_add_f32 v[78:79], v[78:79], v[254:255]
    v_mov_b32 v16, v8
    v_mov_b32 v17, v8
    v_sub_f32 v18, 1.0, v8
    v_sub_f32 v19, 1.0, v8
    v_cvt_pk_bf16_f32 v18, 0, v18
    v_cvt_pk_bf16_f32 v19, 0, v19
    s_mov_b32 s19, 0
    v_cvt_pk_bf16_f32 v48, 0, v48
    v_cvt_pk_bf16_f32 v49, 0, v49
    v_cvt_pk_bf16_f32 v96, 0, v96
    v_cvt_pk_bf16_f32 v97, 0, v97
    v_pk_mul_f32 v[48:49], v[48:49], v[16:17]
    v_pk_mul_f32 v[96:97], v[96:97], v[18:19]
    v_cvt_pk_bf16_f32 v48, 0, v48
    v_cvt_pk_bf16_f32 v49, 0, v49
    v_cvt_pk_bf16_f32 v96, 0, v96
    v_cvt_pk_bf16_f32 v97, 0, v97
    v_pk_add_f32 v[48:49], v[48:49], v[96:97]
    v_cvt_pk_bf16_f32 v24, v48, v49
    v_cvt_pk_bf16_f32 v50, 0, v50
    v_cvt_pk_bf16_f32 v51, 0, v51
    v_cvt_pk_bf16_f32 v98, 0, v98
    v_cvt_pk_bf16_f32 v99, 0, v99
    v_pk_mul_f32 v[50:51], v[50:51], v[16:17]
    v_pk_mul_f32 v[98:99], v[98:99], v[18:19]
    v_cvt_pk_bf16_f32 v50, 0, v50
    v_cvt_pk_bf16_f32 v51, 0, v51
    v_cvt_pk_bf16_f32 v98, 0, v98
    v_cvt_pk_bf16_f32 v99, 0, v99
    v_pk_add_f32 v[50:51], v[50:51], v[98:99]
    v_cvt_pk_bf16_f32 v25, v50, v51
    buffer_store_dwordx2 v[24:25], v10, s[32:35], s19 offen offset:0
    v_cvt_pk_bf16_f32 v52, 0, v52
    v_cvt_pk_bf16_f32 v53, 0, v53
    v_cvt_pk_bf16_f32 v100, 0, v100
    v_cvt_pk_bf16_f32 v101, 0, v101
    v_pk_mul_f32 v[52:53], v[52:53], v[16:17]
    v_pk_mul_f32 v[100:101], v[100:101], v[18:19]
    v_cvt_pk_bf16_f32 v52, 0, v52
    v_cvt_pk_bf16_f32 v53, 0, v53
    v_cvt_pk_bf16_f32 v100, 0, v100
    v_cvt_pk_bf16_f32 v101, 0, v101
    v_pk_add_f32 v[52:53], v[52:53], v[100:101]
    v_cvt_pk_bf16_f32 v26, v52, v53
    v_cvt_pk_bf16_f32 v54, 0, v54
    v_cvt_pk_bf16_f32 v55, 0, v55
    v_cvt_pk_bf16_f32 v102, 0, v102
    v_cvt_pk_bf16_f32 v103, 0, v103
    v_pk_mul_f32 v[54:55], v[54:55], v[16:17]
    v_pk_mul_f32 v[102:103], v[102:103], v[18:19]
    v_cvt_pk_bf16_f32 v54, 0, v54
    v_cvt_pk_bf16_f32 v55, 0, v55
    v_cvt_pk_bf16_f32 v102, 0, v102
    v_cvt_pk_bf16_f32 v103, 0, v103
    v_pk_add_f32 v[54:55], v[54:55], v[102:103]
    v_cvt_pk_bf16_f32 v27, v54, v55
    buffer_store_dwordx2 v[26:27], v10, s[32:35], s19 offen offset:32
    v_cvt_pk_bf16_f32 v56, 0, v56
    v_cvt_pk_bf16_f32 v57, 0, v57
    v_cvt_pk_bf16_f32 v104, 0, v104
    v_cvt_pk_bf16_f32 v105, 0, v105
    v_pk_mul_f32 v[56:57], v[56:57], v[16:17]
    v_pk_mul_f32 v[104:105], v[104:105], v[18:19]
    v_cvt_pk_bf16_f32 v56, 0, v56
    v_cvt_pk_bf16_f32 v57, 0, v57
    v_cvt_pk_bf16_f32 v104, 0, v104
    v_cvt_pk_bf16_f32 v105, 0, v105
    v_pk_add_f32 v[56:57], v[56:57], v[104:105]
    v_cvt_pk_bf16_f32 v28, v56, v57
    v_cvt_pk_bf16_f32 v58, 0, v58
    v_cvt_pk_bf16_f32 v59, 0, v59
    v_cvt_pk_bf16_f32 v106, 0, v106
    v_cvt_pk_bf16_f32 v107, 0, v107
    v_pk_mul_f32 v[58:59], v[58:59], v[16:17]
    v_pk_mul_f32 v[106:107], v[106:107], v[18:19]
    v_cvt_pk_bf16_f32 v58, 0, v58
    v_cvt_pk_bf16_f32 v59, 0, v59
    v_cvt_pk_bf16_f32 v106, 0, v106
    v_cvt_pk_bf16_f32 v107, 0, v107
    v_pk_add_f32 v[58:59], v[58:59], v[106:107]
    v_cvt_pk_bf16_f32 v29, v58, v59
    buffer_store_dwordx2 v[28:29], v10, s[32:35], s19 offen offset:64
    v_cvt_pk_bf16_f32 v60, 0, v60
    v_cvt_pk_bf16_f32 v61, 0, v61
    v_cvt_pk_bf16_f32 v108, 0, v108
    v_cvt_pk_bf16_f32 v109, 0, v109
    v_pk_mul_f32 v[60:61], v[60:61], v[16:17]
    v_pk_mul_f32 v[108:109], v[108:109], v[18:19]
    v_cvt_pk_bf16_f32 v60, 0, v60
    v_cvt_pk_bf16_f32 v61, 0, v61
    v_cvt_pk_bf16_f32 v108, 0, v108
    v_cvt_pk_bf16_f32 v109, 0, v109
    v_pk_add_f32 v[60:61], v[60:61], v[108:109]
    v_cvt_pk_bf16_f32 v30, v60, v61
    v_cvt_pk_bf16_f32 v62, 0, v62
    v_cvt_pk_bf16_f32 v63, 0, v63
    v_cvt_pk_bf16_f32 v110, 0, v110
    v_cvt_pk_bf16_f32 v111, 0, v111
    v_pk_mul_f32 v[62:63], v[62:63], v[16:17]
    v_pk_mul_f32 v[110:111], v[110:111], v[18:19]
    v_cvt_pk_bf16_f32 v62, 0, v62
    v_cvt_pk_bf16_f32 v63, 0, v63
    v_cvt_pk_bf16_f32 v110, 0, v110
    v_cvt_pk_bf16_f32 v111, 0, v111
    v_pk_add_f32 v[62:63], v[62:63], v[110:111]
    v_cvt_pk_bf16_f32 v31, v62, v63
    buffer_store_dwordx2 v[30:31], v10, s[32:35], s19 offen offset:96
    v_mov_b32 v16, v9
    v_mov_b32 v17, v9
    v_sub_f32 v18, 1.0, v9
    v_sub_f32 v19, 1.0, v9
    v_cvt_pk_bf16_f32 v18, 0, v18
    v_cvt_pk_bf16_f32 v19, 0, v19
    s_mov_b32 s20, 32768
    v_cvt_pk_bf16_f32 v64, 0, v64
    v_cvt_pk_bf16_f32 v65, 0, v65
    v_cvt_pk_bf16_f32 v112, 0, v112
    v_cvt_pk_bf16_f32 v113, 0, v113
    v_pk_mul_f32 v[64:65], v[64:65], v[16:17]
    v_pk_mul_f32 v[112:113], v[112:113], v[18:19]
    v_cvt_pk_bf16_f32 v64, 0, v64
    v_cvt_pk_bf16_f32 v65, 0, v65
    v_cvt_pk_bf16_f32 v112, 0, v112
    v_cvt_pk_bf16_f32 v113, 0, v113
    v_pk_add_f32 v[64:65], v[64:65], v[112:113]
    v_cvt_pk_bf16_f32 v24, v64, v65
    v_cvt_pk_bf16_f32 v66, 0, v66
    v_cvt_pk_bf16_f32 v67, 0, v67
    v_cvt_pk_bf16_f32 v114, 0, v114
    v_cvt_pk_bf16_f32 v115, 0, v115
    v_pk_mul_f32 v[66:67], v[66:67], v[16:17]
    v_pk_mul_f32 v[114:115], v[114:115], v[18:19]
    v_cvt_pk_bf16_f32 v66, 0, v66
    v_cvt_pk_bf16_f32 v67, 0, v67
    v_cvt_pk_bf16_f32 v114, 0, v114
    v_cvt_pk_bf16_f32 v115, 0, v115
    v_pk_add_f32 v[66:67], v[66:67], v[114:115]
    v_cvt_pk_bf16_f32 v25, v66, v67
    buffer_store_dwordx2 v[24:25], v10, s[32:35], s20 offen offset:0
    v_cvt_pk_bf16_f32 v68, 0, v68
    v_cvt_pk_bf16_f32 v69, 0, v69
    v_cvt_pk_bf16_f32 v116, 0, v116
    v_cvt_pk_bf16_f32 v117, 0, v117
    v_pk_mul_f32 v[68:69], v[68:69], v[16:17]
    v_pk_mul_f32 v[116:117], v[116:117], v[18:19]
    v_cvt_pk_bf16_f32 v68, 0, v68
    v_cvt_pk_bf16_f32 v69, 0, v69
    v_cvt_pk_bf16_f32 v116, 0, v116
    v_cvt_pk_bf16_f32 v117, 0, v117
    v_pk_add_f32 v[68:69], v[68:69], v[116:117]
    v_cvt_pk_bf16_f32 v26, v68, v69
    v_cvt_pk_bf16_f32 v70, 0, v70
    v_cvt_pk_bf16_f32 v71, 0, v71
    v_cvt_pk_bf16_f32 v118, 0, v118
    v_cvt_pk_bf16_f32 v119, 0, v119
    v_pk_mul_f32 v[70:71], v[70:71], v[16:17]
    v_pk_mul_f32 v[118:119], v[118:119], v[18:19]
    v_cvt_pk_bf16_f32 v70, 0, v70
    v_cvt_pk_bf16_f32 v71, 0, v71
    v_cvt_pk_bf16_f32 v118, 0, v118
    v_cvt_pk_bf16_f32 v119, 0, v119
    v_pk_add_f32 v[70:71], v[70:71], v[118:119]
    v_cvt_pk_bf16_f32 v27, v70, v71
    buffer_store_dwordx2 v[26:27], v10, s[32:35], s20 offen offset:32
    v_cvt_pk_bf16_f32 v72, 0, v72
    v_cvt_pk_bf16_f32 v73, 0, v73
    v_cvt_pk_bf16_f32 v120, 0, v120
    v_cvt_pk_bf16_f32 v121, 0, v121
    v_pk_mul_f32 v[72:73], v[72:73], v[16:17]
    v_pk_mul_f32 v[120:121], v[120:121], v[18:19]
    v_cvt_pk_bf16_f32 v72, 0, v72
    v_cvt_pk_bf16_f32 v73, 0, v73
    v_cvt_pk_bf16_f32 v120, 0, v120
    v_cvt_pk_bf16_f32 v121, 0, v121
    v_pk_add_f32 v[72:73], v[72:73], v[120:121]
    v_cvt_pk_bf16_f32 v28, v72, v73
    v_cvt_pk_bf16_f32 v74, 0, v74
    v_cvt_pk_bf16_f32 v75, 0, v75
    v_cvt_pk_bf16_f32 v122, 0, v122
    v_cvt_pk_bf16_f32 v123, 0, v123
    v_pk_mul_f32 v[74:75], v[74:75], v[16:17]
    v_pk_mul_f32 v[122:123], v[122:123], v[18:19]
    v_cvt_pk_bf16_f32 v74, 0, v74
    v_cvt_pk_bf16_f32 v75, 0, v75
    v_cvt_pk_bf16_f32 v122, 0, v122
    v_cvt_pk_bf16_f32 v123, 0, v123
    v_pk_add_f32 v[74:75], v[74:75], v[122:123]
    v_cvt_pk_bf16_f32 v29, v74, v75
    buffer_store_dwordx2 v[28:29], v10, s[32:35], s20 offen offset:64
    v_cvt_pk_bf16_f32 v76, 0, v76
    v_cvt_pk_bf16_f32 v77, 0, v77
    v_cvt_pk_bf16_f32 v124, 0, v124
    v_cvt_pk_bf16_f32 v125, 0, v125
    v_pk_mul_f32 v[76:77], v[76:77], v[16:17]
    v_pk_mul_f32 v[124:125], v[124:125], v[18:19]
    v_cvt_pk_bf16_f32 v76, 0, v76
    v_cvt_pk_bf16_f32 v77, 0, v77
    v_cvt_pk_bf16_f32 v124, 0, v124
    v_cvt_pk_bf16_f32 v125, 0, v125
    v_pk_add_f32 v[76:77], v[76:77], v[124:125]
    v_cvt_pk_bf16_f32 v30, v76, v77
    v_cvt_pk_bf16_f32 v78, 0, v78
    v_cvt_pk_bf16_f32 v79, 0, v79
    v_cvt_pk_bf16_f32 v126, 0, v126
    v_cvt_pk_bf16_f32 v127, 0, v127
    v_pk_mul_f32 v[78:79], v[78:79], v[16:17]
    v_pk_mul_f32 v[126:127], v[126:127], v[18:19]
    v_cvt_pk_bf16_f32 v78, 0, v78
    v_cvt_pk_bf16_f32 v79, 0, v79
    v_cvt_pk_bf16_f32 v126, 0, v126
    v_cvt_pk_bf16_f32 v127, 0, v127
    v_pk_add_f32 v[78:79], v[78:79], v[126:127]
    v_cvt_pk_bf16_f32 v31, v78, v79
    buffer_store_dwordx2 v[30:31], v10, s[32:35], s20 offen offset:96
    s_endpgm
K23_ATT:
    s_setprio 2
    s_sub_u32 s38, s18, 4
    s_and_b32 s36, s2, 7
    s_lshr_b32 s19, s2, 3
    s_and_b32 s19, s19, 3
    s_lshl_b32 s19, s19, 3
    s_add_u32 s36, s36, s19
    s_lshr_b32 s37, s2, 5
    s_lshl_b32 s37, s37, 4
    v_lshlrev_b32 v2, 4, v0
    s_lshl_b32 s19, s38, 2
    s_add_u32 s19, s19, 65536
    v_mov_b32 v27, s19
    v_mov_b32 v3, 0
    ds_write_b32 v27, v3
    s_add_u32 s19, s37, s38
    s_sub_u32 s19, s19, 16
    s_lshl_b32 s20, s36, 17
    s_add_u32 s20, s20, 0x1800000
    s_lshl_b32 s23, s38, 10
    s_add_u32 s21, s19, 0
    s_max_i32 s21, s21, 0
    s_lshl_b32 s21, s21, 10
    s_add_u32 s21, s21, s20
    s_add_u32 s22, s21, 0x400000
    s_add_u32 m0, s23, 0
    s_nop 0
    buffer_load_dwordx4 v2, s[28:31], s21 offen lds
    s_add_u32 m0, s23, 32768
    s_nop 0
    buffer_load_dwordx4 v2, s[28:31], s22 offen lds
    s_add_u32 s21, s19, 4
    s_max_i32 s21, s21, 0
    s_lshl_b32 s21, s21, 10
    s_add_u32 s21, s21, s20
    s_add_u32 s22, s21, 0x400000
    s_add_u32 m0, s23, 4096
    s_nop 0
    buffer_load_dwordx4 v2, s[28:31], s21 offen lds
    s_add_u32 m0, s23, 36864
    s_nop 0
    buffer_load_dwordx4 v2, s[28:31], s22 offen lds
    s_add_u32 s21, s19, 8
    s_max_i32 s21, s21, 0
    s_lshl_b32 s21, s21, 10
    s_add_u32 s21, s21, s20
    s_add_u32 s22, s21, 0x400000
    s_add_u32 m0, s23, 8192
    s_nop 0
    buffer_load_dwordx4 v2, s[28:31], s21 offen lds
    s_add_u32 m0, s23, 40960
    s_nop 0
    buffer_load_dwordx4 v2, s[28:31], s22 offen lds
    s_add_u32 s21, s19, 12
    s_max_i32 s21, s21, 0
    s_lshl_b32 s21, s21, 10
    s_add_u32 s21, s21, s20
    s_add_u32 s22, s21, 0x400000
    s_add_u32 m0, s23, 12288
    s_nop 0
    buffer_load_dwordx4 v2, s[28:31], s21 offen lds
    s_add_u32 m0, s23, 45056
    s_nop 0
    buffer_load_dwordx4 v2, s[28:31], s22 offen lds
    s_add_u32 s21, s19, 16
    s_max_i32 s21, s21, 0
    s_lshl_b32 s21, s21, 10
    s_add_u32 s21, s21, s20
    s_add_u32 s22, s21, 0x400000
    s_add_u32 m0, s23, 16384
    s_nop 0
    buffer_load_dwordx4 v2, s[28:31], s21 offen lds
    s_add_u32 m0, s23, 49152
    s_nop 0
    buffer_load_dwordx4 v2, s[28:31], s22 offen lds
    s_add_u32 s21, s19, 20
    s_max_i32 s21, s21, 0
    s_lshl_b32 s21, s21, 10
    s_add_u32 s21, s21, s20
    s_add_u32 s22, s21, 0x400000
    s_add_u32 m0, s23, 20480
    s_nop 0
    buffer_load_dwordx4 v2, s[28:31], s21 offen lds
    s_add_u32 m0, s23, 53248
    s_nop 0
    buffer_load_dwordx4 v2, s[28:31], s22 offen lds
    s_add_u32 s21, s19, 24
    s_max_i32 s21, s21, 0
    s_lshl_b32 s21, s21, 10
    s_add_u32 s21, s21, s20
    s_add_u32 s22, s21, 0x400000
    s_add_u32 m0, s23, 24576
    s_nop 0
    buffer_load_dwordx4 v2, s[28:31], s21 offen lds
    s_add_u32 m0, s23, 57344
    s_nop 0
    buffer_load_dwordx4 v2, s[28:31], s22 offen lds
    s_add_u32 s21, s19, 28
    s_max_i32 s21, s21, 0
    s_lshl_b32 s21, s21, 10
    s_add_u32 s21, s21, s20
    s_add_u32 s22, s21, 0x400000
    s_add_u32 m0, s23, 28672
    s_nop 0
    buffer_load_dwordx4 v2, s[28:31], s21 offen lds
    s_add_u32 m0, s23, 61440
    s_nop 0
    buffer_load_dwordx4 v2, s[28:31], s22 offen lds
    s_waitcnt lgkmcnt(0)
    s_barrier
    s_lshl_b32 s19, s38, 1
    s_add_u32 s54, s37, s19
    s_lshl_b32 s21, s36, 7
    s_add_u32 s21, s21, s54
    s_lshl_b32 s21, s21, 10
    s_add_u32 s21, s21, 0x1400000
    s_add_u32 s22, s21, 8192
    buffer_load_dwordx4 v[4:7], v2, s[28:31], s21 offen offset:0
    buffer_load_dwordx4 v[8:11], v2, s[28:31], s21 offen offset:1024
    buffer_load_dwordx4 v[12:15], v2, s[28:31], s22 offen offset:0
    buffer_load_dwordx4 v[16:19], v2, s[28:31], s22 offen offset:1024
    s_lshl_b32 s56, s37, 4
    s_lshl_b32 s19, s36, 2
    s_add_u32 s56, s56, s19
    s_add_u32 s56, s56, s38
    v_and_b32 v20, 15, v0
    v_lshrrev_b32 v21, 4, v0
    v_lshlrev_b32 v30, 2, v21
    v_add_u32 v31, 0, v30
    v_cmp_gt_u32 s[40:41], v31, v20
    v_add_u32 v31, 1, v30
    v_cmp_gt_u32 s[42:43], v31, v20
    v_add_u32 v31, 2, v30
    v_cmp_gt_u32 s[44:45], v31, v20
    v_add_u32 v31, 3, v30
    v_cmp_gt_u32 s[46:47], v31, v20
    v_mov_b32 v22, 0xff800000
    v_mov_b32 v25, 1
    s_lshl_b32 s19, s38, 11
    v_add_u32 v23, s19, v2
    v_and_b32 v31, 3, v20
    v_lshlrev_b32 v31, 4, v31
    v_add_u32 v31, v31, v30
    v_lshrrev_b32 v32, 2, v20
    v_add_u32 v31, v31, v32
    v_lshlrev_b32 v31, 4, v31
    s_add_u32 s19, s19, 32768
    v_add_u32 v24, s19, v31
    s_mov_b32 s50, 0x3e3504f3
    s_mov_b32 s51, 0x3e3504f3
    s_mov_b32 s52, 0x3fb8aa3b
    s_mov_b32 s53, 0x3fb8aa3b
    s_lshl_b32 s19, s56, 2
    s_add_u32 s19, s19, 0x2404000
    v_mov_b32 v26, s19
    s_waitcnt vmcnt(0)
    ds_write_b32 v27, v25
    v_mov_b32 v27, 65536
K23_KVW:
    ds_read_b128 v[28:31], v27
    s_waitcnt lgkmcnt(0)
    v_and_b32 v28, v28, v29
    v_and_b32 v30, v30, v31
    v_and_b32 v28, v28, v30
    s_nop 0
    v_readfirstlane_b32 s19, v28
    s_cmp_eq_u32 s19, 1
    s_cbranch_scc0 K23_KVW
    s_sub_u32 s48, 16, s54
    s_max_i32 s48, s48, 0
    ds_read_b128 v[28:31], v23 offset:0
    ds_read_b128 v[32:35], v23 offset:1024
    ds_read_b128 v[36:39], v23 offset:2048
    ds_read_b128 v[40:43], v23 offset:3072
    ds_read_b128 v[44:47], v23 offset:4096
    ds_read_b128 v[48:51], v23 offset:5120
    ds_read_b128 v[52:55], v23 offset:6144
    s_waitcnt lgkmcnt(6)
    v_mfma_f32_16x16x32_bf16 v[60:63], v[28:31], v[4:7], 0
    ds_read_b128 v[56:59], v23 offset:7168
    s_waitcnt lgkmcnt(6)
    v_mfma_f32_16x16x32_bf16 v[64:67], v[32:35], v[4:7], 0
    v_mfma_f32_16x16x32_bf16 v[128:131], v[32:35], v[8:11], 0
    ds_read_b128 v[28:31], v23 offset:8192
    s_waitcnt lgkmcnt(6)
    v_mfma_f32_16x16x32_bf16 v[68:71], v[36:39], v[4:7], 0
    v_mfma_f32_16x16x32_bf16 v[132:135], v[36:39], v[8:11], 0
    ds_read_b128 v[32:35], v23 offset:9216
    s_waitcnt lgkmcnt(6)
    v_mfma_f32_16x16x32_bf16 v[72:75], v[40:43], v[4:7], 0
    v_mfma_f32_16x16x32_bf16 v[136:139], v[40:43], v[8:11], 0
    ds_read_b128 v[36:39], v23 offset:10240
    s_waitcnt lgkmcnt(6)
    v_mfma_f32_16x16x32_bf16 v[76:79], v[44:47], v[4:7], 0
    v_mfma_f32_16x16x32_bf16 v[140:143], v[44:47], v[8:11], 0
    ds_read_b128 v[40:43], v23 offset:11264
    s_waitcnt lgkmcnt(6)
    v_mfma_f32_16x16x32_bf16 v[80:83], v[48:51], v[4:7], 0
    v_mfma_f32_16x16x32_bf16 v[144:147], v[48:51], v[8:11], 0
    ds_read_b128 v[44:47], v23 offset:12288
    s_waitcnt lgkmcnt(6)
    v_mfma_f32_16x16x32_bf16 v[84:87], v[52:55], v[4:7], 0
    v_mfma_f32_16x16x32_bf16 v[148:151], v[52:55], v[8:11], 0
    ds_read_b128 v[48:51], v23 offset:13312
    s_waitcnt lgkmcnt(6)
    v_mfma_f32_16x16x32_bf16 v[88:91], v[56:59], v[4:7], 0
    v_mfma_f32_16x16x32_bf16 v[152:155], v[56:59], v[8:11], 0
    ds_read_b128 v[52:55], v23 offset:14336
    s_waitcnt lgkmcnt(6)
    v_mfma_f32_16x16x32_bf16 v[92:95], v[28:31], v[4:7], 0
    v_mfma_f32_16x16x32_bf16 v[156:159], v[28:31], v[8:11], 0
    ds_read_b128 v[56:59], v23 offset:15360
    s_waitcnt lgkmcnt(6)
    v_mfma_f32_16x16x32_bf16 v[96:99], v[32:35], v[4:7], 0
    v_mfma_f32_16x16x32_bf16 v[160:163], v[32:35], v[8:11], 0
    ds_read_b128 v[28:31], v23 offset:16384
    s_waitcnt lgkmcnt(6)
    v_mfma_f32_16x16x32_bf16 v[100:103], v[36:39], v[4:7], 0
    v_mfma_f32_16x16x32_bf16 v[164:167], v[36:39], v[8:11], 0
    ds_read_b128 v[32:35], v23 offset:17408
    s_waitcnt lgkmcnt(6)
    v_mfma_f32_16x16x32_bf16 v[104:107], v[40:43], v[4:7], 0
    v_mfma_f32_16x16x32_bf16 v[168:171], v[40:43], v[8:11], 0
    s_waitcnt lgkmcnt(5)
    v_mfma_f32_16x16x32_bf16 v[108:111], v[44:47], v[4:7], 0
    v_mfma_f32_16x16x32_bf16 v[172:175], v[44:47], v[8:11], 0
    s_waitcnt lgkmcnt(4)
    v_mfma_f32_16x16x32_bf16 v[112:115], v[48:51], v[4:7], 0
    v_mfma_f32_16x16x32_bf16 v[176:179], v[48:51], v[8:11], 0
    s_waitcnt lgkmcnt(3)
    v_mfma_f32_16x16x32_bf16 v[116:119], v[52:55], v[4:7], 0
    v_mfma_f32_16x16x32_bf16 v[180:183], v[52:55], v[8:11], 0
    s_waitcnt lgkmcnt(2)
    v_mfma_f32_16x16x32_bf16 v[120:123], v[56:59], v[4:7], 0
    v_mfma_f32_16x16x32_bf16 v[184:187], v[56:59], v[8:11], 0
    s_waitcnt lgkmcnt(1)
    v_mfma_f32_16x16x32_bf16 v[124:127], v[28:31], v[4:7], 0
    v_mfma_f32_16x16x32_bf16 v[188:191], v[28:31], v[8:11], 0
    s_waitcnt lgkmcnt(0)
    v_mfma_f32_16x16x32_bf16 v[192:195], v[32:35], v[8:11], 0
    ds_read_b64_tr_b16 v[196:197], v24 offset:0
    ds_read_b64_tr_b16 v[198:199], v24 offset:1024
    ds_read_b64_tr_b16 v[200:201], v24 offset:8
    ds_read_b64_tr_b16 v[202:203], v24 offset:1032
    ds_read_b64_tr_b16 v[204:205], v24 offset:2048
    ds_read_b64_tr_b16 v[206:207], v24 offset:3072
    ds_read_b64_tr_b16 v[208:209], v24 offset:2056
    ds_read_b64_tr_b16 v[210:211], v24 offset:3080
    ds_read_b64_tr_b16 v[212:213], v24 offset:4096
    ds_read_b64_tr_b16 v[214:215], v24 offset:5120
    ds_read_b64_tr_b16 v[216:217], v24 offset:4104
    ds_read_b64_tr_b16 v[218:219], v24 offset:5128
    s_nop 7
    v_cndmask_b32 v60, v22, v60, s[40:41]
    v_cndmask_b32 v61, v22, v61, s[42:43]
    v_cndmask_b32 v62, v22, v62, s[44:45]
    v_cndmask_b32 v63, v22, v63, s[46:47]
    v_cndmask_b32 v124, v124, v22, s[40:41]
    v_cndmask_b32 v125, v125, v22, s[42:43]
    v_cndmask_b32 v126, v126, v22, s[44:45]
    v_cndmask_b32 v127, v127, v22, s[46:47]
    v_cndmask_b32 v128, v22, v128, s[40:41]
    v_cndmask_b32 v129, v22, v129, s[42:43]
    v_cndmask_b32 v130, v22, v130, s[44:45]
    v_cndmask_b32 v131, v22, v131, s[46:47]
    v_cndmask_b32 v192, v192, v22, s[40:41]
    v_cndmask_b32 v193, v193, v22, s[42:43]
    v_cndmask_b32 v194, v194, v22, s[44:45]
    v_cndmask_b32 v195, v195, v22, s[46:47]
    s_cmp_le_u32 s48, 0
    s_cbranch_scc1 K23_NEG0
    v_mov_b32 v60, v22
    v_mov_b32 v61, v22
    v_mov_b32 v62, v22
    v_mov_b32 v63, v22
    s_cmp_le_u32 s48, 1
    s_cbranch_scc1 K23_NEG0
    v_mov_b32 v64, v22
    v_mov_b32 v65, v22
    v_mov_b32 v66, v22
    v_mov_b32 v67, v22
    v_mov_b32 v128, v22
    v_mov_b32 v129, v22
    v_mov_b32 v130, v22
    v_mov_b32 v131, v22
    s_cmp_le_u32 s48, 2
    s_cbranch_scc1 K23_NEG0
    v_mov_b32 v68, v22
    v_mov_b32 v69, v22
    v_mov_b32 v70, v22
    v_mov_b32 v71, v22
    v_mov_b32 v132, v22
    v_mov_b32 v133, v22
    v_mov_b32 v134, v22
    v_mov_b32 v135, v22
    s_cmp_le_u32 s48, 3
    s_cbranch_scc1 K23_NEG0
    v_mov_b32 v72, v22
    v_mov_b32 v73, v22
    v_mov_b32 v74, v22
    v_mov_b32 v75, v22
    v_mov_b32 v136, v22
    v_mov_b32 v137, v22
    v_mov_b32 v138, v22
    v_mov_b32 v139, v22
    s_cmp_le_u32 s48, 4
    s_cbranch_scc1 K23_NEG0
    v_mov_b32 v76, v22
    v_mov_b32 v77, v22
    v_mov_b32 v78, v22
    v_mov_b32 v79, v22
    v_mov_b32 v140, v22
    v_mov_b32 v141, v22
    v_mov_b32 v142, v22
    v_mov_b32 v143, v22
    s_cmp_le_u32 s48, 5
    s_cbranch_scc1 K23_NEG0
    v_mov_b32 v80, v22
    v_mov_b32 v81, v22
    v_mov_b32 v82, v22
    v_mov_b32 v83, v22
    v_mov_b32 v144, v22
    v_mov_b32 v145, v22
    v_mov_b32 v146, v22
    v_mov_b32 v147, v22
    s_cmp_le_u32 s48, 6
    s_cbranch_scc1 K23_NEG0
    v_mov_b32 v84, v22
    v_mov_b32 v85, v22
    v_mov_b32 v86, v22
    v_mov_b32 v87, v22
    v_mov_b32 v148, v22
    v_mov_b32 v149, v22
    v_mov_b32 v150, v22
    v_mov_b32 v151, v22
    s_cmp_le_u32 s48, 7
    s_cbranch_scc1 K23_NEG0
    v_mov_b32 v88, v22
    v_mov_b32 v89, v22
    v_mov_b32 v90, v22
    v_mov_b32 v91, v22
    v_mov_b32 v152, v22
    v_mov_b32 v153, v22
    v_mov_b32 v154, v22
    v_mov_b32 v155, v22
    s_cmp_le_u32 s48, 8
    s_cbranch_scc1 K23_NEG0
    v_mov_b32 v92, v22
    v_mov_b32 v93, v22
    v_mov_b32 v94, v22
    v_mov_b32 v95, v22
    v_mov_b32 v156, v22
    v_mov_b32 v157, v22
    v_mov_b32 v158, v22
    v_mov_b32 v159, v22
    s_cmp_le_u32 s48, 9
    s_cbranch_scc1 K23_NEG0
    v_mov_b32 v96, v22
    v_mov_b32 v97, v22
    v_mov_b32 v98, v22
    v_mov_b32 v99, v22
    v_mov_b32 v160, v22
    v_mov_b32 v161, v22
    v_mov_b32 v162, v22
    v_mov_b32 v163, v22
    s_cmp_le_u32 s48, 10
    s_cbranch_scc1 K23_NEG0
    v_mov_b32 v100, v22
    v_mov_b32 v101, v22
    v_mov_b32 v102, v22
    v_mov_b32 v103, v22
    v_mov_b32 v164, v22
    v_mov_b32 v165, v22
    v_mov_b32 v166, v22
    v_mov_b32 v167, v22
    s_cmp_le_u32 s48, 11
    s_cbranch_scc1 K23_NEG0
    v_mov_b32 v104, v22
    v_mov_b32 v105, v22
    v_mov_b32 v106, v22
    v_mov_b32 v107, v22
    v_mov_b32 v168, v22
    v_mov_b32 v169, v22
    v_mov_b32 v170, v22
    v_mov_b32 v171, v22
    s_cmp_le_u32 s48, 12
    s_cbranch_scc1 K23_NEG0
    v_mov_b32 v108, v22
    v_mov_b32 v109, v22
    v_mov_b32 v110, v22
    v_mov_b32 v111, v22
    v_mov_b32 v172, v22
    v_mov_b32 v173, v22
    v_mov_b32 v174, v22
    v_mov_b32 v175, v22
    s_cmp_le_u32 s48, 13
    s_cbranch_scc1 K23_NEG0
    v_mov_b32 v112, v22
    v_mov_b32 v113, v22
    v_mov_b32 v114, v22
    v_mov_b32 v115, v22
    v_mov_b32 v176, v22
    v_mov_b32 v177, v22
    v_mov_b32 v178, v22
    v_mov_b32 v179, v22
    s_cmp_le_u32 s48, 14
    s_cbranch_scc1 K23_NEG0
    v_mov_b32 v116, v22
    v_mov_b32 v117, v22
    v_mov_b32 v118, v22
    v_mov_b32 v119, v22
    v_mov_b32 v180, v22
    v_mov_b32 v181, v22
    v_mov_b32 v182, v22
    v_mov_b32 v183, v22
    s_cmp_le_u32 s48, 15
    s_cbranch_scc1 K23_NEG0
    v_mov_b32 v120, v22
    v_mov_b32 v121, v22
    v_mov_b32 v122, v22
    v_mov_b32 v123, v22
    v_mov_b32 v184, v22
    v_mov_b32 v185, v22
    v_mov_b32 v186, v22
    v_mov_b32 v187, v22
K23_NEG0:
    v_max3_f32 v244, v60, v61, v62
    v_max3_f32 v245, v63, v64, v65
    v_max3_f32 v244, v244, v66, v67
    v_max3_f32 v245, v245, v68, v69
    v_max3_f32 v244, v244, v70, v71
    v_max3_f32 v245, v245, v72, v73
    v_max3_f32 v244, v244, v74, v75
    v_max3_f32 v245, v245, v76, v77
    v_max3_f32 v244, v244, v78, v79
    v_max3_f32 v245, v245, v80, v81
    v_max3_f32 v244, v244, v82, v83
    v_max3_f32 v245, v245, v84, v85
    v_max3_f32 v244, v244, v86, v87
    v_max3_f32 v245, v245, v88, v89
    v_max3_f32 v244, v244, v90, v91
    v_max3_f32 v245, v245, v92, v93
    v_max3_f32 v244, v244, v94, v95
    v_max3_f32 v245, v245, v96, v97
    v_max3_f32 v244, v244, v98, v99
    v_max3_f32 v245, v245, v100, v101
    v_max3_f32 v244, v244, v102, v103
    v_max3_f32 v245, v245, v104, v105
    v_max3_f32 v244, v244, v106, v107
    v_max3_f32 v245, v245, v108, v109
    v_max3_f32 v244, v244, v110, v111
    v_max3_f32 v245, v245, v112, v113
    v_max3_f32 v244, v244, v114, v115
    v_max3_f32 v245, v245, v116, v117
    v_max3_f32 v244, v244, v118, v119
    v_max3_f32 v245, v245, v120, v121
    v_max3_f32 v244, v244, v122, v123
    v_max3_f32 v245, v245, v124, v125
    v_max3_f32 v244, v244, v126, v127
    v_max_f32 v244, v244, v245
    v_mov_b32 v245, v244
    s_nop 1
    v_permlane32_swap_b32 v244, v245
    v_max_f32 v244, v244, v245
    v_mov_b32 v245, v244
    s_nop 1
    v_permlane16_swap_b32 v244, v245
    v_max_f32 v244, v244, v245
    v_cvt_pk_bf16_f32 v244, 0, v244
    v_mul_f32 v244, s50, v244
    v_cvt_pk_bf16_f32 v244, 0, v244
    v_mul_f32 v244, s52, v244
    v_sub_f32 v244, 0, v244
    v_mov_b32 v245, v244
    v_cvt_pk_bf16_f32 v60, 0, v60
    v_cvt_pk_bf16_f32 v61, 0, v61
    v_mul_f32 v60, s50, v60
    v_mul_f32 v61, s50, v61
    v_cvt_pk_bf16_f32 v60, 0, v60
    v_cvt_pk_bf16_f32 v61, 0, v61
    v_fma_f32 v60, v60, s52, v244
    v_fma_f32 v61, v61, s52, v244
    v_exp_f32 v60, v60
    v_exp_f32 v61, v61
    v_cvt_pk_bf16_f32 v62, 0, v62
    v_cvt_pk_bf16_f32 v63, 0, v63
    v_mul_f32 v62, s50, v62
    v_mul_f32 v63, s50, v63
    v_cvt_pk_bf16_f32 v62, 0, v62
    v_cvt_pk_bf16_f32 v63, 0, v63
    v_fma_f32 v62, v62, s52, v244
    v_fma_f32 v63, v63, s52, v244
    v_exp_f32 v62, v62
    v_exp_f32 v63, v63
    v_mov_b32 v248, v60
    v_mov_b32 v249, v61
    v_cvt_pk_bf16_f32 v64, 0, v64
    v_cvt_pk_bf16_f32 v65, 0, v65
    v_mul_f32 v64, s50, v64
    v_mul_f32 v65, s50, v65
    v_cvt_pk_bf16_f32 v64, 0, v64
    v_cvt_pk_bf16_f32 v65, 0, v65
    v_fma_f32 v64, v64, s52, v244
    v_fma_f32 v65, v65, s52, v244
    v_exp_f32 v64, v64
    v_exp_f32 v65, v65
    v_mov_b32 v250, v62
    v_mov_b32 v251, v63
    v_cvt_pk_bf16_f32 v66, 0, v66
    v_cvt_pk_bf16_f32 v67, 0, v67
    v_mul_f32 v66, s50, v66
    v_mul_f32 v67, s50, v67
    v_cvt_pk_bf16_f32 v66, 0, v66
    v_cvt_pk_bf16_f32 v67, 0, v67
    v_fma_f32 v66, v66, s52, v244
    v_fma_f32 v67, v67, s52, v244
    v_exp_f32 v66, v66
    v_exp_f32 v67, v67
    v_add_f32 v248, v248, v64
    v_add_f32 v249, v249, v65
    v_cvt_pk_bf16_f32 v68, 0, v68
    v_cvt_pk_bf16_f32 v69, 0, v69
    v_mul_f32 v68, s50, v68
    v_mul_f32 v69, s50, v69
    v_cvt_pk_bf16_f32 v68, 0, v68
    v_cvt_pk_bf16_f32 v69, 0, v69
    v_fma_f32 v68, v68, s52, v244
    v_fma_f32 v69, v69, s52, v244
    v_exp_f32 v68, v68
    v_exp_f32 v69, v69
    v_add_f32 v250, v250, v66
    v_add_f32 v251, v251, v67
    v_cvt_pk_bf16_f32 v70, 0, v70
    v_cvt_pk_bf16_f32 v71, 0, v71
    v_mul_f32 v70, s50, v70
    v_mul_f32 v71, s50, v71
    v_cvt_pk_bf16_f32 v70, 0, v70
    v_cvt_pk_bf16_f32 v71, 0, v71
    v_fma_f32 v70, v70, s52, v244
    v_fma_f32 v71, v71, s52, v244
    v_exp_f32 v70, v70
    v_exp_f32 v71, v71
    v_add_f32 v248, v248, v68
    v_add_f32 v249, v249, v69
    v_cvt_pk_bf16_f32 v72, 0, v72
    v_cvt_pk_bf16_f32 v73, 0, v73
    v_mul_f32 v72, s50, v72
    v_mul_f32 v73, s50, v73
    v_cvt_pk_bf16_f32 v72, 0, v72
    v_cvt_pk_bf16_f32 v73, 0, v73
    v_fma_f32 v72, v72, s52, v244
    v_fma_f32 v73, v73, s52, v244
    v_exp_f32 v72, v72
    v_exp_f32 v73, v73
    v_add_f32 v250, v250, v70
    v_add_f32 v251, v251, v71
    v_cvt_pk_bf16_f32 v74, 0, v74
    v_cvt_pk_bf16_f32 v75, 0, v75
    v_mul_f32 v74, s50, v74
    v_mul_f32 v75, s50, v75
    v_cvt_pk_bf16_f32 v74, 0, v74
    v_cvt_pk_bf16_f32 v75, 0, v75
    v_fma_f32 v74, v74, s52, v244
    v_fma_f32 v75, v75, s52, v244
    v_exp_f32 v74, v74
    v_exp_f32 v75, v75
    v_add_f32 v248, v248, v72
    v_add_f32 v249, v249, v73
    v_cvt_pk_bf16_f32 v76, 0, v76
    v_cvt_pk_bf16_f32 v77, 0, v77
    v_mul_f32 v76, s50, v76
    v_mul_f32 v77, s50, v77
    v_cvt_pk_bf16_f32 v76, 0, v76
    v_cvt_pk_bf16_f32 v77, 0, v77
    v_fma_f32 v76, v76, s52, v244
    v_fma_f32 v77, v77, s52, v244
    v_exp_f32 v76, v76
    v_exp_f32 v77, v77
    v_add_f32 v250, v250, v74
    v_add_f32 v251, v251, v75
    v_cvt_pk_bf16_f32 v78, 0, v78
    v_cvt_pk_bf16_f32 v79, 0, v79
    v_mul_f32 v78, s50, v78
    v_mul_f32 v79, s50, v79
    v_cvt_pk_bf16_f32 v78, 0, v78
    v_cvt_pk_bf16_f32 v79, 0, v79
    v_fma_f32 v78, v78, s52, v244
    v_fma_f32 v79, v79, s52, v244
    v_exp_f32 v78, v78
    v_exp_f32 v79, v79
    v_add_f32 v248, v248, v76
    v_add_f32 v249, v249, v77
    v_cvt_pk_bf16_f32 v80, 0, v80
    v_cvt_pk_bf16_f32 v81, 0, v81
    v_mul_f32 v80, s50, v80
    v_mul_f32 v81, s50, v81
    v_cvt_pk_bf16_f32 v80, 0, v80
    v_cvt_pk_bf16_f32 v81, 0, v81
    v_fma_f32 v80, v80, s52, v244
    v_fma_f32 v81, v81, s52, v244
    v_exp_f32 v80, v80
    v_exp_f32 v81, v81
    v_add_f32 v250, v250, v78
    v_add_f32 v251, v251, v79
    v_cvt_pk_bf16_f32 v82, 0, v82
    v_cvt_pk_bf16_f32 v83, 0, v83
    v_mul_f32 v82, s50, v82
    v_mul_f32 v83, s50, v83
    v_cvt_pk_bf16_f32 v82, 0, v82
    v_cvt_pk_bf16_f32 v83, 0, v83
    v_fma_f32 v82, v82, s52, v244
    v_fma_f32 v83, v83, s52, v244
    v_exp_f32 v82, v82
    v_exp_f32 v83, v83
    v_add_f32 v248, v248, v80
    v_add_f32 v249, v249, v81
    v_cvt_pk_bf16_f32 v84, 0, v84
    v_cvt_pk_bf16_f32 v85, 0, v85
    v_mul_f32 v84, s50, v84
    v_mul_f32 v85, s50, v85
    v_cvt_pk_bf16_f32 v84, 0, v84
    v_cvt_pk_bf16_f32 v85, 0, v85
    v_fma_f32 v84, v84, s52, v244
    v_fma_f32 v85, v85, s52, v244
    v_exp_f32 v84, v84
    v_exp_f32 v85, v85
    v_add_f32 v250, v250, v82
    v_add_f32 v251, v251, v83
    v_cvt_pk_bf16_f32 v86, 0, v86
    v_cvt_pk_bf16_f32 v87, 0, v87
    v_mul_f32 v86, s50, v86
    v_mul_f32 v87, s50, v87
    v_cvt_pk_bf16_f32 v86, 0, v86
    v_cvt_pk_bf16_f32 v87, 0, v87
    v_fma_f32 v86, v86, s52, v244
    v_fma_f32 v87, v87, s52, v244
    v_exp_f32 v86, v86
    v_exp_f32 v87, v87
    v_add_f32 v248, v248, v84
    v_add_f32 v249, v249, v85
    v_cvt_pk_bf16_f32 v88, 0, v88
    v_cvt_pk_bf16_f32 v89, 0, v89
    v_mul_f32 v88, s50, v88
    v_mul_f32 v89, s50, v89
    v_cvt_pk_bf16_f32 v88, 0, v88
    v_cvt_pk_bf16_f32 v89, 0, v89
    v_fma_f32 v88, v88, s52, v244
    v_fma_f32 v89, v89, s52, v244
    v_exp_f32 v88, v88
    v_exp_f32 v89, v89
    v_add_f32 v250, v250, v86
    v_add_f32 v251, v251, v87
    v_cvt_pk_bf16_f32 v90, 0, v90
    v_cvt_pk_bf16_f32 v91, 0, v91
    v_mul_f32 v90, s50, v90
    v_mul_f32 v91, s50, v91
    v_cvt_pk_bf16_f32 v90, 0, v90
    v_cvt_pk_bf16_f32 v91, 0, v91
    v_fma_f32 v90, v90, s52, v244
    v_fma_f32 v91, v91, s52, v244
    v_exp_f32 v90, v90
    v_exp_f32 v91, v91
    v_add_f32 v248, v248, v88
    v_add_f32 v249, v249, v89
    v_cvt_pk_bf16_f32 v92, 0, v92
    v_cvt_pk_bf16_f32 v93, 0, v93
    v_mul_f32 v92, s50, v92
    v_mul_f32 v93, s50, v93
    v_cvt_pk_bf16_f32 v92, 0, v92
    v_cvt_pk_bf16_f32 v93, 0, v93
    v_fma_f32 v92, v92, s52, v244
    v_fma_f32 v93, v93, s52, v244
    v_exp_f32 v92, v92
    v_exp_f32 v93, v93
    v_add_f32 v250, v250, v90
    v_add_f32 v251, v251, v91
    v_cvt_pk_bf16_f32 v94, 0, v94
    v_cvt_pk_bf16_f32 v95, 0, v95
    v_mul_f32 v94, s50, v94
    v_mul_f32 v95, s50, v95
    v_cvt_pk_bf16_f32 v94, 0, v94
    v_cvt_pk_bf16_f32 v95, 0, v95
    v_fma_f32 v94, v94, s52, v244
    v_fma_f32 v95, v95, s52, v244
    v_exp_f32 v94, v94
    v_exp_f32 v95, v95
    v_add_f32 v248, v248, v92
    v_add_f32 v249, v249, v93
    v_cvt_pk_bf16_f32 v96, 0, v96
    v_cvt_pk_bf16_f32 v97, 0, v97
    v_mul_f32 v96, s50, v96
    v_mul_f32 v97, s50, v97
    v_cvt_pk_bf16_f32 v96, 0, v96
    v_cvt_pk_bf16_f32 v97, 0, v97
    v_fma_f32 v96, v96, s52, v244
    v_fma_f32 v97, v97, s52, v244
    v_exp_f32 v96, v96
    v_exp_f32 v97, v97
    v_add_f32 v250, v250, v94
    v_add_f32 v251, v251, v95
    v_cvt_pk_bf16_f32 v98, 0, v98
    v_cvt_pk_bf16_f32 v99, 0, v99
    v_mul_f32 v98, s50, v98
    v_mul_f32 v99, s50, v99
    v_cvt_pk_bf16_f32 v98, 0, v98
    v_cvt_pk_bf16_f32 v99, 0, v99
    v_fma_f32 v98, v98, s52, v244
    v_fma_f32 v99, v99, s52, v244
    v_exp_f32 v98, v98
    v_exp_f32 v99, v99
    v_add_f32 v248, v248, v96
    v_add_f32 v249, v249, v97
    v_cvt_pk_bf16_f32 v100, 0, v100
    v_cvt_pk_bf16_f32 v101, 0, v101
    v_mul_f32 v100, s50, v100
    v_mul_f32 v101, s50, v101
    v_cvt_pk_bf16_f32 v100, 0, v100
    v_cvt_pk_bf16_f32 v101, 0, v101
    v_fma_f32 v100, v100, s52, v244
    v_fma_f32 v101, v101, s52, v244
    v_exp_f32 v100, v100
    v_exp_f32 v101, v101
    v_add_f32 v250, v250, v98
    v_add_f32 v251, v251, v99
    v_cvt_pk_bf16_f32 v102, 0, v102
    v_cvt_pk_bf16_f32 v103, 0, v103
    v_mul_f32 v102, s50, v102
    v_mul_f32 v103, s50, v103
    v_cvt_pk_bf16_f32 v102, 0, v102
    v_cvt_pk_bf16_f32 v103, 0, v103
    v_fma_f32 v102, v102, s52, v244
    v_fma_f32 v103, v103, s52, v244
    v_exp_f32 v102, v102
    v_exp_f32 v103, v103
    v_add_f32 v248, v248, v100
    v_add_f32 v249, v249, v101
    v_cvt_pk_bf16_f32 v104, 0, v104
    v_cvt_pk_bf16_f32 v105, 0, v105
    v_mul_f32 v104, s50, v104
    v_mul_f32 v105, s50, v105
    v_cvt_pk_bf16_f32 v104, 0, v104
    v_cvt_pk_bf16_f32 v105, 0, v105
    v_fma_f32 v104, v104, s52, v244
    v_fma_f32 v105, v105, s52, v244
    v_exp_f32 v104, v104
    v_exp_f32 v105, v105
    v_add_f32 v250, v250, v102
    v_add_f32 v251, v251, v103
    v_cvt_pk_bf16_f32 v106, 0, v106
    v_cvt_pk_bf16_f32 v107, 0, v107
    v_mul_f32 v106, s50, v106
    v_mul_f32 v107, s50, v107
    v_cvt_pk_bf16_f32 v106, 0, v106
    v_cvt_pk_bf16_f32 v107, 0, v107
    v_fma_f32 v106, v106, s52, v244
    v_fma_f32 v107, v107, s52, v244
    v_exp_f32 v106, v106
    v_exp_f32 v107, v107
    v_add_f32 v248, v248, v104
    v_add_f32 v249, v249, v105
    v_cvt_pk_bf16_f32 v108, 0, v108
    v_cvt_pk_bf16_f32 v109, 0, v109
    v_mul_f32 v108, s50, v108
    v_mul_f32 v109, s50, v109
    v_cvt_pk_bf16_f32 v108, 0, v108
    v_cvt_pk_bf16_f32 v109, 0, v109
    v_fma_f32 v108, v108, s52, v244
    v_fma_f32 v109, v109, s52, v244
    v_exp_f32 v108, v108
    v_exp_f32 v109, v109
    v_add_f32 v250, v250, v106
    v_add_f32 v251, v251, v107
    v_cvt_pk_bf16_f32 v110, 0, v110
    v_cvt_pk_bf16_f32 v111, 0, v111
    v_mul_f32 v110, s50, v110
    v_mul_f32 v111, s50, v111
    v_cvt_pk_bf16_f32 v110, 0, v110
    v_cvt_pk_bf16_f32 v111, 0, v111
    v_fma_f32 v110, v110, s52, v244
    v_fma_f32 v111, v111, s52, v244
    v_exp_f32 v110, v110
    v_exp_f32 v111, v111
    v_add_f32 v248, v248, v108
    v_add_f32 v249, v249, v109
    v_cvt_pk_bf16_f32 v112, 0, v112
    v_cvt_pk_bf16_f32 v113, 0, v113
    v_mul_f32 v112, s50, v112
    v_mul_f32 v113, s50, v113
    v_cvt_pk_bf16_f32 v112, 0, v112
    v_cvt_pk_bf16_f32 v113, 0, v113
    v_fma_f32 v112, v112, s52, v244
    v_fma_f32 v113, v113, s52, v244
    v_exp_f32 v112, v112
    v_exp_f32 v113, v113
    v_add_f32 v250, v250, v110
    v_add_f32 v251, v251, v111
    v_cvt_pk_bf16_f32 v114, 0, v114
    v_cvt_pk_bf16_f32 v115, 0, v115
    v_mul_f32 v114, s50, v114
    v_mul_f32 v115, s50, v115
    v_cvt_pk_bf16_f32 v114, 0, v114
    v_cvt_pk_bf16_f32 v115, 0, v115
    v_fma_f32 v114, v114, s52, v244
    v_fma_f32 v115, v115, s52, v244
    v_exp_f32 v114, v114
    v_exp_f32 v115, v115
    v_add_f32 v248, v248, v112
    v_add_f32 v249, v249, v113
    v_cvt_pk_bf16_f32 v116, 0, v116
    v_cvt_pk_bf16_f32 v117, 0, v117
    v_mul_f32 v116, s50, v116
    v_mul_f32 v117, s50, v117
    v_cvt_pk_bf16_f32 v116, 0, v116
    v_cvt_pk_bf16_f32 v117, 0, v117
    v_fma_f32 v116, v116, s52, v244
    v_fma_f32 v117, v117, s52, v244
    v_exp_f32 v116, v116
    v_exp_f32 v117, v117
    v_add_f32 v250, v250, v114
    v_add_f32 v251, v251, v115
    v_cvt_pk_bf16_f32 v118, 0, v118
    v_cvt_pk_bf16_f32 v119, 0, v119
    v_mul_f32 v118, s50, v118
    v_mul_f32 v119, s50, v119
    v_cvt_pk_bf16_f32 v118, 0, v118
    v_cvt_pk_bf16_f32 v119, 0, v119
    v_fma_f32 v118, v118, s52, v244
    v_fma_f32 v119, v119, s52, v244
    v_exp_f32 v118, v118
    v_exp_f32 v119, v119
    v_add_f32 v248, v248, v116
    v_add_f32 v249, v249, v117
    v_cvt_pk_bf16_f32 v120, 0, v120
    v_cvt_pk_bf16_f32 v121, 0, v121
    v_mul_f32 v120, s50, v120
    v_mul_f32 v121, s50, v121
    v_cvt_pk_bf16_f32 v120, 0, v120
    v_cvt_pk_bf16_f32 v121, 0, v121
    v_fma_f32 v120, v120, s52, v244
    v_fma_f32 v121, v121, s52, v244
    v_exp_f32 v120, v120
    v_exp_f32 v121, v121
    v_add_f32 v250, v250, v118
    v_add_f32 v251, v251, v119
    v_cvt_pk_bf16_f32 v122, 0, v122
    v_cvt_pk_bf16_f32 v123, 0, v123
    v_mul_f32 v122, s50, v122
    v_mul_f32 v123, s50, v123
    v_cvt_pk_bf16_f32 v122, 0, v122
    v_cvt_pk_bf16_f32 v123, 0, v123
    v_fma_f32 v122, v122, s52, v244
    v_fma_f32 v123, v123, s52, v244
    v_exp_f32 v122, v122
    v_exp_f32 v123, v123
    v_add_f32 v248, v248, v120
    v_add_f32 v249, v249, v121
    v_cvt_pk_bf16_f32 v124, 0, v124
    v_cvt_pk_bf16_f32 v125, 0, v125
    v_mul_f32 v124, s50, v124
    v_mul_f32 v125, s50, v125
    v_cvt_pk_bf16_f32 v124, 0, v124
    v_cvt_pk_bf16_f32 v125, 0, v125
    v_fma_f32 v124, v124, s52, v244
    v_fma_f32 v125, v125, s52, v244
    v_exp_f32 v124, v124
    v_exp_f32 v125, v125
    v_add_f32 v250, v250, v122
    v_add_f32 v251, v251, v123
    v_cvt_pk_bf16_f32 v126, 0, v126
    v_cvt_pk_bf16_f32 v127, 0, v127
    v_mul_f32 v126, s50, v126
    v_mul_f32 v127, s50, v127
    v_cvt_pk_bf16_f32 v126, 0, v126
    v_cvt_pk_bf16_f32 v127, 0, v127
    v_fma_f32 v126, v126, s52, v244
    v_fma_f32 v127, v127, s52, v244
    v_exp_f32 v126, v126
    v_exp_f32 v127, v127
    v_add_f32 v248, v248, v124
    v_add_f32 v249, v249, v125
    s_nop 0
    v_add_f32 v250, v250, v126
    v_add_f32 v251, v251, v127
    v_add_f32 v248, v248, v250
    v_add_f32 v249, v249, v251
    v_add_f32 v248, v248, v249
    v_mov_b32 v249, v248
    s_nop 1
    v_permlane32_swap_b32 v248, v249
    v_add_f32 v248, v248, v249
    v_mov_b32 v249, v248
    s_nop 1
    v_permlane16_swap_b32 v248, v249
    v_add_f32 v248, v248, v249
    v_rcp_f32 v248, v248
    s_nop 0
    v_mov_b32 v249, v248
    v_mul_f32 v60, v60, v248
    v_mul_f32 v61, v61, v249
    v_mul_f32 v62, v62, v248
    v_mul_f32 v63, v63, v249
    v_cvt_pk_bf16_f32 v252, v60, v61
    v_cvt_pk_bf16_f32 v61, v62, v63
    v_mov_b32 v60, v252
    v_mul_f32 v64, v64, v248
    v_mul_f32 v65, v65, v249
    v_mul_f32 v66, v66, v248
    v_mul_f32 v67, v67, v249
    v_cvt_pk_bf16_f32 v252, v64, v65
    v_cvt_pk_bf16_f32 v63, v66, v67
    v_mov_b32 v62, v252
    v_mul_f32 v68, v68, v248
    v_mul_f32 v69, v69, v249
    v_mul_f32 v70, v70, v248
    v_mul_f32 v71, v71, v249
    v_cvt_pk_bf16_f32 v252, v68, v69
    v_cvt_pk_bf16_f32 v69, v70, v71
    v_mov_b32 v68, v252
    v_mul_f32 v72, v72, v248
    v_mul_f32 v73, v73, v249
    v_mul_f32 v74, v74, v248
    v_mul_f32 v75, v75, v249
    v_cvt_pk_bf16_f32 v252, v72, v73
    v_cvt_pk_bf16_f32 v71, v74, v75
    v_mov_b32 v70, v252
    v_mul_f32 v76, v76, v248
    v_mul_f32 v77, v77, v249
    v_mul_f32 v78, v78, v248
    v_mul_f32 v79, v79, v249
    v_cvt_pk_bf16_f32 v252, v76, v77
    v_cvt_pk_bf16_f32 v77, v78, v79
    v_mov_b32 v76, v252
    v_mul_f32 v80, v80, v248
    v_mul_f32 v81, v81, v249
    v_mul_f32 v82, v82, v248
    v_mul_f32 v83, v83, v249
    v_cvt_pk_bf16_f32 v252, v80, v81
    v_cvt_pk_bf16_f32 v79, v82, v83
    v_mov_b32 v78, v252
    v_mul_f32 v84, v84, v248
    v_mul_f32 v85, v85, v249
    v_mul_f32 v86, v86, v248
    v_mul_f32 v87, v87, v249
    v_cvt_pk_bf16_f32 v252, v84, v85
    v_cvt_pk_bf16_f32 v85, v86, v87
    v_mov_b32 v84, v252
    v_mul_f32 v88, v88, v248
    v_mul_f32 v89, v89, v249
    v_mul_f32 v90, v90, v248
    v_mul_f32 v91, v91, v249
    v_cvt_pk_bf16_f32 v252, v88, v89
    v_cvt_pk_bf16_f32 v87, v90, v91
    v_mov_b32 v86, v252
    v_mul_f32 v92, v92, v248
    v_mul_f32 v93, v93, v249
    v_mul_f32 v94, v94, v248
    v_mul_f32 v95, v95, v249
    v_cvt_pk_bf16_f32 v252, v92, v93
    v_cvt_pk_bf16_f32 v93, v94, v95
    v_mov_b32 v92, v252
    v_mul_f32 v96, v96, v248
    v_mul_f32 v97, v97, v249
    v_mul_f32 v98, v98, v248
    v_mul_f32 v99, v99, v249
    v_cvt_pk_bf16_f32 v252, v96, v97
    v_cvt_pk_bf16_f32 v95, v98, v99
    v_mov_b32 v94, v252
    v_mul_f32 v100, v100, v248
    v_mul_f32 v101, v101, v249
    v_mul_f32 v102, v102, v248
    v_mul_f32 v103, v103, v249
    v_cvt_pk_bf16_f32 v252, v100, v101
    v_cvt_pk_bf16_f32 v101, v102, v103
    v_mov_b32 v100, v252
    v_mul_f32 v104, v104, v248
    v_mul_f32 v105, v105, v249
    v_mul_f32 v106, v106, v248
    v_mul_f32 v107, v107, v249
    v_cvt_pk_bf16_f32 v252, v104, v105
    v_cvt_pk_bf16_f32 v103, v106, v107
    v_mov_b32 v102, v252
    v_mul_f32 v108, v108, v248
    v_mul_f32 v109, v109, v249
    v_mul_f32 v110, v110, v248
    v_mul_f32 v111, v111, v249
    v_cvt_pk_bf16_f32 v252, v108, v109
    v_cvt_pk_bf16_f32 v109, v110, v111
    v_mov_b32 v108, v252
    v_mul_f32 v112, v112, v248
    v_mul_f32 v113, v113, v249
    v_mul_f32 v114, v114, v248
    v_mul_f32 v115, v115, v249
    v_cvt_pk_bf16_f32 v252, v112, v113
    v_cvt_pk_bf16_f32 v111, v114, v115
    v_mov_b32 v110, v252
    v_mul_f32 v116, v116, v248
    v_mul_f32 v117, v117, v249
    v_mul_f32 v118, v118, v248
    v_mul_f32 v119, v119, v249
    v_cvt_pk_bf16_f32 v252, v116, v117
    v_cvt_pk_bf16_f32 v117, v118, v119
    v_mov_b32 v116, v252
    v_mul_f32 v120, v120, v248
    v_mul_f32 v121, v121, v249
    v_mul_f32 v122, v122, v248
    v_mul_f32 v123, v123, v249
    v_cvt_pk_bf16_f32 v252, v120, v121
    v_cvt_pk_bf16_f32 v119, v122, v123
    v_mov_b32 v118, v252
    v_mul_f32 v124, v124, v248
    v_mul_f32 v125, v125, v249
    v_mul_f32 v126, v126, v248
    v_mul_f32 v127, v127, v249
    v_cvt_pk_bf16_f32 v252, v124, v125
    v_cvt_pk_bf16_f32 v125, v126, v127
    v_mov_b32 v124, v252
    v_mov_b32 v126, 0
    v_mov_b32 v127, 0
    v_max3_f32 v244, v128, v129, v130
    v_max3_f32 v245, v131, v132, v133
    v_max3_f32 v244, v244, v134, v135
    v_max3_f32 v245, v245, v136, v137
    v_max3_f32 v244, v244, v138, v139
    v_max3_f32 v245, v245, v140, v141
    v_max3_f32 v244, v244, v142, v143
    v_max3_f32 v245, v245, v144, v145
    v_max3_f32 v244, v244, v146, v147
    v_max3_f32 v245, v245, v148, v149
    v_max3_f32 v244, v244, v150, v151
    v_max3_f32 v245, v245, v152, v153
    v_max3_f32 v244, v244, v154, v155
    v_max3_f32 v245, v245, v156, v157
    v_max3_f32 v244, v244, v158, v159
    v_max3_f32 v245, v245, v160, v161
    v_max3_f32 v244, v244, v162, v163
    v_max3_f32 v245, v245, v164, v165
    v_max3_f32 v244, v244, v166, v167
    v_max3_f32 v245, v245, v168, v169
    v_max3_f32 v244, v244, v170, v171
    v_max3_f32 v245, v245, v172, v173
    v_max3_f32 v244, v244, v174, v175
    v_max3_f32 v245, v245, v176, v177
    v_max3_f32 v244, v244, v178, v179
    v_max3_f32 v245, v245, v180, v181
    v_max3_f32 v244, v244, v182, v183
    v_max3_f32 v245, v245, v184, v185
    v_max3_f32 v244, v244, v186, v187
    v_max3_f32 v245, v245, v188, v189
    v_max3_f32 v244, v244, v190, v191
    v_max3_f32 v245, v245, v192, v193
    v_max3_f32 v244, v244, v194, v195
    v_max_f32 v244, v244, v245
    v_mov_b32 v245, v244
    s_nop 1
    v_permlane32_swap_b32 v244, v245
    v_max_f32 v244, v244, v245
    v_mov_b32 v245, v244
    s_nop 1
    v_permlane16_swap_b32 v244, v245
    v_max_f32 v244, v244, v245
    v_cvt_pk_bf16_f32 v244, 0, v244
    v_mul_f32 v244, s50, v244
    v_cvt_pk_bf16_f32 v244, 0, v244
    v_mul_f32 v244, s52, v244
    v_sub_f32 v244, 0, v244
    v_mov_b32 v245, v244
    v_cvt_pk_bf16_f32 v128, 0, v128
    v_cvt_pk_bf16_f32 v129, 0, v129
    v_mul_f32 v128, s50, v128
    v_mul_f32 v129, s50, v129
    v_cvt_pk_bf16_f32 v128, 0, v128
    v_cvt_pk_bf16_f32 v129, 0, v129
    v_fma_f32 v128, v128, s52, v244
    v_fma_f32 v129, v129, s52, v244
    v_exp_f32 v128, v128
    v_exp_f32 v129, v129
    v_cvt_pk_bf16_f32 v130, 0, v130
    v_cvt_pk_bf16_f32 v131, 0, v131
    v_mul_f32 v130, s50, v130
    v_mul_f32 v131, s50, v131
    v_cvt_pk_bf16_f32 v130, 0, v130
    v_cvt_pk_bf16_f32 v131, 0, v131
    v_fma_f32 v130, v130, s52, v244
    v_fma_f32 v131, v131, s52, v244
    v_exp_f32 v130, v130
    v_exp_f32 v131, v131
    v_mov_b32 v248, v128
    v_mov_b32 v249, v129
    v_cvt_pk_bf16_f32 v132, 0, v132
    v_cvt_pk_bf16_f32 v133, 0, v133
    v_mul_f32 v132, s50, v132
    v_mul_f32 v133, s50, v133
    v_cvt_pk_bf16_f32 v132, 0, v132
    v_cvt_pk_bf16_f32 v133, 0, v133
    v_fma_f32 v132, v132, s52, v244
    v_fma_f32 v133, v133, s52, v244
    v_exp_f32 v132, v132
    v_exp_f32 v133, v133
    v_mov_b32 v250, v130
    v_mov_b32 v251, v131
    v_cvt_pk_bf16_f32 v134, 0, v134
    v_cvt_pk_bf16_f32 v135, 0, v135
    v_mul_f32 v134, s50, v134
    v_mul_f32 v135, s50, v135
    v_cvt_pk_bf16_f32 v134, 0, v134
    v_cvt_pk_bf16_f32 v135, 0, v135
    v_fma_f32 v134, v134, s52, v244
    v_fma_f32 v135, v135, s52, v244
    v_exp_f32 v134, v134
    v_exp_f32 v135, v135
    v_add_f32 v248, v248, v132
    v_add_f32 v249, v249, v133
    v_cvt_pk_bf16_f32 v136, 0, v136
    v_cvt_pk_bf16_f32 v137, 0, v137
    v_mul_f32 v136, s50, v136
    v_mul_f32 v137, s50, v137
    v_cvt_pk_bf16_f32 v136, 0, v136
    v_cvt_pk_bf16_f32 v137, 0, v137
    v_fma_f32 v136, v136, s52, v244
    v_fma_f32 v137, v137, s52, v244
    v_exp_f32 v136, v136
    v_exp_f32 v137, v137
    v_add_f32 v250, v250, v134
    v_add_f32 v251, v251, v135
    v_cvt_pk_bf16_f32 v138, 0, v138
    v_cvt_pk_bf16_f32 v139, 0, v139
    v_mul_f32 v138, s50, v138
    v_mul_f32 v139, s50, v139
    v_cvt_pk_bf16_f32 v138, 0, v138
    v_cvt_pk_bf16_f32 v139, 0, v139
    v_fma_f32 v138, v138, s52, v244
    v_fma_f32 v139, v139, s52, v244
    v_exp_f32 v138, v138
    v_exp_f32 v139, v139
    v_add_f32 v248, v248, v136
    v_add_f32 v249, v249, v137
    v_cvt_pk_bf16_f32 v140, 0, v140
    v_cvt_pk_bf16_f32 v141, 0, v141
    v_mul_f32 v140, s50, v140
    v_mul_f32 v141, s50, v141
    v_cvt_pk_bf16_f32 v140, 0, v140
    v_cvt_pk_bf16_f32 v141, 0, v141
    v_fma_f32 v140, v140, s52, v244
    v_fma_f32 v141, v141, s52, v244
    v_exp_f32 v140, v140
    v_exp_f32 v141, v141
    v_add_f32 v250, v250, v138
    v_add_f32 v251, v251, v139
    v_cvt_pk_bf16_f32 v142, 0, v142
    v_cvt_pk_bf16_f32 v143, 0, v143
    v_mul_f32 v142, s50, v142
    v_mul_f32 v143, s50, v143
    v_cvt_pk_bf16_f32 v142, 0, v142
    v_cvt_pk_bf16_f32 v143, 0, v143
    v_fma_f32 v142, v142, s52, v244
    v_fma_f32 v143, v143, s52, v244
    v_exp_f32 v142, v142
    v_exp_f32 v143, v143
    v_add_f32 v248, v248, v140
    v_add_f32 v249, v249, v141
    v_cvt_pk_bf16_f32 v144, 0, v144
    v_cvt_pk_bf16_f32 v145, 0, v145
    v_mul_f32 v144, s50, v144
    v_mul_f32 v145, s50, v145
    v_cvt_pk_bf16_f32 v144, 0, v144
    v_cvt_pk_bf16_f32 v145, 0, v145
    v_fma_f32 v144, v144, s52, v244
    v_fma_f32 v145, v145, s52, v244
    v_exp_f32 v144, v144
    v_exp_f32 v145, v145
    v_add_f32 v250, v250, v142
    v_add_f32 v251, v251, v143
    v_cvt_pk_bf16_f32 v146, 0, v146
    v_cvt_pk_bf16_f32 v147, 0, v147
    v_mul_f32 v146, s50, v146
    v_mul_f32 v147, s50, v147
    v_cvt_pk_bf16_f32 v146, 0, v146
    v_cvt_pk_bf16_f32 v147, 0, v147
    v_fma_f32 v146, v146, s52, v244
    v_fma_f32 v147, v147, s52, v244
    v_exp_f32 v146, v146
    v_exp_f32 v147, v147
    v_add_f32 v248, v248, v144
    v_add_f32 v249, v249, v145
    v_cvt_pk_bf16_f32 v148, 0, v148
    v_cvt_pk_bf16_f32 v149, 0, v149
    v_mul_f32 v148, s50, v148
    v_mul_f32 v149, s50, v149
    v_cvt_pk_bf16_f32 v148, 0, v148
    v_cvt_pk_bf16_f32 v149, 0, v149
    v_fma_f32 v148, v148, s52, v244
    v_fma_f32 v149, v149, s52, v244
    v_exp_f32 v148, v148
    v_exp_f32 v149, v149
    v_add_f32 v250, v250, v146
    v_add_f32 v251, v251, v147
    v_cvt_pk_bf16_f32 v150, 0, v150
    v_cvt_pk_bf16_f32 v151, 0, v151
    v_mul_f32 v150, s50, v150
    v_mul_f32 v151, s50, v151
    v_cvt_pk_bf16_f32 v150, 0, v150
    v_cvt_pk_bf16_f32 v151, 0, v151
    v_fma_f32 v150, v150, s52, v244
    v_fma_f32 v151, v151, s52, v244
    v_exp_f32 v150, v150
    v_exp_f32 v151, v151
    v_add_f32 v248, v248, v148
    v_add_f32 v249, v249, v149
    v_cvt_pk_bf16_f32 v152, 0, v152
    v_cvt_pk_bf16_f32 v153, 0, v153
    v_mul_f32 v152, s50, v152
    v_mul_f32 v153, s50, v153
    v_cvt_pk_bf16_f32 v152, 0, v152
    v_cvt_pk_bf16_f32 v153, 0, v153
    v_fma_f32 v152, v152, s52, v244
    v_fma_f32 v153, v153, s52, v244
    v_exp_f32 v152, v152
    v_exp_f32 v153, v153
    v_add_f32 v250, v250, v150
    v_add_f32 v251, v251, v151
    v_cvt_pk_bf16_f32 v154, 0, v154
    v_cvt_pk_bf16_f32 v155, 0, v155
    v_mul_f32 v154, s50, v154
    v_mul_f32 v155, s50, v155
    v_cvt_pk_bf16_f32 v154, 0, v154
    v_cvt_pk_bf16_f32 v155, 0, v155
    v_fma_f32 v154, v154, s52, v244
    v_fma_f32 v155, v155, s52, v244
    v_exp_f32 v154, v154
    v_exp_f32 v155, v155
    v_add_f32 v248, v248, v152
    v_add_f32 v249, v249, v153
    v_cvt_pk_bf16_f32 v156, 0, v156
    v_cvt_pk_bf16_f32 v157, 0, v157
    v_mul_f32 v156, s50, v156
    v_mul_f32 v157, s50, v157
    v_cvt_pk_bf16_f32 v156, 0, v156
    v_cvt_pk_bf16_f32 v157, 0, v157
    v_fma_f32 v156, v156, s52, v244
    v_fma_f32 v157, v157, s52, v244
    v_exp_f32 v156, v156
    v_exp_f32 v157, v157
    v_add_f32 v250, v250, v154
    v_add_f32 v251, v251, v155
    v_cvt_pk_bf16_f32 v158, 0, v158
    v_cvt_pk_bf16_f32 v159, 0, v159
    v_mul_f32 v158, s50, v158
    v_mul_f32 v159, s50, v159
    v_cvt_pk_bf16_f32 v158, 0, v158
    v_cvt_pk_bf16_f32 v159, 0, v159
    v_fma_f32 v158, v158, s52, v244
    v_fma_f32 v159, v159, s52, v244
    v_exp_f32 v158, v158
    v_exp_f32 v159, v159
    v_add_f32 v248, v248, v156
    v_add_f32 v249, v249, v157
    v_cvt_pk_bf16_f32 v160, 0, v160
    v_cvt_pk_bf16_f32 v161, 0, v161
    v_mul_f32 v160, s50, v160
    v_mul_f32 v161, s50, v161
    v_cvt_pk_bf16_f32 v160, 0, v160
    v_cvt_pk_bf16_f32 v161, 0, v161
    v_fma_f32 v160, v160, s52, v244
    v_fma_f32 v161, v161, s52, v244
    v_exp_f32 v160, v160
    v_exp_f32 v161, v161
    v_add_f32 v250, v250, v158
    v_add_f32 v251, v251, v159
    v_cvt_pk_bf16_f32 v162, 0, v162
    v_cvt_pk_bf16_f32 v163, 0, v163
    v_mul_f32 v162, s50, v162
    v_mul_f32 v163, s50, v163
    v_cvt_pk_bf16_f32 v162, 0, v162
    v_cvt_pk_bf16_f32 v163, 0, v163
    v_fma_f32 v162, v162, s52, v244
    v_fma_f32 v163, v163, s52, v244
    v_exp_f32 v162, v162
    v_exp_f32 v163, v163
    v_add_f32 v248, v248, v160
    v_add_f32 v249, v249, v161
    v_cvt_pk_bf16_f32 v164, 0, v164
    v_cvt_pk_bf16_f32 v165, 0, v165
    v_mul_f32 v164, s50, v164
    v_mul_f32 v165, s50, v165
    v_cvt_pk_bf16_f32 v164, 0, v164
    v_cvt_pk_bf16_f32 v165, 0, v165
    v_fma_f32 v164, v164, s52, v244
    v_fma_f32 v165, v165, s52, v244
    v_exp_f32 v164, v164
    v_exp_f32 v165, v165
    v_add_f32 v250, v250, v162
    v_add_f32 v251, v251, v163
    v_cvt_pk_bf16_f32 v166, 0, v166
    v_cvt_pk_bf16_f32 v167, 0, v167
    v_mul_f32 v166, s50, v166
    v_mul_f32 v167, s50, v167
    v_cvt_pk_bf16_f32 v166, 0, v166
    v_cvt_pk_bf16_f32 v167, 0, v167
    v_fma_f32 v166, v166, s52, v244
    v_fma_f32 v167, v167, s52, v244
    v_exp_f32 v166, v166
    v_exp_f32 v167, v167
    v_add_f32 v248, v248, v164
    v_add_f32 v249, v249, v165
    v_cvt_pk_bf16_f32 v168, 0, v168
    v_cvt_pk_bf16_f32 v169, 0, v169
    v_mul_f32 v168, s50, v168
    v_mul_f32 v169, s50, v169
    v_cvt_pk_bf16_f32 v168, 0, v168
    v_cvt_pk_bf16_f32 v169, 0, v169
    v_fma_f32 v168, v168, s52, v244
    v_fma_f32 v169, v169, s52, v244
    v_exp_f32 v168, v168
    v_exp_f32 v169, v169
    v_add_f32 v250, v250, v166
    v_add_f32 v251, v251, v167
    v_cvt_pk_bf16_f32 v170, 0, v170
    v_cvt_pk_bf16_f32 v171, 0, v171
    v_mul_f32 v170, s50, v170
    v_mul_f32 v171, s50, v171
    v_cvt_pk_bf16_f32 v170, 0, v170
    v_cvt_pk_bf16_f32 v171, 0, v171
    v_fma_f32 v170, v170, s52, v244
    v_fma_f32 v171, v171, s52, v244
    v_exp_f32 v170, v170
    v_exp_f32 v171, v171
    v_add_f32 v248, v248, v168
    v_add_f32 v249, v249, v169
    v_cvt_pk_bf16_f32 v172, 0, v172
    v_cvt_pk_bf16_f32 v173, 0, v173
    v_mul_f32 v172, s50, v172
    v_mul_f32 v173, s50, v173
    v_cvt_pk_bf16_f32 v172, 0, v172
    v_cvt_pk_bf16_f32 v173, 0, v173
    v_fma_f32 v172, v172, s52, v244
    v_fma_f32 v173, v173, s52, v244
    v_exp_f32 v172, v172
    v_exp_f32 v173, v173
    v_add_f32 v250, v250, v170
    v_add_f32 v251, v251, v171
    v_cvt_pk_bf16_f32 v174, 0, v174
    v_cvt_pk_bf16_f32 v175, 0, v175
    v_mul_f32 v174, s50, v174
    v_mul_f32 v175, s50, v175
    v_cvt_pk_bf16_f32 v174, 0, v174
    v_cvt_pk_bf16_f32 v175, 0, v175
    v_fma_f32 v174, v174, s52, v244
    v_fma_f32 v175, v175, s52, v244
    v_exp_f32 v174, v174
    v_exp_f32 v175, v175
    v_add_f32 v248, v248, v172
    v_add_f32 v249, v249, v173
    v_cvt_pk_bf16_f32 v176, 0, v176
    v_cvt_pk_bf16_f32 v177, 0, v177
    v_mul_f32 v176, s50, v176
    v_mul_f32 v177, s50, v177
    v_cvt_pk_bf16_f32 v176, 0, v176
    v_cvt_pk_bf16_f32 v177, 0, v177
    v_fma_f32 v176, v176, s52, v244
    v_fma_f32 v177, v177, s52, v244
    v_exp_f32 v176, v176
    v_exp_f32 v177, v177
    v_add_f32 v250, v250, v174
    v_add_f32 v251, v251, v175
    v_cvt_pk_bf16_f32 v178, 0, v178
    v_cvt_pk_bf16_f32 v179, 0, v179
    v_mul_f32 v178, s50, v178
    v_mul_f32 v179, s50, v179
    v_cvt_pk_bf16_f32 v178, 0, v178
    v_cvt_pk_bf16_f32 v179, 0, v179
    v_fma_f32 v178, v178, s52, v244
    v_fma_f32 v179, v179, s52, v244
    v_exp_f32 v178, v178
    v_exp_f32 v179, v179
    v_add_f32 v248, v248, v176
    v_add_f32 v249, v249, v177
    v_cvt_pk_bf16_f32 v180, 0, v180
    v_cvt_pk_bf16_f32 v181, 0, v181
    v_mul_f32 v180, s50, v180
    v_mul_f32 v181, s50, v181
    v_cvt_pk_bf16_f32 v180, 0, v180
    v_cvt_pk_bf16_f32 v181, 0, v181
    v_fma_f32 v180, v180, s52, v244
    v_fma_f32 v181, v181, s52, v244
    v_exp_f32 v180, v180
    v_exp_f32 v181, v181
    v_add_f32 v250, v250, v178
    v_add_f32 v251, v251, v179
    v_cvt_pk_bf16_f32 v182, 0, v182
    v_cvt_pk_bf16_f32 v183, 0, v183
    v_mul_f32 v182, s50, v182
    v_mul_f32 v183, s50, v183
    v_cvt_pk_bf16_f32 v182, 0, v182
    v_cvt_pk_bf16_f32 v183, 0, v183
    v_fma_f32 v182, v182, s52, v244
    v_fma_f32 v183, v183, s52, v244
    v_exp_f32 v182, v182
    v_exp_f32 v183, v183
    v_add_f32 v248, v248, v180
    v_add_f32 v249, v249, v181
    v_cvt_pk_bf16_f32 v184, 0, v184
    v_cvt_pk_bf16_f32 v185, 0, v185
    v_mul_f32 v184, s50, v184
    v_mul_f32 v185, s50, v185
    v_cvt_pk_bf16_f32 v184, 0, v184
    v_cvt_pk_bf16_f32 v185, 0, v185
    v_fma_f32 v184, v184, s52, v244
    v_fma_f32 v185, v185, s52, v244
    v_exp_f32 v184, v184
    v_exp_f32 v185, v185
    v_add_f32 v250, v250, v182
    v_add_f32 v251, v251, v183
    v_cvt_pk_bf16_f32 v186, 0, v186
    v_cvt_pk_bf16_f32 v187, 0, v187
    v_mul_f32 v186, s50, v186
    v_mul_f32 v187, s50, v187
    v_cvt_pk_bf16_f32 v186, 0, v186
    v_cvt_pk_bf16_f32 v187, 0, v187
    v_fma_f32 v186, v186, s52, v244
    v_fma_f32 v187, v187, s52, v244
    v_exp_f32 v186, v186
    v_exp_f32 v187, v187
    v_add_f32 v248, v248, v184
    v_add_f32 v249, v249, v185
    v_cvt_pk_bf16_f32 v188, 0, v188
    v_cvt_pk_bf16_f32 v189, 0, v189
    v_mul_f32 v188, s50, v188
    v_mul_f32 v189, s50, v189
    v_cvt_pk_bf16_f32 v188, 0, v188
    v_cvt_pk_bf16_f32 v189, 0, v189
    v_fma_f32 v188, v188, s52, v244
    v_fma_f32 v189, v189, s52, v244
    v_exp_f32 v188, v188
    v_exp_f32 v189, v189
    v_add_f32 v250, v250, v186
    v_add_f32 v251, v251, v187
    v_cvt_pk_bf16_f32 v190, 0, v190
    v_cvt_pk_bf16_f32 v191, 0, v191
    v_mul_f32 v190, s50, v190
    v_mul_f32 v191, s50, v191
    v_cvt_pk_bf16_f32 v190, 0, v190
    v_cvt_pk_bf16_f32 v191, 0, v191
    v_fma_f32 v190, v190, s52, v244
    v_fma_f32 v191, v191, s52, v244
    v_exp_f32 v190, v190
    v_exp_f32 v191, v191
    v_add_f32 v248, v248, v188
    v_add_f32 v249, v249, v189
    v_cvt_pk_bf16_f32 v192, 0, v192
    v_cvt_pk_bf16_f32 v193, 0, v193
    v_mul_f32 v192, s50, v192
    v_mul_f32 v193, s50, v193
    v_cvt_pk_bf16_f32 v192, 0, v192
    v_cvt_pk_bf16_f32 v193, 0, v193
    v_fma_f32 v192, v192, s52, v244
    v_fma_f32 v193, v193, s52, v244
    v_exp_f32 v192, v192
    v_exp_f32 v193, v193
    v_add_f32 v250, v250, v190
    v_add_f32 v251, v251, v191
    v_cvt_pk_bf16_f32 v194, 0, v194
    v_cvt_pk_bf16_f32 v195, 0, v195
    v_mul_f32 v194, s50, v194
    v_mul_f32 v195, s50, v195
    v_cvt_pk_bf16_f32 v194, 0, v194
    v_cvt_pk_bf16_f32 v195, 0, v195
    v_fma_f32 v194, v194, s52, v244
    v_fma_f32 v195, v195, s52, v244
    v_exp_f32 v194, v194
    v_exp_f32 v195, v195
    v_add_f32 v248, v248, v192
    v_add_f32 v249, v249, v193
    s_nop 0
    v_add_f32 v250, v250, v194
    v_add_f32 v251, v251, v195
    v_add_f32 v248, v248, v250
    v_add_f32 v249, v249, v251
    v_add_f32 v248, v248, v249
    v_mov_b32 v249, v248
    s_nop 1
    v_permlane32_swap_b32 v248, v249
    v_add_f32 v248, v248, v249
    v_mov_b32 v249, v248
    s_nop 1
    v_permlane16_swap_b32 v248, v249
    v_add_f32 v248, v248, v249
    v_rcp_f32 v248, v248
    s_nop 0
    v_mov_b32 v249, v248
    v_mul_f32 v192, v192, v248
    v_mul_f32 v193, v193, v249
    v_mul_f32 v194, v194, v248
    v_mul_f32 v195, v195, v249
    v_cvt_pk_bf16_f32 v252, v192, v193
    v_cvt_pk_bf16_f32 v195, v194, v195
    v_mov_b32 v194, v252
    v_mul_f32 v188, v188, v248
    v_mul_f32 v189, v189, v249
    v_mul_f32 v190, v190, v248
    v_mul_f32 v191, v191, v249
    v_cvt_pk_bf16_f32 v252, v188, v189
    v_cvt_pk_bf16_f32 v193, v190, v191
    v_mov_b32 v192, v252
    v_mul_f32 v184, v184, v248
    v_mul_f32 v185, v185, v249
    v_mul_f32 v186, v186, v248
    v_mul_f32 v187, v187, v249
    v_cvt_pk_bf16_f32 v252, v184, v185
    v_cvt_pk_bf16_f32 v187, v186, v187
    v_mov_b32 v186, v252
    v_mul_f32 v180, v180, v248
    v_mul_f32 v181, v181, v249
    v_mul_f32 v182, v182, v248
    v_mul_f32 v183, v183, v249
    v_cvt_pk_bf16_f32 v252, v180, v181
    v_cvt_pk_bf16_f32 v185, v182, v183
    v_mov_b32 v184, v252
    v_mul_f32 v176, v176, v248
    v_mul_f32 v177, v177, v249
    v_mul_f32 v178, v178, v248
    v_mul_f32 v179, v179, v249
    v_cvt_pk_bf16_f32 v252, v176, v177
    v_cvt_pk_bf16_f32 v179, v178, v179
    v_mov_b32 v178, v252
    v_mul_f32 v172, v172, v248
    v_mul_f32 v173, v173, v249
    v_mul_f32 v174, v174, v248
    v_mul_f32 v175, v175, v249
    v_cvt_pk_bf16_f32 v252, v172, v173
    v_cvt_pk_bf16_f32 v177, v174, v175
    v_mov_b32 v176, v252
    v_mul_f32 v168, v168, v248
    v_mul_f32 v169, v169, v249
    v_mul_f32 v170, v170, v248
    v_mul_f32 v171, v171, v249
    v_cvt_pk_bf16_f32 v252, v168, v169
    v_cvt_pk_bf16_f32 v171, v170, v171
    v_mov_b32 v170, v252
    v_mul_f32 v164, v164, v248
    v_mul_f32 v165, v165, v249
    v_mul_f32 v166, v166, v248
    v_mul_f32 v167, v167, v249
    v_cvt_pk_bf16_f32 v252, v164, v165
    v_cvt_pk_bf16_f32 v169, v166, v167
    v_mov_b32 v168, v252
    v_mul_f32 v160, v160, v248
    v_mul_f32 v161, v161, v249
    v_mul_f32 v162, v162, v248
    v_mul_f32 v163, v163, v249
    v_cvt_pk_bf16_f32 v252, v160, v161
    v_cvt_pk_bf16_f32 v163, v162, v163
    v_mov_b32 v162, v252
    v_mul_f32 v156, v156, v248
    v_mul_f32 v157, v157, v249
    v_mul_f32 v158, v158, v248
    v_mul_f32 v159, v159, v249
    v_cvt_pk_bf16_f32 v252, v156, v157
    v_cvt_pk_bf16_f32 v161, v158, v159
    v_mov_b32 v160, v252
    v_mul_f32 v152, v152, v248
    v_mul_f32 v153, v153, v249
    v_mul_f32 v154, v154, v248
    v_mul_f32 v155, v155, v249
    v_cvt_pk_bf16_f32 v252, v152, v153
    v_cvt_pk_bf16_f32 v155, v154, v155
    v_mov_b32 v154, v252
    v_mul_f32 v148, v148, v248
    v_mul_f32 v149, v149, v249
    v_mul_f32 v150, v150, v248
    v_mul_f32 v151, v151, v249
    v_cvt_pk_bf16_f32 v252, v148, v149
    v_cvt_pk_bf16_f32 v153, v150, v151
    v_mov_b32 v152, v252
    v_mul_f32 v144, v144, v248
    v_mul_f32 v145, v145, v249
    v_mul_f32 v146, v146, v248
    v_mul_f32 v147, v147, v249
    v_cvt_pk_bf16_f32 v252, v144, v145
    v_cvt_pk_bf16_f32 v147, v146, v147
    v_mov_b32 v146, v252
    v_mul_f32 v140, v140, v248
    v_mul_f32 v141, v141, v249
    v_mul_f32 v142, v142, v248
    v_mul_f32 v143, v143, v249
    v_cvt_pk_bf16_f32 v252, v140, v141
    v_cvt_pk_bf16_f32 v145, v142, v143
    v_mov_b32 v144, v252
    v_mul_f32 v136, v136, v248
    v_mul_f32 v137, v137, v249
    v_mul_f32 v138, v138, v248
    v_mul_f32 v139, v139, v249
    v_cvt_pk_bf16_f32 v252, v136, v137
    v_cvt_pk_bf16_f32 v139, v138, v139
    v_mov_b32 v138, v252
    v_mul_f32 v132, v132, v248
    v_mul_f32 v133, v133, v249
    v_mul_f32 v134, v134, v248
    v_mul_f32 v135, v135, v249
    v_cvt_pk_bf16_f32 v252, v132, v133
    v_cvt_pk_bf16_f32 v137, v134, v135
    v_mov_b32 v136, v252
    v_mul_f32 v128, v128, v248
    v_mul_f32 v129, v129, v249
    v_mul_f32 v130, v130, v248
    v_mul_f32 v131, v131, v249
    v_cvt_pk_bf16_f32 v252, v128, v129
    v_cvt_pk_bf16_f32 v131, v130, v131
    v_mov_b32 v130, v252
    v_mov_b32 v128, 0
    v_mov_b32 v129, 0
    s_nop 1
    ds_read_b64_tr_b16 v[220:221], v24 offset:6144
    ds_read_b64_tr_b16 v[222:223], v24 offset:7168
    s_waitcnt lgkmcnt(12)
    v_mfma_f32_16x16x32_bf16 v[228:231], v[196:199], v[60:63], 0
    v_mfma_f32_16x16x32_bf16 v[236:239], v[196:199], v[128:131], 0
    ds_read_b64_tr_b16 v[224:225], v24 offset:6152
    ds_read_b64_tr_b16 v[226:227], v24 offset:7176
    s_waitcnt lgkmcnt(12)
    v_mfma_f32_16x16x32_bf16 v[232:235], v[200:203], v[60:63], 0
    v_mfma_f32_16x16x32_bf16 v[240:243], v[200:203], v[128:131], 0
    ds_read_b64_tr_b16 v[196:197], v24 offset:8192
    ds_read_b64_tr_b16 v[198:199], v24 offset:9216
    s_waitcnt lgkmcnt(12)
    v_mfma_f32_16x16x32_bf16 v[228:231], v[204:207], v[68:71], v[228:231]
    v_mfma_f32_16x16x32_bf16 v[236:239], v[204:207], v[136:139], v[236:239]
    ds_read_b64_tr_b16 v[200:201], v24 offset:8200
    ds_read_b64_tr_b16 v[202:203], v24 offset:9224
    s_waitcnt lgkmcnt(12)
    v_mfma_f32_16x16x32_bf16 v[232:235], v[208:211], v[68:71], v[232:235]
    v_mfma_f32_16x16x32_bf16 v[240:243], v[208:211], v[136:139], v[240:243]
    ds_read_b64_tr_b16 v[204:205], v24 offset:10240
    ds_read_b64_tr_b16 v[206:207], v24 offset:11264
    s_waitcnt lgkmcnt(12)
    v_mfma_f32_16x16x32_bf16 v[228:231], v[212:215], v[76:79], v[228:231]
    v_mfma_f32_16x16x32_bf16 v[236:239], v[212:215], v[144:147], v[236:239]
    ds_read_b64_tr_b16 v[208:209], v24 offset:10248
    ds_read_b64_tr_b16 v[210:211], v24 offset:11272
    s_waitcnt lgkmcnt(12)
    v_mfma_f32_16x16x32_bf16 v[232:235], v[216:219], v[76:79], v[232:235]
    v_mfma_f32_16x16x32_bf16 v[240:243], v[216:219], v[144:147], v[240:243]
    ds_read_b64_tr_b16 v[212:213], v24 offset:12288
    ds_read_b64_tr_b16 v[214:215], v24 offset:13312
    s_waitcnt lgkmcnt(12)
    v_mfma_f32_16x16x32_bf16 v[228:231], v[220:223], v[84:87], v[228:231]
    v_mfma_f32_16x16x32_bf16 v[236:239], v[220:223], v[152:155], v[236:239]
    ds_read_b64_tr_b16 v[216:217], v24 offset:12296
    ds_read_b64_tr_b16 v[218:219], v24 offset:13320
    s_waitcnt lgkmcnt(12)
    v_mfma_f32_16x16x32_bf16 v[232:235], v[224:227], v[84:87], v[232:235]
    v_mfma_f32_16x16x32_bf16 v[240:243], v[224:227], v[152:155], v[240:243]
    ds_read_b64_tr_b16 v[220:221], v24 offset:14336
    ds_read_b64_tr_b16 v[222:223], v24 offset:15360
    s_waitcnt lgkmcnt(12)
    v_mfma_f32_16x16x32_bf16 v[228:231], v[196:199], v[92:95], v[228:231]
    v_mfma_f32_16x16x32_bf16 v[236:239], v[196:199], v[160:163], v[236:239]
    ds_read_b64_tr_b16 v[224:225], v24 offset:14344
    ds_read_b64_tr_b16 v[226:227], v24 offset:15368
    s_waitcnt lgkmcnt(12)
    v_mfma_f32_16x16x32_bf16 v[232:235], v[200:203], v[92:95], v[232:235]
    v_mfma_f32_16x16x32_bf16 v[240:243], v[200:203], v[160:163], v[240:243]
    ds_read_b64_tr_b16 v[196:197], v24 offset:16384
    ds_read_b64_tr_b16 v[198:199], v24 offset:17408
    s_waitcnt lgkmcnt(12)
    v_mfma_f32_16x16x32_bf16 v[228:231], v[204:207], v[100:103], v[228:231]
    v_mfma_f32_16x16x32_bf16 v[236:239], v[204:207], v[168:171], v[236:239]
    ds_read_b64_tr_b16 v[200:201], v24 offset:16392
    ds_read_b64_tr_b16 v[202:203], v24 offset:17416
    s_waitcnt lgkmcnt(12)
    v_mfma_f32_16x16x32_bf16 v[232:235], v[208:211], v[100:103], v[232:235]
    v_mfma_f32_16x16x32_bf16 v[240:243], v[208:211], v[168:171], v[240:243]
    s_waitcnt lgkmcnt(10)
    v_mfma_f32_16x16x32_bf16 v[228:231], v[212:215], v[108:111], v[228:231]
    v_mfma_f32_16x16x32_bf16 v[236:239], v[212:215], v[176:179], v[236:239]
    s_waitcnt lgkmcnt(8)
    v_mfma_f32_16x16x32_bf16 v[232:235], v[216:219], v[108:111], v[232:235]
    v_mfma_f32_16x16x32_bf16 v[240:243], v[216:219], v[176:179], v[240:243]
    s_waitcnt lgkmcnt(6)
    v_mfma_f32_16x16x32_bf16 v[228:231], v[220:223], v[116:119], v[228:231]
    v_mfma_f32_16x16x32_bf16 v[236:239], v[220:223], v[184:187], v[236:239]
    s_waitcnt lgkmcnt(4)
    v_mfma_f32_16x16x32_bf16 v[232:235], v[224:227], v[116:119], v[232:235]
    v_mfma_f32_16x16x32_bf16 v[240:243], v[224:227], v[184:187], v[240:243]
    s_waitcnt lgkmcnt(2)
    v_mfma_f32_16x16x32_bf16 v[228:231], v[196:199], v[124:127], v[228:231]
    v_mfma_f32_16x16x32_bf16 v[236:239], v[196:199], v[192:195], v[236:239]
    s_waitcnt lgkmcnt(0)
    v_mfma_f32_16x16x32_bf16 v[232:235], v[200:203], v[124:127], v[232:235]
    v_mfma_f32_16x16x32_bf16 v[240:243], v[200:203], v[192:195], v[240:243]
    s_mul_i32 s19, s54, 144
    s_add_u32 s19, s19, s36
    s_lshl_b32 s19, s19, 10
    s_add_u32 s20, s19, 147456
    s_nop 7
    v_cvt_pk_bf16_f32 v244, v228, v229
    v_cvt_pk_bf16_f32 v245, v230, v231
    v_cvt_pk_bf16_f32 v246, v232, v233
    v_cvt_pk_bf16_f32 v247, v234, v235
    buffer_store_dwordx4 v[244:247], v2, s[28:31], s19 offen sc1
    v_cvt_pk_bf16_f32 v248, v236, v237
    v_cvt_pk_bf16_f32 v249, v238, v239
    v_cvt_pk_bf16_f32 v250, v240, v241
    v_cvt_pk_bf16_f32 v251, v242, v243
    buffer_store_dwordx4 v[248:251], v2, s[28:31], s20 offen sc1
    s_add_u32 s54, s54, 8
    s_sub_u32 s48, 16, s54
    s_max_i32 s48, s48, 0
    ds_read_b128 v[28:31], v23 offset:8192
    ds_read_b128 v[32:35], v23 offset:9216
    ds_read_b128 v[36:39], v23 offset:10240
    ds_read_b128 v[40:43], v23 offset:11264
    ds_read_b128 v[44:47], v23 offset:12288
    ds_read_b128 v[48:51], v23 offset:13312
    ds_read_b128 v[52:55], v23 offset:14336
    s_waitcnt lgkmcnt(6)
    v_mfma_f32_16x16x32_bf16 v[60:63], v[28:31], v[12:15], 0
    ds_read_b128 v[56:59], v23 offset:15360
    s_waitcnt lgkmcnt(6)
    v_mfma_f32_16x16x32_bf16 v[64:67], v[32:35], v[12:15], 0
    v_mfma_f32_16x16x32_bf16 v[128:131], v[32:35], v[16:19], 0
    ds_read_b128 v[28:31], v23 offset:16384
    s_waitcnt lgkmcnt(6)
    v_mfma_f32_16x16x32_bf16 v[68:71], v[36:39], v[12:15], 0
    v_mfma_f32_16x16x32_bf16 v[132:135], v[36:39], v[16:19], 0
    ds_read_b128 v[32:35], v23 offset:17408
    s_waitcnt lgkmcnt(6)
    v_mfma_f32_16x16x32_bf16 v[72:75], v[40:43], v[12:15], 0
    v_mfma_f32_16x16x32_bf16 v[136:139], v[40:43], v[16:19], 0
    ds_read_b128 v[36:39], v23 offset:18432
    s_waitcnt lgkmcnt(6)
    v_mfma_f32_16x16x32_bf16 v[76:79], v[44:47], v[12:15], 0
    v_mfma_f32_16x16x32_bf16 v[140:143], v[44:47], v[16:19], 0
    ds_read_b128 v[40:43], v23 offset:19456
    s_waitcnt lgkmcnt(6)
    v_mfma_f32_16x16x32_bf16 v[80:83], v[48:51], v[12:15], 0
    v_mfma_f32_16x16x32_bf16 v[144:147], v[48:51], v[16:19], 0
    ds_read_b128 v[44:47], v23 offset:20480
    s_waitcnt lgkmcnt(6)
    v_mfma_f32_16x16x32_bf16 v[84:87], v[52:55], v[12:15], 0
    v_mfma_f32_16x16x32_bf16 v[148:151], v[52:55], v[16:19], 0
    ds_read_b128 v[48:51], v23 offset:21504
    s_waitcnt lgkmcnt(6)
    v_mfma_f32_16x16x32_bf16 v[88:91], v[56:59], v[12:15], 0
    v_mfma_f32_16x16x32_bf16 v[152:155], v[56:59], v[16:19], 0
    ds_read_b128 v[52:55], v23 offset:22528
    s_waitcnt lgkmcnt(6)
    v_mfma_f32_16x16x32_bf16 v[92:95], v[28:31], v[12:15], 0
    v_mfma_f32_16x16x32_bf16 v[156:159], v[28:31], v[16:19], 0
    ds_read_b128 v[56:59], v23 offset:23552
    s_waitcnt lgkmcnt(6)
    v_mfma_f32_16x16x32_bf16 v[96:99], v[32:35], v[12:15], 0
    v_mfma_f32_16x16x32_bf16 v[160:163], v[32:35], v[16:19], 0
    ds_read_b128 v[28:31], v23 offset:24576
    s_waitcnt lgkmcnt(6)
    v_mfma_f32_16x16x32_bf16 v[100:103], v[36:39], v[12:15], 0
    v_mfma_f32_16x16x32_bf16 v[164:167], v[36:39], v[16:19], 0
    ds_read_b128 v[32:35], v23 offset:25600
    s_waitcnt lgkmcnt(6)
    v_mfma_f32_16x16x32_bf16 v[104:107], v[40:43], v[12:15], 0
    v_mfma_f32_16x16x32_bf16 v[168:171], v[40:43], v[16:19], 0
    s_waitcnt lgkmcnt(5)
    v_mfma_f32_16x16x32_bf16 v[108:111], v[44:47], v[12:15], 0
    v_mfma_f32_16x16x32_bf16 v[172:175], v[44:47], v[16:19], 0
    s_waitcnt lgkmcnt(4)
    v_mfma_f32_16x16x32_bf16 v[112:115], v[48:51], v[12:15], 0
    v_mfma_f32_16x16x32_bf16 v[176:179], v[48:51], v[16:19], 0
    s_waitcnt lgkmcnt(3)
    v_mfma_f32_16x16x32_bf16 v[116:119], v[52:55], v[12:15], 0
    v_mfma_f32_16x16x32_bf16 v[180:183], v[52:55], v[16:19], 0
    s_waitcnt lgkmcnt(2)
    v_mfma_f32_16x16x32_bf16 v[120:123], v[56:59], v[12:15], 0
    v_mfma_f32_16x16x32_bf16 v[184:187], v[56:59], v[16:19], 0
    s_waitcnt lgkmcnt(1)
    v_mfma_f32_16x16x32_bf16 v[124:127], v[28:31], v[12:15], 0
    v_mfma_f32_16x16x32_bf16 v[188:191], v[28:31], v[16:19], 0
    s_waitcnt lgkmcnt(0)
    v_mfma_f32_16x16x32_bf16 v[192:195], v[32:35], v[16:19], 0
    ds_read_b64_tr_b16 v[196:197], v24 offset:8192
    ds_read_b64_tr_b16 v[198:199], v24 offset:9216
    ds_read_b64_tr_b16 v[200:201], v24 offset:8200
    ds_read_b64_tr_b16 v[202:203], v24 offset:9224
    ds_read_b64_tr_b16 v[204:205], v24 offset:10240
    ds_read_b64_tr_b16 v[206:207], v24 offset:11264
    ds_read_b64_tr_b16 v[208:209], v24 offset:10248
    ds_read_b64_tr_b16 v[210:211], v24 offset:11272
    ds_read_b64_tr_b16 v[212:213], v24 offset:12288
    ds_read_b64_tr_b16 v[214:215], v24 offset:13312
    ds_read_b64_tr_b16 v[216:217], v24 offset:12296
    ds_read_b64_tr_b16 v[218:219], v24 offset:13320
    s_nop 7
    v_cndmask_b32 v60, v22, v60, s[40:41]
    v_cndmask_b32 v61, v22, v61, s[42:43]
    v_cndmask_b32 v62, v22, v62, s[44:45]
    v_cndmask_b32 v63, v22, v63, s[46:47]
    v_cndmask_b32 v124, v124, v22, s[40:41]
    v_cndmask_b32 v125, v125, v22, s[42:43]
    v_cndmask_b32 v126, v126, v22, s[44:45]
    v_cndmask_b32 v127, v127, v22, s[46:47]
    v_cndmask_b32 v128, v22, v128, s[40:41]
    v_cndmask_b32 v129, v22, v129, s[42:43]
    v_cndmask_b32 v130, v22, v130, s[44:45]
    v_cndmask_b32 v131, v22, v131, s[46:47]
    v_cndmask_b32 v192, v192, v22, s[40:41]
    v_cndmask_b32 v193, v193, v22, s[42:43]
    v_cndmask_b32 v194, v194, v22, s[44:45]
    v_cndmask_b32 v195, v195, v22, s[46:47]
    s_cmp_le_u32 s48, 0
    s_cbranch_scc1 K23_NEG1
    v_mov_b32 v60, v22
    v_mov_b32 v61, v22
    v_mov_b32 v62, v22
    v_mov_b32 v63, v22
    s_cmp_le_u32 s48, 1
    s_cbranch_scc1 K23_NEG1
    v_mov_b32 v64, v22
    v_mov_b32 v65, v22
    v_mov_b32 v66, v22
    v_mov_b32 v67, v22
    v_mov_b32 v128, v22
    v_mov_b32 v129, v22
    v_mov_b32 v130, v22
    v_mov_b32 v131, v22
    s_cmp_le_u32 s48, 2
    s_cbranch_scc1 K23_NEG1
    v_mov_b32 v68, v22
    v_mov_b32 v69, v22
    v_mov_b32 v70, v22
    v_mov_b32 v71, v22
    v_mov_b32 v132, v22
    v_mov_b32 v133, v22
    v_mov_b32 v134, v22
    v_mov_b32 v135, v22
    s_cmp_le_u32 s48, 3
    s_cbranch_scc1 K23_NEG1
    v_mov_b32 v72, v22
    v_mov_b32 v73, v22
    v_mov_b32 v74, v22
    v_mov_b32 v75, v22
    v_mov_b32 v136, v22
    v_mov_b32 v137, v22
    v_mov_b32 v138, v22
    v_mov_b32 v139, v22
    s_cmp_le_u32 s48, 4
    s_cbranch_scc1 K23_NEG1
    v_mov_b32 v76, v22
    v_mov_b32 v77, v22
    v_mov_b32 v78, v22
    v_mov_b32 v79, v22
    v_mov_b32 v140, v22
    v_mov_b32 v141, v22
    v_mov_b32 v142, v22
    v_mov_b32 v143, v22
    s_cmp_le_u32 s48, 5
    s_cbranch_scc1 K23_NEG1
    v_mov_b32 v80, v22
    v_mov_b32 v81, v22
    v_mov_b32 v82, v22
    v_mov_b32 v83, v22
    v_mov_b32 v144, v22
    v_mov_b32 v145, v22
    v_mov_b32 v146, v22
    v_mov_b32 v147, v22
    s_cmp_le_u32 s48, 6
    s_cbranch_scc1 K23_NEG1
    v_mov_b32 v84, v22
    v_mov_b32 v85, v22
    v_mov_b32 v86, v22
    v_mov_b32 v87, v22
    v_mov_b32 v148, v22
    v_mov_b32 v149, v22
    v_mov_b32 v150, v22
    v_mov_b32 v151, v22
    s_cmp_le_u32 s48, 7
    s_cbranch_scc1 K23_NEG1
    v_mov_b32 v88, v22
    v_mov_b32 v89, v22
    v_mov_b32 v90, v22
    v_mov_b32 v91, v22
    v_mov_b32 v152, v22
    v_mov_b32 v153, v22
    v_mov_b32 v154, v22
    v_mov_b32 v155, v22
    s_cmp_le_u32 s48, 8
    s_cbranch_scc1 K23_NEG1
    v_mov_b32 v92, v22
    v_mov_b32 v93, v22
    v_mov_b32 v94, v22
    v_mov_b32 v95, v22
    v_mov_b32 v156, v22
    v_mov_b32 v157, v22
    v_mov_b32 v158, v22
    v_mov_b32 v159, v22
    s_cmp_le_u32 s48, 9
    s_cbranch_scc1 K23_NEG1
    v_mov_b32 v96, v22
    v_mov_b32 v97, v22
    v_mov_b32 v98, v22
    v_mov_b32 v99, v22
    v_mov_b32 v160, v22
    v_mov_b32 v161, v22
    v_mov_b32 v162, v22
    v_mov_b32 v163, v22
    s_cmp_le_u32 s48, 10
    s_cbranch_scc1 K23_NEG1
    v_mov_b32 v100, v22
    v_mov_b32 v101, v22
    v_mov_b32 v102, v22
    v_mov_b32 v103, v22
    v_mov_b32 v164, v22
    v_mov_b32 v165, v22
    v_mov_b32 v166, v22
    v_mov_b32 v167, v22
    s_cmp_le_u32 s48, 11
    s_cbranch_scc1 K23_NEG1
    v_mov_b32 v104, v22
    v_mov_b32 v105, v22
    v_mov_b32 v106, v22
    v_mov_b32 v107, v22
    v_mov_b32 v168, v22
    v_mov_b32 v169, v22
    v_mov_b32 v170, v22
    v_mov_b32 v171, v22
    s_cmp_le_u32 s48, 12
    s_cbranch_scc1 K23_NEG1
    v_mov_b32 v108, v22
    v_mov_b32 v109, v22
    v_mov_b32 v110, v22
    v_mov_b32 v111, v22
    v_mov_b32 v172, v22
    v_mov_b32 v173, v22
    v_mov_b32 v174, v22
    v_mov_b32 v175, v22
    s_cmp_le_u32 s48, 13
    s_cbranch_scc1 K23_NEG1
    v_mov_b32 v112, v22
    v_mov_b32 v113, v22
    v_mov_b32 v114, v22
    v_mov_b32 v115, v22
    v_mov_b32 v176, v22
    v_mov_b32 v177, v22
    v_mov_b32 v178, v22
    v_mov_b32 v179, v22
    s_cmp_le_u32 s48, 14
    s_cbranch_scc1 K23_NEG1
    v_mov_b32 v116, v22
    v_mov_b32 v117, v22
    v_mov_b32 v118, v22
    v_mov_b32 v119, v22
    v_mov_b32 v180, v22
    v_mov_b32 v181, v22
    v_mov_b32 v182, v22
    v_mov_b32 v183, v22
    s_cmp_le_u32 s48, 15
    s_cbranch_scc1 K23_NEG1
    v_mov_b32 v120, v22
    v_mov_b32 v121, v22
    v_mov_b32 v122, v22
    v_mov_b32 v123, v22
    v_mov_b32 v184, v22
    v_mov_b32 v185, v22
    v_mov_b32 v186, v22
    v_mov_b32 v187, v22
K23_NEG1:
    s_waitcnt vmcnt(0)
    s_mov_b64 exec, 1
    global_store_dword v26, v25, s[4:5] offset:0 sc1
    s_mov_b64 exec, -1
    v_max3_f32 v244, v60, v61, v62
    v_max3_f32 v245, v63, v64, v65
    v_max3_f32 v244, v244, v66, v67
    v_max3_f32 v245, v245, v68, v69
    v_max3_f32 v244, v244, v70, v71
    v_max3_f32 v245, v245, v72, v73
    v_max3_f32 v244, v244, v74, v75
    v_max3_f32 v245, v245, v76, v77
    v_max3_f32 v244, v244, v78, v79
    v_max3_f32 v245, v245, v80, v81
    v_max3_f32 v244, v244, v82, v83
    v_max3_f32 v245, v245, v84, v85
    v_max3_f32 v244, v244, v86, v87
    v_max3_f32 v245, v245, v88, v89
    v_max3_f32 v244, v244, v90, v91
    v_max3_f32 v245, v245, v92, v93
    v_max3_f32 v244, v244, v94, v95
    v_max3_f32 v245, v245, v96, v97
    v_max3_f32 v244, v244, v98, v99
    v_max3_f32 v245, v245, v100, v101
    v_max3_f32 v244, v244, v102, v103
    v_max3_f32 v245, v245, v104, v105
    v_max3_f32 v244, v244, v106, v107
    v_max3_f32 v245, v245, v108, v109
    v_max3_f32 v244, v244, v110, v111
    v_max3_f32 v245, v245, v112, v113
    v_max3_f32 v244, v244, v114, v115
    v_max3_f32 v245, v245, v116, v117
    v_max3_f32 v244, v244, v118, v119
    v_max3_f32 v245, v245, v120, v121
    v_max3_f32 v244, v244, v122, v123
    v_max3_f32 v245, v245, v124, v125
    v_max3_f32 v244, v244, v126, v127
    v_max_f32 v244, v244, v245
    v_mov_b32 v245, v244
    s_nop 1
    v_permlane32_swap_b32 v244, v245
    v_max_f32 v244, v244, v245
    v_mov_b32 v245, v244
    s_nop 1
    v_permlane16_swap_b32 v244, v245
    v_max_f32 v244, v244, v245
    v_cvt_pk_bf16_f32 v244, 0, v244
    v_mul_f32 v244, s50, v244
    v_cvt_pk_bf16_f32 v244, 0, v244
    v_mul_f32 v244, s52, v244
    v_sub_f32 v244, 0, v244
    v_mov_b32 v245, v244
    v_cvt_pk_bf16_f32 v60, 0, v60
    v_cvt_pk_bf16_f32 v61, 0, v61
    v_mul_f32 v60, s50, v60
    v_mul_f32 v61, s50, v61
    v_cvt_pk_bf16_f32 v60, 0, v60
    v_cvt_pk_bf16_f32 v61, 0, v61
    v_fma_f32 v60, v60, s52, v244
    v_fma_f32 v61, v61, s52, v244
    v_exp_f32 v60, v60
    v_exp_f32 v61, v61
    v_cvt_pk_bf16_f32 v62, 0, v62
    v_cvt_pk_bf16_f32 v63, 0, v63
    v_mul_f32 v62, s50, v62
    v_mul_f32 v63, s50, v63
    v_cvt_pk_bf16_f32 v62, 0, v62
    v_cvt_pk_bf16_f32 v63, 0, v63
    v_fma_f32 v62, v62, s52, v244
    v_fma_f32 v63, v63, s52, v244
    v_exp_f32 v62, v62
    v_exp_f32 v63, v63
    v_mov_b32 v248, v60
    v_mov_b32 v249, v61
    v_cvt_pk_bf16_f32 v64, 0, v64
    v_cvt_pk_bf16_f32 v65, 0, v65
    v_mul_f32 v64, s50, v64
    v_mul_f32 v65, s50, v65
    v_cvt_pk_bf16_f32 v64, 0, v64
    v_cvt_pk_bf16_f32 v65, 0, v65
    v_fma_f32 v64, v64, s52, v244
    v_fma_f32 v65, v65, s52, v244
    v_exp_f32 v64, v64
    v_exp_f32 v65, v65
    v_mov_b32 v250, v62
    v_mov_b32 v251, v63
    v_cvt_pk_bf16_f32 v66, 0, v66
    v_cvt_pk_bf16_f32 v67, 0, v67
    v_mul_f32 v66, s50, v66
    v_mul_f32 v67, s50, v67
    v_cvt_pk_bf16_f32 v66, 0, v66
    v_cvt_pk_bf16_f32 v67, 0, v67
    v_fma_f32 v66, v66, s52, v244
    v_fma_f32 v67, v67, s52, v244
    v_exp_f32 v66, v66
    v_exp_f32 v67, v67
    v_add_f32 v248, v248, v64
    v_add_f32 v249, v249, v65
    v_cvt_pk_bf16_f32 v68, 0, v68
    v_cvt_pk_bf16_f32 v69, 0, v69
    v_mul_f32 v68, s50, v68
    v_mul_f32 v69, s50, v69
    v_cvt_pk_bf16_f32 v68, 0, v68
    v_cvt_pk_bf16_f32 v69, 0, v69
    v_fma_f32 v68, v68, s52, v244
    v_fma_f32 v69, v69, s52, v244
    v_exp_f32 v68, v68
    v_exp_f32 v69, v69
    v_add_f32 v250, v250, v66
    v_add_f32 v251, v251, v67
    v_cvt_pk_bf16_f32 v70, 0, v70
    v_cvt_pk_bf16_f32 v71, 0, v71
    v_mul_f32 v70, s50, v70
    v_mul_f32 v71, s50, v71
    v_cvt_pk_bf16_f32 v70, 0, v70
    v_cvt_pk_bf16_f32 v71, 0, v71
    v_fma_f32 v70, v70, s52, v244
    v_fma_f32 v71, v71, s52, v244
    v_exp_f32 v70, v70
    v_exp_f32 v71, v71
    v_add_f32 v248, v248, v68
    v_add_f32 v249, v249, v69
    v_cvt_pk_bf16_f32 v72, 0, v72
    v_cvt_pk_bf16_f32 v73, 0, v73
    v_mul_f32 v72, s50, v72
    v_mul_f32 v73, s50, v73
    v_cvt_pk_bf16_f32 v72, 0, v72
    v_cvt_pk_bf16_f32 v73, 0, v73
    v_fma_f32 v72, v72, s52, v244
    v_fma_f32 v73, v73, s52, v244
    v_exp_f32 v72, v72
    v_exp_f32 v73, v73
    v_add_f32 v250, v250, v70
    v_add_f32 v251, v251, v71
    v_cvt_pk_bf16_f32 v74, 0, v74
    v_cvt_pk_bf16_f32 v75, 0, v75
    v_mul_f32 v74, s50, v74
    v_mul_f32 v75, s50, v75
    v_cvt_pk_bf16_f32 v74, 0, v74
    v_cvt_pk_bf16_f32 v75, 0, v75
    v_fma_f32 v74, v74, s52, v244
    v_fma_f32 v75, v75, s52, v244
    v_exp_f32 v74, v74
    v_exp_f32 v75, v75
    v_add_f32 v248, v248, v72
    v_add_f32 v249, v249, v73
    v_cvt_pk_bf16_f32 v76, 0, v76
    v_cvt_pk_bf16_f32 v77, 0, v77
    v_mul_f32 v76, s50, v76
    v_mul_f32 v77, s50, v77
    v_cvt_pk_bf16_f32 v76, 0, v76
    v_cvt_pk_bf16_f32 v77, 0, v77
    v_fma_f32 v76, v76, s52, v244
    v_fma_f32 v77, v77, s52, v244
    v_exp_f32 v76, v76
    v_exp_f32 v77, v77
    v_add_f32 v250, v250, v74
    v_add_f32 v251, v251, v75
    v_cvt_pk_bf16_f32 v78, 0, v78
    v_cvt_pk_bf16_f32 v79, 0, v79
    v_mul_f32 v78, s50, v78
    v_mul_f32 v79, s50, v79
    v_cvt_pk_bf16_f32 v78, 0, v78
    v_cvt_pk_bf16_f32 v79, 0, v79
    v_fma_f32 v78, v78, s52, v244
    v_fma_f32 v79, v79, s52, v244
    v_exp_f32 v78, v78
    v_exp_f32 v79, v79
    v_add_f32 v248, v248, v76
    v_add_f32 v249, v249, v77
    v_cvt_pk_bf16_f32 v80, 0, v80
    v_cvt_pk_bf16_f32 v81, 0, v81
    v_mul_f32 v80, s50, v80
    v_mul_f32 v81, s50, v81
    v_cvt_pk_bf16_f32 v80, 0, v80
    v_cvt_pk_bf16_f32 v81, 0, v81
    v_fma_f32 v80, v80, s52, v244
    v_fma_f32 v81, v81, s52, v244
    v_exp_f32 v80, v80
    v_exp_f32 v81, v81
    v_add_f32 v250, v250, v78
    v_add_f32 v251, v251, v79
    v_cvt_pk_bf16_f32 v82, 0, v82
    v_cvt_pk_bf16_f32 v83, 0, v83
    v_mul_f32 v82, s50, v82
    v_mul_f32 v83, s50, v83
    v_cvt_pk_bf16_f32 v82, 0, v82
    v_cvt_pk_bf16_f32 v83, 0, v83
    v_fma_f32 v82, v82, s52, v244
    v_fma_f32 v83, v83, s52, v244
    v_exp_f32 v82, v82
    v_exp_f32 v83, v83
    v_add_f32 v248, v248, v80
    v_add_f32 v249, v249, v81
    v_cvt_pk_bf16_f32 v84, 0, v84
    v_cvt_pk_bf16_f32 v85, 0, v85
    v_mul_f32 v84, s50, v84
    v_mul_f32 v85, s50, v85
    v_cvt_pk_bf16_f32 v84, 0, v84
    v_cvt_pk_bf16_f32 v85, 0, v85
    v_fma_f32 v84, v84, s52, v244
    v_fma_f32 v85, v85, s52, v244
    v_exp_f32 v84, v84
    v_exp_f32 v85, v85
    v_add_f32 v250, v250, v82
    v_add_f32 v251, v251, v83
    v_cvt_pk_bf16_f32 v86, 0, v86
    v_cvt_pk_bf16_f32 v87, 0, v87
    v_mul_f32 v86, s50, v86
    v_mul_f32 v87, s50, v87
    v_cvt_pk_bf16_f32 v86, 0, v86
    v_cvt_pk_bf16_f32 v87, 0, v87
    v_fma_f32 v86, v86, s52, v244
    v_fma_f32 v87, v87, s52, v244
    v_exp_f32 v86, v86
    v_exp_f32 v87, v87
    v_add_f32 v248, v248, v84
    v_add_f32 v249, v249, v85
    v_cvt_pk_bf16_f32 v88, 0, v88
    v_cvt_pk_bf16_f32 v89, 0, v89
    v_mul_f32 v88, s50, v88
    v_mul_f32 v89, s50, v89
    v_cvt_pk_bf16_f32 v88, 0, v88
    v_cvt_pk_bf16_f32 v89, 0, v89
    v_fma_f32 v88, v88, s52, v244
    v_fma_f32 v89, v89, s52, v244
    v_exp_f32 v88, v88
    v_exp_f32 v89, v89
    v_add_f32 v250, v250, v86
    v_add_f32 v251, v251, v87
    v_cvt_pk_bf16_f32 v90, 0, v90
    v_cvt_pk_bf16_f32 v91, 0, v91
    v_mul_f32 v90, s50, v90
    v_mul_f32 v91, s50, v91
    v_cvt_pk_bf16_f32 v90, 0, v90
    v_cvt_pk_bf16_f32 v91, 0, v91
    v_fma_f32 v90, v90, s52, v244
    v_fma_f32 v91, v91, s52, v244
    v_exp_f32 v90, v90
    v_exp_f32 v91, v91
    v_add_f32 v248, v248, v88
    v_add_f32 v249, v249, v89
    v_cvt_pk_bf16_f32 v92, 0, v92
    v_cvt_pk_bf16_f32 v93, 0, v93
    v_mul_f32 v92, s50, v92
    v_mul_f32 v93, s50, v93
    v_cvt_pk_bf16_f32 v92, 0, v92
    v_cvt_pk_bf16_f32 v93, 0, v93
    v_fma_f32 v92, v92, s52, v244
    v_fma_f32 v93, v93, s52, v244
    v_exp_f32 v92, v92
    v_exp_f32 v93, v93
    v_add_f32 v250, v250, v90
    v_add_f32 v251, v251, v91
    v_cvt_pk_bf16_f32 v94, 0, v94
    v_cvt_pk_bf16_f32 v95, 0, v95
    v_mul_f32 v94, s50, v94
    v_mul_f32 v95, s50, v95
    v_cvt_pk_bf16_f32 v94, 0, v94
    v_cvt_pk_bf16_f32 v95, 0, v95
    v_fma_f32 v94, v94, s52, v244
    v_fma_f32 v95, v95, s52, v244
    v_exp_f32 v94, v94
    v_exp_f32 v95, v95
    v_add_f32 v248, v248, v92
    v_add_f32 v249, v249, v93
    v_cvt_pk_bf16_f32 v96, 0, v96
    v_cvt_pk_bf16_f32 v97, 0, v97
    v_mul_f32 v96, s50, v96
    v_mul_f32 v97, s50, v97
    v_cvt_pk_bf16_f32 v96, 0, v96
    v_cvt_pk_bf16_f32 v97, 0, v97
    v_fma_f32 v96, v96, s52, v244
    v_fma_f32 v97, v97, s52, v244
    v_exp_f32 v96, v96
    v_exp_f32 v97, v97
    v_add_f32 v250, v250, v94
    v_add_f32 v251, v251, v95
    v_cvt_pk_bf16_f32 v98, 0, v98
    v_cvt_pk_bf16_f32 v99, 0, v99
    v_mul_f32 v98, s50, v98
    v_mul_f32 v99, s50, v99
    v_cvt_pk_bf16_f32 v98, 0, v98
    v_cvt_pk_bf16_f32 v99, 0, v99
    v_fma_f32 v98, v98, s52, v244
    v_fma_f32 v99, v99, s52, v244
    v_exp_f32 v98, v98
    v_exp_f32 v99, v99
    v_add_f32 v248, v248, v96
    v_add_f32 v249, v249, v97
    v_cvt_pk_bf16_f32 v100, 0, v100
    v_cvt_pk_bf16_f32 v101, 0, v101
    v_mul_f32 v100, s50, v100
    v_mul_f32 v101, s50, v101
    v_cvt_pk_bf16_f32 v100, 0, v100
    v_cvt_pk_bf16_f32 v101, 0, v101
    v_fma_f32 v100, v100, s52, v244
    v_fma_f32 v101, v101, s52, v244
    v_exp_f32 v100, v100
    v_exp_f32 v101, v101
    v_add_f32 v250, v250, v98
    v_add_f32 v251, v251, v99
    v_cvt_pk_bf16_f32 v102, 0, v102
    v_cvt_pk_bf16_f32 v103, 0, v103
    v_mul_f32 v102, s50, v102
    v_mul_f32 v103, s50, v103
    v_cvt_pk_bf16_f32 v102, 0, v102
    v_cvt_pk_bf16_f32 v103, 0, v103
    v_fma_f32 v102, v102, s52, v244
    v_fma_f32 v103, v103, s52, v244
    v_exp_f32 v102, v102
    v_exp_f32 v103, v103
    v_add_f32 v248, v248, v100
    v_add_f32 v249, v249, v101
    v_cvt_pk_bf16_f32 v104, 0, v104
    v_cvt_pk_bf16_f32 v105, 0, v105
    v_mul_f32 v104, s50, v104
    v_mul_f32 v105, s50, v105
    v_cvt_pk_bf16_f32 v104, 0, v104
    v_cvt_pk_bf16_f32 v105, 0, v105
    v_fma_f32 v104, v104, s52, v244
    v_fma_f32 v105, v105, s52, v244
    v_exp_f32 v104, v104
    v_exp_f32 v105, v105
    v_add_f32 v250, v250, v102
    v_add_f32 v251, v251, v103
    v_cvt_pk_bf16_f32 v106, 0, v106
    v_cvt_pk_bf16_f32 v107, 0, v107
    v_mul_f32 v106, s50, v106
    v_mul_f32 v107, s50, v107
    v_cvt_pk_bf16_f32 v106, 0, v106
    v_cvt_pk_bf16_f32 v107, 0, v107
    v_fma_f32 v106, v106, s52, v244
    v_fma_f32 v107, v107, s52, v244
    v_exp_f32 v106, v106
    v_exp_f32 v107, v107
    v_add_f32 v248, v248, v104
    v_add_f32 v249, v249, v105
    v_cvt_pk_bf16_f32 v108, 0, v108
    v_cvt_pk_bf16_f32 v109, 0, v109
    v_mul_f32 v108, s50, v108
    v_mul_f32 v109, s50, v109
    v_cvt_pk_bf16_f32 v108, 0, v108
    v_cvt_pk_bf16_f32 v109, 0, v109
    v_fma_f32 v108, v108, s52, v244
    v_fma_f32 v109, v109, s52, v244
    v_exp_f32 v108, v108
    v_exp_f32 v109, v109
    v_add_f32 v250, v250, v106
    v_add_f32 v251, v251, v107
    v_cvt_pk_bf16_f32 v110, 0, v110
    v_cvt_pk_bf16_f32 v111, 0, v111
    v_mul_f32 v110, s50, v110
    v_mul_f32 v111, s50, v111
    v_cvt_pk_bf16_f32 v110, 0, v110
    v_cvt_pk_bf16_f32 v111, 0, v111
    v_fma_f32 v110, v110, s52, v244
    v_fma_f32 v111, v111, s52, v244
    v_exp_f32 v110, v110
    v_exp_f32 v111, v111
    v_add_f32 v248, v248, v108
    v_add_f32 v249, v249, v109
    v_cvt_pk_bf16_f32 v112, 0, v112
    v_cvt_pk_bf16_f32 v113, 0, v113
    v_mul_f32 v112, s50, v112
    v_mul_f32 v113, s50, v113
    v_cvt_pk_bf16_f32 v112, 0, v112
    v_cvt_pk_bf16_f32 v113, 0, v113
    v_fma_f32 v112, v112, s52, v244
    v_fma_f32 v113, v113, s52, v244
    v_exp_f32 v112, v112
    v_exp_f32 v113, v113
    v_add_f32 v250, v250, v110
    v_add_f32 v251, v251, v111
    v_cvt_pk_bf16_f32 v114, 0, v114
    v_cvt_pk_bf16_f32 v115, 0, v115
    v_mul_f32 v114, s50, v114
    v_mul_f32 v115, s50, v115
    v_cvt_pk_bf16_f32 v114, 0, v114
    v_cvt_pk_bf16_f32 v115, 0, v115
    v_fma_f32 v114, v114, s52, v244
    v_fma_f32 v115, v115, s52, v244
    v_exp_f32 v114, v114
    v_exp_f32 v115, v115
    v_add_f32 v248, v248, v112
    v_add_f32 v249, v249, v113
    v_cvt_pk_bf16_f32 v116, 0, v116
    v_cvt_pk_bf16_f32 v117, 0, v117
    v_mul_f32 v116, s50, v116
    v_mul_f32 v117, s50, v117
    v_cvt_pk_bf16_f32 v116, 0, v116
    v_cvt_pk_bf16_f32 v117, 0, v117
    v_fma_f32 v116, v116, s52, v244
    v_fma_f32 v117, v117, s52, v244
    v_exp_f32 v116, v116
    v_exp_f32 v117, v117
    v_add_f32 v250, v250, v114
    v_add_f32 v251, v251, v115
    v_cvt_pk_bf16_f32 v118, 0, v118
    v_cvt_pk_bf16_f32 v119, 0, v119
    v_mul_f32 v118, s50, v118
    v_mul_f32 v119, s50, v119
    v_cvt_pk_bf16_f32 v118, 0, v118
    v_cvt_pk_bf16_f32 v119, 0, v119
    v_fma_f32 v118, v118, s52, v244
    v_fma_f32 v119, v119, s52, v244
    v_exp_f32 v118, v118
    v_exp_f32 v119, v119
    v_add_f32 v248, v248, v116
    v_add_f32 v249, v249, v117
    v_cvt_pk_bf16_f32 v120, 0, v120
    v_cvt_pk_bf16_f32 v121, 0, v121
    v_mul_f32 v120, s50, v120
    v_mul_f32 v121, s50, v121
    v_cvt_pk_bf16_f32 v120, 0, v120
    v_cvt_pk_bf16_f32 v121, 0, v121
    v_fma_f32 v120, v120, s52, v244
    v_fma_f32 v121, v121, s52, v244
    v_exp_f32 v120, v120
    v_exp_f32 v121, v121
    v_add_f32 v250, v250, v118
    v_add_f32 v251, v251, v119
    v_cvt_pk_bf16_f32 v122, 0, v122
    v_cvt_pk_bf16_f32 v123, 0, v123
    v_mul_f32 v122, s50, v122
    v_mul_f32 v123, s50, v123
    v_cvt_pk_bf16_f32 v122, 0, v122
    v_cvt_pk_bf16_f32 v123, 0, v123
    v_fma_f32 v122, v122, s52, v244
    v_fma_f32 v123, v123, s52, v244
    v_exp_f32 v122, v122
    v_exp_f32 v123, v123
    v_add_f32 v248, v248, v120
    v_add_f32 v249, v249, v121
    v_cvt_pk_bf16_f32 v124, 0, v124
    v_cvt_pk_bf16_f32 v125, 0, v125
    v_mul_f32 v124, s50, v124
    v_mul_f32 v125, s50, v125
    v_cvt_pk_bf16_f32 v124, 0, v124
    v_cvt_pk_bf16_f32 v125, 0, v125
    v_fma_f32 v124, v124, s52, v244
    v_fma_f32 v125, v125, s52, v244
    v_exp_f32 v124, v124
    v_exp_f32 v125, v125
    v_add_f32 v250, v250, v122
    v_add_f32 v251, v251, v123
    v_cvt_pk_bf16_f32 v126, 0, v126
    v_cvt_pk_bf16_f32 v127, 0, v127
    v_mul_f32 v126, s50, v126
    v_mul_f32 v127, s50, v127
    v_cvt_pk_bf16_f32 v126, 0, v126
    v_cvt_pk_bf16_f32 v127, 0, v127
    v_fma_f32 v126, v126, s52, v244
    v_fma_f32 v127, v127, s52, v244
    v_exp_f32 v126, v126
    v_exp_f32 v127, v127
    v_add_f32 v248, v248, v124
    v_add_f32 v249, v249, v125
    s_nop 0
    v_add_f32 v250, v250, v126
    v_add_f32 v251, v251, v127
    v_add_f32 v248, v248, v250
    v_add_f32 v249, v249, v251
    v_add_f32 v248, v248, v249
    v_mov_b32 v249, v248
    s_nop 1
    v_permlane32_swap_b32 v248, v249
    v_add_f32 v248, v248, v249
    v_mov_b32 v249, v248
    s_nop 1
    v_permlane16_swap_b32 v248, v249
    v_add_f32 v248, v248, v249
    v_rcp_f32 v248, v248
    s_nop 0
    v_mov_b32 v249, v248
    v_mul_f32 v60, v60, v248
    v_mul_f32 v61, v61, v249
    v_mul_f32 v62, v62, v248
    v_mul_f32 v63, v63, v249
    v_cvt_pk_bf16_f32 v252, v60, v61
    v_cvt_pk_bf16_f32 v61, v62, v63
    v_mov_b32 v60, v252
    v_mul_f32 v64, v64, v248
    v_mul_f32 v65, v65, v249
    v_mul_f32 v66, v66, v248
    v_mul_f32 v67, v67, v249
    v_cvt_pk_bf16_f32 v252, v64, v65
    v_cvt_pk_bf16_f32 v63, v66, v67
    v_mov_b32 v62, v252
    v_mul_f32 v68, v68, v248
    v_mul_f32 v69, v69, v249
    v_mul_f32 v70, v70, v248
    v_mul_f32 v71, v71, v249
    v_cvt_pk_bf16_f32 v252, v68, v69
    v_cvt_pk_bf16_f32 v69, v70, v71
    v_mov_b32 v68, v252
    v_mul_f32 v72, v72, v248
    v_mul_f32 v73, v73, v249
    v_mul_f32 v74, v74, v248
    v_mul_f32 v75, v75, v249
    v_cvt_pk_bf16_f32 v252, v72, v73
    v_cvt_pk_bf16_f32 v71, v74, v75
    v_mov_b32 v70, v252
    v_mul_f32 v76, v76, v248
    v_mul_f32 v77, v77, v249
    v_mul_f32 v78, v78, v248
    v_mul_f32 v79, v79, v249
    v_cvt_pk_bf16_f32 v252, v76, v77
    v_cvt_pk_bf16_f32 v77, v78, v79
    v_mov_b32 v76, v252
    v_mul_f32 v80, v80, v248
    v_mul_f32 v81, v81, v249
    v_mul_f32 v82, v82, v248
    v_mul_f32 v83, v83, v249
    v_cvt_pk_bf16_f32 v252, v80, v81
    v_cvt_pk_bf16_f32 v79, v82, v83
    v_mov_b32 v78, v252
    v_mul_f32 v84, v84, v248
    v_mul_f32 v85, v85, v249
    v_mul_f32 v86, v86, v248
    v_mul_f32 v87, v87, v249
    v_cvt_pk_bf16_f32 v252, v84, v85
    v_cvt_pk_bf16_f32 v85, v86, v87
    v_mov_b32 v84, v252
    v_mul_f32 v88, v88, v248
    v_mul_f32 v89, v89, v249
    v_mul_f32 v90, v90, v248
    v_mul_f32 v91, v91, v249
    v_cvt_pk_bf16_f32 v252, v88, v89
    v_cvt_pk_bf16_f32 v87, v90, v91
    v_mov_b32 v86, v252
    v_mul_f32 v92, v92, v248
    v_mul_f32 v93, v93, v249
    v_mul_f32 v94, v94, v248
    v_mul_f32 v95, v95, v249
    v_cvt_pk_bf16_f32 v252, v92, v93
    v_cvt_pk_bf16_f32 v93, v94, v95
    v_mov_b32 v92, v252
    v_mul_f32 v96, v96, v248
    v_mul_f32 v97, v97, v249
    v_mul_f32 v98, v98, v248
    v_mul_f32 v99, v99, v249
    v_cvt_pk_bf16_f32 v252, v96, v97
    v_cvt_pk_bf16_f32 v95, v98, v99
    v_mov_b32 v94, v252
    v_mul_f32 v100, v100, v248
    v_mul_f32 v101, v101, v249
    v_mul_f32 v102, v102, v248
    v_mul_f32 v103, v103, v249
    v_cvt_pk_bf16_f32 v252, v100, v101
    v_cvt_pk_bf16_f32 v101, v102, v103
    v_mov_b32 v100, v252
    v_mul_f32 v104, v104, v248
    v_mul_f32 v105, v105, v249
    v_mul_f32 v106, v106, v248
    v_mul_f32 v107, v107, v249
    v_cvt_pk_bf16_f32 v252, v104, v105
    v_cvt_pk_bf16_f32 v103, v106, v107
    v_mov_b32 v102, v252
    v_mul_f32 v108, v108, v248
    v_mul_f32 v109, v109, v249
    v_mul_f32 v110, v110, v248
    v_mul_f32 v111, v111, v249
    v_cvt_pk_bf16_f32 v252, v108, v109
    v_cvt_pk_bf16_f32 v109, v110, v111
    v_mov_b32 v108, v252
    v_mul_f32 v112, v112, v248
    v_mul_f32 v113, v113, v249
    v_mul_f32 v114, v114, v248
    v_mul_f32 v115, v115, v249
    v_cvt_pk_bf16_f32 v252, v112, v113
    v_cvt_pk_bf16_f32 v111, v114, v115
    v_mov_b32 v110, v252
    v_mul_f32 v116, v116, v248
    v_mul_f32 v117, v117, v249
    v_mul_f32 v118, v118, v248
    v_mul_f32 v119, v119, v249
    v_cvt_pk_bf16_f32 v252, v116, v117
    v_cvt_pk_bf16_f32 v117, v118, v119
    v_mov_b32 v116, v252
    v_mul_f32 v120, v120, v248
    v_mul_f32 v121, v121, v249
    v_mul_f32 v122, v122, v248
    v_mul_f32 v123, v123, v249
    v_cvt_pk_bf16_f32 v252, v120, v121
    v_cvt_pk_bf16_f32 v119, v122, v123
    v_mov_b32 v118, v252
    v_mul_f32 v124, v124, v248
    v_mul_f32 v125, v125, v249
    v_mul_f32 v126, v126, v248
    v_mul_f32 v127, v127, v249
    v_cvt_pk_bf16_f32 v252, v124, v125
    v_cvt_pk_bf16_f32 v125, v126, v127
    v_mov_b32 v124, v252
    v_mov_b32 v126, 0
    v_mov_b32 v127, 0
    v_max3_f32 v244, v128, v129, v130
    v_max3_f32 v245, v131, v132, v133
    v_max3_f32 v244, v244, v134, v135
    v_max3_f32 v245, v245, v136, v137
    v_max3_f32 v244, v244, v138, v139
    v_max3_f32 v245, v245, v140, v141
    v_max3_f32 v244, v244, v142, v143
    v_max3_f32 v245, v245, v144, v145
    v_max3_f32 v244, v244, v146, v147
    v_max3_f32 v245, v245, v148, v149
    v_max3_f32 v244, v244, v150, v151
    v_max3_f32 v245, v245, v152, v153
    v_max3_f32 v244, v244, v154, v155
    v_max3_f32 v245, v245, v156, v157
    v_max3_f32 v244, v244, v158, v159
    v_max3_f32 v245, v245, v160, v161
    v_max3_f32 v244, v244, v162, v163
    v_max3_f32 v245, v245, v164, v165
    v_max3_f32 v244, v244, v166, v167
    v_max3_f32 v245, v245, v168, v169
    v_max3_f32 v244, v244, v170, v171
    v_max3_f32 v245, v245, v172, v173
    v_max3_f32 v244, v244, v174, v175
    v_max3_f32 v245, v245, v176, v177
    v_max3_f32 v244, v244, v178, v179
    v_max3_f32 v245, v245, v180, v181
    v_max3_f32 v244, v244, v182, v183
    v_max3_f32 v245, v245, v184, v185
    v_max3_f32 v244, v244, v186, v187
    v_max3_f32 v245, v245, v188, v189
    v_max3_f32 v244, v244, v190, v191
    v_max3_f32 v245, v245, v192, v193
    v_max3_f32 v244, v244, v194, v195
    v_max_f32 v244, v244, v245
    v_mov_b32 v245, v244
    s_nop 1
    v_permlane32_swap_b32 v244, v245
    v_max_f32 v244, v244, v245
    v_mov_b32 v245, v244
    s_nop 1
    v_permlane16_swap_b32 v244, v245
    v_max_f32 v244, v244, v245
    v_cvt_pk_bf16_f32 v244, 0, v244
    v_mul_f32 v244, s50, v244
    v_cvt_pk_bf16_f32 v244, 0, v244
    v_mul_f32 v244, s52, v244
    v_sub_f32 v244, 0, v244
    v_mov_b32 v245, v244
    v_cvt_pk_bf16_f32 v128, 0, v128
    v_cvt_pk_bf16_f32 v129, 0, v129
    v_mul_f32 v128, s50, v128
    v_mul_f32 v129, s50, v129
    v_cvt_pk_bf16_f32 v128, 0, v128
    v_cvt_pk_bf16_f32 v129, 0, v129
    v_fma_f32 v128, v128, s52, v244
    v_fma_f32 v129, v129, s52, v244
    v_exp_f32 v128, v128
    v_exp_f32 v129, v129
    v_cvt_pk_bf16_f32 v130, 0, v130
    v_cvt_pk_bf16_f32 v131, 0, v131
    v_mul_f32 v130, s50, v130
    v_mul_f32 v131, s50, v131
    v_cvt_pk_bf16_f32 v130, 0, v130
    v_cvt_pk_bf16_f32 v131, 0, v131
    v_fma_f32 v130, v130, s52, v244
    v_fma_f32 v131, v131, s52, v244
    v_exp_f32 v130, v130
    v_exp_f32 v131, v131
    v_mov_b32 v248, v128
    v_mov_b32 v249, v129
    v_cvt_pk_bf16_f32 v132, 0, v132
    v_cvt_pk_bf16_f32 v133, 0, v133
    v_mul_f32 v132, s50, v132
    v_mul_f32 v133, s50, v133
    v_cvt_pk_bf16_f32 v132, 0, v132
    v_cvt_pk_bf16_f32 v133, 0, v133
    v_fma_f32 v132, v132, s52, v244
    v_fma_f32 v133, v133, s52, v244
    v_exp_f32 v132, v132
    v_exp_f32 v133, v133
    v_mov_b32 v250, v130
    v_mov_b32 v251, v131
    v_cvt_pk_bf16_f32 v134, 0, v134
    v_cvt_pk_bf16_f32 v135, 0, v135
    v_mul_f32 v134, s50, v134
    v_mul_f32 v135, s50, v135
    v_cvt_pk_bf16_f32 v134, 0, v134
    v_cvt_pk_bf16_f32 v135, 0, v135
    v_fma_f32 v134, v134, s52, v244
    v_fma_f32 v135, v135, s52, v244
    v_exp_f32 v134, v134
    v_exp_f32 v135, v135
    v_add_f32 v248, v248, v132
    v_add_f32 v249, v249, v133
    v_cvt_pk_bf16_f32 v136, 0, v136
    v_cvt_pk_bf16_f32 v137, 0, v137
    v_mul_f32 v136, s50, v136
    v_mul_f32 v137, s50, v137
    v_cvt_pk_bf16_f32 v136, 0, v136
    v_cvt_pk_bf16_f32 v137, 0, v137
    v_fma_f32 v136, v136, s52, v244
    v_fma_f32 v137, v137, s52, v244
    v_exp_f32 v136, v136
    v_exp_f32 v137, v137
    v_add_f32 v250, v250, v134
    v_add_f32 v251, v251, v135
    v_cvt_pk_bf16_f32 v138, 0, v138
    v_cvt_pk_bf16_f32 v139, 0, v139
    v_mul_f32 v138, s50, v138
    v_mul_f32 v139, s50, v139
    v_cvt_pk_bf16_f32 v138, 0, v138
    v_cvt_pk_bf16_f32 v139, 0, v139
    v_fma_f32 v138, v138, s52, v244
    v_fma_f32 v139, v139, s52, v244
    v_exp_f32 v138, v138
    v_exp_f32 v139, v139
    v_add_f32 v248, v248, v136
    v_add_f32 v249, v249, v137
    v_cvt_pk_bf16_f32 v140, 0, v140
    v_cvt_pk_bf16_f32 v141, 0, v141
    v_mul_f32 v140, s50, v140
    v_mul_f32 v141, s50, v141
    v_cvt_pk_bf16_f32 v140, 0, v140
    v_cvt_pk_bf16_f32 v141, 0, v141
    v_fma_f32 v140, v140, s52, v244
    v_fma_f32 v141, v141, s52, v244
    v_exp_f32 v140, v140
    v_exp_f32 v141, v141
    v_add_f32 v250, v250, v138
    v_add_f32 v251, v251, v139
    v_cvt_pk_bf16_f32 v142, 0, v142
    v_cvt_pk_bf16_f32 v143, 0, v143
    v_mul_f32 v142, s50, v142
    v_mul_f32 v143, s50, v143
    v_cvt_pk_bf16_f32 v142, 0, v142
    v_cvt_pk_bf16_f32 v143, 0, v143
    v_fma_f32 v142, v142, s52, v244
    v_fma_f32 v143, v143, s52, v244
    v_exp_f32 v142, v142
    v_exp_f32 v143, v143
    v_add_f32 v248, v248, v140
    v_add_f32 v249, v249, v141
    v_cvt_pk_bf16_f32 v144, 0, v144
    v_cvt_pk_bf16_f32 v145, 0, v145
    v_mul_f32 v144, s50, v144
    v_mul_f32 v145, s50, v145
    v_cvt_pk_bf16_f32 v144, 0, v144
    v_cvt_pk_bf16_f32 v145, 0, v145
    v_fma_f32 v144, v144, s52, v244
    v_fma_f32 v145, v145, s52, v244
    v_exp_f32 v144, v144
    v_exp_f32 v145, v145
    v_add_f32 v250, v250, v142
    v_add_f32 v251, v251, v143
    v_cvt_pk_bf16_f32 v146, 0, v146
    v_cvt_pk_bf16_f32 v147, 0, v147
    v_mul_f32 v146, s50, v146
    v_mul_f32 v147, s50, v147
    v_cvt_pk_bf16_f32 v146, 0, v146
    v_cvt_pk_bf16_f32 v147, 0, v147
    v_fma_f32 v146, v146, s52, v244
    v_fma_f32 v147, v147, s52, v244
    v_exp_f32 v146, v146
    v_exp_f32 v147, v147
    v_add_f32 v248, v248, v144
    v_add_f32 v249, v249, v145
    v_cvt_pk_bf16_f32 v148, 0, v148
    v_cvt_pk_bf16_f32 v149, 0, v149
    v_mul_f32 v148, s50, v148
    v_mul_f32 v149, s50, v149
    v_cvt_pk_bf16_f32 v148, 0, v148
    v_cvt_pk_bf16_f32 v149, 0, v149
    v_fma_f32 v148, v148, s52, v244
    v_fma_f32 v149, v149, s52, v244
    v_exp_f32 v148, v148
    v_exp_f32 v149, v149
    v_add_f32 v250, v250, v146
    v_add_f32 v251, v251, v147
    v_cvt_pk_bf16_f32 v150, 0, v150
    v_cvt_pk_bf16_f32 v151, 0, v151
    v_mul_f32 v150, s50, v150
    v_mul_f32 v151, s50, v151
    v_cvt_pk_bf16_f32 v150, 0, v150
    v_cvt_pk_bf16_f32 v151, 0, v151
    v_fma_f32 v150, v150, s52, v244
    v_fma_f32 v151, v151, s52, v244
    v_exp_f32 v150, v150
    v_exp_f32 v151, v151
    v_add_f32 v248, v248, v148
    v_add_f32 v249, v249, v149
    v_cvt_pk_bf16_f32 v152, 0, v152
    v_cvt_pk_bf16_f32 v153, 0, v153
    v_mul_f32 v152, s50, v152
    v_mul_f32 v153, s50, v153
    v_cvt_pk_bf16_f32 v152, 0, v152
    v_cvt_pk_bf16_f32 v153, 0, v153
    v_fma_f32 v152, v152, s52, v244
    v_fma_f32 v153, v153, s52, v244
    v_exp_f32 v152, v152
    v_exp_f32 v153, v153
    v_add_f32 v250, v250, v150
    v_add_f32 v251, v251, v151
    v_cvt_pk_bf16_f32 v154, 0, v154
    v_cvt_pk_bf16_f32 v155, 0, v155
    v_mul_f32 v154, s50, v154
    v_mul_f32 v155, s50, v155
    v_cvt_pk_bf16_f32 v154, 0, v154
    v_cvt_pk_bf16_f32 v155, 0, v155
    v_fma_f32 v154, v154, s52, v244
    v_fma_f32 v155, v155, s52, v244
    v_exp_f32 v154, v154
    v_exp_f32 v155, v155
    v_add_f32 v248, v248, v152
    v_add_f32 v249, v249, v153
    v_cvt_pk_bf16_f32 v156, 0, v156
    v_cvt_pk_bf16_f32 v157, 0, v157
    v_mul_f32 v156, s50, v156
    v_mul_f32 v157, s50, v157
    v_cvt_pk_bf16_f32 v156, 0, v156
    v_cvt_pk_bf16_f32 v157, 0, v157
    v_fma_f32 v156, v156, s52, v244
    v_fma_f32 v157, v157, s52, v244
    v_exp_f32 v156, v156
    v_exp_f32 v157, v157
    v_add_f32 v250, v250, v154
    v_add_f32 v251, v251, v155
    v_cvt_pk_bf16_f32 v158, 0, v158
    v_cvt_pk_bf16_f32 v159, 0, v159
    v_mul_f32 v158, s50, v158
    v_mul_f32 v159, s50, v159
    v_cvt_pk_bf16_f32 v158, 0, v158
    v_cvt_pk_bf16_f32 v159, 0, v159
    v_fma_f32 v158, v158, s52, v244
    v_fma_f32 v159, v159, s52, v244
    v_exp_f32 v158, v158
    v_exp_f32 v159, v159
    v_add_f32 v248, v248, v156
    v_add_f32 v249, v249, v157
    v_cvt_pk_bf16_f32 v160, 0, v160
    v_cvt_pk_bf16_f32 v161, 0, v161
    v_mul_f32 v160, s50, v160
    v_mul_f32 v161, s50, v161
    v_cvt_pk_bf16_f32 v160, 0, v160
    v_cvt_pk_bf16_f32 v161, 0, v161
    v_fma_f32 v160, v160, s52, v244
    v_fma_f32 v161, v161, s52, v244
    v_exp_f32 v160, v160
    v_exp_f32 v161, v161
    v_add_f32 v250, v250, v158
    v_add_f32 v251, v251, v159
    v_cvt_pk_bf16_f32 v162, 0, v162
    v_cvt_pk_bf16_f32 v163, 0, v163
    v_mul_f32 v162, s50, v162
    v_mul_f32 v163, s50, v163
    v_cvt_pk_bf16_f32 v162, 0, v162
    v_cvt_pk_bf16_f32 v163, 0, v163
    v_fma_f32 v162, v162, s52, v244
    v_fma_f32 v163, v163, s52, v244
    v_exp_f32 v162, v162
    v_exp_f32 v163, v163
    v_add_f32 v248, v248, v160
    v_add_f32 v249, v249, v161
    v_cvt_pk_bf16_f32 v164, 0, v164
    v_cvt_pk_bf16_f32 v165, 0, v165
    v_mul_f32 v164, s50, v164
    v_mul_f32 v165, s50, v165
    v_cvt_pk_bf16_f32 v164, 0, v164
    v_cvt_pk_bf16_f32 v165, 0, v165
    v_fma_f32 v164, v164, s52, v244
    v_fma_f32 v165, v165, s52, v244
    v_exp_f32 v164, v164
    v_exp_f32 v165, v165
    v_add_f32 v250, v250, v162
    v_add_f32 v251, v251, v163
    v_cvt_pk_bf16_f32 v166, 0, v166
    v_cvt_pk_bf16_f32 v167, 0, v167
    v_mul_f32 v166, s50, v166
    v_mul_f32 v167, s50, v167
    v_cvt_pk_bf16_f32 v166, 0, v166
    v_cvt_pk_bf16_f32 v167, 0, v167
    v_fma_f32 v166, v166, s52, v244
    v_fma_f32 v167, v167, s52, v244
    v_exp_f32 v166, v166
    v_exp_f32 v167, v167
    v_add_f32 v248, v248, v164
    v_add_f32 v249, v249, v165
    v_cvt_pk_bf16_f32 v168, 0, v168
    v_cvt_pk_bf16_f32 v169, 0, v169
    v_mul_f32 v168, s50, v168
    v_mul_f32 v169, s50, v169
    v_cvt_pk_bf16_f32 v168, 0, v168
    v_cvt_pk_bf16_f32 v169, 0, v169
    v_fma_f32 v168, v168, s52, v244
    v_fma_f32 v169, v169, s52, v244
    v_exp_f32 v168, v168
    v_exp_f32 v169, v169
    v_add_f32 v250, v250, v166
    v_add_f32 v251, v251, v167
    v_cvt_pk_bf16_f32 v170, 0, v170
    v_cvt_pk_bf16_f32 v171, 0, v171
    v_mul_f32 v170, s50, v170
    v_mul_f32 v171, s50, v171
    v_cvt_pk_bf16_f32 v170, 0, v170
    v_cvt_pk_bf16_f32 v171, 0, v171
    v_fma_f32 v170, v170, s52, v244
    v_fma_f32 v171, v171, s52, v244
    v_exp_f32 v170, v170
    v_exp_f32 v171, v171
    v_add_f32 v248, v248, v168
    v_add_f32 v249, v249, v169
    v_cvt_pk_bf16_f32 v172, 0, v172
    v_cvt_pk_bf16_f32 v173, 0, v173
    v_mul_f32 v172, s50, v172
    v_mul_f32 v173, s50, v173
    v_cvt_pk_bf16_f32 v172, 0, v172
    v_cvt_pk_bf16_f32 v173, 0, v173
    v_fma_f32 v172, v172, s52, v244
    v_fma_f32 v173, v173, s52, v244
    v_exp_f32 v172, v172
    v_exp_f32 v173, v173
    v_add_f32 v250, v250, v170
    v_add_f32 v251, v251, v171
    v_cvt_pk_bf16_f32 v174, 0, v174
    v_cvt_pk_bf16_f32 v175, 0, v175
    v_mul_f32 v174, s50, v174
    v_mul_f32 v175, s50, v175
    v_cvt_pk_bf16_f32 v174, 0, v174
    v_cvt_pk_bf16_f32 v175, 0, v175
    v_fma_f32 v174, v174, s52, v244
    v_fma_f32 v175, v175, s52, v244
    v_exp_f32 v174, v174
    v_exp_f32 v175, v175
    v_add_f32 v248, v248, v172
    v_add_f32 v249, v249, v173
    v_cvt_pk_bf16_f32 v176, 0, v176
    v_cvt_pk_bf16_f32 v177, 0, v177
    v_mul_f32 v176, s50, v176
    v_mul_f32 v177, s50, v177
    v_cvt_pk_bf16_f32 v176, 0, v176
    v_cvt_pk_bf16_f32 v177, 0, v177
    v_fma_f32 v176, v176, s52, v244
    v_fma_f32 v177, v177, s52, v244
    v_exp_f32 v176, v176
    v_exp_f32 v177, v177
    v_add_f32 v250, v250, v174
    v_add_f32 v251, v251, v175
    v_cvt_pk_bf16_f32 v178, 0, v178
    v_cvt_pk_bf16_f32 v179, 0, v179
    v_mul_f32 v178, s50, v178
    v_mul_f32 v179, s50, v179
    v_cvt_pk_bf16_f32 v178, 0, v178
    v_cvt_pk_bf16_f32 v179, 0, v179
    v_fma_f32 v178, v178, s52, v244
    v_fma_f32 v179, v179, s52, v244
    v_exp_f32 v178, v178
    v_exp_f32 v179, v179
    v_add_f32 v248, v248, v176
    v_add_f32 v249, v249, v177
    v_cvt_pk_bf16_f32 v180, 0, v180
    v_cvt_pk_bf16_f32 v181, 0, v181
    v_mul_f32 v180, s50, v180
    v_mul_f32 v181, s50, v181
    v_cvt_pk_bf16_f32 v180, 0, v180
    v_cvt_pk_bf16_f32 v181, 0, v181
    v_fma_f32 v180, v180, s52, v244
    v_fma_f32 v181, v181, s52, v244
    v_exp_f32 v180, v180
    v_exp_f32 v181, v181
    v_add_f32 v250, v250, v178
    v_add_f32 v251, v251, v179
    v_cvt_pk_bf16_f32 v182, 0, v182
    v_cvt_pk_bf16_f32 v183, 0, v183
    v_mul_f32 v182, s50, v182
    v_mul_f32 v183, s50, v183
    v_cvt_pk_bf16_f32 v182, 0, v182
    v_cvt_pk_bf16_f32 v183, 0, v183
    v_fma_f32 v182, v182, s52, v244
    v_fma_f32 v183, v183, s52, v244
    v_exp_f32 v182, v182
    v_exp_f32 v183, v183
    v_add_f32 v248, v248, v180
    v_add_f32 v249, v249, v181
    v_cvt_pk_bf16_f32 v184, 0, v184
    v_cvt_pk_bf16_f32 v185, 0, v185
    v_mul_f32 v184, s50, v184
    v_mul_f32 v185, s50, v185
    v_cvt_pk_bf16_f32 v184, 0, v184
    v_cvt_pk_bf16_f32 v185, 0, v185
    v_fma_f32 v184, v184, s52, v244
    v_fma_f32 v185, v185, s52, v244
    v_exp_f32 v184, v184
    v_exp_f32 v185, v185
    v_add_f32 v250, v250, v182
    v_add_f32 v251, v251, v183
    v_cvt_pk_bf16_f32 v186, 0, v186
    v_cvt_pk_bf16_f32 v187, 0, v187
    v_mul_f32 v186, s50, v186
    v_mul_f32 v187, s50, v187
    v_cvt_pk_bf16_f32 v186, 0, v186
    v_cvt_pk_bf16_f32 v187, 0, v187
    v_fma_f32 v186, v186, s52, v244
    v_fma_f32 v187, v187, s52, v244
    v_exp_f32 v186, v186
    v_exp_f32 v187, v187
    v_add_f32 v248, v248, v184
    v_add_f32 v249, v249, v185
    v_cvt_pk_bf16_f32 v188, 0, v188
    v_cvt_pk_bf16_f32 v189, 0, v189
    v_mul_f32 v188, s50, v188
    v_mul_f32 v189, s50, v189
    v_cvt_pk_bf16_f32 v188, 0, v188
    v_cvt_pk_bf16_f32 v189, 0, v189
    v_fma_f32 v188, v188, s52, v244
    v_fma_f32 v189, v189, s52, v244
    v_exp_f32 v188, v188
    v_exp_f32 v189, v189
    v_add_f32 v250, v250, v186
    v_add_f32 v251, v251, v187
    v_cvt_pk_bf16_f32 v190, 0, v190
    v_cvt_pk_bf16_f32 v191, 0, v191
    v_mul_f32 v190, s50, v190
    v_mul_f32 v191, s50, v191
    v_cvt_pk_bf16_f32 v190, 0, v190
    v_cvt_pk_bf16_f32 v191, 0, v191
    v_fma_f32 v190, v190, s52, v244
    v_fma_f32 v191, v191, s52, v244
    v_exp_f32 v190, v190
    v_exp_f32 v191, v191
    v_add_f32 v248, v248, v188
    v_add_f32 v249, v249, v189
    v_cvt_pk_bf16_f32 v192, 0, v192
    v_cvt_pk_bf16_f32 v193, 0, v193
    v_mul_f32 v192, s50, v192
    v_mul_f32 v193, s50, v193
    v_cvt_pk_bf16_f32 v192, 0, v192
    v_cvt_pk_bf16_f32 v193, 0, v193
    v_fma_f32 v192, v192, s52, v244
    v_fma_f32 v193, v193, s52, v244
    v_exp_f32 v192, v192
    v_exp_f32 v193, v193
    v_add_f32 v250, v250, v190
    v_add_f32 v251, v251, v191
    v_cvt_pk_bf16_f32 v194, 0, v194
    v_cvt_pk_bf16_f32 v195, 0, v195
    v_mul_f32 v194, s50, v194
    v_mul_f32 v195, s50, v195
    v_cvt_pk_bf16_f32 v194, 0, v194
    v_cvt_pk_bf16_f32 v195, 0, v195
    v_fma_f32 v194, v194, s52, v244
    v_fma_f32 v195, v195, s52, v244
    v_exp_f32 v194, v194
    v_exp_f32 v195, v195
    v_add_f32 v248, v248, v192
    v_add_f32 v249, v249, v193
    s_nop 0
    v_add_f32 v250, v250, v194
    v_add_f32 v251, v251, v195
    v_add_f32 v248, v248, v250
    v_add_f32 v249, v249, v251
    v_add_f32 v248, v248, v249
    v_mov_b32 v249, v248
    s_nop 1
    v_permlane32_swap_b32 v248, v249
    v_add_f32 v248, v248, v249
    v_mov_b32 v249, v248
    s_nop 1
    v_permlane16_swap_b32 v248, v249
    v_add_f32 v248, v248, v249
    v_rcp_f32 v248, v248
    s_nop 0
    v_mov_b32 v249, v248
    v_mul_f32 v192, v192, v248
    v_mul_f32 v193, v193, v249
    v_mul_f32 v194, v194, v248
    v_mul_f32 v195, v195, v249
    v_cvt_pk_bf16_f32 v252, v192, v193
    v_cvt_pk_bf16_f32 v195, v194, v195
    v_mov_b32 v194, v252
    v_mul_f32 v188, v188, v248
    v_mul_f32 v189, v189, v249
    v_mul_f32 v190, v190, v248
    v_mul_f32 v191, v191, v249
    v_cvt_pk_bf16_f32 v252, v188, v189
    v_cvt_pk_bf16_f32 v193, v190, v191
    v_mov_b32 v192, v252
    v_mul_f32 v184, v184, v248
    v_mul_f32 v185, v185, v249
    v_mul_f32 v186, v186, v248
    v_mul_f32 v187, v187, v249
    v_cvt_pk_bf16_f32 v252, v184, v185
    v_cvt_pk_bf16_f32 v187, v186, v187
    v_mov_b32 v186, v252
    v_mul_f32 v180, v180, v248
    v_mul_f32 v181, v181, v249
    v_mul_f32 v182, v182, v248
    v_mul_f32 v183, v183, v249
    v_cvt_pk_bf16_f32 v252, v180, v181
    v_cvt_pk_bf16_f32 v185, v182, v183
    v_mov_b32 v184, v252
    v_mul_f32 v176, v176, v248
    v_mul_f32 v177, v177, v249
    v_mul_f32 v178, v178, v248
    v_mul_f32 v179, v179, v249
    v_cvt_pk_bf16_f32 v252, v176, v177
    v_cvt_pk_bf16_f32 v179, v178, v179
    v_mov_b32 v178, v252
    v_mul_f32 v172, v172, v248
    v_mul_f32 v173, v173, v249
    v_mul_f32 v174, v174, v248
    v_mul_f32 v175, v175, v249
    v_cvt_pk_bf16_f32 v252, v172, v173
    v_cvt_pk_bf16_f32 v177, v174, v175
    v_mov_b32 v176, v252
    v_mul_f32 v168, v168, v248
    v_mul_f32 v169, v169, v249
    v_mul_f32 v170, v170, v248
    v_mul_f32 v171, v171, v249
    v_cvt_pk_bf16_f32 v252, v168, v169
    v_cvt_pk_bf16_f32 v171, v170, v171
    v_mov_b32 v170, v252
    v_mul_f32 v164, v164, v248
    v_mul_f32 v165, v165, v249
    v_mul_f32 v166, v166, v248
    v_mul_f32 v167, v167, v249
    v_cvt_pk_bf16_f32 v252, v164, v165
    v_cvt_pk_bf16_f32 v169, v166, v167
    v_mov_b32 v168, v252
    v_mul_f32 v160, v160, v248
    v_mul_f32 v161, v161, v249
    v_mul_f32 v162, v162, v248
    v_mul_f32 v163, v163, v249
    v_cvt_pk_bf16_f32 v252, v160, v161
    v_cvt_pk_bf16_f32 v163, v162, v163
    v_mov_b32 v162, v252
    v_mul_f32 v156, v156, v248
    v_mul_f32 v157, v157, v249
    v_mul_f32 v158, v158, v248
    v_mul_f32 v159, v159, v249
    v_cvt_pk_bf16_f32 v252, v156, v157
    v_cvt_pk_bf16_f32 v161, v158, v159
    v_mov_b32 v160, v252
    v_mul_f32 v152, v152, v248
    v_mul_f32 v153, v153, v249
    v_mul_f32 v154, v154, v248
    v_mul_f32 v155, v155, v249
    v_cvt_pk_bf16_f32 v252, v152, v153
    v_cvt_pk_bf16_f32 v155, v154, v155
    v_mov_b32 v154, v252
    v_mul_f32 v148, v148, v248
    v_mul_f32 v149, v149, v249
    v_mul_f32 v150, v150, v248
    v_mul_f32 v151, v151, v249
    v_cvt_pk_bf16_f32 v252, v148, v149
    v_cvt_pk_bf16_f32 v153, v150, v151
    v_mov_b32 v152, v252
    v_mul_f32 v144, v144, v248
    v_mul_f32 v145, v145, v249
    v_mul_f32 v146, v146, v248
    v_mul_f32 v147, v147, v249
    v_cvt_pk_bf16_f32 v252, v144, v145
    v_cvt_pk_bf16_f32 v147, v146, v147
    v_mov_b32 v146, v252
    v_mul_f32 v140, v140, v248
    v_mul_f32 v141, v141, v249
    v_mul_f32 v142, v142, v248
    v_mul_f32 v143, v143, v249
    v_cvt_pk_bf16_f32 v252, v140, v141
    v_cvt_pk_bf16_f32 v145, v142, v143
    v_mov_b32 v144, v252
    v_mul_f32 v136, v136, v248
    v_mul_f32 v137, v137, v249
    v_mul_f32 v138, v138, v248
    v_mul_f32 v139, v139, v249
    v_cvt_pk_bf16_f32 v252, v136, v137
    v_cvt_pk_bf16_f32 v139, v138, v139
    v_mov_b32 v138, v252
    v_mul_f32 v132, v132, v248
    v_mul_f32 v133, v133, v249
    v_mul_f32 v134, v134, v248
    v_mul_f32 v135, v135, v249
    v_cvt_pk_bf16_f32 v252, v132, v133
    v_cvt_pk_bf16_f32 v137, v134, v135
    v_mov_b32 v136, v252
    v_mul_f32 v128, v128, v248
    v_mul_f32 v129, v129, v249
    v_mul_f32 v130, v130, v248
    v_mul_f32 v131, v131, v249
    v_cvt_pk_bf16_f32 v252, v128, v129
    v_cvt_pk_bf16_f32 v131, v130, v131
    v_mov_b32 v130, v252
    v_mov_b32 v128, 0
    v_mov_b32 v129, 0
    s_nop 1
    ds_read_b64_tr_b16 v[220:221], v24 offset:14336
    ds_read_b64_tr_b16 v[222:223], v24 offset:15360
    s_waitcnt lgkmcnt(12)
    v_mfma_f32_16x16x32_bf16 v[228:231], v[196:199], v[60:63], 0
    v_mfma_f32_16x16x32_bf16 v[236:239], v[196:199], v[128:131], 0
    ds_read_b64_tr_b16 v[224:225], v24 offset:14344
    ds_read_b64_tr_b16 v[226:227], v24 offset:15368
    s_waitcnt lgkmcnt(12)
    v_mfma_f32_16x16x32_bf16 v[232:235], v[200:203], v[60:63], 0
    v_mfma_f32_16x16x32_bf16 v[240:243], v[200:203], v[128:131], 0
    ds_read_b64_tr_b16 v[196:197], v24 offset:16384
    ds_read_b64_tr_b16 v[198:199], v24 offset:17408
    s_waitcnt lgkmcnt(12)
    v_mfma_f32_16x16x32_bf16 v[228:231], v[204:207], v[68:71], v[228:231]
    v_mfma_f32_16x16x32_bf16 v[236:239], v[204:207], v[136:139], v[236:239]
    ds_read_b64_tr_b16 v[200:201], v24 offset:16392
    ds_read_b64_tr_b16 v[202:203], v24 offset:17416
    s_waitcnt lgkmcnt(12)
    v_mfma_f32_16x16x32_bf16 v[232:235], v[208:211], v[68:71], v[232:235]
    v_mfma_f32_16x16x32_bf16 v[240:243], v[208:211], v[136:139], v[240:243]
    ds_read_b64_tr_b16 v[204:205], v24 offset:18432
    ds_read_b64_tr_b16 v[206:207], v24 offset:19456
    s_waitcnt lgkmcnt(12)
    v_mfma_f32_16x16x32_bf16 v[228:231], v[212:215], v[76:79], v[228:231]
    v_mfma_f32_16x16x32_bf16 v[236:239], v[212:215], v[144:147], v[236:239]
    ds_read_b64_tr_b16 v[208:209], v24 offset:18440
    ds_read_b64_tr_b16 v[210:211], v24 offset:19464
    s_waitcnt lgkmcnt(12)
    v_mfma_f32_16x16x32_bf16 v[232:235], v[216:219], v[76:79], v[232:235]
    v_mfma_f32_16x16x32_bf16 v[240:243], v[216:219], v[144:147], v[240:243]
    ds_read_b64_tr_b16 v[212:213], v24 offset:20480
    ds_read_b64_tr_b16 v[214:215], v24 offset:21504
    s_waitcnt lgkmcnt(12)
    v_mfma_f32_16x16x32_bf16 v[228:231], v[220:223], v[84:87], v[228:231]
    v_mfma_f32_16x16x32_bf16 v[236:239], v[220:223], v[152:155], v[236:239]
    ds_read_b64_tr_b16 v[216:217], v24 offset:20488
    ds_read_b64_tr_b16 v[218:219], v24 offset:21512
    s_waitcnt lgkmcnt(12)
    v_mfma_f32_16x16x32_bf16 v[232:235], v[224:227], v[84:87], v[232:235]
    v_mfma_f32_16x16x32_bf16 v[240:243], v[224:227], v[152:155], v[240:243]
    ds_read_b64_tr_b16 v[220:221], v24 offset:22528
    ds_read_b64_tr_b16 v[222:223], v24 offset:23552
    s_waitcnt lgkmcnt(12)
    v_mfma_f32_16x16x32_bf16 v[228:231], v[196:199], v[92:95], v[228:231]
    v_mfma_f32_16x16x32_bf16 v[236:239], v[196:199], v[160:163], v[236:239]
    ds_read_b64_tr_b16 v[224:225], v24 offset:22536
    ds_read_b64_tr_b16 v[226:227], v24 offset:23560
    s_waitcnt lgkmcnt(12)
    v_mfma_f32_16x16x32_bf16 v[232:235], v[200:203], v[92:95], v[232:235]
    v_mfma_f32_16x16x32_bf16 v[240:243], v[200:203], v[160:163], v[240:243]
    ds_read_b64_tr_b16 v[196:197], v24 offset:24576
    ds_read_b64_tr_b16 v[198:199], v24 offset:25600
    s_waitcnt lgkmcnt(12)
    v_mfma_f32_16x16x32_bf16 v[228:231], v[204:207], v[100:103], v[228:231]
    v_mfma_f32_16x16x32_bf16 v[236:239], v[204:207], v[168:171], v[236:239]
    ds_read_b64_tr_b16 v[200:201], v24 offset:24584
    ds_read_b64_tr_b16 v[202:203], v24 offset:25608
    s_waitcnt lgkmcnt(12)
    v_mfma_f32_16x16x32_bf16 v[232:235], v[208:211], v[100:103], v[232:235]
    v_mfma_f32_16x16x32_bf16 v[240:243], v[208:211], v[168:171], v[240:243]
    s_waitcnt lgkmcnt(10)
    v_mfma_f32_16x16x32_bf16 v[228:231], v[212:215], v[108:111], v[228:231]
    v_mfma_f32_16x16x32_bf16 v[236:239], v[212:215], v[176:179], v[236:239]
    s_waitcnt lgkmcnt(8)
    v_mfma_f32_16x16x32_bf16 v[232:235], v[216:219], v[108:111], v[232:235]
    v_mfma_f32_16x16x32_bf16 v[240:243], v[216:219], v[176:179], v[240:243]
    s_waitcnt lgkmcnt(6)
    v_mfma_f32_16x16x32_bf16 v[228:231], v[220:223], v[116:119], v[228:231]
    v_mfma_f32_16x16x32_bf16 v[236:239], v[220:223], v[184:187], v[236:239]
    s_waitcnt lgkmcnt(4)
    v_mfma_f32_16x16x32_bf16 v[232:235], v[224:227], v[116:119], v[232:235]
    v_mfma_f32_16x16x32_bf16 v[240:243], v[224:227], v[184:187], v[240:243]
    s_waitcnt lgkmcnt(2)
    v_mfma_f32_16x16x32_bf16 v[228:231], v[196:199], v[124:127], v[228:231]
    v_mfma_f32_16x16x32_bf16 v[236:239], v[196:199], v[192:195], v[236:239]
    s_waitcnt lgkmcnt(0)
    v_mfma_f32_16x16x32_bf16 v[232:235], v[200:203], v[124:127], v[232:235]
    v_mfma_f32_16x16x32_bf16 v[240:243], v[200:203], v[192:195], v[240:243]
    s_mul_i32 s19, s54, 144
    s_add_u32 s19, s19, s36
    s_lshl_b32 s19, s19, 10
    s_add_u32 s20, s19, 147456
    s_nop 7
    v_cvt_pk_bf16_f32 v244, v228, v229
    v_cvt_pk_bf16_f32 v245, v230, v231
    v_cvt_pk_bf16_f32 v246, v232, v233
    v_cvt_pk_bf16_f32 v247, v234, v235
    buffer_store_dwordx4 v[244:247], v2, s[28:31], s19 offen sc1
    v_cvt_pk_bf16_f32 v248, v236, v237
    v_cvt_pk_bf16_f32 v249, v238, v239
    v_cvt_pk_bf16_f32 v250, v240, v241
    v_cvt_pk_bf16_f32 v251, v242, v243
    buffer_store_dwordx4 v[248:251], v2, s[28:31], s20 offen sc1
    s_add_u32 s54, s54, 8
    s_waitcnt vmcnt(0)
    s_mov_b64 exec, 1
    global_store_dword v26, v25, s[4:5] offset:512 sc1
    s_mov_b64 exec, -1
K23_END:
    s_endpgm
.section .rodata,"a"
.p2align 6
.amdhsa_kernel k1_gemm1_kernel
  .amdhsa_next_free_vgpr 256
  .amdhsa_next_free_sgpr 80
  .amdhsa_accum_offset 256
  .amdhsa_group_segment_fixed_size 0
  .amdhsa_kernarg_size 88
  .amdhsa_user_sgpr_count 2
  .amdhsa_user_sgpr_kernarg_segment_ptr 1
  .amdhsa_system_sgpr_workgroup_id_x 1
.end_amdhsa_kernel
.text
.section .rodata,"a"
.p2align 6
.amdhsa_kernel k23_kernel
  .amdhsa_next_free_vgpr 256
  .amdhsa_next_free_sgpr 72
  .amdhsa_accum_offset 256
  .amdhsa_group_segment_fixed_size 0
  .amdhsa_kernarg_size 88
  .amdhsa_user_sgpr_count 2
  .amdhsa_user_sgpr_kernarg_segment_ptr 1
  .amdhsa_system_sgpr_workgroup_id_x 1
.end_amdhsa_kernel
.text
```
